```python
import torch

def _softmax(x, axis=-1):
    return torch.softmax(x, dim=axis)
def _gelu(x):
    return torch.nn.functional.gelu(x, approximate="tanh")
def _silu(x):
    return torch.nn.functional.silu(x)
def _sigmoid(x):
    return torch.sigmoid(x)
def _layernorm(x, axis=-1, eps=1e-5):
    m = x.mean(dim=axis, keepdim=True)
    v = x.var(dim=axis, keepdim=True, unbiased=False)
    return (x - m) / torch.sqrt(v + eps)
def _scatter_add(tgt, idx, src, axis=0):
    return tgt.clone().index_add_(axis, idx, src)
def _segment_sum(src, seg, n):
    out = torch.zeros((n,) + src.shape[1:], dtype=src.dtype)
    return out.index_add_(0, seg, src)
def _pad(x, pw):
    flat = tuple(v for pair in reversed(pw) for v in pair)
    return torch.nn.functional.pad(x, flat)

kernel_name = 'concat_heads__gqa_block_cached__mha_block_cached__near_ridge'

def setup_inputs():

    _w = (lambda a: (lambda t: t.to(torch.bfloat16) if t.is_floating_point() else t)(torch.as_tensor(a)))
    def _A_setup():
        B, Sq, D = 8, 112, 640
        Hq, Hkv, Sk, Dh = 32, 32, 512, 192
        assert Hq % Hkv == 0, (Hq, Hkv)
        return {
            "x": _w((lambda *s: torch.randn(*s, dtype=torch.bfloat16) * 0.8)(B, Sq, D)),
            "k_cache": _w((lambda *s: torch.randn(*s, dtype=torch.bfloat16) * 0.8)(B, Hkv, Sk, Dh)),
            "v_cache": _w((lambda *s: torch.randn(*s, dtype=torch.bfloat16) * 0.05)(B, Hkv, Sk, Dh)),
            "wq": _w((lambda *s: torch.randn(*s, dtype=torch.bfloat16) * 0.8)(D, Hq * Dh) * (D ** -0.5)),
            "wo": _w((lambda *s: torch.randn(*s, dtype=torch.bfloat16) * 0.05)(Hq * Dh, D) * ((Hq * Dh) ** -0.5)),
        }
    _A_in = _A_setup()

    def _B_setup():
        B, Sq, D = 8, 112, 640
        H, Sk, Dh = 32, 512, 192
        return {
            "x": _w((lambda *s: torch.randn(*s, dtype=torch.bfloat16) * 0.8)(B, Sq, D)),
            "k_cache": _w((lambda *s: torch.randn(*s, dtype=torch.bfloat16) * 0.8)(B, H, Sk, Dh)),
            "v_cache": _w((lambda *s: torch.randn(*s, dtype=torch.bfloat16) * 0.05)(B, H, Sk, Dh)),
            "wq": _w((lambda *s: torch.randn(*s, dtype=torch.bfloat16) * 0.8)(D, H * Dh) * (D ** -0.5)),
            "wo": _w((lambda *s: torch.randn(*s, dtype=torch.bfloat16) * 0.05)(H * Dh, D) * ((H * Dh) ** -0.5)),
        }
    _B_in = _B_setup()

    return {
        "A_x": _A_in["x"],
        "A_k_cache": _A_in["k_cache"],
        "A_v_cache": _A_in["v_cache"],
        "A_wq": _A_in["wq"],
        "A_wo": _A_in["wo"],
        "B_x": _B_in["x"],
        "B_k_cache": _B_in["k_cache"],
        "B_v_cache": _B_in["v_cache"],
        "B_wq": _B_in["wq"],
        "B_wo": _B_in["wo"],
    }

def reference(A_x, A_k_cache, A_v_cache, A_wq, A_wo, B_x, B_k_cache, B_v_cache, B_wq, B_wo):
    def _A_ref(x, k_cache, v_cache, wq, wo):
        B, Sq, D = x.shape
        Hq, Dh = 32, 192
        Hkv = k_cache.shape[1]
        rep = Hq // Hkv
        q = (lambda x, *d: x.permute(*d))((x @ wq).reshape(B, Sq, Hq, Dh), 0, 2, 1, 3)
        k = (lambda x, n, axis: torch.repeat_interleave(x, n, dim=axis))(k_cache, rep, axis=1)
        v = (lambda x, n, axis: torch.repeat_interleave(x, n, dim=axis))(v_cache, rep, axis=1)
        scores = torch.einsum("bhqd,bhkd->bhqk", q, k) * (Dh ** -0.5)
        p = _softmax(scores, axis=-1)
        o = torch.einsum("bhqk,bhkd->bhqd", p, v)
        return (lambda x, *d: x.permute(*d))(o, 0, 2, 1, 3).reshape(B, Sq, Hq * Dh) @ wo

    def _B_ref(x, k_cache, v_cache, wq, wo):
        B, Sq, D = x.shape
        H, Dh = 32, 192
        q = (lambda x, *d: x.permute(*d))((x @ wq).reshape(B, Sq, H, Dh), 0, 2, 1, 3)
        scores = torch.einsum("bhqd,bhkd->bhqk", q, k_cache) * (Dh ** -0.5)
        p = _softmax(scores, axis=-1)
        o = torch.einsum("bhqk,bhkd->bhqd", p, v_cache)
        return (lambda x, *d: x.permute(*d))(o, 0, 2, 1, 3).reshape(B, Sq, H * Dh) @ wo

    a = _A_ref(A_x, A_k_cache, A_v_cache, A_wq, A_wo)
    b = _B_ref(B_x, B_k_cache, B_v_cache, B_wq, B_wo)
    return torch.concatenate([a, b], axis=-1)
```

```asm
; @launch kernel=concat_heads__gqa_block_cached__mha_block_cached__near_ridge_kernel grid=(256,1,1) block=(256,1,1) lds=163840
; @launch kernel=reduce_kernel grid=(640,1,1) block=(256,1,1) lds=0
.amdgcn_target "amdgcn-amd-amdhsa--gfx950"
.text
.globl concat_heads__gqa_block_cached__mha_block_cached__near_ridge_kernel
.p2align 8
.type concat_heads__gqa_block_cached__mha_block_cached__near_ridge_kernel,@function
concat_heads__gqa_block_cached__mha_block_cached__near_ridge_kernel:
  s_cmp_ge_u32 s2, 256
  s_cbranch_scc1 L_end
  s_load_dwordx16 s[64:79], s[0:1], 0
  s_load_dwordx4 s[80:83], s[0:1], 64
  s_load_dwordx2 s[84:85], s[0:1], 96
  s_and_b32 s34, s2, 7
  s_lshr_b32 s35, s2, 3
  s_lshr_b32 s36, s34, 2
  s_and_b32 s37, s34, 3
  s_lshl_b32 s37, s37, 2
  s_and_b32 s38, s35, 3
  s_add_u32 s37, s37, s38
  s_lshr_b32 s38, s35, 2
  v_lshrrev_b32 v29, 6, v0
  v_and_b32 v28, 63, v0
  v_readfirstlane_b32 s28, v29
  s_nop 1
  s_mul_i32 s32, s28, 3072
  s_lshl_b32 s33, s28, 11
  s_mov_b32 s31, 0x3dd53b95
  s_mov_b32 s43, 0x41000000
  s_mov_b32 s42, 0
  s_mul_i32 s39, s28, 98304
  s_lshr_b32 s40, s28, 1
  s_lshl_b32 s40, s40, 2
  v_add_u32 v34, 0, v28
  v_mul_u32_u24 v35, 2731, v34
  v_lshrrev_b32 v35, 16, v35
  v_mul_u32_u24 v29, 24, v35
  v_sub_u32 v36, v34, v29
  v_bfe_u32 v30, v35, 1, 1
  v_lshlrev_b32 v30, 2, v30
  v_xor_b32 v30, v30, v36
  v_lshlrev_b32 v30, 4, v30
  v_mul_u32_u24 v29, 12288, v35
  v_add3_u32 v17, v29, v30, s39
  v_mul_u32_u24 v32, 384, v35
  v_add3_u32 v14, v32, v30, s32
  v_bfe_u32 v30, v35, 1, 2
  v_or_b32 v30, s40, v30
  v_xor_b32 v30, v30, v36
  v_lshlrev_b32 v30, 4, v30
  v_add3_u32 v11, v32, v30, s32
  v_add_u32 v34, 64, v28
  v_mul_u32_u24 v35, 2731, v34
  v_lshrrev_b32 v35, 16, v35
  v_mul_u32_u24 v29, 24, v35
  v_sub_u32 v36, v34, v29
  v_bfe_u32 v30, v35, 1, 1
  v_lshlrev_b32 v30, 2, v30
  v_xor_b32 v30, v30, v36
  v_lshlrev_b32 v30, 4, v30
  v_subrev_u32 v30, 1024, v30
  v_mul_u32_u24 v29, 12288, v35
  v_add3_u32 v18, v29, v30, s39
  v_mul_u32_u24 v32, 384, v35
  v_add3_u32 v15, v32, v30, s32
  v_bfe_u32 v30, v35, 1, 2
  v_or_b32 v30, s40, v30
  v_xor_b32 v30, v30, v36
  v_lshlrev_b32 v30, 4, v30
  v_subrev_u32 v30, 1024, v30
  v_add3_u32 v12, v32, v30, s32
  v_add_u32 v34, 128, v28
  v_mul_u32_u24 v35, 2731, v34
  v_lshrrev_b32 v35, 16, v35
  v_mul_u32_u24 v29, 24, v35
  v_sub_u32 v36, v34, v29
  v_bfe_u32 v30, v35, 1, 1
  v_lshlrev_b32 v30, 2, v30
  v_xor_b32 v30, v30, v36
  v_lshlrev_b32 v30, 4, v30
  v_subrev_u32 v30, 2048, v30
  v_mul_u32_u24 v29, 12288, v35
  v_add3_u32 v19, v29, v30, s39
  v_mul_u32_u24 v32, 384, v35
  v_add3_u32 v16, v32, v30, s32
  v_bfe_u32 v30, v35, 1, 2
  v_or_b32 v30, s40, v30
  v_xor_b32 v30, v30, v36
  v_lshlrev_b32 v30, 4, v30
  v_subrev_u32 v30, 2048, v30
  v_add3_u32 v13, v32, v30, s32
  v_lshrrev_b32 v29, 2, v28
  v_mul_u32_u24 v29, 1280, v29
  v_bfe_u32 v30, v28, 4, 2
  v_and_b32 v31, 3, v28
  v_xor_b32 v30, v30, v31
  v_lshlrev_b32 v30, 4, v30
  s_mul_i32 s39, s28, 40960
  v_add3_u32 v20, v29, v30, s39
  v_add_u32 v21, 19456, v20
  s_waitcnt lgkmcnt(0)
  s_cmp_eq_u32 s36, 0
  s_cselect_b32 s16, s64, s74
  s_cselect_b32 s17, s65, s75
  s_cselect_b32 s4, s66, s76
  s_cselect_b32 s5, s67, s77
  s_cselect_b32 s8, s68, s78
  s_cselect_b32 s9, s69, s79
  s_cselect_b32 s12, s70, s80
  s_cselect_b32 s13, s71, s81
  s_cselect_b32 s20, s72, s82
  s_cselect_b32 s21, s73, s83
  s_mul_i32 s40, s37, 768
  s_add_u32 s12, s12, s40
  s_addc_u32 s13, s13, 0
  s_sub_u32 s14, 7864320, s40
  s_mov_b32 s15, 0x20000
  s_mul_i32 s40, s38, 143360
  s_add_u32 s16, s16, s40
  s_addc_u32 s17, s17, 0
  s_mov_b32 s18, 143360
  s_mov_b32 s19, 0x20000
  s_lshl_b32 s39, s38, 4
  s_add_u32 s39, s39, s37
  s_mul_i32 s40, s39, 393216
  s_add_u32 s4, s4, s40
  s_addc_u32 s5, s5, 0
  s_mov_b32 s6, 393216
  s_mov_b32 s7, 0x20000
  s_add_u32 s8, s8, s40
  s_addc_u32 s9, s9, 0
  s_mov_b32 s10, 393216
  s_mov_b32 s11, 0x20000
  s_mov_b32 s44, 0
  s_add_u32 m0, s32, 0
  s_nop 0
  buffer_load_dwordx4 v17, s[12:15], s44 offen offset:0 nt lds
  buffer_load_dwordx4 v18, s[12:15], s44 offen offset:1024 nt lds
  buffer_load_dwordx4 v19, s[12:15], s44 offen offset:2048 nt lds
  s_mov_b32 s45, 0
  s_add_u32 m0, s33, 12288
  s_nop 0
  buffer_load_dwordx4 v20, s[16:19], s45 offen offset:0 lds
  buffer_load_dwordx4 v21, s[16:19], s45 offen offset:1024 lds
  s_mov_b32 s44, 393216
  s_add_u32 m0, s32, 20480
  s_nop 0
  buffer_load_dwordx4 v17, s[12:15], s44 offen offset:0 nt lds
  buffer_load_dwordx4 v18, s[12:15], s44 offen offset:1024 nt lds
  buffer_load_dwordx4 v19, s[12:15], s44 offen offset:2048 nt lds
  s_mov_b32 s45, 64
  s_add_u32 m0, s33, 32768
  s_nop 0
  buffer_load_dwordx4 v20, s[16:19], s45 offen offset:0 lds
  buffer_load_dwordx4 v21, s[16:19], s45 offen offset:1024 lds
  s_mov_b32 s44, 786432
  s_add_u32 m0, s32, 40960
  s_nop 0
  buffer_load_dwordx4 v17, s[12:15], s44 offen offset:0 nt lds
  buffer_load_dwordx4 v18, s[12:15], s44 offen offset:1024 nt lds
  buffer_load_dwordx4 v19, s[12:15], s44 offen offset:2048 nt lds
  s_mov_b32 s45, 128
  s_add_u32 m0, s33, 53248
  s_nop 0
  buffer_load_dwordx4 v20, s[16:19], s45 offen offset:0 lds
  buffer_load_dwordx4 v21, s[16:19], s45 offen offset:1024 lds
  s_mov_b32 s44, 1179648
  s_add_u32 m0, s32, 61440
  s_nop 0
  buffer_load_dwordx4 v17, s[12:15], s44 offen offset:0 nt lds
  buffer_load_dwordx4 v18, s[12:15], s44 offen offset:1024 nt lds
  buffer_load_dwordx4 v19, s[12:15], s44 offen offset:2048 nt lds
  s_mov_b32 s45, 192
  s_add_u32 m0, s33, 73728
  s_nop 0
  buffer_load_dwordx4 v20, s[16:19], s45 offen offset:0 lds
  buffer_load_dwordx4 v21, s[16:19], s45 offen offset:1024 lds
  s_mov_b32 s44, 1572864
  s_add_u32 m0, s32, 81920
  s_nop 0
  buffer_load_dwordx4 v17, s[12:15], s44 offen offset:0 nt lds
  buffer_load_dwordx4 v18, s[12:15], s44 offen offset:1024 nt lds
  buffer_load_dwordx4 v19, s[12:15], s44 offen offset:2048 nt lds
  s_mov_b32 s45, 256
  s_add_u32 m0, s33, 94208
  s_nop 0
  buffer_load_dwordx4 v20, s[16:19], s45 offen offset:0 lds
  buffer_load_dwordx4 v21, s[16:19], s45 offen offset:1024 lds
  s_mul_i32 s40, s37, 491520
  s_add_u32 s20, s20, s40
  s_addc_u32 s21, s21, 0
  s_mov_b32 s22, 491520
  s_mov_b32 s23, 0x20000
  s_mov_b32 s24, s84
  s_mov_b32 s25, s85
  s_lshl_b32 s40, s36, 7
  s_add_u32 s40, s40, s39
  s_mul_i32 s40, s40, 163840
  s_add_u32 s24, s24, s40
  s_addc_u32 s25, s25, 0
  s_mov_b32 s26, 163840
  s_mov_b32 s27, 0x20000
  v_and_b32 v28, 63, v0
  v_lshrrev_b32 v34, 5, v28
  v_bfe_u32 v35, v28, 2, 2
  v_bfe_u32 v29, v28, 4, 1
  v_lshlrev_b32 v29, 5, v29
  v_and_b32 v30, 1, v28
  v_lshl_or_b32 v29, v30, 4, v29
  v_bfe_u32 v30, v28, 1, 1
  v_lshl_or_b32 v29, v30, 3, v29
  v_bfe_u32 v30, v28, 3, 1
  v_lshl_or_b32 v31, v30, 6, v29
  v_lshl_add_u32 v32, v34, 3, v35
  v_mul_u32_u24 v33, 384, v32
  v_add_u32 v7, v33, v31
  v_xor_b32 v8, 64, v7
  v_and_b32 v29, 31, v28
  v_xor_b32 v30, v35, v34
  v_lshlrev_b32 v33, 6, v29
  v_lshl_or_b32 v33, v30, 4, v33
  s_add_u32 s41, s33, 0
  v_add_u32 v9, s41, v33
  v_xor_b32 v10, 32, v9
  v_add_u32 v128, 49152, v7
  v_add_u32 v129, 49152, v8
  v_add_u32 v130, 49152, v9
  v_add_u32 v131, 49152, v10
  v_add_u32 v132, 98304, v7
  v_add_u32 v133, 98304, v8
  v_add_u32 v134, 98304, v9
  v_add_u32 v135, 98304, v10
  v_lshl_add_u32 v32, v34, 2, v35
  v_mul_u32_u24 v32, 384, v32
  v_add3_u32 v5, v32, v31, 0
  v_add_u32 v5, 102400, v5
  v_xor_b32 v6, 64, v5
  v_bfe_u32 v30, v28, 1, 2
  v_bfe_u32 v31, v28, 4, 1
  v_lshl_or_b32 v30, v31, 2, v30
  v_xor_b32 v30, v30, v34
  v_mul_u32_u24 v31, 384, v29
  v_lshl_or_b32 v1, v30, 4, v31
  v_add_u32 v1, 65536, v1
  v_xor_b32 v2, 32, v1
  v_xor_b32 v3, 64, v1
  v_xor_b32 v4, 96, v1
  v_mov_b32 v24, 1.0
  v_lshlrev_b32 v30, 4, v28
  s_mul_i32 s41, s28, 40960
  v_add_u32 v25, s41, v30
  s_lshl_b32 s41, s28, 5
  v_add_u32 v29, s41, v29
  v_cmp_le_u32 vcc, 112, v29
  v_mov_b32 v30, 2146435072
  s_nop 0
  v_cndmask_b32 v25, v25, v30, vcc
  v_mov_b32 v30, 4286578688
  v_mov_b32 v31, 1900671690
  v_cndmask_b32 v127, v30, v31, vcc
  s_waitcnt vmcnt(20)
  s_barrier
  ds_read_b128 v[112:115], v9 offset:12288
  ds_read_b64_tr_b16 v[40:41], v7 offset:0
  ds_read_b64_tr_b16 v[42:43], v7 offset:1536
  ds_read_b64_tr_b16 v[44:45], v8 offset:0
  ds_read_b64_tr_b16 v[46:47], v8 offset:1536
  ds_read_b64_tr_b16 v[48:49], v7 offset:128
  ds_read_b64_tr_b16 v[50:51], v7 offset:1664
  ds_read_b64_tr_b16 v[52:53], v8 offset:128
  ds_read_b64_tr_b16 v[54:55], v8 offset:1664
  ds_read_b64_tr_b16 v[56:57], v7 offset:256
  ds_read_b64_tr_b16 v[58:59], v7 offset:1792
  ds_read_b64_tr_b16 v[60:61], v8 offset:256
  ds_read_b64_tr_b16 v[62:63], v8 offset:1792
  s_waitcnt lgkmcnt(6)
  v_mfma_f32_32x32x16_bf16 v[160:175], v[40:43], v[112:115], 0
  ds_read_b128 v[116:119], v10 offset:12288
  ds_read_b64_tr_b16 v[40:41], v7 offset:6144
  ds_read_b64_tr_b16 v[42:43], v7 offset:7680
  s_mov_b32 s44, 0
  s_add_u32 m0, s32, 102400
  s_nop 0
  buffer_load_dwordx4 v11, s[4:7], s44 offen offset:0 nt lds
  v_mfma_f32_32x32x16_bf16 v[176:191], v[44:47], v[112:115], 0
  ds_read_b64_tr_b16 v[44:45], v8 offset:6144
  ds_read_b64_tr_b16 v[46:47], v8 offset:7680
  buffer_load_dwordx4 v12, s[4:7], s44 offen offset:1024 nt lds
  buffer_load_dwordx4 v13, s[4:7], s44 offen offset:2048 nt lds
  s_mov_b32 s45, 12288
  s_add_u32 m0, s32, 114688
  v_mfma_f32_32x32x16_bf16 v[192:207], v[48:51], v[112:115], 0
  ds_read_b64_tr_b16 v[48:49], v7 offset:6272
  ds_read_b64_tr_b16 v[50:51], v7 offset:7808
  buffer_load_dwordx4 v11, s[4:7], s45 offen offset:0 nt lds
  buffer_load_dwordx4 v12, s[4:7], s45 offen offset:1024 nt lds
  buffer_load_dwordx4 v13, s[4:7], s45 offen offset:2048 nt lds
  s_waitcnt lgkmcnt(7)
  v_mfma_f32_32x32x16_bf16 v[208:223], v[52:55], v[112:115], 0
  ds_read_b64_tr_b16 v[52:53], v8 offset:6272
  ds_read_b64_tr_b16 v[54:55], v8 offset:7808
  s_mov_b32 s44, 0
  s_add_u32 m0, s32, 151552
  s_nop 0
  buffer_load_dwordx4 v14, s[8:11], s44 offen offset:0 nt lds
  buffer_load_dwordx4 v15, s[8:11], s44 offen offset:1024 nt lds
  v_mfma_f32_32x32x16_bf16 v[224:239], v[56:59], v[112:115], 0
  ds_read_b64_tr_b16 v[56:57], v7 offset:6400
  ds_read_b64_tr_b16 v[58:59], v7 offset:7936
  buffer_load_dwordx4 v16, s[8:11], s44 offen offset:2048 nt lds
  v_mfma_f32_32x32x16_bf16 v[240:255], v[60:63], v[112:115], 0
  ds_read_b64_tr_b16 v[60:61], v8 offset:6400
  ds_read_b64_tr_b16 v[62:63], v8 offset:7936
  s_waitcnt vmcnt(24)
  s_barrier
  s_waitcnt lgkmcnt(6)
  v_mfma_f32_32x32x16_bf16 v[160:175], v[40:43], v[116:119], v[160:175]
  ds_read_b128 v[112:115], v9 offset:32768
  ds_read_b64_tr_b16 v[40:41], v7 offset:20480
  ds_read_b64_tr_b16 v[42:43], v7 offset:22016
  v_mfma_f32_32x32x16_bf16 v[176:191], v[44:47], v[116:119], v[176:191]
  ds_read_b64_tr_b16 v[44:45], v8 offset:20480
  ds_read_b64_tr_b16 v[46:47], v8 offset:22016
  v_mfma_f32_32x32x16_bf16 v[192:207], v[48:51], v[116:119], v[192:207]
  ds_read_b64_tr_b16 v[48:49], v7 offset:20608
  ds_read_b64_tr_b16 v[50:51], v7 offset:22144
  s_waitcnt lgkmcnt(7)
  v_mfma_f32_32x32x16_bf16 v[208:223], v[52:55], v[116:119], v[208:223]
  ds_read_b64_tr_b16 v[52:53], v8 offset:20608
  ds_read_b64_tr_b16 v[54:55], v8 offset:22144
  v_mfma_f32_32x32x16_bf16 v[224:239], v[56:59], v[116:119], v[224:239]
  ds_read_b64_tr_b16 v[56:57], v7 offset:20736
  ds_read_b64_tr_b16 v[58:59], v7 offset:22272
  v_mfma_f32_32x32x16_bf16 v[240:255], v[60:63], v[116:119], v[240:255]
  ds_read_b64_tr_b16 v[60:61], v8 offset:20736
  ds_read_b64_tr_b16 v[62:63], v8 offset:22272
  s_waitcnt lgkmcnt(6)
  v_mfma_f32_32x32x16_bf16 v[160:175], v[40:43], v[112:115], v[160:175]
  ds_read_b128 v[116:119], v10 offset:32768
  ds_read_b64_tr_b16 v[40:41], v7 offset:26624
  ds_read_b64_tr_b16 v[42:43], v7 offset:28160
  v_mfma_f32_32x32x16_bf16 v[176:191], v[44:47], v[112:115], v[176:191]
  ds_read_b64_tr_b16 v[44:45], v8 offset:26624
  ds_read_b64_tr_b16 v[46:47], v8 offset:28160
  v_mfma_f32_32x32x16_bf16 v[192:207], v[48:51], v[112:115], v[192:207]
  ds_read_b64_tr_b16 v[48:49], v7 offset:26752
  ds_read_b64_tr_b16 v[50:51], v7 offset:28288
  s_waitcnt lgkmcnt(7)
  v_mfma_f32_32x32x16_bf16 v[208:223], v[52:55], v[112:115], v[208:223]
  ds_read_b64_tr_b16 v[52:53], v8 offset:26752
  ds_read_b64_tr_b16 v[54:55], v8 offset:28288
  v_mfma_f32_32x32x16_bf16 v[224:239], v[56:59], v[112:115], v[224:239]
  ds_read_b64_tr_b16 v[56:57], v7 offset:26880
  ds_read_b64_tr_b16 v[58:59], v7 offset:28416
  v_mfma_f32_32x32x16_bf16 v[240:255], v[60:63], v[112:115], v[240:255]
  ds_read_b64_tr_b16 v[60:61], v8 offset:26880
  ds_read_b64_tr_b16 v[62:63], v8 offset:28416
  s_waitcnt vmcnt(19)
  s_barrier
  s_mov_b32 s45, 1966080
  s_waitcnt lgkmcnt(6)
  v_mfma_f32_32x32x16_bf16 v[160:175], v[40:43], v[116:119], v[160:175]
  ds_read_b128 v[112:115], v130 offset:4096
  ds_read_b64_tr_b16 v[40:41], v7 offset:40960
  ds_read_b64_tr_b16 v[42:43], v7 offset:42496
  s_add_u32 m0, s32, 0
  s_nop 0
  buffer_load_dwordx4 v17, s[12:15], s45 offen offset:0 nt lds
  buffer_load_dwordx4 v18, s[12:15], s45 offen offset:1024 nt lds
  v_mfma_f32_32x32x16_bf16 v[176:191], v[44:47], v[116:119], v[176:191]
  ds_read_b64_tr_b16 v[44:45], v8 offset:40960
  ds_read_b64_tr_b16 v[46:47], v8 offset:42496
  buffer_load_dwordx4 v19, s[12:15], s45 offen offset:2048 nt lds
  s_mov_b32 s44, 320
  s_add_u32 m0, s33, 12288
  s_nop 0
  buffer_load_dwordx4 v20, s[16:19], s44 offen offset:0 lds
  v_mfma_f32_32x32x16_bf16 v[192:207], v[48:51], v[116:119], v[192:207]
  ds_read_b64_tr_b16 v[48:49], v7 offset:41088
  ds_read_b64_tr_b16 v[50:51], v7 offset:42624
  buffer_load_dwordx4 v21, s[16:19], s44 offen offset:1024 lds
  s_waitcnt lgkmcnt(7)
  v_mfma_f32_32x32x16_bf16 v[208:223], v[52:55], v[116:119], v[208:223]
  ds_read_b64_tr_b16 v[52:53], v8 offset:41088
  ds_read_b64_tr_b16 v[54:55], v8 offset:42624
  v_mfma_f32_32x32x16_bf16 v[224:239], v[56:59], v[116:119], v[224:239]
  ds_read_b64_tr_b16 v[56:57], v7 offset:41216
  ds_read_b64_tr_b16 v[58:59], v7 offset:42752
  v_mfma_f32_32x32x16_bf16 v[240:255], v[60:63], v[116:119], v[240:255]
  ds_read_b64_tr_b16 v[60:61], v8 offset:41216
  ds_read_b64_tr_b16 v[62:63], v8 offset:42752
  s_waitcnt lgkmcnt(6)
  v_mfma_f32_32x32x16_bf16 v[160:175], v[40:43], v[112:115], v[160:175]
  ds_read_b128 v[116:119], v131 offset:4096
  ds_read_b64_tr_b16 v[40:41], v7 offset:47104
  ds_read_b64_tr_b16 v[42:43], v7 offset:48640
  v_mfma_f32_32x32x16_bf16 v[176:191], v[44:47], v[112:115], v[176:191]
  ds_read_b64_tr_b16 v[44:45], v8 offset:47104
  ds_read_b64_tr_b16 v[46:47], v8 offset:48640
  v_mfma_f32_32x32x16_bf16 v[192:207], v[48:51], v[112:115], v[192:207]
  ds_read_b64_tr_b16 v[48:49], v7 offset:47232
  ds_read_b64_tr_b16 v[50:51], v7 offset:48768
  s_waitcnt lgkmcnt(7)
  v_mfma_f32_32x32x16_bf16 v[208:223], v[52:55], v[112:115], v[208:223]
  ds_read_b64_tr_b16 v[52:53], v8 offset:47232
  ds_read_b64_tr_b16 v[54:55], v8 offset:48768
  v_mfma_f32_32x32x16_bf16 v[224:239], v[56:59], v[112:115], v[224:239]
  ds_read_b64_tr_b16 v[56:57], v7 offset:47360
  ds_read_b64_tr_b16 v[58:59], v7 offset:48896
  v_mfma_f32_32x32x16_bf16 v[240:255], v[60:63], v[112:115], v[240:255]
  ds_read_b64_tr_b16 v[60:61], v8 offset:47360
  ds_read_b64_tr_b16 v[62:63], v8 offset:48896
  s_waitcnt vmcnt(19)
  s_barrier
  s_mov_b32 s45, 2359296
  s_waitcnt lgkmcnt(6)
  v_mfma_f32_32x32x16_bf16 v[160:175], v[40:43], v[116:119], v[160:175]
  ds_read_b128 v[112:115], v130 offset:24576
  ds_read_b64_tr_b16 v[40:41], v128 offset:12288
  ds_read_b64_tr_b16 v[42:43], v128 offset:13824
  s_add_u32 m0, s32, 20480
  s_nop 0
  buffer_load_dwordx4 v17, s[12:15], s45 offen offset:0 nt lds
  buffer_load_dwordx4 v18, s[12:15], s45 offen offset:1024 nt lds
  v_mfma_f32_32x32x16_bf16 v[176:191], v[44:47], v[116:119], v[176:191]
  ds_read_b64_tr_b16 v[44:45], v129 offset:12288
  ds_read_b64_tr_b16 v[46:47], v129 offset:13824
  buffer_load_dwordx4 v19, s[12:15], s45 offen offset:2048 nt lds
  s_mov_b32 s44, 384
  s_add_u32 m0, s33, 32768
  s_nop 0
  buffer_load_dwordx4 v20, s[16:19], s44 offen offset:0 lds
  v_mfma_f32_32x32x16_bf16 v[192:207], v[48:51], v[116:119], v[192:207]
  ds_read_b64_tr_b16 v[48:49], v128 offset:12416
  ds_read_b64_tr_b16 v[50:51], v128 offset:13952
  buffer_load_dwordx4 v21, s[16:19], s44 offen offset:1024 lds
  s_waitcnt lgkmcnt(7)
  v_mfma_f32_32x32x16_bf16 v[208:223], v[52:55], v[116:119], v[208:223]
  ds_read_b64_tr_b16 v[52:53], v129 offset:12416
  ds_read_b64_tr_b16 v[54:55], v129 offset:13952
  v_mfma_f32_32x32x16_bf16 v[224:239], v[56:59], v[116:119], v[224:239]
  ds_read_b64_tr_b16 v[56:57], v128 offset:12544
  ds_read_b64_tr_b16 v[58:59], v128 offset:14080
  v_mfma_f32_32x32x16_bf16 v[240:255], v[60:63], v[116:119], v[240:255]
  ds_read_b64_tr_b16 v[60:61], v129 offset:12544
  ds_read_b64_tr_b16 v[62:63], v129 offset:14080
  s_waitcnt lgkmcnt(6)
  v_mfma_f32_32x32x16_bf16 v[160:175], v[40:43], v[112:115], v[160:175]
  ds_read_b128 v[116:119], v131 offset:24576
  ds_read_b64_tr_b16 v[40:41], v128 offset:18432
  ds_read_b64_tr_b16 v[42:43], v128 offset:19968
  v_mfma_f32_32x32x16_bf16 v[176:191], v[44:47], v[112:115], v[176:191]
  ds_read_b64_tr_b16 v[44:45], v129 offset:18432
  ds_read_b64_tr_b16 v[46:47], v129 offset:19968
  v_mfma_f32_32x32x16_bf16 v[192:207], v[48:51], v[112:115], v[192:207]
  ds_read_b64_tr_b16 v[48:49], v128 offset:18560
  ds_read_b64_tr_b16 v[50:51], v128 offset:20096
  s_waitcnt lgkmcnt(7)
  v_mfma_f32_32x32x16_bf16 v[208:223], v[52:55], v[112:115], v[208:223]
  ds_read_b64_tr_b16 v[52:53], v129 offset:18560
  ds_read_b64_tr_b16 v[54:55], v129 offset:20096
  v_mfma_f32_32x32x16_bf16 v[224:239], v[56:59], v[112:115], v[224:239]
  ds_read_b64_tr_b16 v[56:57], v128 offset:18688
  ds_read_b64_tr_b16 v[58:59], v128 offset:20224
  v_mfma_f32_32x32x16_bf16 v[240:255], v[60:63], v[112:115], v[240:255]
  ds_read_b64_tr_b16 v[60:61], v129 offset:18688
  ds_read_b64_tr_b16 v[62:63], v129 offset:20224
  s_waitcnt vmcnt(19)
  s_barrier
  s_mov_b32 s45, 2752512
  s_waitcnt lgkmcnt(6)
  v_mfma_f32_32x32x16_bf16 v[160:175], v[40:43], v[116:119], v[160:175]
  ds_read_b128 v[112:115], v130 offset:45056
  ds_read_b64_tr_b16 v[40:41], v128 offset:32768
  ds_read_b64_tr_b16 v[42:43], v128 offset:34304
  s_add_u32 m0, s32, 40960
  s_nop 0
  buffer_load_dwordx4 v17, s[12:15], s45 offen offset:0 nt lds
  buffer_load_dwordx4 v18, s[12:15], s45 offen offset:1024 nt lds
  v_mfma_f32_32x32x16_bf16 v[176:191], v[44:47], v[116:119], v[176:191]
  ds_read_b64_tr_b16 v[44:45], v129 offset:32768
  ds_read_b64_tr_b16 v[46:47], v129 offset:34304
  buffer_load_dwordx4 v19, s[12:15], s45 offen offset:2048 nt lds
  s_mov_b32 s44, 448
  s_add_u32 m0, s33, 53248
  s_nop 0
  buffer_load_dwordx4 v20, s[16:19], s44 offen offset:0 lds
  v_mfma_f32_32x32x16_bf16 v[192:207], v[48:51], v[116:119], v[192:207]
  ds_read_b64_tr_b16 v[48:49], v128 offset:32896
  ds_read_b64_tr_b16 v[50:51], v128 offset:34432
  buffer_load_dwordx4 v21, s[16:19], s44 offen offset:1024 lds
  s_waitcnt lgkmcnt(7)
  v_mfma_f32_32x32x16_bf16 v[208:223], v[52:55], v[116:119], v[208:223]
  ds_read_b64_tr_b16 v[52:53], v129 offset:32896
  ds_read_b64_tr_b16 v[54:55], v129 offset:34432
  v_mfma_f32_32x32x16_bf16 v[224:239], v[56:59], v[116:119], v[224:239]
  ds_read_b64_tr_b16 v[56:57], v128 offset:33024
  ds_read_b64_tr_b16 v[58:59], v128 offset:34560
  v_mfma_f32_32x32x16_bf16 v[240:255], v[60:63], v[116:119], v[240:255]
  ds_read_b64_tr_b16 v[60:61], v129 offset:33024
  ds_read_b64_tr_b16 v[62:63], v129 offset:34560
  s_waitcnt lgkmcnt(6)
  v_mfma_f32_32x32x16_bf16 v[160:175], v[40:43], v[112:115], v[160:175]
  ds_read_b128 v[116:119], v131 offset:45056
  ds_read_b64_tr_b16 v[40:41], v128 offset:38912
  ds_read_b64_tr_b16 v[42:43], v128 offset:40448
  v_mfma_f32_32x32x16_bf16 v[176:191], v[44:47], v[112:115], v[176:191]
  ds_read_b64_tr_b16 v[44:45], v129 offset:38912
  ds_read_b64_tr_b16 v[46:47], v129 offset:40448
  v_mfma_f32_32x32x16_bf16 v[192:207], v[48:51], v[112:115], v[192:207]
  ds_read_b64_tr_b16 v[48:49], v128 offset:39040
  ds_read_b64_tr_b16 v[50:51], v128 offset:40576
  s_waitcnt lgkmcnt(7)
  v_mfma_f32_32x32x16_bf16 v[208:223], v[52:55], v[112:115], v[208:223]
  ds_read_b64_tr_b16 v[52:53], v129 offset:39040
  ds_read_b64_tr_b16 v[54:55], v129 offset:40576
  v_mfma_f32_32x32x16_bf16 v[224:239], v[56:59], v[112:115], v[224:239]
  ds_read_b64_tr_b16 v[56:57], v128 offset:39168
  ds_read_b64_tr_b16 v[58:59], v128 offset:40704
  v_mfma_f32_32x32x16_bf16 v[240:255], v[60:63], v[112:115], v[240:255]
  ds_read_b64_tr_b16 v[60:61], v129 offset:39168
  ds_read_b64_tr_b16 v[62:63], v129 offset:40704
  s_waitcnt vmcnt(10)
  s_barrier
  s_mov_b32 s45, 3145728
  s_waitcnt lgkmcnt(6)
  v_mfma_f32_32x32x16_bf16 v[160:175], v[40:43], v[116:119], v[160:175]
  ds_read_b128 v[112:115], v9 offset:12288
  ds_read_b64_tr_b16 v[40:41], v7 offset:0
  ds_read_b64_tr_b16 v[42:43], v7 offset:1536
  s_add_u32 m0, s32, 61440
  s_nop 0
  buffer_load_dwordx4 v17, s[12:15], s45 offen offset:0 nt lds
  buffer_load_dwordx4 v18, s[12:15], s45 offen offset:1024 nt lds
  v_mfma_f32_32x32x16_bf16 v[176:191], v[44:47], v[116:119], v[176:191]
  ds_read_b64_tr_b16 v[44:45], v8 offset:0
  ds_read_b64_tr_b16 v[46:47], v8 offset:1536
  buffer_load_dwordx4 v19, s[12:15], s45 offen offset:2048 nt lds
  s_mov_b32 s44, 512
  s_add_u32 m0, s33, 73728
  s_nop 0
  buffer_load_dwordx4 v20, s[16:19], s44 offen offset:0 lds
  v_mfma_f32_32x32x16_bf16 v[192:207], v[48:51], v[116:119], v[192:207]
  ds_read_b64_tr_b16 v[48:49], v7 offset:128
  ds_read_b64_tr_b16 v[50:51], v7 offset:1664
  buffer_load_dwordx4 v21, s[16:19], s44 offen offset:1024 lds
  s_waitcnt lgkmcnt(7)
  v_mfma_f32_32x32x16_bf16 v[208:223], v[52:55], v[116:119], v[208:223]
  ds_read_b64_tr_b16 v[52:53], v8 offset:128
  ds_read_b64_tr_b16 v[54:55], v8 offset:1664
  v_mfma_f32_32x32x16_bf16 v[224:239], v[56:59], v[116:119], v[224:239]
  ds_read_b64_tr_b16 v[56:57], v7 offset:256
  ds_read_b64_tr_b16 v[58:59], v7 offset:1792
  v_mfma_f32_32x32x16_bf16 v[240:255], v[60:63], v[116:119], v[240:255]
  ds_read_b64_tr_b16 v[60:61], v8 offset:256
  ds_read_b64_tr_b16 v[62:63], v8 offset:1792
  s_waitcnt lgkmcnt(6)
  v_mfma_f32_32x32x16_bf16 v[160:175], v[40:43], v[112:115], v[160:175]
  ds_read_b128 v[116:119], v10 offset:12288
  ds_read_b64_tr_b16 v[40:41], v7 offset:6144
  ds_read_b64_tr_b16 v[42:43], v7 offset:7680
  v_mfma_f32_32x32x16_bf16 v[176:191], v[44:47], v[112:115], v[176:191]
  ds_read_b64_tr_b16 v[44:45], v8 offset:6144
  ds_read_b64_tr_b16 v[46:47], v8 offset:7680
  v_mfma_f32_32x32x16_bf16 v[192:207], v[48:51], v[112:115], v[192:207]
  ds_read_b64_tr_b16 v[48:49], v7 offset:6272
  ds_read_b64_tr_b16 v[50:51], v7 offset:7808
  s_waitcnt lgkmcnt(7)
  v_mfma_f32_32x32x16_bf16 v[208:223], v[52:55], v[112:115], v[208:223]
  ds_read_b64_tr_b16 v[52:53], v8 offset:6272
  ds_read_b64_tr_b16 v[54:55], v8 offset:7808
  v_mfma_f32_32x32x16_bf16 v[224:239], v[56:59], v[112:115], v[224:239]
  ds_read_b64_tr_b16 v[56:57], v7 offset:6400
  ds_read_b64_tr_b16 v[58:59], v7 offset:7936
  v_mfma_f32_32x32x16_bf16 v[240:255], v[60:63], v[112:115], v[240:255]
  ds_read_b64_tr_b16 v[60:61], v8 offset:6400
  ds_read_b64_tr_b16 v[62:63], v8 offset:7936
  s_waitcnt vmcnt(10)
  s_barrier
  s_mov_b32 s45, 3538944
  s_waitcnt lgkmcnt(6)
  v_mfma_f32_32x32x16_bf16 v[160:175], v[40:43], v[116:119], v[160:175]
  ds_read_b128 v[112:115], v9 offset:32768
  ds_read_b64_tr_b16 v[40:41], v7 offset:20480
  ds_read_b64_tr_b16 v[42:43], v7 offset:22016
  s_add_u32 m0, s32, 81920
  s_nop 0
  buffer_load_dwordx4 v17, s[12:15], s45 offen offset:0 nt lds
  buffer_load_dwordx4 v18, s[12:15], s45 offen offset:1024 nt lds
  v_mfma_f32_32x32x16_bf16 v[176:191], v[44:47], v[116:119], v[176:191]
  ds_read_b64_tr_b16 v[44:45], v8 offset:20480
  ds_read_b64_tr_b16 v[46:47], v8 offset:22016
  buffer_load_dwordx4 v19, s[12:15], s45 offen offset:2048 nt lds
  s_mov_b32 s44, 576
  s_add_u32 m0, s33, 94208
  s_nop 0
  buffer_load_dwordx4 v20, s[16:19], s44 offen offset:0 lds
  v_mfma_f32_32x32x16_bf16 v[192:207], v[48:51], v[116:119], v[192:207]
  ds_read_b64_tr_b16 v[48:49], v7 offset:20608
  ds_read_b64_tr_b16 v[50:51], v7 offset:22144
  buffer_load_dwordx4 v21, s[16:19], s44 offen offset:1024 lds
  s_waitcnt lgkmcnt(7)
  v_mfma_f32_32x32x16_bf16 v[208:223], v[52:55], v[116:119], v[208:223]
  ds_read_b64_tr_b16 v[52:53], v8 offset:20608
  ds_read_b64_tr_b16 v[54:55], v8 offset:22144
  v_mfma_f32_32x32x16_bf16 v[224:239], v[56:59], v[116:119], v[224:239]
  ds_read_b64_tr_b16 v[56:57], v7 offset:20736
  ds_read_b64_tr_b16 v[58:59], v7 offset:22272
  v_mfma_f32_32x32x16_bf16 v[240:255], v[60:63], v[116:119], v[240:255]
  ds_read_b64_tr_b16 v[60:61], v8 offset:20736
  ds_read_b64_tr_b16 v[62:63], v8 offset:22272
  s_waitcnt lgkmcnt(6)
  v_mfma_f32_32x32x16_bf16 v[160:175], v[40:43], v[112:115], v[160:175]
  ds_read_b128 v[116:119], v10 offset:32768
  ds_read_b64_tr_b16 v[40:41], v7 offset:26624
  ds_read_b64_tr_b16 v[42:43], v7 offset:28160
  v_mfma_f32_32x32x16_bf16 v[176:191], v[44:47], v[112:115], v[176:191]
  ds_read_b64_tr_b16 v[44:45], v8 offset:26624
  ds_read_b64_tr_b16 v[46:47], v8 offset:28160
  v_mfma_f32_32x32x16_bf16 v[192:207], v[48:51], v[112:115], v[192:207]
  ds_read_b64_tr_b16 v[48:49], v7 offset:26752
  ds_read_b64_tr_b16 v[50:51], v7 offset:28288
  s_waitcnt lgkmcnt(7)
  v_mfma_f32_32x32x16_bf16 v[208:223], v[52:55], v[112:115], v[208:223]
  ds_read_b64_tr_b16 v[52:53], v8 offset:26752
  ds_read_b64_tr_b16 v[54:55], v8 offset:28288
  v_mfma_f32_32x32x16_bf16 v[224:239], v[56:59], v[112:115], v[224:239]
  ds_read_b64_tr_b16 v[56:57], v7 offset:26880
  ds_read_b64_tr_b16 v[58:59], v7 offset:28416
  v_mfma_f32_32x32x16_bf16 v[240:255], v[60:63], v[112:115], v[240:255]
  ds_read_b64_tr_b16 v[60:61], v8 offset:26880
  ds_read_b64_tr_b16 v[62:63], v8 offset:28416
  s_waitcnt vmcnt(10)
  s_barrier
  s_mov_b32 s45, 3932160
  s_waitcnt lgkmcnt(6)
  v_mfma_f32_32x32x16_bf16 v[160:175], v[40:43], v[116:119], v[160:175]
  ds_read_b128 v[112:115], v130 offset:4096
  ds_read_b64_tr_b16 v[40:41], v7 offset:40960
  ds_read_b64_tr_b16 v[42:43], v7 offset:42496
  s_add_u32 m0, s32, 0
  s_nop 0
  buffer_load_dwordx4 v17, s[12:15], s45 offen offset:0 nt lds
  buffer_load_dwordx4 v18, s[12:15], s45 offen offset:1024 nt lds
  v_mfma_f32_32x32x16_bf16 v[176:191], v[44:47], v[116:119], v[176:191]
  ds_read_b64_tr_b16 v[44:45], v8 offset:40960
  ds_read_b64_tr_b16 v[46:47], v8 offset:42496
  buffer_load_dwordx4 v19, s[12:15], s45 offen offset:2048 nt lds
  s_mov_b32 s44, 640
  s_add_u32 m0, s33, 12288
  s_nop 0
  buffer_load_dwordx4 v20, s[16:19], s44 offen offset:0 lds
  v_mfma_f32_32x32x16_bf16 v[192:207], v[48:51], v[116:119], v[192:207]
  ds_read_b64_tr_b16 v[48:49], v7 offset:41088
  ds_read_b64_tr_b16 v[50:51], v7 offset:42624
  buffer_load_dwordx4 v21, s[16:19], s44 offen offset:1024 lds
  s_waitcnt lgkmcnt(7)
  v_mfma_f32_32x32x16_bf16 v[208:223], v[52:55], v[116:119], v[208:223]
  ds_read_b64_tr_b16 v[52:53], v8 offset:41088
  ds_read_b64_tr_b16 v[54:55], v8 offset:42624
  v_mfma_f32_32x32x16_bf16 v[224:239], v[56:59], v[116:119], v[224:239]
  ds_read_b64_tr_b16 v[56:57], v7 offset:41216
  ds_read_b64_tr_b16 v[58:59], v7 offset:42752
  v_mfma_f32_32x32x16_bf16 v[240:255], v[60:63], v[116:119], v[240:255]
  ds_read_b64_tr_b16 v[60:61], v8 offset:41216
  ds_read_b64_tr_b16 v[62:63], v8 offset:42752
  s_waitcnt lgkmcnt(6)
  v_mfma_f32_32x32x16_bf16 v[160:175], v[40:43], v[112:115], v[160:175]
  ds_read_b128 v[116:119], v131 offset:4096
  ds_read_b64_tr_b16 v[40:41], v7 offset:47104
  ds_read_b64_tr_b16 v[42:43], v7 offset:48640
  v_mfma_f32_32x32x16_bf16 v[176:191], v[44:47], v[112:115], v[176:191]
  ds_read_b64_tr_b16 v[44:45], v8 offset:47104
  ds_read_b64_tr_b16 v[46:47], v8 offset:48640
  v_mfma_f32_32x32x16_bf16 v[192:207], v[48:51], v[112:115], v[192:207]
  ds_read_b64_tr_b16 v[48:49], v7 offset:47232
  ds_read_b64_tr_b16 v[50:51], v7 offset:48768
  s_waitcnt lgkmcnt(7)
  v_mfma_f32_32x32x16_bf16 v[208:223], v[52:55], v[112:115], v[208:223]
  ds_read_b64_tr_b16 v[52:53], v8 offset:47232
  ds_read_b64_tr_b16 v[54:55], v8 offset:48768
  v_mfma_f32_32x32x16_bf16 v[224:239], v[56:59], v[112:115], v[224:239]
  ds_read_b64_tr_b16 v[56:57], v7 offset:47360
  ds_read_b64_tr_b16 v[58:59], v7 offset:48896
  v_mfma_f32_32x32x16_bf16 v[240:255], v[60:63], v[112:115], v[240:255]
  ds_read_b64_tr_b16 v[60:61], v8 offset:47360
  ds_read_b64_tr_b16 v[62:63], v8 offset:48896
  s_waitcnt vmcnt(10)
  s_barrier
  s_mov_b32 s45, 4325376
  s_waitcnt lgkmcnt(6)
  v_mfma_f32_32x32x16_bf16 v[160:175], v[40:43], v[116:119], v[160:175]
  ds_read_b128 v[112:115], v130 offset:24576
  ds_read_b64_tr_b16 v[40:41], v128 offset:12288
  ds_read_b64_tr_b16 v[42:43], v128 offset:13824
  s_add_u32 m0, s32, 20480
  s_nop 0
  buffer_load_dwordx4 v17, s[12:15], s45 offen offset:0 nt lds
  buffer_load_dwordx4 v18, s[12:15], s45 offen offset:1024 nt lds
  v_mfma_f32_32x32x16_bf16 v[176:191], v[44:47], v[116:119], v[176:191]
  ds_read_b64_tr_b16 v[44:45], v129 offset:12288
  ds_read_b64_tr_b16 v[46:47], v129 offset:13824
  buffer_load_dwordx4 v19, s[12:15], s45 offen offset:2048 nt lds
  s_mov_b32 s44, 704
  s_add_u32 m0, s33, 32768
  s_nop 0
  buffer_load_dwordx4 v20, s[16:19], s44 offen offset:0 lds
  v_mfma_f32_32x32x16_bf16 v[192:207], v[48:51], v[116:119], v[192:207]
  ds_read_b64_tr_b16 v[48:49], v128 offset:12416
  ds_read_b64_tr_b16 v[50:51], v128 offset:13952
  buffer_load_dwordx4 v21, s[16:19], s44 offen offset:1024 lds
  s_waitcnt lgkmcnt(7)
  v_mfma_f32_32x32x16_bf16 v[208:223], v[52:55], v[116:119], v[208:223]
  ds_read_b64_tr_b16 v[52:53], v129 offset:12416
  ds_read_b64_tr_b16 v[54:55], v129 offset:13952
  v_mfma_f32_32x32x16_bf16 v[224:239], v[56:59], v[116:119], v[224:239]
  ds_read_b64_tr_b16 v[56:57], v128 offset:12544
  ds_read_b64_tr_b16 v[58:59], v128 offset:14080
  v_mfma_f32_32x32x16_bf16 v[240:255], v[60:63], v[116:119], v[240:255]
  ds_read_b64_tr_b16 v[60:61], v129 offset:12544
  ds_read_b64_tr_b16 v[62:63], v129 offset:14080
  s_waitcnt lgkmcnt(6)
  v_mfma_f32_32x32x16_bf16 v[160:175], v[40:43], v[112:115], v[160:175]
  ds_read_b128 v[116:119], v131 offset:24576
  ds_read_b64_tr_b16 v[40:41], v128 offset:18432
  ds_read_b64_tr_b16 v[42:43], v128 offset:19968
  v_mfma_f32_32x32x16_bf16 v[176:191], v[44:47], v[112:115], v[176:191]
  ds_read_b64_tr_b16 v[44:45], v129 offset:18432
  ds_read_b64_tr_b16 v[46:47], v129 offset:19968
  v_mfma_f32_32x32x16_bf16 v[192:207], v[48:51], v[112:115], v[192:207]
  ds_read_b64_tr_b16 v[48:49], v128 offset:18560
  ds_read_b64_tr_b16 v[50:51], v128 offset:20096
  s_waitcnt lgkmcnt(7)
  v_mfma_f32_32x32x16_bf16 v[208:223], v[52:55], v[112:115], v[208:223]
  ds_read_b64_tr_b16 v[52:53], v129 offset:18560
  ds_read_b64_tr_b16 v[54:55], v129 offset:20096
  v_mfma_f32_32x32x16_bf16 v[224:239], v[56:59], v[112:115], v[224:239]
  ds_read_b64_tr_b16 v[56:57], v128 offset:18688
  ds_read_b64_tr_b16 v[58:59], v128 offset:20224
  v_mfma_f32_32x32x16_bf16 v[240:255], v[60:63], v[112:115], v[240:255]
  ds_read_b64_tr_b16 v[60:61], v129 offset:18688
  ds_read_b64_tr_b16 v[62:63], v129 offset:20224
  s_waitcnt vmcnt(10)
  s_barrier
  s_mov_b32 s45, 4718592
  s_waitcnt lgkmcnt(6)
  v_mfma_f32_32x32x16_bf16 v[160:175], v[40:43], v[116:119], v[160:175]
  ds_read_b128 v[112:115], v130 offset:45056
  ds_read_b64_tr_b16 v[40:41], v128 offset:32768
  ds_read_b64_tr_b16 v[42:43], v128 offset:34304
  s_add_u32 m0, s32, 40960
  s_nop 0
  buffer_load_dwordx4 v17, s[12:15], s45 offen offset:0 nt lds
  buffer_load_dwordx4 v18, s[12:15], s45 offen offset:1024 nt lds
  v_mfma_f32_32x32x16_bf16 v[176:191], v[44:47], v[116:119], v[176:191]
  ds_read_b64_tr_b16 v[44:45], v129 offset:32768
  ds_read_b64_tr_b16 v[46:47], v129 offset:34304
  buffer_load_dwordx4 v19, s[12:15], s45 offen offset:2048 nt lds
  s_mov_b32 s44, 768
  s_add_u32 m0, s33, 53248
  s_nop 0
  buffer_load_dwordx4 v20, s[16:19], s44 offen offset:0 lds
  v_mfma_f32_32x32x16_bf16 v[192:207], v[48:51], v[116:119], v[192:207]
  ds_read_b64_tr_b16 v[48:49], v128 offset:32896
  ds_read_b64_tr_b16 v[50:51], v128 offset:34432
  buffer_load_dwordx4 v21, s[16:19], s44 offen offset:1024 lds
  s_waitcnt lgkmcnt(7)
  v_mfma_f32_32x32x16_bf16 v[208:223], v[52:55], v[116:119], v[208:223]
  ds_read_b64_tr_b16 v[52:53], v129 offset:32896
  ds_read_b64_tr_b16 v[54:55], v129 offset:34432
  v_mfma_f32_32x32x16_bf16 v[224:239], v[56:59], v[116:119], v[224:239]
  ds_read_b64_tr_b16 v[56:57], v128 offset:33024
  ds_read_b64_tr_b16 v[58:59], v128 offset:34560
  v_mfma_f32_32x32x16_bf16 v[240:255], v[60:63], v[116:119], v[240:255]
  ds_read_b64_tr_b16 v[60:61], v129 offset:33024
  ds_read_b64_tr_b16 v[62:63], v129 offset:34560
  s_waitcnt lgkmcnt(6)
  v_mfma_f32_32x32x16_bf16 v[160:175], v[40:43], v[112:115], v[160:175]
  ds_read_b128 v[116:119], v131 offset:45056
  ds_read_b64_tr_b16 v[40:41], v128 offset:38912
  ds_read_b64_tr_b16 v[42:43], v128 offset:40448
  v_mfma_f32_32x32x16_bf16 v[176:191], v[44:47], v[112:115], v[176:191]
  ds_read_b64_tr_b16 v[44:45], v129 offset:38912
  ds_read_b64_tr_b16 v[46:47], v129 offset:40448
  v_mfma_f32_32x32x16_bf16 v[192:207], v[48:51], v[112:115], v[192:207]
  ds_read_b64_tr_b16 v[48:49], v128 offset:39040
  ds_read_b64_tr_b16 v[50:51], v128 offset:40576
  s_waitcnt lgkmcnt(7)
  v_mfma_f32_32x32x16_bf16 v[208:223], v[52:55], v[112:115], v[208:223]
  ds_read_b64_tr_b16 v[52:53], v129 offset:39040
  ds_read_b64_tr_b16 v[54:55], v129 offset:40576
  v_mfma_f32_32x32x16_bf16 v[224:239], v[56:59], v[112:115], v[224:239]
  ds_read_b64_tr_b16 v[56:57], v128 offset:39168
  ds_read_b64_tr_b16 v[58:59], v128 offset:40704
  v_mfma_f32_32x32x16_bf16 v[240:255], v[60:63], v[112:115], v[240:255]
  ds_read_b64_tr_b16 v[60:61], v129 offset:39168
  ds_read_b64_tr_b16 v[62:63], v129 offset:40704
  s_waitcnt vmcnt(10)
  s_barrier
  s_mov_b32 s45, 5111808
  s_waitcnt lgkmcnt(6)
  v_mfma_f32_32x32x16_bf16 v[160:175], v[40:43], v[116:119], v[160:175]
  ds_read_b128 v[112:115], v9 offset:12288
  ds_read_b64_tr_b16 v[40:41], v7 offset:0
  ds_read_b64_tr_b16 v[42:43], v7 offset:1536
  s_add_u32 m0, s32, 61440
  s_nop 0
  buffer_load_dwordx4 v17, s[12:15], s45 offen offset:0 nt lds
  buffer_load_dwordx4 v18, s[12:15], s45 offen offset:1024 nt lds
  v_mfma_f32_32x32x16_bf16 v[176:191], v[44:47], v[116:119], v[176:191]
  ds_read_b64_tr_b16 v[44:45], v8 offset:0
  ds_read_b64_tr_b16 v[46:47], v8 offset:1536
  buffer_load_dwordx4 v19, s[12:15], s45 offen offset:2048 nt lds
  s_mov_b32 s44, 832
  s_add_u32 m0, s33, 73728
  s_nop 0
  buffer_load_dwordx4 v20, s[16:19], s44 offen offset:0 lds
  v_mfma_f32_32x32x16_bf16 v[192:207], v[48:51], v[116:119], v[192:207]
  ds_read_b64_tr_b16 v[48:49], v7 offset:128
  ds_read_b64_tr_b16 v[50:51], v7 offset:1664
  buffer_load_dwordx4 v21, s[16:19], s44 offen offset:1024 lds
  s_waitcnt lgkmcnt(7)
  v_mfma_f32_32x32x16_bf16 v[208:223], v[52:55], v[116:119], v[208:223]
  ds_read_b64_tr_b16 v[52:53], v8 offset:128
  ds_read_b64_tr_b16 v[54:55], v8 offset:1664
  v_mfma_f32_32x32x16_bf16 v[224:239], v[56:59], v[116:119], v[224:239]
  ds_read_b64_tr_b16 v[56:57], v7 offset:256
  ds_read_b64_tr_b16 v[58:59], v7 offset:1792
  v_mfma_f32_32x32x16_bf16 v[240:255], v[60:63], v[116:119], v[240:255]
  ds_read_b64_tr_b16 v[60:61], v8 offset:256
  ds_read_b64_tr_b16 v[62:63], v8 offset:1792
  s_waitcnt lgkmcnt(6)
  v_mfma_f32_32x32x16_bf16 v[160:175], v[40:43], v[112:115], v[160:175]
  ds_read_b128 v[116:119], v10 offset:12288
  ds_read_b64_tr_b16 v[40:41], v7 offset:6144
  ds_read_b64_tr_b16 v[42:43], v7 offset:7680
  v_mfma_f32_32x32x16_bf16 v[176:191], v[44:47], v[112:115], v[176:191]
  ds_read_b64_tr_b16 v[44:45], v8 offset:6144
  ds_read_b64_tr_b16 v[46:47], v8 offset:7680
  v_mfma_f32_32x32x16_bf16 v[192:207], v[48:51], v[112:115], v[192:207]
  ds_read_b64_tr_b16 v[48:49], v7 offset:6272
  ds_read_b64_tr_b16 v[50:51], v7 offset:7808
  s_waitcnt lgkmcnt(7)
  v_mfma_f32_32x32x16_bf16 v[208:223], v[52:55], v[112:115], v[208:223]
  ds_read_b64_tr_b16 v[52:53], v8 offset:6272
  ds_read_b64_tr_b16 v[54:55], v8 offset:7808
  v_mfma_f32_32x32x16_bf16 v[224:239], v[56:59], v[112:115], v[224:239]
  ds_read_b64_tr_b16 v[56:57], v7 offset:6400
  ds_read_b64_tr_b16 v[58:59], v7 offset:7936
  v_mfma_f32_32x32x16_bf16 v[240:255], v[60:63], v[112:115], v[240:255]
  ds_read_b64_tr_b16 v[60:61], v8 offset:6400
  ds_read_b64_tr_b16 v[62:63], v8 offset:7936
  s_waitcnt vmcnt(10)
  s_barrier
  s_mov_b32 s45, 5505024
  s_waitcnt lgkmcnt(6)
  v_mfma_f32_32x32x16_bf16 v[160:175], v[40:43], v[116:119], v[160:175]
  ds_read_b128 v[112:115], v9 offset:32768
  ds_read_b64_tr_b16 v[40:41], v7 offset:20480
  ds_read_b64_tr_b16 v[42:43], v7 offset:22016
  s_add_u32 m0, s32, 81920
  s_nop 0
  buffer_load_dwordx4 v17, s[12:15], s45 offen offset:0 nt lds
  buffer_load_dwordx4 v18, s[12:15], s45 offen offset:1024 nt lds
  v_mfma_f32_32x32x16_bf16 v[176:191], v[44:47], v[116:119], v[176:191]
  ds_read_b64_tr_b16 v[44:45], v8 offset:20480
  ds_read_b64_tr_b16 v[46:47], v8 offset:22016
  buffer_load_dwordx4 v19, s[12:15], s45 offen offset:2048 nt lds
  s_mov_b32 s44, 896
  s_add_u32 m0, s33, 94208
  s_nop 0
  buffer_load_dwordx4 v20, s[16:19], s44 offen offset:0 lds
  v_mfma_f32_32x32x16_bf16 v[192:207], v[48:51], v[116:119], v[192:207]
  ds_read_b64_tr_b16 v[48:49], v7 offset:20608
  ds_read_b64_tr_b16 v[50:51], v7 offset:22144
  buffer_load_dwordx4 v21, s[16:19], s44 offen offset:1024 lds
  s_waitcnt lgkmcnt(7)
  v_mfma_f32_32x32x16_bf16 v[208:223], v[52:55], v[116:119], v[208:223]
  ds_read_b64_tr_b16 v[52:53], v8 offset:20608
  ds_read_b64_tr_b16 v[54:55], v8 offset:22144
  v_mfma_f32_32x32x16_bf16 v[224:239], v[56:59], v[116:119], v[224:239]
  ds_read_b64_tr_b16 v[56:57], v7 offset:20736
  ds_read_b64_tr_b16 v[58:59], v7 offset:22272
  v_mfma_f32_32x32x16_bf16 v[240:255], v[60:63], v[116:119], v[240:255]
  ds_read_b64_tr_b16 v[60:61], v8 offset:20736
  ds_read_b64_tr_b16 v[62:63], v8 offset:22272
  s_waitcnt lgkmcnt(6)
  v_mfma_f32_32x32x16_bf16 v[160:175], v[40:43], v[112:115], v[160:175]
  ds_read_b128 v[116:119], v10 offset:32768
  ds_read_b64_tr_b16 v[40:41], v7 offset:26624
  ds_read_b64_tr_b16 v[42:43], v7 offset:28160
  v_mfma_f32_32x32x16_bf16 v[176:191], v[44:47], v[112:115], v[176:191]
  ds_read_b64_tr_b16 v[44:45], v8 offset:26624
  ds_read_b64_tr_b16 v[46:47], v8 offset:28160
  v_mfma_f32_32x32x16_bf16 v[192:207], v[48:51], v[112:115], v[192:207]
  ds_read_b64_tr_b16 v[48:49], v7 offset:26752
  ds_read_b64_tr_b16 v[50:51], v7 offset:28288
  s_waitcnt lgkmcnt(7)
  v_mfma_f32_32x32x16_bf16 v[208:223], v[52:55], v[112:115], v[208:223]
  ds_read_b64_tr_b16 v[52:53], v8 offset:26752
  ds_read_b64_tr_b16 v[54:55], v8 offset:28288
  v_mfma_f32_32x32x16_bf16 v[224:239], v[56:59], v[112:115], v[224:239]
  ds_read_b64_tr_b16 v[56:57], v7 offset:26880
  ds_read_b64_tr_b16 v[58:59], v7 offset:28416
  v_mfma_f32_32x32x16_bf16 v[240:255], v[60:63], v[112:115], v[240:255]
  ds_read_b64_tr_b16 v[60:61], v8 offset:26880
  ds_read_b64_tr_b16 v[62:63], v8 offset:28416
  s_waitcnt vmcnt(10)
  s_barrier
  s_mov_b32 s45, 5898240
  s_waitcnt lgkmcnt(6)
  v_mfma_f32_32x32x16_bf16 v[160:175], v[40:43], v[116:119], v[160:175]
  ds_read_b128 v[112:115], v130 offset:4096
  ds_read_b64_tr_b16 v[40:41], v7 offset:40960
  ds_read_b64_tr_b16 v[42:43], v7 offset:42496
  s_add_u32 m0, s32, 0
  s_nop 0
  buffer_load_dwordx4 v17, s[12:15], s45 offen offset:0 nt lds
  buffer_load_dwordx4 v18, s[12:15], s45 offen offset:1024 nt lds
  v_mfma_f32_32x32x16_bf16 v[176:191], v[44:47], v[116:119], v[176:191]
  ds_read_b64_tr_b16 v[44:45], v8 offset:40960
  ds_read_b64_tr_b16 v[46:47], v8 offset:42496
  buffer_load_dwordx4 v19, s[12:15], s45 offen offset:2048 nt lds
  s_mov_b32 s44, 960
  s_add_u32 m0, s33, 12288
  s_nop 0
  buffer_load_dwordx4 v20, s[16:19], s44 offen offset:0 lds
  v_mfma_f32_32x32x16_bf16 v[192:207], v[48:51], v[116:119], v[192:207]
  ds_read_b64_tr_b16 v[48:49], v7 offset:41088
  ds_read_b64_tr_b16 v[50:51], v7 offset:42624
  buffer_load_dwordx4 v21, s[16:19], s44 offen offset:1024 lds
  s_waitcnt lgkmcnt(7)
  v_mfma_f32_32x32x16_bf16 v[208:223], v[52:55], v[116:119], v[208:223]
  ds_read_b64_tr_b16 v[52:53], v8 offset:41088
  ds_read_b64_tr_b16 v[54:55], v8 offset:42624
  v_mfma_f32_32x32x16_bf16 v[224:239], v[56:59], v[116:119], v[224:239]
  ds_read_b64_tr_b16 v[56:57], v7 offset:41216
  ds_read_b64_tr_b16 v[58:59], v7 offset:42752
  v_mfma_f32_32x32x16_bf16 v[240:255], v[60:63], v[116:119], v[240:255]
  ds_read_b64_tr_b16 v[60:61], v8 offset:41216
  ds_read_b64_tr_b16 v[62:63], v8 offset:42752
  s_waitcnt lgkmcnt(6)
  v_mfma_f32_32x32x16_bf16 v[160:175], v[40:43], v[112:115], v[160:175]
  ds_read_b128 v[116:119], v131 offset:4096
  ds_read_b64_tr_b16 v[40:41], v7 offset:47104
  ds_read_b64_tr_b16 v[42:43], v7 offset:48640
  v_mfma_f32_32x32x16_bf16 v[176:191], v[44:47], v[112:115], v[176:191]
  ds_read_b64_tr_b16 v[44:45], v8 offset:47104
  ds_read_b64_tr_b16 v[46:47], v8 offset:48640
  v_mfma_f32_32x32x16_bf16 v[192:207], v[48:51], v[112:115], v[192:207]
  ds_read_b64_tr_b16 v[48:49], v7 offset:47232
  ds_read_b64_tr_b16 v[50:51], v7 offset:48768
  s_waitcnt lgkmcnt(7)
  v_mfma_f32_32x32x16_bf16 v[208:223], v[52:55], v[112:115], v[208:223]
  ds_read_b64_tr_b16 v[52:53], v8 offset:47232
  ds_read_b64_tr_b16 v[54:55], v8 offset:48768
  v_mfma_f32_32x32x16_bf16 v[224:239], v[56:59], v[112:115], v[224:239]
  ds_read_b64_tr_b16 v[56:57], v7 offset:47360
  ds_read_b64_tr_b16 v[58:59], v7 offset:48896
  v_mfma_f32_32x32x16_bf16 v[240:255], v[60:63], v[112:115], v[240:255]
  ds_read_b64_tr_b16 v[60:61], v8 offset:47360
  ds_read_b64_tr_b16 v[62:63], v8 offset:48896
  s_waitcnt vmcnt(10)
  s_barrier
  s_mov_b32 s45, 6291456
  s_waitcnt lgkmcnt(6)
  v_mfma_f32_32x32x16_bf16 v[160:175], v[40:43], v[116:119], v[160:175]
  ds_read_b128 v[112:115], v130 offset:24576
  ds_read_b64_tr_b16 v[40:41], v128 offset:12288
  ds_read_b64_tr_b16 v[42:43], v128 offset:13824
  s_add_u32 m0, s32, 20480
  s_nop 0
  buffer_load_dwordx4 v17, s[12:15], s45 offen offset:0 nt lds
  buffer_load_dwordx4 v18, s[12:15], s45 offen offset:1024 nt lds
  v_mfma_f32_32x32x16_bf16 v[176:191], v[44:47], v[116:119], v[176:191]
  ds_read_b64_tr_b16 v[44:45], v129 offset:12288
  ds_read_b64_tr_b16 v[46:47], v129 offset:13824
  buffer_load_dwordx4 v19, s[12:15], s45 offen offset:2048 nt lds
  s_mov_b32 s44, 1024
  s_add_u32 m0, s33, 32768
  s_nop 0
  buffer_load_dwordx4 v20, s[16:19], s44 offen offset:0 lds
  v_mfma_f32_32x32x16_bf16 v[192:207], v[48:51], v[116:119], v[192:207]
  ds_read_b64_tr_b16 v[48:49], v128 offset:12416
  ds_read_b64_tr_b16 v[50:51], v128 offset:13952
  buffer_load_dwordx4 v21, s[16:19], s44 offen offset:1024 lds
  s_waitcnt lgkmcnt(7)
  v_mfma_f32_32x32x16_bf16 v[208:223], v[52:55], v[116:119], v[208:223]
  ds_read_b64_tr_b16 v[52:53], v129 offset:12416
  ds_read_b64_tr_b16 v[54:55], v129 offset:13952
  v_mfma_f32_32x32x16_bf16 v[224:239], v[56:59], v[116:119], v[224:239]
  ds_read_b64_tr_b16 v[56:57], v128 offset:12544
  ds_read_b64_tr_b16 v[58:59], v128 offset:14080
  v_mfma_f32_32x32x16_bf16 v[240:255], v[60:63], v[116:119], v[240:255]
  ds_read_b64_tr_b16 v[60:61], v129 offset:12544
  ds_read_b64_tr_b16 v[62:63], v129 offset:14080
  s_waitcnt lgkmcnt(6)
  v_mfma_f32_32x32x16_bf16 v[160:175], v[40:43], v[112:115], v[160:175]
  ds_read_b128 v[116:119], v131 offset:24576
  ds_read_b64_tr_b16 v[40:41], v128 offset:18432
  ds_read_b64_tr_b16 v[42:43], v128 offset:19968
  v_mfma_f32_32x32x16_bf16 v[176:191], v[44:47], v[112:115], v[176:191]
  ds_read_b64_tr_b16 v[44:45], v129 offset:18432
  ds_read_b64_tr_b16 v[46:47], v129 offset:19968
  v_mfma_f32_32x32x16_bf16 v[192:207], v[48:51], v[112:115], v[192:207]
  ds_read_b64_tr_b16 v[48:49], v128 offset:18560
  ds_read_b64_tr_b16 v[50:51], v128 offset:20096
  s_waitcnt lgkmcnt(7)
  v_mfma_f32_32x32x16_bf16 v[208:223], v[52:55], v[112:115], v[208:223]
  ds_read_b64_tr_b16 v[52:53], v129 offset:18560
  ds_read_b64_tr_b16 v[54:55], v129 offset:20096
  v_mfma_f32_32x32x16_bf16 v[224:239], v[56:59], v[112:115], v[224:239]
  ds_read_b64_tr_b16 v[56:57], v128 offset:18688
  ds_read_b64_tr_b16 v[58:59], v128 offset:20224
  v_mfma_f32_32x32x16_bf16 v[240:255], v[60:63], v[112:115], v[240:255]
  ds_read_b64_tr_b16 v[60:61], v129 offset:18688
  ds_read_b64_tr_b16 v[62:63], v129 offset:20224
  s_waitcnt vmcnt(10)
  s_barrier
  s_mov_b32 s45, 6684672
  s_waitcnt lgkmcnt(6)
  v_mfma_f32_32x32x16_bf16 v[160:175], v[40:43], v[116:119], v[160:175]
  ds_read_b128 v[112:115], v130 offset:45056
  ds_read_b64_tr_b16 v[40:41], v128 offset:32768
  ds_read_b64_tr_b16 v[42:43], v128 offset:34304
  s_add_u32 m0, s32, 40960
  s_nop 0
  buffer_load_dwordx4 v17, s[12:15], s45 offen offset:0 nt lds
  buffer_load_dwordx4 v18, s[12:15], s45 offen offset:1024 nt lds
  v_mfma_f32_32x32x16_bf16 v[176:191], v[44:47], v[116:119], v[176:191]
  ds_read_b64_tr_b16 v[44:45], v129 offset:32768
  ds_read_b64_tr_b16 v[46:47], v129 offset:34304
  buffer_load_dwordx4 v19, s[12:15], s45 offen offset:2048 nt lds
  s_mov_b32 s44, 1088
  s_add_u32 m0, s33, 53248
  s_nop 0
  buffer_load_dwordx4 v20, s[16:19], s44 offen offset:0 lds
  v_mfma_f32_32x32x16_bf16 v[192:207], v[48:51], v[116:119], v[192:207]
  ds_read_b64_tr_b16 v[48:49], v128 offset:32896
  ds_read_b64_tr_b16 v[50:51], v128 offset:34432
  buffer_load_dwordx4 v21, s[16:19], s44 offen offset:1024 lds
  s_waitcnt lgkmcnt(7)
  v_mfma_f32_32x32x16_bf16 v[208:223], v[52:55], v[116:119], v[208:223]
  ds_read_b64_tr_b16 v[52:53], v129 offset:32896
  ds_read_b64_tr_b16 v[54:55], v129 offset:34432
  v_mfma_f32_32x32x16_bf16 v[224:239], v[56:59], v[116:119], v[224:239]
  ds_read_b64_tr_b16 v[56:57], v128 offset:33024
  ds_read_b64_tr_b16 v[58:59], v128 offset:34560
  v_mfma_f32_32x32x16_bf16 v[240:255], v[60:63], v[116:119], v[240:255]
  ds_read_b64_tr_b16 v[60:61], v129 offset:33024
  ds_read_b64_tr_b16 v[62:63], v129 offset:34560
  s_waitcnt lgkmcnt(6)
  v_mfma_f32_32x32x16_bf16 v[160:175], v[40:43], v[112:115], v[160:175]
  ds_read_b128 v[116:119], v131 offset:45056
  ds_read_b64_tr_b16 v[40:41], v128 offset:38912
  ds_read_b64_tr_b16 v[42:43], v128 offset:40448
  v_mfma_f32_32x32x16_bf16 v[176:191], v[44:47], v[112:115], v[176:191]
  ds_read_b64_tr_b16 v[44:45], v129 offset:38912
  ds_read_b64_tr_b16 v[46:47], v129 offset:40448
  v_mfma_f32_32x32x16_bf16 v[192:207], v[48:51], v[112:115], v[192:207]
  ds_read_b64_tr_b16 v[48:49], v128 offset:39040
  ds_read_b64_tr_b16 v[50:51], v128 offset:40576
  s_waitcnt lgkmcnt(7)
  v_mfma_f32_32x32x16_bf16 v[208:223], v[52:55], v[112:115], v[208:223]
  ds_read_b64_tr_b16 v[52:53], v129 offset:39040
  ds_read_b64_tr_b16 v[54:55], v129 offset:40576
  v_mfma_f32_32x32x16_bf16 v[224:239], v[56:59], v[112:115], v[224:239]
  ds_read_b64_tr_b16 v[56:57], v128 offset:39168
  ds_read_b64_tr_b16 v[58:59], v128 offset:40704
  v_mfma_f32_32x32x16_bf16 v[240:255], v[60:63], v[112:115], v[240:255]
  ds_read_b64_tr_b16 v[60:61], v129 offset:39168
  ds_read_b64_tr_b16 v[62:63], v129 offset:40704
  s_waitcnt vmcnt(10)
  s_barrier
  s_mov_b32 s45, 7077888
  s_waitcnt lgkmcnt(6)
  v_mfma_f32_32x32x16_bf16 v[160:175], v[40:43], v[116:119], v[160:175]
  ds_read_b128 v[112:115], v9 offset:12288
  ds_read_b64_tr_b16 v[40:41], v7 offset:0
  ds_read_b64_tr_b16 v[42:43], v7 offset:1536
  s_add_u32 m0, s32, 61440
  s_nop 0
  buffer_load_dwordx4 v17, s[12:15], s45 offen offset:0 nt lds
  buffer_load_dwordx4 v18, s[12:15], s45 offen offset:1024 nt lds
  v_mfma_f32_32x32x16_bf16 v[176:191], v[44:47], v[116:119], v[176:191]
  ds_read_b64_tr_b16 v[44:45], v8 offset:0
  ds_read_b64_tr_b16 v[46:47], v8 offset:1536
  buffer_load_dwordx4 v19, s[12:15], s45 offen offset:2048 nt lds
  s_mov_b32 s44, 1152
  s_add_u32 m0, s33, 73728
  s_nop 0
  buffer_load_dwordx4 v20, s[16:19], s44 offen offset:0 lds
  v_mfma_f32_32x32x16_bf16 v[192:207], v[48:51], v[116:119], v[192:207]
  ds_read_b64_tr_b16 v[48:49], v7 offset:128
  ds_read_b64_tr_b16 v[50:51], v7 offset:1664
  buffer_load_dwordx4 v21, s[16:19], s44 offen offset:1024 lds
  s_waitcnt lgkmcnt(7)
  v_mfma_f32_32x32x16_bf16 v[208:223], v[52:55], v[116:119], v[208:223]
  ds_read_b64_tr_b16 v[52:53], v8 offset:128
  ds_read_b64_tr_b16 v[54:55], v8 offset:1664
  v_mfma_f32_32x32x16_bf16 v[224:239], v[56:59], v[116:119], v[224:239]
  ds_read_b64_tr_b16 v[56:57], v7 offset:256
  ds_read_b64_tr_b16 v[58:59], v7 offset:1792
  v_mfma_f32_32x32x16_bf16 v[240:255], v[60:63], v[116:119], v[240:255]
  ds_read_b64_tr_b16 v[60:61], v8 offset:256
  ds_read_b64_tr_b16 v[62:63], v8 offset:1792
  s_waitcnt lgkmcnt(6)
  v_mfma_f32_32x32x16_bf16 v[160:175], v[40:43], v[112:115], v[160:175]
  ds_read_b128 v[116:119], v10 offset:12288
  ds_read_b64_tr_b16 v[40:41], v7 offset:6144
  ds_read_b64_tr_b16 v[42:43], v7 offset:7680
  v_mfma_f32_32x32x16_bf16 v[176:191], v[44:47], v[112:115], v[176:191]
  ds_read_b64_tr_b16 v[44:45], v8 offset:6144
  ds_read_b64_tr_b16 v[46:47], v8 offset:7680
  v_mfma_f32_32x32x16_bf16 v[192:207], v[48:51], v[112:115], v[192:207]
  ds_read_b64_tr_b16 v[48:49], v7 offset:6272
  ds_read_b64_tr_b16 v[50:51], v7 offset:7808
  s_waitcnt lgkmcnt(7)
  v_mfma_f32_32x32x16_bf16 v[208:223], v[52:55], v[112:115], v[208:223]
  ds_read_b64_tr_b16 v[52:53], v8 offset:6272
  ds_read_b64_tr_b16 v[54:55], v8 offset:7808
  v_mfma_f32_32x32x16_bf16 v[224:239], v[56:59], v[112:115], v[224:239]
  ds_read_b64_tr_b16 v[56:57], v7 offset:6400
  ds_read_b64_tr_b16 v[58:59], v7 offset:7936
  v_mfma_f32_32x32x16_bf16 v[240:255], v[60:63], v[112:115], v[240:255]
  ds_read_b64_tr_b16 v[60:61], v8 offset:6400
  ds_read_b64_tr_b16 v[62:63], v8 offset:7936
  s_waitcnt vmcnt(10)
  s_barrier
  s_mov_b32 s45, 24576
  s_waitcnt lgkmcnt(6)
  v_mfma_f32_32x32x16_bf16 v[160:175], v[40:43], v[116:119], v[160:175]
  ds_read_b128 v[112:115], v9 offset:32768
  ds_read_b64_tr_b16 v[40:41], v7 offset:20480
  ds_read_b64_tr_b16 v[42:43], v7 offset:22016
  s_add_u32 m0, s32, 81920
  s_nop 0
  buffer_load_dwordx4 v11, s[4:7], s45 offen offset:0 nt lds
  buffer_load_dwordx4 v12, s[4:7], s45 offen offset:1024 nt lds
  v_mfma_f32_32x32x16_bf16 v[176:191], v[44:47], v[116:119], v[176:191]
  ds_read_b64_tr_b16 v[44:45], v8 offset:20480
  ds_read_b64_tr_b16 v[46:47], v8 offset:22016
  buffer_load_dwordx4 v13, s[4:7], s45 offen offset:2048 nt lds
  s_mov_b32 s44, 12288
  s_add_u32 m0, s32, 139264
  s_nop 0
  buffer_load_dwordx4 v14, s[8:11], s44 offen offset:0 nt lds
  v_mfma_f32_32x32x16_bf16 v[192:207], v[48:51], v[116:119], v[192:207]
  ds_read_b64_tr_b16 v[48:49], v7 offset:20608
  ds_read_b64_tr_b16 v[50:51], v7 offset:22144
  buffer_load_dwordx4 v15, s[8:11], s44 offen offset:1024 nt lds
  buffer_load_dwordx4 v16, s[8:11], s44 offen offset:2048 nt lds
  s_waitcnt lgkmcnt(7)
  v_mfma_f32_32x32x16_bf16 v[208:223], v[52:55], v[116:119], v[208:223]
  ds_read_b64_tr_b16 v[52:53], v8 offset:20608
  ds_read_b64_tr_b16 v[54:55], v8 offset:22144
  v_mfma_f32_32x32x16_bf16 v[224:239], v[56:59], v[116:119], v[224:239]
  ds_read_b64_tr_b16 v[56:57], v7 offset:20736
  ds_read_b64_tr_b16 v[58:59], v7 offset:22272
  v_mfma_f32_32x32x16_bf16 v[240:255], v[60:63], v[116:119], v[240:255]
  ds_read_b64_tr_b16 v[60:61], v8 offset:20736
  ds_read_b64_tr_b16 v[62:63], v8 offset:22272
  s_waitcnt lgkmcnt(6)
  v_mfma_f32_32x32x16_bf16 v[160:175], v[40:43], v[112:115], v[160:175]
  ds_read_b128 v[116:119], v10 offset:32768
  ds_read_b64_tr_b16 v[40:41], v7 offset:26624
  ds_read_b64_tr_b16 v[42:43], v7 offset:28160
  v_mfma_f32_32x32x16_bf16 v[176:191], v[44:47], v[112:115], v[176:191]
  ds_read_b64_tr_b16 v[44:45], v8 offset:26624
  ds_read_b64_tr_b16 v[46:47], v8 offset:28160
  v_mfma_f32_32x32x16_bf16 v[192:207], v[48:51], v[112:115], v[192:207]
  ds_read_b64_tr_b16 v[48:49], v7 offset:26752
  ds_read_b64_tr_b16 v[50:51], v7 offset:28288
  s_waitcnt lgkmcnt(7)
  v_mfma_f32_32x32x16_bf16 v[208:223], v[52:55], v[112:115], v[208:223]
  ds_read_b64_tr_b16 v[52:53], v8 offset:26752
  ds_read_b64_tr_b16 v[54:55], v8 offset:28288
  v_mfma_f32_32x32x16_bf16 v[224:239], v[56:59], v[112:115], v[224:239]
  ds_read_b64_tr_b16 v[56:57], v7 offset:26880
  ds_read_b64_tr_b16 v[58:59], v7 offset:28416
  v_mfma_f32_32x32x16_bf16 v[240:255], v[60:63], v[112:115], v[240:255]
  ds_read_b64_tr_b16 v[60:61], v8 offset:26880
  ds_read_b64_tr_b16 v[62:63], v8 offset:28416
  s_waitcnt vmcnt(11)
  s_barrier
  s_waitcnt lgkmcnt(6)
  v_mfma_f32_32x32x16_bf16 v[160:175], v[40:43], v[116:119], v[160:175]
  ds_read_b128 v[112:115], v130 offset:4096
  ds_read_b64_tr_b16 v[40:41], v7 offset:40960
  ds_read_b64_tr_b16 v[42:43], v7 offset:42496
  v_mfma_f32_32x32x16_bf16 v[176:191], v[44:47], v[116:119], v[176:191]
  ds_read_b64_tr_b16 v[44:45], v8 offset:40960
  ds_read_b64_tr_b16 v[46:47], v8 offset:42496
  v_mfma_f32_32x32x16_bf16 v[192:207], v[48:51], v[116:119], v[192:207]
  ds_read_b64_tr_b16 v[48:49], v7 offset:41088
  ds_read_b64_tr_b16 v[50:51], v7 offset:42624
  s_waitcnt lgkmcnt(7)
  v_mfma_f32_32x32x16_bf16 v[208:223], v[52:55], v[116:119], v[208:223]
  ds_read_b64_tr_b16 v[52:53], v8 offset:41088
  ds_read_b64_tr_b16 v[54:55], v8 offset:42624
  v_mfma_f32_32x32x16_bf16 v[224:239], v[56:59], v[116:119], v[224:239]
  ds_read_b64_tr_b16 v[56:57], v7 offset:41216
  ds_read_b64_tr_b16 v[58:59], v7 offset:42752
  v_mfma_f32_32x32x16_bf16 v[240:255], v[60:63], v[116:119], v[240:255]
  ds_read_b64_tr_b16 v[60:61], v8 offset:41216
  ds_read_b64_tr_b16 v[62:63], v8 offset:42752
  s_waitcnt lgkmcnt(6)
  v_mfma_f32_32x32x16_bf16 v[160:175], v[40:43], v[112:115], v[160:175]
  ds_read_b128 v[116:119], v131 offset:4096
  ds_read_b64_tr_b16 v[40:41], v7 offset:47104
  ds_read_b64_tr_b16 v[42:43], v7 offset:48640
  v_mfma_f32_32x32x16_bf16 v[176:191], v[44:47], v[112:115], v[176:191]
  ds_read_b64_tr_b16 v[44:45], v8 offset:47104
  ds_read_b64_tr_b16 v[46:47], v8 offset:48640
  v_mfma_f32_32x32x16_bf16 v[192:207], v[48:51], v[112:115], v[192:207]
  ds_read_b64_tr_b16 v[48:49], v7 offset:47232
  ds_read_b64_tr_b16 v[50:51], v7 offset:48768
  s_waitcnt lgkmcnt(7)
  v_mfma_f32_32x32x16_bf16 v[208:223], v[52:55], v[112:115], v[208:223]
  ds_read_b64_tr_b16 v[52:53], v8 offset:47232
  ds_read_b64_tr_b16 v[54:55], v8 offset:48768
  v_mfma_f32_32x32x16_bf16 v[224:239], v[56:59], v[112:115], v[224:239]
  ds_read_b64_tr_b16 v[56:57], v7 offset:47360
  ds_read_b64_tr_b16 v[58:59], v7 offset:48896
  v_mfma_f32_32x32x16_bf16 v[240:255], v[60:63], v[112:115], v[240:255]
  ds_read_b64_tr_b16 v[60:61], v8 offset:47360
  ds_read_b64_tr_b16 v[62:63], v8 offset:48896
  s_waitcnt vmcnt(6)
  s_barrier
  s_mov_b32 s45, 7471104
  s_waitcnt lgkmcnt(6)
  v_mfma_f32_32x32x16_bf16 v[160:175], v[40:43], v[116:119], v[160:175]
  ds_read_b128 v[112:115], v130 offset:24576
  ds_read_b64_tr_b16 v[40:41], v128 offset:12288
  ds_read_b64_tr_b16 v[42:43], v128 offset:13824
  s_add_u32 m0, s32, 0
  s_nop 0
  buffer_load_dwordx4 v17, s[12:15], s45 offen offset:0 nt lds
  buffer_load_dwordx4 v18, s[12:15], s45 offen offset:1024 nt lds
  v_mfma_f32_32x32x16_bf16 v[176:191], v[44:47], v[116:119], v[176:191]
  ds_read_b64_tr_b16 v[44:45], v129 offset:12288
  ds_read_b64_tr_b16 v[46:47], v129 offset:13824
  buffer_load_dwordx4 v19, s[12:15], s45 offen offset:2048 nt lds
  s_mov_b32 s44, 1216
  s_add_u32 m0, s33, 12288
  s_nop 0
  buffer_load_dwordx4 v20, s[16:19], s44 offen offset:0 lds
  v_mfma_f32_32x32x16_bf16 v[192:207], v[48:51], v[116:119], v[192:207]
  ds_read_b64_tr_b16 v[48:49], v128 offset:12416
  ds_read_b64_tr_b16 v[50:51], v128 offset:13952
  buffer_load_dwordx4 v21, s[16:19], s44 offen offset:1024 lds
  s_waitcnt lgkmcnt(7)
  v_mfma_f32_32x32x16_bf16 v[208:223], v[52:55], v[116:119], v[208:223]
  ds_read_b64_tr_b16 v[52:53], v129 offset:12416
  ds_read_b64_tr_b16 v[54:55], v129 offset:13952
  v_mfma_f32_32x32x16_bf16 v[224:239], v[56:59], v[116:119], v[224:239]
  ds_read_b64_tr_b16 v[56:57], v128 offset:12544
  ds_read_b64_tr_b16 v[58:59], v128 offset:14080
  v_mfma_f32_32x32x16_bf16 v[240:255], v[60:63], v[116:119], v[240:255]
  ds_read_b64_tr_b16 v[60:61], v129 offset:12544
  ds_read_b64_tr_b16 v[62:63], v129 offset:14080
  s_waitcnt lgkmcnt(6)
  v_mfma_f32_32x32x16_bf16 v[160:175], v[40:43], v[112:115], v[160:175]
  ds_read_b128 v[116:119], v131 offset:24576
  ds_read_b64_tr_b16 v[40:41], v128 offset:18432
  ds_read_b64_tr_b16 v[42:43], v128 offset:19968
  v_mfma_f32_32x32x16_bf16 v[176:191], v[44:47], v[112:115], v[176:191]
  ds_read_b64_tr_b16 v[44:45], v129 offset:18432
  ds_read_b64_tr_b16 v[46:47], v129 offset:19968
  v_mfma_f32_32x32x16_bf16 v[192:207], v[48:51], v[112:115], v[192:207]
  ds_read_b64_tr_b16 v[48:49], v128 offset:18560
  ds_read_b64_tr_b16 v[50:51], v128 offset:20096
  s_waitcnt lgkmcnt(7)
  v_mfma_f32_32x32x16_bf16 v[208:223], v[52:55], v[112:115], v[208:223]
  ds_read_b64_tr_b16 v[52:53], v129 offset:18560
  ds_read_b64_tr_b16 v[54:55], v129 offset:20096
  v_mfma_f32_32x32x16_bf16 v[224:239], v[56:59], v[112:115], v[224:239]
  ds_read_b64_tr_b16 v[56:57], v128 offset:18688
  ds_read_b64_tr_b16 v[58:59], v128 offset:20224
  v_mfma_f32_32x32x16_bf16 v[240:255], v[60:63], v[112:115], v[240:255]
  ds_read_b64_tr_b16 v[60:61], v129 offset:18688
  ds_read_b64_tr_b16 v[62:63], v129 offset:20224
  s_waitcnt vmcnt(0)
  s_barrier
  s_mov_b32 s45, 384
  s_waitcnt lgkmcnt(6)
  v_mfma_f32_32x32x16_bf16 v[160:175], v[40:43], v[116:119], v[160:175]
  ds_read_b128 v[112:115], v9 offset:12288
  ds_read_b64_tr_b16 v[40:41], v7 offset:0
  ds_read_b64_tr_b16 v[42:43], v7 offset:1536
  s_add_u32 m0, s32, 20480
  s_nop 0
  buffer_load_dwordx4 v17, s[12:15], s45 offen offset:0 nt lds
  buffer_load_dwordx4 v18, s[12:15], s45 offen offset:1024 nt lds
  v_mfma_f32_32x32x16_bf16 v[176:191], v[44:47], v[116:119], v[176:191]
  ds_read_b64_tr_b16 v[44:45], v8 offset:0
  ds_read_b64_tr_b16 v[46:47], v8 offset:1536
  buffer_load_dwordx4 v19, s[12:15], s45 offen offset:2048 nt lds
  s_mov_b32 s44, 0
  s_add_u32 m0, s33, 32768
  s_nop 0
  buffer_load_dwordx4 v20, s[16:19], s44 offen offset:0 lds
  v_mfma_f32_32x32x16_bf16 v[192:207], v[48:51], v[116:119], v[192:207]
  ds_read_b64_tr_b16 v[48:49], v7 offset:128
  ds_read_b64_tr_b16 v[50:51], v7 offset:1664
  buffer_load_dwordx4 v21, s[16:19], s44 offen offset:1024 lds
  s_waitcnt lgkmcnt(7)
  v_mfma_f32_32x32x16_bf16 v[208:223], v[52:55], v[116:119], v[208:223]
  ds_read_b64_tr_b16 v[52:53], v8 offset:128
  ds_read_b64_tr_b16 v[54:55], v8 offset:1664
  v_mfma_f32_32x32x16_bf16 v[224:239], v[56:59], v[116:119], v[224:239]
  ds_read_b64_tr_b16 v[56:57], v7 offset:256
  ds_read_b64_tr_b16 v[58:59], v7 offset:1792
  v_mfma_f32_32x32x16_bf16 v[240:255], v[60:63], v[116:119], v[240:255]
  ds_read_b64_tr_b16 v[60:61], v8 offset:256
  ds_read_b64_tr_b16 v[62:63], v8 offset:1792
  s_waitcnt lgkmcnt(6)
  v_mfma_f32_32x32x16_bf16 v[160:175], v[40:43], v[112:115], v[160:175]
  ds_read_b128 v[116:119], v10 offset:12288
  ds_read_b64_tr_b16 v[40:41], v7 offset:6144
  ds_read_b64_tr_b16 v[42:43], v7 offset:7680
  v_mfma_f32_32x32x16_bf16 v[176:191], v[44:47], v[112:115], v[176:191]
  ds_read_b64_tr_b16 v[44:45], v8 offset:6144
  ds_read_b64_tr_b16 v[46:47], v8 offset:7680
  v_mfma_f32_32x32x16_bf16 v[192:207], v[48:51], v[112:115], v[192:207]
  ds_read_b64_tr_b16 v[48:49], v7 offset:6272
  ds_read_b64_tr_b16 v[50:51], v7 offset:7808
  s_waitcnt lgkmcnt(7)
  v_mfma_f32_32x32x16_bf16 v[208:223], v[52:55], v[112:115], v[208:223]
  ds_read_b64_tr_b16 v[52:53], v8 offset:6272
  ds_read_b64_tr_b16 v[54:55], v8 offset:7808
  v_mfma_f32_32x32x16_bf16 v[224:239], v[56:59], v[112:115], v[224:239]
  ds_read_b64_tr_b16 v[56:57], v7 offset:6400
  ds_read_b64_tr_b16 v[58:59], v7 offset:7936
  v_mfma_f32_32x32x16_bf16 v[240:255], v[60:63], v[112:115], v[240:255]
  ds_read_b64_tr_b16 v[60:61], v8 offset:6400
  ds_read_b64_tr_b16 v[62:63], v8 offset:7936
  s_waitcnt vmcnt(63)
  s_barrier
  s_mov_b32 s45, 393600
  s_waitcnt lgkmcnt(6)
  v_mfma_f32_32x32x16_bf16 v[160:175], v[40:43], v[116:119], v[160:175]
  ds_read_b128 v[40:43], v1 offset:36864
  s_add_u32 m0, s32, 40960
  s_nop 0
  buffer_load_dwordx4 v17, s[12:15], s45 offen offset:0 nt lds
  buffer_load_dwordx4 v18, s[12:15], s45 offen offset:1024 nt lds
  buffer_load_dwordx4 v19, s[12:15], s45 offen offset:2048 nt lds
  s_mov_b32 s44, 64
  v_mfma_f32_32x32x16_bf16 v[176:191], v[44:47], v[116:119], v[176:191]
  ds_read_b128 v[44:47], v2 offset:36864
  s_add_u32 m0, s33, 53248
  s_nop 0
  buffer_load_dwordx4 v20, s[16:19], s44 offen offset:0 lds
  buffer_load_dwordx4 v21, s[16:19], s44 offen offset:1024 lds
  s_mov_b32 s45, 36864
  s_add_u32 m0, s32, 65536
  v_mfma_f32_32x32x16_bf16 v[192:207], v[48:51], v[116:119], v[192:207]
  ds_read_b128 v[48:51], v3 offset:36864
  buffer_load_dwordx4 v11, s[4:7], s45 offen offset:0 nt lds
  buffer_load_dwordx4 v12, s[4:7], s45 offen offset:1024 nt lds
  buffer_load_dwordx4 v13, s[4:7], s45 offen offset:2048 nt lds
  s_waitcnt lgkmcnt(3)
  v_mfma_f32_32x32x16_bf16 v[208:223], v[52:55], v[116:119], v[208:223]
  ds_read_b128 v[52:55], v4 offset:36864
  v_mfma_f32_32x32x16_bf16 v[224:239], v[56:59], v[116:119], v[224:239]
  ds_read_b128 v[56:59], v1 offset:36992
  v_mfma_f32_32x32x16_bf16 v[240:255], v[60:63], v[116:119], v[240:255]
  ds_read_b128 v[60:63], v2 offset:36992
  v_mul_f32 v32, s31, v160
  v_mul_f32 v33, s31, v161
  v_cvt_pk_bf16_f32 v32, v32, v33
  v_accvgpr_write_b32 a0, v32
  v_mul_f32 v34, s31, v162
  v_mul_f32 v35, s31, v163
  v_cvt_pk_bf16_f32 v34, v34, v35
  v_accvgpr_write_b32 a1, v34
  v_mul_f32 v36, s31, v164
  v_mul_f32 v37, s31, v165
  v_cvt_pk_bf16_f32 v36, v36, v37
  v_accvgpr_write_b32 a2, v36
  v_mul_f32 v32, s31, v166
  v_mul_f32 v33, s31, v167
  v_cvt_pk_bf16_f32 v32, v32, v33
  v_accvgpr_write_b32 a3, v32
  v_mul_f32 v34, s31, v168
  v_mul_f32 v35, s31, v169
  v_cvt_pk_bf16_f32 v34, v34, v35
  v_accvgpr_write_b32 a4, v34
  v_mul_f32 v36, s31, v170
  v_mul_f32 v37, s31, v171
  v_cvt_pk_bf16_f32 v36, v36, v37
  v_accvgpr_write_b32 a5, v36
  v_mul_f32 v32, s31, v172
  v_mul_f32 v33, s31, v173
  v_cvt_pk_bf16_f32 v32, v32, v33
  v_accvgpr_write_b32 a6, v32
  v_mul_f32 v34, s31, v174
  v_mul_f32 v35, s31, v175
  v_cvt_pk_bf16_f32 v34, v34, v35
  v_accvgpr_write_b32 a7, v34
  s_waitcnt lgkmcnt(3)
  v_mfma_f32_32x32x16_bf16 v[64:79], v[40:43], a[0:3], 0
  ds_read_b128 v[40:43], v3 offset:36992
  v_mfma_f32_32x32x16_bf16 v[64:79], v[44:47], a[4:7], v[64:79]
  ds_read_b128 v[44:47], v4 offset:36992
  v_mul_f32 v32, s31, v176
  v_mul_f32 v33, s31, v177
  v_cvt_pk_bf16_f32 v32, v32, v33
  v_accvgpr_write_b32 a8, v32
  v_mul_f32 v34, s31, v178
  v_mul_f32 v35, s31, v179
  v_cvt_pk_bf16_f32 v34, v34, v35
  v_accvgpr_write_b32 a9, v34
  v_mul_f32 v36, s31, v180
  v_mul_f32 v37, s31, v181
  v_cvt_pk_bf16_f32 v36, v36, v37
  v_accvgpr_write_b32 a10, v36
  v_mul_f32 v32, s31, v182
  v_mul_f32 v33, s31, v183
  v_cvt_pk_bf16_f32 v32, v32, v33
  v_accvgpr_write_b32 a11, v32
  v_mul_f32 v34, s31, v184
  v_mul_f32 v35, s31, v185
  v_cvt_pk_bf16_f32 v34, v34, v35
  v_accvgpr_write_b32 a12, v34
  v_mul_f32 v36, s31, v186
  v_mul_f32 v37, s31, v187
  v_cvt_pk_bf16_f32 v36, v36, v37
  v_accvgpr_write_b32 a13, v36
  v_mul_f32 v32, s31, v188
  v_mul_f32 v33, s31, v189
  v_cvt_pk_bf16_f32 v32, v32, v33
  v_accvgpr_write_b32 a14, v32
  v_mul_f32 v34, s31, v190
  v_mul_f32 v35, s31, v191
  v_cvt_pk_bf16_f32 v34, v34, v35
  v_accvgpr_write_b32 a15, v34
  v_mfma_f32_32x32x16_bf16 v[64:79], v[48:51], a[8:11], v[64:79]
  ds_read_b128 v[48:51], v1 offset:37120
  s_waitcnt lgkmcnt(3)
  v_mfma_f32_32x32x16_bf16 v[64:79], v[52:55], a[12:15], v[64:79]
  ds_read_b128 v[52:55], v2 offset:37120
  v_mul_f32 v32, s31, v192
  v_mul_f32 v33, s31, v193
  v_cvt_pk_bf16_f32 v32, v32, v33
  v_accvgpr_write_b32 a16, v32
  v_mul_f32 v34, s31, v194
  v_mul_f32 v35, s31, v195
  v_cvt_pk_bf16_f32 v34, v34, v35
  v_accvgpr_write_b32 a17, v34
  v_mul_f32 v36, s31, v196
  v_mul_f32 v37, s31, v197
  v_cvt_pk_bf16_f32 v36, v36, v37
  v_accvgpr_write_b32 a18, v36
  v_mul_f32 v32, s31, v198
  v_mul_f32 v33, s31, v199
  v_cvt_pk_bf16_f32 v32, v32, v33
  v_accvgpr_write_b32 a19, v32
  v_mul_f32 v34, s31, v200
  v_mul_f32 v35, s31, v201
  v_cvt_pk_bf16_f32 v34, v34, v35
  v_accvgpr_write_b32 a20, v34
  v_mul_f32 v36, s31, v202
  v_mul_f32 v37, s31, v203
  v_cvt_pk_bf16_f32 v36, v36, v37
  v_accvgpr_write_b32 a21, v36
  v_mul_f32 v32, s31, v204
  v_mul_f32 v33, s31, v205
  v_cvt_pk_bf16_f32 v32, v32, v33
  v_accvgpr_write_b32 a22, v32
  v_mul_f32 v34, s31, v206
  v_mul_f32 v35, s31, v207
  v_cvt_pk_bf16_f32 v34, v34, v35
  v_accvgpr_write_b32 a23, v34
  v_mfma_f32_32x32x16_bf16 v[64:79], v[56:59], a[16:19], v[64:79]
  ds_read_b128 v[56:59], v3 offset:37120
  v_mfma_f32_32x32x16_bf16 v[64:79], v[60:63], a[20:23], v[64:79]
  ds_read_b128 v[60:63], v4 offset:37120
  s_waitcnt vmcnt(63)
  s_barrier
  s_mov_b32 s44, 786816
  s_add_u32 m0, s32, 0
  v_mul_f32 v32, s31, v208
  v_mul_f32 v33, s31, v209
  v_cvt_pk_bf16_f32 v32, v32, v33
  v_accvgpr_write_b32 a24, v32
  v_mul_f32 v34, s31, v210
  v_mul_f32 v35, s31, v211
  v_cvt_pk_bf16_f32 v34, v34, v35
  v_accvgpr_write_b32 a25, v34
  v_mul_f32 v36, s31, v212
  v_mul_f32 v37, s31, v213
  v_cvt_pk_bf16_f32 v36, v36, v37
  v_accvgpr_write_b32 a26, v36
  v_mul_f32 v32, s31, v214
  v_mul_f32 v33, s31, v215
  v_cvt_pk_bf16_f32 v32, v32, v33
  v_accvgpr_write_b32 a27, v32
  v_mul_f32 v34, s31, v216
  v_mul_f32 v35, s31, v217
  v_cvt_pk_bf16_f32 v34, v34, v35
  v_accvgpr_write_b32 a28, v34
  v_mul_f32 v36, s31, v218
  v_mul_f32 v37, s31, v219
  v_cvt_pk_bf16_f32 v36, v36, v37
  v_accvgpr_write_b32 a29, v36
  v_mul_f32 v32, s31, v220
  v_mul_f32 v33, s31, v221
  v_cvt_pk_bf16_f32 v32, v32, v33
  v_accvgpr_write_b32 a30, v32
  v_mul_f32 v34, s31, v222
  v_mul_f32 v35, s31, v223
  v_cvt_pk_bf16_f32 v34, v34, v35
  v_accvgpr_write_b32 a31, v34
  s_waitcnt lgkmcnt(3)
  v_mfma_f32_32x32x16_bf16 v[64:79], v[40:43], a[24:27], v[64:79]
  ds_read_b128 v[40:43], v1 offset:49152
  buffer_load_dwordx4 v17, s[12:15], s44 offen offset:0 nt lds
  buffer_load_dwordx4 v18, s[12:15], s44 offen offset:1024 nt lds
  buffer_load_dwordx4 v19, s[12:15], s44 offen offset:2048 nt lds
  s_mov_b32 s45, 128
  s_add_u32 m0, s33, 12288
  v_mfma_f32_32x32x16_bf16 v[64:79], v[44:47], a[28:31], v[64:79]
  ds_read_b128 v[44:47], v2 offset:49152
  buffer_load_dwordx4 v20, s[16:19], s45 offen offset:0 lds
  buffer_load_dwordx4 v21, s[16:19], s45 offen offset:1024 lds
  s_mov_b32 s44, 24576
  s_add_u32 m0, s32, 126976
  s_nop 0
  buffer_load_dwordx4 v14, s[8:11], s44 offen offset:0 nt lds
  v_mul_f32 v32, s31, v224
  v_mul_f32 v33, s31, v225
  v_cvt_pk_bf16_f32 v32, v32, v33
  v_accvgpr_write_b32 a32, v32
  v_mul_f32 v34, s31, v226
  v_mul_f32 v35, s31, v227
  v_cvt_pk_bf16_f32 v34, v34, v35
  v_accvgpr_write_b32 a33, v34
  v_mul_f32 v36, s31, v228
  v_mul_f32 v37, s31, v229
  v_cvt_pk_bf16_f32 v36, v36, v37
  v_accvgpr_write_b32 a34, v36
  v_mul_f32 v32, s31, v230
  v_mul_f32 v33, s31, v231
  v_cvt_pk_bf16_f32 v32, v32, v33
  v_accvgpr_write_b32 a35, v32
  v_mul_f32 v34, s31, v232
  v_mul_f32 v35, s31, v233
  v_cvt_pk_bf16_f32 v34, v34, v35
  v_accvgpr_write_b32 a36, v34
  v_mul_f32 v36, s31, v234
  v_mul_f32 v37, s31, v235
  v_cvt_pk_bf16_f32 v36, v36, v37
  v_accvgpr_write_b32 a37, v36
  v_mul_f32 v32, s31, v236
  v_mul_f32 v33, s31, v237
  v_cvt_pk_bf16_f32 v32, v32, v33
  v_accvgpr_write_b32 a38, v32
  v_mul_f32 v34, s31, v238
  v_mul_f32 v35, s31, v239
  v_cvt_pk_bf16_f32 v34, v34, v35
  v_accvgpr_write_b32 a39, v34
  v_mfma_f32_32x32x16_bf16 v[64:79], v[48:51], a[32:35], v[64:79]
  ds_read_b128 v[48:51], v3 offset:49152
  buffer_load_dwordx4 v15, s[8:11], s44 offen offset:1024 nt lds
  buffer_load_dwordx4 v16, s[8:11], s44 offen offset:2048 nt lds
  s_waitcnt lgkmcnt(3)
  v_mfma_f32_32x32x16_bf16 v[64:79], v[52:55], a[36:39], v[64:79]
  ds_read_b128 v[52:55], v4 offset:49152
  v_mul_f32 v32, s31, v240
  v_mul_f32 v33, s31, v241
  v_cvt_pk_bf16_f32 v32, v32, v33
  v_accvgpr_write_b32 a40, v32
  v_mul_f32 v34, s31, v242
  v_mul_f32 v35, s31, v243
  v_cvt_pk_bf16_f32 v34, v34, v35
  v_accvgpr_write_b32 a41, v34
  v_mul_f32 v36, s31, v244
  v_mul_f32 v37, s31, v245
  v_cvt_pk_bf16_f32 v36, v36, v37
  v_accvgpr_write_b32 a42, v36
  v_mul_f32 v32, s31, v246
  v_mul_f32 v33, s31, v247
  v_cvt_pk_bf16_f32 v32, v32, v33
  v_accvgpr_write_b32 a43, v32
  v_mul_f32 v34, s31, v248
  v_mul_f32 v35, s31, v249
  v_cvt_pk_bf16_f32 v34, v34, v35
  v_accvgpr_write_b32 a44, v34
  v_mul_f32 v36, s31, v250
  v_mul_f32 v37, s31, v251
  v_cvt_pk_bf16_f32 v36, v36, v37
  v_accvgpr_write_b32 a45, v36
  v_mul_f32 v32, s31, v252
  v_mul_f32 v33, s31, v253
  v_cvt_pk_bf16_f32 v32, v32, v33
  v_accvgpr_write_b32 a46, v32
  v_mul_f32 v34, s31, v254
  v_mul_f32 v35, s31, v255
  v_cvt_pk_bf16_f32 v34, v34, v35
  v_accvgpr_write_b32 a47, v34
  v_mfma_f32_32x32x16_bf16 v[64:79], v[56:59], a[40:43], v[64:79]
  ds_read_b128 v[56:59], v1 offset:49280
  v_mfma_f32_32x32x16_bf16 v[64:79], v[60:63], a[44:47], v[64:79]
  ds_read_b128 v[60:63], v2 offset:49280
  s_waitcnt lgkmcnt(3)
  v_mfma_f32_32x32x16_bf16 v[80:95], v[40:43], a[0:3], 0
  ds_read_b128 v[40:43], v3 offset:49280
  v_mfma_f32_32x32x16_bf16 v[80:95], v[44:47], a[4:7], v[80:95]
  ds_read_b128 v[44:47], v4 offset:49280
  s_nop 5
  v_max3_f32 v28, v64, v65, v66
  v_max3_f32 v29, v67, v68, v69
  v_max3_f32 v28, v28, v70, v71
  v_max3_f32 v29, v29, v72, v73
  v_max3_f32 v28, v28, v74, v75
  v_mfma_f32_32x32x16_bf16 v[80:95], v[48:51], a[8:11], v[80:95]
  ds_read_b128 v[48:51], v1 offset:49408
  v_max3_f32 v29, v29, v76, v77
  v_max3_f32 v28, v28, v78, v79
  v_max_f32 v28, v28, v29
  v_mov_b32 v29, v28
  s_waitcnt lgkmcnt(3)
  v_mfma_f32_32x32x16_bf16 v[80:95], v[52:55], a[12:15], v[80:95]
  ds_read_b128 v[52:55], v2 offset:49408
  v_mov_b32 v22, 0
  v_mov_b32 v23, 0
  v_permlane32_swap_b32 v28, v29
  v_max3_f32 v28, v28, v29, v127
  v_sub_f32 v96, 0, v28
  v_mfma_f32_32x32x16_bf16 v[80:95], v[56:59], a[16:19], v[80:95]
  ds_read_b128 v[56:59], v3 offset:49408
  v_sub_f32 v97, 0, v28
  v_sub_f32 v98, 0, v28
  v_sub_f32 v99, 0, v28
  v_sub_f32 v100, 0, v28
  v_sub_f32 v101, 0, v28
  v_mfma_f32_32x32x16_bf16 v[80:95], v[60:63], a[20:23], v[80:95]
  ds_read_b128 v[60:63], v4 offset:49408
  s_waitcnt vmcnt(16)
  s_barrier
  s_mov_b32 s45, 36864
  s_add_u32 m0, s32, 102400
  s_waitcnt lgkmcnt(3)
  v_mfma_f32_32x32x16_bf16 v[80:95], v[40:43], a[24:27], v[80:95]
  ds_read_b128 v[112:115], v9 offset:32768
  ds_read_b64_tr_b16 v[40:41], v7 offset:20480
  ds_read_b64_tr_b16 v[42:43], v7 offset:22016
  buffer_load_dwordx4 v14, s[8:11], s45 offen offset:0 nt lds
  buffer_load_dwordx4 v15, s[8:11], s45 offen offset:1024 nt lds
  buffer_load_dwordx4 v16, s[8:11], s45 offen offset:2048 nt lds
  v_mfma_f32_32x32x16_bf16 v[80:95], v[44:47], a[28:31], v[80:95]
  ds_read_b64_tr_b16 v[44:45], v8 offset:20480
  ds_read_b64_tr_b16 v[46:47], v8 offset:22016
  v_sub_f32 v102, 0, v28
  v_sub_f32 v103, 0, v28
  v_sub_f32 v104, 0, v28
  v_sub_f32 v105, 0, v28
  v_mfma_f32_32x32x16_bf16 v[80:95], v[48:51], a[32:35], v[80:95]
  ds_read_b64_tr_b16 v[48:49], v7 offset:20608
  ds_read_b64_tr_b16 v[50:51], v7 offset:22144
  v_sub_f32 v106, 0, v28
  v_sub_f32 v107, 0, v28
  v_sub_f32 v108, 0, v28
  s_waitcnt lgkmcnt(7)
  v_mfma_f32_32x32x16_bf16 v[80:95], v[52:55], a[36:39], v[80:95]
  ds_read_b64_tr_b16 v[52:53], v8 offset:20608
  ds_read_b64_tr_b16 v[54:55], v8 offset:22144
  v_sub_f32 v109, 0, v28
  v_sub_f32 v110, 0, v28
  v_sub_f32 v111, 0, v28
  v_sub_f32 v64, v64, v28
  v_mfma_f32_32x32x16_bf16 v[80:95], v[56:59], a[40:43], v[80:95]
  ds_read_b64_tr_b16 v[56:57], v7 offset:20736
  ds_read_b64_tr_b16 v[58:59], v7 offset:22272
  v_sub_f32 v65, v65, v28
  v_sub_f32 v66, v66, v28
  v_sub_f32 v67, v67, v28
  v_sub_f32 v68, v68, v28
  v_mfma_f32_32x32x16_bf16 v[80:95], v[60:63], a[44:47], v[80:95]
  ds_read_b64_tr_b16 v[60:61], v8 offset:20736
  ds_read_b64_tr_b16 v[62:63], v8 offset:22272
  v_sub_f32 v69, v69, v28
  v_sub_f32 v70, v70, v28
  v_sub_f32 v71, v71, v28
  s_waitcnt lgkmcnt(6)
  v_mfma_f32_32x32x16_bf16 a[96:111], v[40:43], v[112:115], 0
  ds_read_b128 v[116:119], v10 offset:32768
  ds_read_b64_tr_b16 v[40:41], v7 offset:26624
  ds_read_b64_tr_b16 v[42:43], v7 offset:28160
  v_sub_f32 v72, v72, v28
  v_sub_f32 v73, v73, v28
  v_sub_f32 v74, v74, v28
  v_mfma_f32_32x32x16_bf16 a[112:127], v[44:47], v[112:115], 0
  ds_read_b64_tr_b16 v[44:45], v8 offset:26624
  ds_read_b64_tr_b16 v[46:47], v8 offset:28160
  v_sub_f32 v75, v75, v28
  v_sub_f32 v76, v76, v28
  v_sub_f32 v77, v77, v28
  v_sub_f32 v78, v78, v28
  v_mfma_f32_32x32x16_bf16 a[128:143], v[48:51], v[112:115], 0
  ds_read_b64_tr_b16 v[48:49], v7 offset:26752
  ds_read_b64_tr_b16 v[50:51], v7 offset:28288
  v_sub_f32 v79, v79, v28
  v_exp_f32 v64, v64
  s_waitcnt lgkmcnt(7)
  v_mfma_f32_32x32x16_bf16 a[144:159], v[52:55], v[112:115], 0
  ds_read_b64_tr_b16 v[52:53], v8 offset:26752
  ds_read_b64_tr_b16 v[54:55], v8 offset:28288
  v_exp_f32 v65, v65
  v_add_f32 v22, v22, v64
  v_mfma_f32_32x32x16_bf16 a[160:175], v[56:59], v[112:115], 0
  ds_read_b64_tr_b16 v[56:57], v7 offset:26880
  ds_read_b64_tr_b16 v[58:59], v7 offset:28416
  v_exp_f32 v66, v66
  v_add_f32 v23, v23, v65
  v_mfma_f32_32x32x16_bf16 a[176:191], v[60:63], v[112:115], 0
  ds_read_b64_tr_b16 v[60:61], v8 offset:26880
  ds_read_b64_tr_b16 v[62:63], v8 offset:28416
  s_waitcnt vmcnt(63)
  s_barrier
  s_mov_b32 s44, 49152
  s_waitcnt lgkmcnt(6)
  v_mfma_f32_32x32x16_bf16 a[96:111], v[40:43], v[116:119], a[96:111]
  ds_read_b64_tr_b16 v[40:41], v5 offset:49152
  ds_read_b64_tr_b16 v[42:43], v5 offset:52224
  s_add_u32 m0, s32, 114688
  s_nop 0
  buffer_load_dwordx4 v11, s[4:7], s44 offen offset:0 nt lds
  buffer_load_dwordx4 v12, s[4:7], s44 offen offset:1024 nt lds
  buffer_load_dwordx4 v13, s[4:7], s44 offen offset:2048 nt lds
  v_mfma_f32_32x32x16_bf16 a[112:127], v[44:47], v[116:119], a[112:127]
  ds_read_b64_tr_b16 v[44:45], v6 offset:49152
  ds_read_b64_tr_b16 v[46:47], v6 offset:52224
  v_exp_f32 v67, v67
  v_add_f32 v22, v22, v66
  v_mfma_f32_32x32x16_bf16 a[128:143], v[48:51], v[116:119], a[128:143]
  ds_read_b64_tr_b16 v[48:49], v5 offset:49280
  ds_read_b64_tr_b16 v[50:51], v5 offset:52352
  v_exp_f32 v68, v68
  v_add_f32 v23, v23, v67
  s_waitcnt lgkmcnt(6)
  v_mfma_f32_32x32x16_bf16 a[144:159], v[52:55], v[116:119], a[144:159]
  ds_read_b64_tr_b16 v[52:53], v6 offset:49280
  ds_read_b64_tr_b16 v[54:55], v6 offset:52352
  v_exp_f32 v69, v69
  v_add_f32 v22, v22, v68
  v_mfma_f32_32x32x16_bf16 a[160:175], v[56:59], v[116:119], a[160:175]
  ds_read_b64_tr_b16 v[56:57], v5 offset:49408
  ds_read_b64_tr_b16 v[58:59], v5 offset:52480
  v_exp_f32 v70, v70
  v_add_f32 v23, v23, v69
  v_mfma_f32_32x32x16_bf16 a[176:191], v[60:63], v[116:119], a[176:191]
  ds_read_b64_tr_b16 v[60:61], v6 offset:49408
  ds_read_b64_tr_b16 v[62:63], v6 offset:52480
  v_exp_f32 v71, v71
  v_add_f32 v22, v22, v70
  v_exp_f32 v72, v72
  v_add_f32 v23, v23, v71
  v_exp_f32 v73, v73
  v_add_f32 v22, v22, v72
  v_cvt_pk_bf16_f32 v64, v64, v65
  v_cvt_pk_bf16_f32 v65, v66, v67
  v_cvt_pk_bf16_f32 v66, v68, v69
  v_cvt_pk_bf16_f32 v67, v70, v71
  v_exp_f32 v74, v74
  v_add_f32 v23, v23, v73
  v_exp_f32 v75, v75
  v_add_f32 v22, v22, v74
  v_exp_f32 v76, v76
  v_add_f32 v23, v23, v75
  v_exp_f32 v77, v77
  v_add_f32 v22, v22, v76
  v_exp_f32 v78, v78
  v_add_f32 v23, v23, v77
  v_exp_f32 v79, v79
  v_add_f32 v22, v22, v78
  v_cvt_pk_bf16_f32 v72, v72, v73
  v_add_f32 v23, v23, v79
  v_cvt_pk_bf16_f32 v73, v74, v75
  v_cvt_pk_bf16_f32 v74, v76, v77
  v_cvt_pk_bf16_f32 v75, v78, v79
  s_waitcnt lgkmcnt(6)
  v_mfma_f32_32x32x16_bf16 v[160:175], v[40:43], v[64:67], 0
  ds_read_b64_tr_b16 v[40:41], v5 offset:55296
  ds_read_b64_tr_b16 v[42:43], v5 offset:58368
  v_add_f32 v80, v80, v96
  v_add_f32 v81, v81, v97
  v_add_f32 v82, v82, v98
  v_add_f32 v83, v83, v99
  v_mfma_f32_32x32x16_bf16 v[176:191], v[44:47], v[64:67], 0
  ds_read_b64_tr_b16 v[44:45], v6 offset:55296
  ds_read_b64_tr_b16 v[46:47], v6 offset:58368
  v_add_f32 v84, v84, v100
  v_add_f32 v85, v85, v101
  v_add_f32 v86, v86, v102
  v_add_f32 v87, v87, v103
  v_mfma_f32_32x32x16_bf16 v[192:207], v[48:51], v[64:67], 0
  ds_read_b64_tr_b16 v[48:49], v5 offset:55424
  ds_read_b64_tr_b16 v[50:51], v5 offset:58496
  v_add_f32 v88, v88, v104
  v_add_f32 v89, v89, v105
  v_add_f32 v90, v90, v106
  s_waitcnt lgkmcnt(6)
  v_mfma_f32_32x32x16_bf16 v[208:223], v[52:55], v[64:67], 0
  ds_read_b64_tr_b16 v[52:53], v6 offset:55424
  ds_read_b64_tr_b16 v[54:55], v6 offset:58496
  v_add_f32 v91, v91, v107
  v_add_f32 v92, v92, v108
  v_add_f32 v93, v93, v109
  v_add_f32 v94, v94, v110
  v_mfma_f32_32x32x16_bf16 v[224:239], v[56:59], v[64:67], 0
  ds_read_b64_tr_b16 v[56:57], v5 offset:55552
  ds_read_b64_tr_b16 v[58:59], v5 offset:58624
  v_add_f32 v95, v95, v111
  v_max3_f32 v28, v80, v81, v82
  v_max3_f32 v29, v83, v84, v85
  v_max3_f32 v28, v28, v86, v87
  v_mfma_f32_32x32x16_bf16 v[240:255], v[60:63], v[64:67], 0
  ds_read_b64_tr_b16 v[60:61], v6 offset:55552
  ds_read_b64_tr_b16 v[62:63], v6 offset:58624
  s_waitcnt vmcnt(17)
  s_barrier
  s_mov_b32 s45, 1180032
  s_waitcnt lgkmcnt(6)
  v_mfma_f32_32x32x16_bf16 v[160:175], v[40:43], v[72:75], v[160:175]
  ds_read_b128 v[112:115], v9 offset:53248
  ds_read_b64_tr_b16 v[40:41], v7 offset:40960
  ds_read_b64_tr_b16 v[42:43], v7 offset:42496
  s_add_u32 m0, s32, 20480
  s_nop 0
  buffer_load_dwordx4 v17, s[12:15], s45 offen offset:0 nt lds
  buffer_load_dwordx4 v18, s[12:15], s45 offen offset:1024 nt lds
  v_mfma_f32_32x32x16_bf16 v[176:191], v[44:47], v[72:75], v[176:191]
  ds_read_b64_tr_b16 v[44:45], v8 offset:40960
  ds_read_b64_tr_b16 v[46:47], v8 offset:42496
  buffer_load_dwordx4 v19, s[12:15], s45 offen offset:2048 nt lds
  s_mov_b32 s44, 192
  s_add_u32 m0, s33, 32768
  s_nop 0
  buffer_load_dwordx4 v20, s[16:19], s44 offen offset:0 lds
  v_mfma_f32_32x32x16_bf16 v[192:207], v[48:51], v[72:75], v[192:207]
  ds_read_b64_tr_b16 v[48:49], v7 offset:41088
  ds_read_b64_tr_b16 v[50:51], v7 offset:42624
  buffer_load_dwordx4 v21, s[16:19], s44 offen offset:1024 lds
  v_max3_f32 v29, v29, v88, v89
  v_max3_f32 v28, v28, v90, v91
  s_waitcnt lgkmcnt(7)
  v_mfma_f32_32x32x16_bf16 v[208:223], v[52:55], v[72:75], v[208:223]
  ds_read_b64_tr_b16 v[52:53], v8 offset:41088
  ds_read_b64_tr_b16 v[54:55], v8 offset:42624
  v_max3_f32 v29, v29, v92, v93
  v_max3_f32 v28, v28, v94, v95
  v_max_f32 v28, v28, v29
  v_mfma_f32_32x32x16_bf16 v[224:239], v[56:59], v[72:75], v[224:239]
  ds_read_b64_tr_b16 v[56:57], v7 offset:41216
  ds_read_b64_tr_b16 v[58:59], v7 offset:42752
  v_cmp_lt_f32 vcc, s43, v28
  s_cbranch_vccnz Lrare_1
Lback_2:
  v_exp_f32 v80, v80
  v_mfma_f32_32x32x16_bf16 v[240:255], v[60:63], v[72:75], v[240:255]
  ds_read_b64_tr_b16 v[60:61], v8 offset:41216
  ds_read_b64_tr_b16 v[62:63], v8 offset:42752
  v_exp_f32 v81, v81
  v_add_f32 v22, v22, v80
  s_waitcnt lgkmcnt(6)
  v_mfma_f32_32x32x16_bf16 a[96:111], v[40:43], v[112:115], a[96:111]
  ds_read_b128 v[116:119], v10 offset:53248
  ds_read_b64_tr_b16 v[40:41], v7 offset:47104
  ds_read_b64_tr_b16 v[42:43], v7 offset:48640
  v_exp_f32 v82, v82
  v_add_f32 v23, v23, v81
  v_mfma_f32_32x32x16_bf16 a[112:127], v[44:47], v[112:115], a[112:127]
  ds_read_b64_tr_b16 v[44:45], v8 offset:47104
  ds_read_b64_tr_b16 v[46:47], v8 offset:48640
  v_exp_f32 v83, v83
  v_add_f32 v22, v22, v82
  v_mfma_f32_32x32x16_bf16 a[128:143], v[48:51], v[112:115], a[128:143]
  ds_read_b64_tr_b16 v[48:49], v7 offset:47232
  ds_read_b64_tr_b16 v[50:51], v7 offset:48768
  v_exp_f32 v84, v84
  v_add_f32 v23, v23, v83
  s_waitcnt lgkmcnt(7)
  v_mfma_f32_32x32x16_bf16 a[144:159], v[52:55], v[112:115], a[144:159]
  ds_read_b64_tr_b16 v[52:53], v8 offset:47232
  ds_read_b64_tr_b16 v[54:55], v8 offset:48768
  v_exp_f32 v85, v85
  v_add_f32 v22, v22, v84
  v_mfma_f32_32x32x16_bf16 a[160:175], v[56:59], v[112:115], a[160:175]
  ds_read_b64_tr_b16 v[56:57], v7 offset:47360
  ds_read_b64_tr_b16 v[58:59], v7 offset:48896
  v_exp_f32 v86, v86
  v_add_f32 v23, v23, v85
  v_mfma_f32_32x32x16_bf16 a[176:191], v[60:63], v[112:115], a[176:191]
  ds_read_b64_tr_b16 v[60:61], v8 offset:47360
  ds_read_b64_tr_b16 v[62:63], v8 offset:48896
  s_waitcnt vmcnt(40)
  s_barrier
  s_waitcnt lgkmcnt(6)
  v_mfma_f32_32x32x16_bf16 a[96:111], v[40:43], v[116:119], a[96:111]
  ds_read_b128 v[40:43], v1 offset:16384
  v_exp_f32 v87, v87
  v_add_f32 v22, v22, v86
  v_exp_f32 v88, v88
  v_mfma_f32_32x32x16_bf16 a[112:127], v[44:47], v[116:119], a[112:127]
  ds_read_b128 v[44:47], v2 offset:16384
  v_add_f32 v23, v23, v87
  v_exp_f32 v89, v89
  v_add_f32 v22, v22, v88
  v_cvt_pk_bf16_f32 v80, v80, v81
  v_mfma_f32_32x32x16_bf16 a[128:143], v[48:51], v[116:119], a[128:143]
  ds_read_b128 v[48:51], v3 offset:16384
  v_cvt_pk_bf16_f32 v81, v82, v83
  v_cvt_pk_bf16_f32 v82, v84, v85
  v_cvt_pk_bf16_f32 v83, v86, v87
  s_waitcnt lgkmcnt(3)
  v_mfma_f32_32x32x16_bf16 a[144:159], v[52:55], v[116:119], a[144:159]
  ds_read_b128 v[52:55], v4 offset:16384
  v_exp_f32 v90, v90
  v_add_f32 v23, v23, v89
  v_exp_f32 v91, v91
  v_mfma_f32_32x32x16_bf16 a[160:175], v[56:59], v[116:119], a[160:175]
  ds_read_b128 v[56:59], v1 offset:16512
  v_add_f32 v22, v22, v90
  v_exp_f32 v92, v92
  v_add_f32 v23, v23, v91
  v_mfma_f32_32x32x16_bf16 a[176:191], v[60:63], v[116:119], a[176:191]
  ds_read_b128 v[60:63], v2 offset:16512
  v_exp_f32 v93, v93
  v_add_f32 v22, v22, v92
  s_waitcnt lgkmcnt(3)
  v_mfma_f32_32x32x16_bf16 v[64:79], v[40:43], a[0:3], v[96:111]
  ds_read_b128 v[40:43], v3 offset:16512
  v_exp_f32 v94, v94
  v_add_f32 v23, v23, v93
  v_exp_f32 v95, v95
  v_mfma_f32_32x32x16_bf16 v[64:79], v[44:47], a[4:7], v[64:79]
  ds_read_b128 v[44:47], v4 offset:16512
  v_add_f32 v22, v22, v94
  v_cvt_pk_bf16_f32 v88, v88, v89
  v_add_f32 v23, v23, v95
  v_cvt_pk_bf16_f32 v89, v90, v91
  v_cvt_pk_bf16_f32 v90, v92, v93
  v_mfma_f32_32x32x16_bf16 v[64:79], v[48:51], a[8:11], v[64:79]
  ds_read_b128 v[48:51], v1 offset:16640
  v_cvt_pk_bf16_f32 v91, v94, v95
  s_waitcnt lgkmcnt(3)
  v_mfma_f32_32x32x16_bf16 v[64:79], v[52:55], a[12:15], v[64:79]
  ds_read_b128 v[52:55], v2 offset:16640
  v_mfma_f32_32x32x16_bf16 v[64:79], v[56:59], a[16:19], v[64:79]
  ds_read_b128 v[56:59], v3 offset:16640
  v_mfma_f32_32x32x16_bf16 v[64:79], v[60:63], a[20:23], v[64:79]
  ds_read_b128 v[60:63], v4 offset:16640
  s_waitcnt vmcnt(14)
  s_barrier
  s_mov_b32 s45, 1573248
  s_add_u32 m0, s32, 40960
  s_waitcnt lgkmcnt(3)
  v_mfma_f32_32x32x16_bf16 v[64:79], v[40:43], a[24:27], v[64:79]
  ds_read_b128 v[112:115], v9 offset:12288
  ds_read_b64_tr_b16 v[40:41], v7 offset:0
  ds_read_b64_tr_b16 v[42:43], v7 offset:1536
  buffer_load_dwordx4 v17, s[12:15], s45 offen offset:0 nt lds
  buffer_load_dwordx4 v18, s[12:15], s45 offen offset:1024 nt lds
  buffer_load_dwordx4 v19, s[12:15], s45 offen offset:2048 nt lds
  v_mfma_f32_32x32x16_bf16 v[64:79], v[44:47], a[28:31], v[64:79]
  ds_read_b64_tr_b16 v[44:45], v8 offset:0
  ds_read_b64_tr_b16 v[46:47], v8 offset:1536
  s_mov_b32 s44, 256
  s_add_u32 m0, s33, 53248
  s_nop 0
  buffer_load_dwordx4 v20, s[16:19], s44 offen offset:0 lds
  buffer_load_dwordx4 v21, s[16:19], s44 offen offset:1024 lds
  v_mfma_f32_32x32x16_bf16 v[64:79], v[48:51], a[32:35], v[64:79]
  ds_read_b64_tr_b16 v[48:49], v7 offset:128
  ds_read_b64_tr_b16 v[50:51], v7 offset:1664
  s_waitcnt lgkmcnt(7)
  v_mfma_f32_32x32x16_bf16 v[64:79], v[52:55], a[36:39], v[64:79]
  ds_read_b64_tr_b16 v[52:53], v8 offset:128
  ds_read_b64_tr_b16 v[54:55], v8 offset:1664
  v_mfma_f32_32x32x16_bf16 v[64:79], v[56:59], a[40:43], v[64:79]
  ds_read_b64_tr_b16 v[56:57], v7 offset:256
  ds_read_b64_tr_b16 v[58:59], v7 offset:1792
  v_mfma_f32_32x32x16_bf16 v[64:79], v[60:63], a[44:47], v[64:79]
  ds_read_b64_tr_b16 v[60:61], v8 offset:256
  ds_read_b64_tr_b16 v[62:63], v8 offset:1792
  s_waitcnt lgkmcnt(6)
  v_mfma_f32_32x32x16_bf16 a[96:111], v[40:43], v[112:115], a[96:111]
  ds_read_b128 v[116:119], v10 offset:12288
  ds_read_b64_tr_b16 v[40:41], v7 offset:6144
  ds_read_b64_tr_b16 v[42:43], v7 offset:7680
  v_mfma_f32_32x32x16_bf16 a[112:127], v[44:47], v[112:115], a[112:127]
  ds_read_b64_tr_b16 v[44:45], v8 offset:6144
  ds_read_b64_tr_b16 v[46:47], v8 offset:7680
  s_nop 1
  v_max3_f32 v28, v64, v65, v66
  v_max3_f32 v29, v67, v68, v69
  v_max3_f32 v28, v28, v70, v71
  v_max3_f32 v29, v29, v72, v73
  v_mfma_f32_32x32x16_bf16 a[128:143], v[48:51], v[112:115], a[128:143]
  ds_read_b64_tr_b16 v[48:49], v7 offset:6272
  ds_read_b64_tr_b16 v[50:51], v7 offset:7808
  v_max3_f32 v28, v28, v74, v75
  v_max3_f32 v29, v29, v76, v77
  v_max3_f32 v28, v28, v78, v79
  s_waitcnt lgkmcnt(7)
  v_mfma_f32_32x32x16_bf16 a[144:159], v[52:55], v[112:115], a[144:159]
  ds_read_b64_tr_b16 v[52:53], v8 offset:6272
  ds_read_b64_tr_b16 v[54:55], v8 offset:7808
  v_max_f32 v28, v28, v29
  v_mfma_f32_32x32x16_bf16 a[160:175], v[56:59], v[112:115], a[160:175]
  ds_read_b64_tr_b16 v[56:57], v7 offset:6400
  ds_read_b64_tr_b16 v[58:59], v7 offset:7936
  v_mfma_f32_32x32x16_bf16 a[176:191], v[60:63], v[112:115], a[176:191]
  ds_read_b64_tr_b16 v[60:61], v8 offset:6400
  ds_read_b64_tr_b16 v[62:63], v8 offset:7936
  s_waitcnt vmcnt(42)
  s_barrier
  s_mov_b32 s45, 61440
  s_waitcnt lgkmcnt(6)
  v_mfma_f32_32x32x16_bf16 a[96:111], v[40:43], v[116:119], a[96:111]
  ds_read_b64_tr_b16 v[40:41], v5 offset:36864
  ds_read_b64_tr_b16 v[42:43], v5 offset:39936
  s_add_u32 m0, s32, 77824
  s_nop 0
  buffer_load_dwordx4 v11, s[4:7], s45 offen offset:0 nt lds
  buffer_load_dwordx4 v12, s[4:7], s45 offen offset:1024 nt lds
  buffer_load_dwordx4 v13, s[4:7], s45 offen offset:2048 nt lds
  v_mfma_f32_32x32x16_bf16 a[112:127], v[44:47], v[116:119], a[112:127]
  ds_read_b64_tr_b16 v[44:45], v6 offset:36864
  ds_read_b64_tr_b16 v[46:47], v6 offset:39936
  s_mov_b32 s44, 49152
  s_add_u32 m0, s32, 151552
  s_nop 0
  buffer_load_dwordx4 v14, s[8:11], s44 offen offset:0 nt lds
  buffer_load_dwordx4 v15, s[8:11], s44 offen offset:1024 nt lds
  v_mfma_f32_32x32x16_bf16 a[128:143], v[48:51], v[116:119], a[128:143]
  ds_read_b64_tr_b16 v[48:49], v5 offset:36992
  ds_read_b64_tr_b16 v[50:51], v5 offset:40064
  buffer_load_dwordx4 v16, s[8:11], s44 offen offset:2048 nt lds
  s_mov_b32 s45, 73728
  s_add_u32 m0, s32, 90112
  s_waitcnt lgkmcnt(6)
  v_mfma_f32_32x32x16_bf16 a[144:159], v[52:55], v[116:119], a[144:159]
  ds_read_b64_tr_b16 v[52:53], v6 offset:36992
  ds_read_b64_tr_b16 v[54:55], v6 offset:40064
  buffer_load_dwordx4 v11, s[4:7], s45 offen offset:0 nt lds
  buffer_load_dwordx4 v12, s[4:7], s45 offen offset:1024 nt lds
  buffer_load_dwordx4 v13, s[4:7], s45 offen offset:2048 nt lds
  v_mfma_f32_32x32x16_bf16 a[160:175], v[56:59], v[116:119], a[160:175]
  ds_read_b64_tr_b16 v[56:57], v5 offset:37120
  ds_read_b64_tr_b16 v[58:59], v5 offset:40192
  v_mfma_f32_32x32x16_bf16 a[176:191], v[60:63], v[116:119], a[176:191]
  ds_read_b64_tr_b16 v[60:61], v6 offset:37120
  ds_read_b64_tr_b16 v[62:63], v6 offset:40192
  s_cmp_lg_u32 s42, 0
  s_cbranch_scc1 LrB_3
LbB_4:
  s_waitcnt lgkmcnt(6)
  v_mfma_f32_32x32x16_bf16 v[160:175], v[40:43], v[80:83], v[160:175]
  ds_read_b64_tr_b16 v[40:41], v5 offset:43008
  ds_read_b64_tr_b16 v[42:43], v5 offset:46080
  v_cmp_lt_f32 vcc, s43, v28
  s_cbranch_vccnz Lrare_5
Lback_6:
  v_exp_f32 v64, v64
  v_mfma_f32_32x32x16_bf16 v[176:191], v[44:47], v[80:83], v[176:191]
  ds_read_b64_tr_b16 v[44:45], v6 offset:43008
  ds_read_b64_tr_b16 v[46:47], v6 offset:46080
  v_exp_f32 v65, v65
  v_add_f32 v22, v22, v64
  v_mfma_f32_32x32x16_bf16 v[192:207], v[48:51], v[80:83], v[192:207]
  ds_read_b64_tr_b16 v[48:49], v5 offset:43136
  ds_read_b64_tr_b16 v[50:51], v5 offset:46208
  v_exp_f32 v66, v66
  v_add_f32 v23, v23, v65
  s_waitcnt lgkmcnt(6)
  v_mfma_f32_32x32x16_bf16 v[208:223], v[52:55], v[80:83], v[208:223]
  ds_read_b64_tr_b16 v[52:53], v6 offset:43136
  ds_read_b64_tr_b16 v[54:55], v6 offset:46208
  v_exp_f32 v67, v67
  v_add_f32 v22, v22, v66
  v_mfma_f32_32x32x16_bf16 v[224:239], v[56:59], v[80:83], v[224:239]
  ds_read_b64_tr_b16 v[56:57], v5 offset:43264
  ds_read_b64_tr_b16 v[58:59], v5 offset:46336
  v_exp_f32 v68, v68
  v_add_f32 v23, v23, v67
  v_mfma_f32_32x32x16_bf16 v[240:255], v[60:63], v[80:83], v[240:255]
  ds_read_b64_tr_b16 v[60:61], v6 offset:43264
  ds_read_b64_tr_b16 v[62:63], v6 offset:46336
  s_waitcnt vmcnt(14)
  s_barrier
  s_mov_b32 s44, 1966464
  s_waitcnt lgkmcnt(6)
  v_mfma_f32_32x32x16_bf16 v[160:175], v[40:43], v[88:91], v[160:175]
  ds_read_b128 v[112:115], v9 offset:32768
  ds_read_b64_tr_b16 v[40:41], v7 offset:20480
  ds_read_b64_tr_b16 v[42:43], v7 offset:22016
  s_add_u32 m0, s32, 0
  s_nop 0
  buffer_load_dwordx4 v17, s[12:15], s44 offen offset:0 nt lds
  buffer_load_dwordx4 v18, s[12:15], s44 offen offset:1024 nt lds
  v_mfma_f32_32x32x16_bf16 v[176:191], v[44:47], v[88:91], v[176:191]
  ds_read_b64_tr_b16 v[44:45], v8 offset:20480
  ds_read_b64_tr_b16 v[46:47], v8 offset:22016
  buffer_load_dwordx4 v19, s[12:15], s44 offen offset:2048 nt lds
  s_mov_b32 s45, 320
  s_add_u32 m0, s33, 12288
  s_nop 0
  buffer_load_dwordx4 v20, s[16:19], s45 offen offset:0 lds
  v_mfma_f32_32x32x16_bf16 v[192:207], v[48:51], v[88:91], v[192:207]
  ds_read_b64_tr_b16 v[48:49], v7 offset:20608
  ds_read_b64_tr_b16 v[50:51], v7 offset:22144
  buffer_load_dwordx4 v21, s[16:19], s45 offen offset:1024 lds
  v_exp_f32 v69, v69
  s_waitcnt lgkmcnt(7)
  v_mfma_f32_32x32x16_bf16 v[208:223], v[52:55], v[88:91], v[208:223]
  ds_read_b64_tr_b16 v[52:53], v8 offset:20608
  ds_read_b64_tr_b16 v[54:55], v8 offset:22144
  v_add_f32 v22, v22, v68
  v_exp_f32 v70, v70
  v_add_f32 v23, v23, v69
  v_mfma_f32_32x32x16_bf16 v[224:239], v[56:59], v[88:91], v[224:239]
  ds_read_b64_tr_b16 v[56:57], v7 offset:20736
  ds_read_b64_tr_b16 v[58:59], v7 offset:22272
  v_exp_f32 v71, v71
  v_add_f32 v22, v22, v70
  v_mfma_f32_32x32x16_bf16 v[240:255], v[60:63], v[88:91], v[240:255]
  ds_read_b64_tr_b16 v[60:61], v8 offset:20736
  ds_read_b64_tr_b16 v[62:63], v8 offset:22272
  v_exp_f32 v72, v72
  v_add_f32 v23, v23, v71
  s_waitcnt lgkmcnt(6)
  v_mfma_f32_32x32x16_bf16 a[96:111], v[40:43], v[112:115], a[96:111]
  ds_read_b128 v[116:119], v10 offset:32768
  ds_read_b64_tr_b16 v[40:41], v7 offset:26624
  ds_read_b64_tr_b16 v[42:43], v7 offset:28160
  v_exp_f32 v73, v73
  v_add_f32 v22, v22, v72
  v_mfma_f32_32x32x16_bf16 a[112:127], v[44:47], v[112:115], a[112:127]
  ds_read_b64_tr_b16 v[44:45], v8 offset:26624
  ds_read_b64_tr_b16 v[46:47], v8 offset:28160
  v_cvt_pk_bf16_f32 v64, v64, v65
  v_cvt_pk_bf16_f32 v65, v66, v67
  v_cvt_pk_bf16_f32 v66, v68, v69
  v_cvt_pk_bf16_f32 v67, v70, v71
  v_mfma_f32_32x32x16_bf16 a[128:143], v[48:51], v[112:115], a[128:143]
  ds_read_b64_tr_b16 v[48:49], v7 offset:26752
  ds_read_b64_tr_b16 v[50:51], v7 offset:28288
  v_exp_f32 v74, v74
  v_add_f32 v23, v23, v73
  s_waitcnt lgkmcnt(7)
  v_mfma_f32_32x32x16_bf16 a[144:159], v[52:55], v[112:115], a[144:159]
  ds_read_b64_tr_b16 v[52:53], v8 offset:26752
  ds_read_b64_tr_b16 v[54:55], v8 offset:28288
  v_exp_f32 v75, v75
  v_add_f32 v22, v22, v74
  v_mfma_f32_32x32x16_bf16 a[160:175], v[56:59], v[112:115], a[160:175]
  ds_read_b64_tr_b16 v[56:57], v7 offset:26880
  ds_read_b64_tr_b16 v[58:59], v7 offset:28416
  v_exp_f32 v76, v76
  v_add_f32 v23, v23, v75
  v_mfma_f32_32x32x16_bf16 a[176:191], v[60:63], v[112:115], a[176:191]
  ds_read_b64_tr_b16 v[60:61], v8 offset:26880
  ds_read_b64_tr_b16 v[62:63], v8 offset:28416
  s_waitcnt vmcnt(38)
  s_barrier
  s_mov_b32 s44, 61440
  s_waitcnt lgkmcnt(6)
  v_mfma_f32_32x32x16_bf16 a[96:111], v[40:43], v[116:119], a[96:111]
  ds_read_b128 v[40:43], v1 offset:0
  s_add_u32 m0, s32, 139264
  s_nop 0
  buffer_load_dwordx4 v14, s[8:11], s44 offen offset:0 nt lds
  buffer_load_dwordx4 v15, s[8:11], s44 offen offset:1024 nt lds
  buffer_load_dwordx4 v16, s[8:11], s44 offen offset:2048 nt lds
  v_mfma_f32_32x32x16_bf16 a[112:127], v[44:47], v[116:119], a[112:127]
  ds_read_b128 v[44:47], v2 offset:0
  v_exp_f32 v77, v77
  v_add_f32 v22, v22, v76
  v_exp_f32 v78, v78
  v_mfma_f32_32x32x16_bf16 a[128:143], v[48:51], v[116:119], a[128:143]
  ds_read_b128 v[48:51], v3 offset:0
  v_add_f32 v23, v23, v77
  v_exp_f32 v79, v79
  v_add_f32 v22, v22, v78
  s_waitcnt lgkmcnt(3)
  v_mfma_f32_32x32x16_bf16 a[144:159], v[52:55], v[116:119], a[144:159]
  ds_read_b128 v[52:55], v4 offset:0
  v_cvt_pk_bf16_f32 v72, v72, v73
  v_add_f32 v23, v23, v79
  v_cvt_pk_bf16_f32 v73, v74, v75
  v_cvt_pk_bf16_f32 v74, v76, v77
  v_cvt_pk_bf16_f32 v75, v78, v79
  v_mfma_f32_32x32x16_bf16 a[160:175], v[56:59], v[116:119], a[160:175]
  ds_read_b128 v[56:59], v1 offset:128
  v_mfma_f32_32x32x16_bf16 a[176:191], v[60:63], v[116:119], a[176:191]
  ds_read_b128 v[60:63], v2 offset:128
  s_waitcnt lgkmcnt(3)
  v_mfma_f32_32x32x16_bf16 v[80:95], v[40:43], a[0:3], v[96:111]
  ds_read_b128 v[40:43], v3 offset:128
  v_mfma_f32_32x32x16_bf16 v[80:95], v[44:47], a[4:7], v[80:95]
  ds_read_b128 v[44:47], v4 offset:128
  v_mfma_f32_32x32x16_bf16 v[80:95], v[48:51], a[8:11], v[80:95]
  ds_read_b128 v[48:51], v1 offset:256
  s_waitcnt lgkmcnt(3)
  v_mfma_f32_32x32x16_bf16 v[80:95], v[52:55], a[12:15], v[80:95]
  ds_read_b128 v[52:55], v2 offset:256
  v_mfma_f32_32x32x16_bf16 v[80:95], v[56:59], a[16:19], v[80:95]
  ds_read_b128 v[56:59], v3 offset:256
  v_mfma_f32_32x32x16_bf16 v[80:95], v[60:63], a[20:23], v[80:95]
  ds_read_b128 v[60:63], v4 offset:256
  s_waitcnt vmcnt(17)
  s_barrier
  s_mov_b32 s45, 2359680
  s_add_u32 m0, s32, 20480
  s_waitcnt lgkmcnt(3)
  v_mfma_f32_32x32x16_bf16 v[80:95], v[40:43], a[24:27], v[80:95]
  ds_read_b128 v[112:115], v9 offset:53248
  ds_read_b64_tr_b16 v[40:41], v7 offset:40960
  ds_read_b64_tr_b16 v[42:43], v7 offset:42496
  buffer_load_dwordx4 v17, s[12:15], s45 offen offset:0 nt lds
  buffer_load_dwordx4 v18, s[12:15], s45 offen offset:1024 nt lds
  buffer_load_dwordx4 v19, s[12:15], s45 offen offset:2048 nt lds
  v_mfma_f32_32x32x16_bf16 v[80:95], v[44:47], a[28:31], v[80:95]
  ds_read_b64_tr_b16 v[44:45], v8 offset:40960
  ds_read_b64_tr_b16 v[46:47], v8 offset:42496
  s_mov_b32 s44, 384
  s_add_u32 m0, s33, 32768
  s_nop 0
  buffer_load_dwordx4 v20, s[16:19], s44 offen offset:0 lds
  buffer_load_dwordx4 v21, s[16:19], s44 offen offset:1024 lds
  v_mfma_f32_32x32x16_bf16 v[80:95], v[48:51], a[32:35], v[80:95]
  ds_read_b64_tr_b16 v[48:49], v7 offset:41088
  ds_read_b64_tr_b16 v[50:51], v7 offset:42624
  s_waitcnt lgkmcnt(7)
  v_mfma_f32_32x32x16_bf16 v[80:95], v[52:55], a[36:39], v[80:95]
  ds_read_b64_tr_b16 v[52:53], v8 offset:41088
  ds_read_b64_tr_b16 v[54:55], v8 offset:42624
  v_mfma_f32_32x32x16_bf16 v[80:95], v[56:59], a[40:43], v[80:95]
  ds_read_b64_tr_b16 v[56:57], v7 offset:41216
  ds_read_b64_tr_b16 v[58:59], v7 offset:42752
  v_mfma_f32_32x32x16_bf16 v[80:95], v[60:63], a[44:47], v[80:95]
  ds_read_b64_tr_b16 v[60:61], v8 offset:41216
  ds_read_b64_tr_b16 v[62:63], v8 offset:42752
  s_waitcnt lgkmcnt(6)
  v_mfma_f32_32x32x16_bf16 a[96:111], v[40:43], v[112:115], a[96:111]
  ds_read_b128 v[116:119], v10 offset:53248
  ds_read_b64_tr_b16 v[40:41], v7 offset:47104
  ds_read_b64_tr_b16 v[42:43], v7 offset:48640
  v_mfma_f32_32x32x16_bf16 a[112:127], v[44:47], v[112:115], a[112:127]
  ds_read_b64_tr_b16 v[44:45], v8 offset:47104
  ds_read_b64_tr_b16 v[46:47], v8 offset:48640
  s_nop 1
  v_max3_f32 v28, v80, v81, v82
  v_max3_f32 v29, v83, v84, v85
  v_max3_f32 v28, v28, v86, v87
  v_max3_f32 v29, v29, v88, v89
  v_mfma_f32_32x32x16_bf16 a[128:143], v[48:51], v[112:115], a[128:143]
  ds_read_b64_tr_b16 v[48:49], v7 offset:47232
  ds_read_b64_tr_b16 v[50:51], v7 offset:48768
  v_max3_f32 v28, v28, v90, v91
  v_max3_f32 v29, v29, v92, v93
  v_max3_f32 v28, v28, v94, v95
  s_waitcnt lgkmcnt(7)
  v_mfma_f32_32x32x16_bf16 a[144:159], v[52:55], v[112:115], a[144:159]
  ds_read_b64_tr_b16 v[52:53], v8 offset:47232
  ds_read_b64_tr_b16 v[54:55], v8 offset:48768
  v_max_f32 v28, v28, v29
  v_mfma_f32_32x32x16_bf16 a[160:175], v[56:59], v[112:115], a[160:175]
  ds_read_b64_tr_b16 v[56:57], v7 offset:47360
  ds_read_b64_tr_b16 v[58:59], v7 offset:48896
  v_mfma_f32_32x32x16_bf16 a[176:191], v[60:63], v[112:115], a[176:191]
  ds_read_b64_tr_b16 v[60:61], v8 offset:47360
  ds_read_b64_tr_b16 v[62:63], v8 offset:48896
  s_waitcnt vmcnt(38)
  s_barrier
  s_mov_b32 s45, 86016
  s_waitcnt lgkmcnt(6)
  v_mfma_f32_32x32x16_bf16 a[96:111], v[40:43], v[116:119], a[96:111]
  ds_read_b64_tr_b16 v[40:41], v5 offset:24576
  ds_read_b64_tr_b16 v[42:43], v5 offset:27648
  s_add_u32 m0, s32, 65536
  s_nop 0
  buffer_load_dwordx4 v11, s[4:7], s45 offen offset:0 nt lds
  buffer_load_dwordx4 v12, s[4:7], s45 offen offset:1024 nt lds
  buffer_load_dwordx4 v13, s[4:7], s45 offen offset:2048 nt lds
  v_mfma_f32_32x32x16_bf16 a[112:127], v[44:47], v[116:119], a[112:127]
  ds_read_b64_tr_b16 v[44:45], v6 offset:24576
  ds_read_b64_tr_b16 v[46:47], v6 offset:27648
  v_mfma_f32_32x32x16_bf16 a[128:143], v[48:51], v[116:119], a[128:143]
  ds_read_b64_tr_b16 v[48:49], v5 offset:24704
  ds_read_b64_tr_b16 v[50:51], v5 offset:27776
  s_waitcnt lgkmcnt(6)
  v_mfma_f32_32x32x16_bf16 a[144:159], v[52:55], v[116:119], a[144:159]
  ds_read_b64_tr_b16 v[52:53], v6 offset:24704
  ds_read_b64_tr_b16 v[54:55], v6 offset:27776
  v_mfma_f32_32x32x16_bf16 a[160:175], v[56:59], v[116:119], a[160:175]
  ds_read_b64_tr_b16 v[56:57], v5 offset:24832
  ds_read_b64_tr_b16 v[58:59], v5 offset:27904
  v_mfma_f32_32x32x16_bf16 a[176:191], v[60:63], v[116:119], a[176:191]
  ds_read_b64_tr_b16 v[60:61], v6 offset:24832
  ds_read_b64_tr_b16 v[62:63], v6 offset:27904
  s_cmp_lg_u32 s42, 0
  s_cbranch_scc1 LrB_7
LbB_8:
  s_waitcnt lgkmcnt(6)
  v_mfma_f32_32x32x16_bf16 v[160:175], v[40:43], v[64:67], v[160:175]
  ds_read_b64_tr_b16 v[40:41], v5 offset:30720
  ds_read_b64_tr_b16 v[42:43], v5 offset:33792
  v_cmp_lt_f32 vcc, s43, v28
  s_cbranch_vccnz Lrare_9
Lback_10:
  v_exp_f32 v80, v80
  v_mfma_f32_32x32x16_bf16 v[176:191], v[44:47], v[64:67], v[176:191]
  ds_read_b64_tr_b16 v[44:45], v6 offset:30720
  ds_read_b64_tr_b16 v[46:47], v6 offset:33792
  v_exp_f32 v81, v81
  v_add_f32 v22, v22, v80
  v_mfma_f32_32x32x16_bf16 v[192:207], v[48:51], v[64:67], v[192:207]
  ds_read_b64_tr_b16 v[48:49], v5 offset:30848
  ds_read_b64_tr_b16 v[50:51], v5 offset:33920
  v_exp_f32 v82, v82
  v_add_f32 v23, v23, v81
  s_waitcnt lgkmcnt(6)
  v_mfma_f32_32x32x16_bf16 v[208:223], v[52:55], v[64:67], v[208:223]
  ds_read_b64_tr_b16 v[52:53], v6 offset:30848
  ds_read_b64_tr_b16 v[54:55], v6 offset:33920
  v_exp_f32 v83, v83
  v_add_f32 v22, v22, v82
  v_mfma_f32_32x32x16_bf16 v[224:239], v[56:59], v[64:67], v[224:239]
  ds_read_b64_tr_b16 v[56:57], v5 offset:30976
  ds_read_b64_tr_b16 v[58:59], v5 offset:34048
  v_exp_f32 v84, v84
  v_add_f32 v23, v23, v83
  v_mfma_f32_32x32x16_bf16 v[240:255], v[60:63], v[64:67], v[240:255]
  ds_read_b64_tr_b16 v[60:61], v6 offset:30976
  ds_read_b64_tr_b16 v[62:63], v6 offset:34048
  s_waitcnt vmcnt(11)
  s_barrier
  s_mov_b32 s44, 2752896
  s_waitcnt lgkmcnt(6)
  v_mfma_f32_32x32x16_bf16 v[160:175], v[40:43], v[72:75], v[160:175]
  ds_read_b128 v[112:115], v9 offset:12288
  ds_read_b64_tr_b16 v[40:41], v7 offset:0
  ds_read_b64_tr_b16 v[42:43], v7 offset:1536
  s_add_u32 m0, s32, 40960
  s_nop 0
  buffer_load_dwordx4 v17, s[12:15], s44 offen offset:0 nt lds
  buffer_load_dwordx4 v18, s[12:15], s44 offen offset:1024 nt lds
  v_mfma_f32_32x32x16_bf16 v[176:191], v[44:47], v[72:75], v[176:191]
  ds_read_b64_tr_b16 v[44:45], v8 offset:0
  ds_read_b64_tr_b16 v[46:47], v8 offset:1536
  buffer_load_dwordx4 v19, s[12:15], s44 offen offset:2048 nt lds
  s_mov_b32 s45, 448
  s_add_u32 m0, s33, 53248
  s_nop 0
  buffer_load_dwordx4 v20, s[16:19], s45 offen offset:0 lds
  v_mfma_f32_32x32x16_bf16 v[192:207], v[48:51], v[72:75], v[192:207]
  ds_read_b64_tr_b16 v[48:49], v7 offset:128
  ds_read_b64_tr_b16 v[50:51], v7 offset:1664
  buffer_load_dwordx4 v21, s[16:19], s45 offen offset:1024 lds
  v_exp_f32 v85, v85
  s_waitcnt lgkmcnt(7)
  v_mfma_f32_32x32x16_bf16 v[208:223], v[52:55], v[72:75], v[208:223]
  ds_read_b64_tr_b16 v[52:53], v8 offset:128
  ds_read_b64_tr_b16 v[54:55], v8 offset:1664
  v_add_f32 v22, v22, v84
  v_exp_f32 v86, v86
  v_add_f32 v23, v23, v85
  v_mfma_f32_32x32x16_bf16 v[224:239], v[56:59], v[72:75], v[224:239]
  ds_read_b64_tr_b16 v[56:57], v7 offset:256
  ds_read_b64_tr_b16 v[58:59], v7 offset:1792
  v_exp_f32 v87, v87
  v_add_f32 v22, v22, v86
  v_mfma_f32_32x32x16_bf16 v[240:255], v[60:63], v[72:75], v[240:255]
  ds_read_b64_tr_b16 v[60:61], v8 offset:256
  ds_read_b64_tr_b16 v[62:63], v8 offset:1792
  v_exp_f32 v88, v88
  v_add_f32 v23, v23, v87
  s_waitcnt lgkmcnt(6)
  v_mfma_f32_32x32x16_bf16 a[96:111], v[40:43], v[112:115], a[96:111]
  ds_read_b128 v[116:119], v10 offset:12288
  ds_read_b64_tr_b16 v[40:41], v7 offset:6144
  ds_read_b64_tr_b16 v[42:43], v7 offset:7680
  v_exp_f32 v89, v89
  v_add_f32 v22, v22, v88
  v_mfma_f32_32x32x16_bf16 a[112:127], v[44:47], v[112:115], a[112:127]
  ds_read_b64_tr_b16 v[44:45], v8 offset:6144
  ds_read_b64_tr_b16 v[46:47], v8 offset:7680
  v_cvt_pk_bf16_f32 v80, v80, v81
  v_cvt_pk_bf16_f32 v81, v82, v83
  v_cvt_pk_bf16_f32 v82, v84, v85
  v_cvt_pk_bf16_f32 v83, v86, v87
  v_mfma_f32_32x32x16_bf16 a[128:143], v[48:51], v[112:115], a[128:143]
  ds_read_b64_tr_b16 v[48:49], v7 offset:6272
  ds_read_b64_tr_b16 v[50:51], v7 offset:7808
  v_exp_f32 v90, v90
  v_add_f32 v23, v23, v89
  s_waitcnt lgkmcnt(7)
  v_mfma_f32_32x32x16_bf16 a[144:159], v[52:55], v[112:115], a[144:159]
  ds_read_b64_tr_b16 v[52:53], v8 offset:6272
  ds_read_b64_tr_b16 v[54:55], v8 offset:7808
  v_exp_f32 v91, v91
  v_add_f32 v22, v22, v90
  v_mfma_f32_32x32x16_bf16 a[160:175], v[56:59], v[112:115], a[160:175]
  ds_read_b64_tr_b16 v[56:57], v7 offset:6400
  ds_read_b64_tr_b16 v[58:59], v7 offset:7936
  v_exp_f32 v92, v92
  v_add_f32 v23, v23, v91
  v_mfma_f32_32x32x16_bf16 a[176:191], v[60:63], v[112:115], a[176:191]
  ds_read_b64_tr_b16 v[60:61], v8 offset:6400
  ds_read_b64_tr_b16 v[62:63], v8 offset:7936
  s_waitcnt vmcnt(43)
  s_barrier
  s_mov_b32 s44, 73728
  s_waitcnt lgkmcnt(6)
  v_mfma_f32_32x32x16_bf16 a[96:111], v[40:43], v[116:119], a[96:111]
  ds_read_b64_tr_b16 v[40:41], v5 offset:0
  ds_read_b64_tr_b16 v[42:43], v5 offset:3072
  s_add_u32 m0, s32, 126976
  s_nop 0
  buffer_load_dwordx4 v14, s[8:11], s44 offen offset:0 nt lds
  buffer_load_dwordx4 v15, s[8:11], s44 offen offset:1024 nt lds
  buffer_load_dwordx4 v16, s[8:11], s44 offen offset:2048 nt lds
  v_mfma_f32_32x32x16_bf16 a[112:127], v[44:47], v[116:119], a[112:127]
  ds_read_b64_tr_b16 v[44:45], v6 offset:0
  ds_read_b64_tr_b16 v[46:47], v6 offset:3072
  v_exp_f32 v93, v93
  v_add_f32 v22, v22, v92
  v_mfma_f32_32x32x16_bf16 a[128:143], v[48:51], v[116:119], a[128:143]
  ds_read_b64_tr_b16 v[48:49], v5 offset:128
  ds_read_b64_tr_b16 v[50:51], v5 offset:3200
  v_exp_f32 v94, v94
  v_add_f32 v23, v23, v93
  s_waitcnt lgkmcnt(6)
  v_mfma_f32_32x32x16_bf16 a[144:159], v[52:55], v[116:119], a[144:159]
  ds_read_b64_tr_b16 v[52:53], v6 offset:128
  ds_read_b64_tr_b16 v[54:55], v6 offset:3200
  v_exp_f32 v95, v95
  v_add_f32 v22, v22, v94
  v_cvt_pk_bf16_f32 v88, v88, v89
  v_mfma_f32_32x32x16_bf16 a[160:175], v[56:59], v[116:119], a[160:175]
  ds_read_b64_tr_b16 v[56:57], v5 offset:256
  ds_read_b64_tr_b16 v[58:59], v5 offset:3328
  v_add_f32 v23, v23, v95
  v_cvt_pk_bf16_f32 v89, v90, v91
  v_cvt_pk_bf16_f32 v90, v92, v93
  v_cvt_pk_bf16_f32 v91, v94, v95
  v_mfma_f32_32x32x16_bf16 a[176:191], v[60:63], v[116:119], a[176:191]
  ds_read_b64_tr_b16 v[60:61], v6 offset:256
  ds_read_b64_tr_b16 v[62:63], v6 offset:3328
  s_cmp_lg_u32 s42, 0
  s_cbranch_scc1 LrB_11
LbB_12:
  s_waitcnt lgkmcnt(6)
  v_mfma_f32_32x32x16_bf16 v[160:175], v[40:43], v[80:83], v[160:175]
  ds_read_b64_tr_b16 v[40:41], v5 offset:6144
  ds_read_b64_tr_b16 v[42:43], v5 offset:9216
  v_mfma_f32_32x32x16_bf16 v[176:191], v[44:47], v[80:83], v[176:191]
  ds_read_b64_tr_b16 v[44:45], v6 offset:6144
  ds_read_b64_tr_b16 v[46:47], v6 offset:9216
  v_mfma_f32_32x32x16_bf16 v[192:207], v[48:51], v[80:83], v[192:207]
  ds_read_b64_tr_b16 v[48:49], v5 offset:6272
  ds_read_b64_tr_b16 v[50:51], v5 offset:9344
  s_waitcnt lgkmcnt(6)
  v_mfma_f32_32x32x16_bf16 v[208:223], v[52:55], v[80:83], v[208:223]
  ds_read_b64_tr_b16 v[52:53], v6 offset:6272
  ds_read_b64_tr_b16 v[54:55], v6 offset:9344
  v_mfma_f32_32x32x16_bf16 v[224:239], v[56:59], v[80:83], v[224:239]
  ds_read_b64_tr_b16 v[56:57], v5 offset:6400
  ds_read_b64_tr_b16 v[58:59], v5 offset:9472
  v_mfma_f32_32x32x16_bf16 v[240:255], v[60:63], v[80:83], v[240:255]
  ds_read_b64_tr_b16 v[60:61], v6 offset:6400
  ds_read_b64_tr_b16 v[62:63], v6 offset:9472
  s_waitcnt vmcnt(11)
  s_barrier
  s_mov_b32 s45, 3146112
  s_waitcnt lgkmcnt(6)
  v_mfma_f32_32x32x16_bf16 v[160:175], v[40:43], v[88:91], v[160:175]
  ds_read_b128 v[112:115], v9 offset:32768
  ds_read_b64_tr_b16 v[40:41], v7 offset:20480
  ds_read_b64_tr_b16 v[42:43], v7 offset:22016
  s_add_u32 m0, s32, 0
  s_nop 0
  buffer_load_dwordx4 v17, s[12:15], s45 offen offset:0 nt lds
  buffer_load_dwordx4 v18, s[12:15], s45 offen offset:1024 nt lds
  v_mfma_f32_32x32x16_bf16 v[176:191], v[44:47], v[88:91], v[176:191]
  ds_read_b64_tr_b16 v[44:45], v8 offset:20480
  ds_read_b64_tr_b16 v[46:47], v8 offset:22016
  buffer_load_dwordx4 v19, s[12:15], s45 offen offset:2048 nt lds
  s_mov_b32 s44, 512
  s_add_u32 m0, s33, 12288
  s_nop 0
  buffer_load_dwordx4 v20, s[16:19], s44 offen offset:0 lds
  v_mfma_f32_32x32x16_bf16 v[192:207], v[48:51], v[88:91], v[192:207]
  ds_read_b64_tr_b16 v[48:49], v7 offset:20608
  ds_read_b64_tr_b16 v[50:51], v7 offset:22144
  buffer_load_dwordx4 v21, s[16:19], s44 offen offset:1024 lds
  s_waitcnt lgkmcnt(7)
  v_mfma_f32_32x32x16_bf16 v[208:223], v[52:55], v[88:91], v[208:223]
  ds_read_b64_tr_b16 v[52:53], v8 offset:20608
  ds_read_b64_tr_b16 v[54:55], v8 offset:22144
  v_mfma_f32_32x32x16_bf16 v[224:239], v[56:59], v[88:91], v[224:239]
  ds_read_b64_tr_b16 v[56:57], v7 offset:20736
  ds_read_b64_tr_b16 v[58:59], v7 offset:22272
  v_mfma_f32_32x32x16_bf16 v[240:255], v[60:63], v[88:91], v[240:255]
  ds_read_b64_tr_b16 v[60:61], v8 offset:20736
  ds_read_b64_tr_b16 v[62:63], v8 offset:22272
  s_waitcnt lgkmcnt(6)
  v_mfma_f32_32x32x16_bf16 a[96:111], v[40:43], v[112:115], a[96:111]
  ds_read_b128 v[116:119], v10 offset:32768
  ds_read_b64_tr_b16 v[40:41], v7 offset:26624
  ds_read_b64_tr_b16 v[42:43], v7 offset:28160
  v_mfma_f32_32x32x16_bf16 a[112:127], v[44:47], v[112:115], a[112:127]
  ds_read_b64_tr_b16 v[44:45], v8 offset:26624
  ds_read_b64_tr_b16 v[46:47], v8 offset:28160
  v_mfma_f32_32x32x16_bf16 a[128:143], v[48:51], v[112:115], a[128:143]
  ds_read_b64_tr_b16 v[48:49], v7 offset:26752
  ds_read_b64_tr_b16 v[50:51], v7 offset:28288
  s_waitcnt lgkmcnt(7)
  v_mfma_f32_32x32x16_bf16 a[144:159], v[52:55], v[112:115], a[144:159]
  ds_read_b64_tr_b16 v[52:53], v8 offset:26752
  ds_read_b64_tr_b16 v[54:55], v8 offset:28288
  v_mfma_f32_32x32x16_bf16 a[160:175], v[56:59], v[112:115], a[160:175]
  ds_read_b64_tr_b16 v[56:57], v7 offset:26880
  ds_read_b64_tr_b16 v[58:59], v7 offset:28416
  v_mfma_f32_32x32x16_bf16 a[176:191], v[60:63], v[112:115], a[176:191]
  ds_read_b64_tr_b16 v[60:61], v8 offset:26880
  ds_read_b64_tr_b16 v[62:63], v8 offset:28416
  s_waitcnt vmcnt(48)
  s_barrier
  s_mov_b32 s45, 86016
  s_waitcnt lgkmcnt(6)
  v_mfma_f32_32x32x16_bf16 a[96:111], v[40:43], v[116:119], a[96:111]
  ds_read_b128 v[40:43], v1 offset:49152
  s_add_u32 m0, s32, 102400
  s_nop 0
  buffer_load_dwordx4 v14, s[8:11], s45 offen offset:0 nt lds
  buffer_load_dwordx4 v15, s[8:11], s45 offen offset:1024 nt lds
  buffer_load_dwordx4 v16, s[8:11], s45 offen offset:2048 nt lds
  v_mfma_f32_32x32x16_bf16 a[112:127], v[44:47], v[116:119], a[112:127]
  ds_read_b128 v[44:47], v2 offset:49152
  v_mfma_f32_32x32x16_bf16 a[128:143], v[48:51], v[116:119], a[128:143]
  ds_read_b128 v[48:51], v3 offset:49152
  s_waitcnt lgkmcnt(3)
  v_mfma_f32_32x32x16_bf16 a[144:159], v[52:55], v[116:119], a[144:159]
  ds_read_b128 v[52:55], v4 offset:49152
  v_mfma_f32_32x32x16_bf16 a[160:175], v[56:59], v[116:119], a[160:175]
  ds_read_b128 v[56:59], v1 offset:49280
  v_mfma_f32_32x32x16_bf16 a[176:191], v[60:63], v[116:119], a[176:191]
  ds_read_b128 v[60:63], v2 offset:49280
  s_waitcnt lgkmcnt(3)
  v_mfma_f32_32x32x16_bf16 v[64:79], v[40:43], a[0:3], v[96:111]
  ds_read_b128 v[40:43], v3 offset:49280
  v_mfma_f32_32x32x16_bf16 v[64:79], v[44:47], a[4:7], v[64:79]
  ds_read_b128 v[44:47], v4 offset:49280
  v_mfma_f32_32x32x16_bf16 v[64:79], v[48:51], a[8:11], v[64:79]
  ds_read_b128 v[48:51], v1 offset:49408
  s_waitcnt lgkmcnt(3)
  v_mfma_f32_32x32x16_bf16 v[64:79], v[52:55], a[12:15], v[64:79]
  ds_read_b128 v[52:55], v2 offset:49408
  v_mfma_f32_32x32x16_bf16 v[64:79], v[56:59], a[16:19], v[64:79]
  ds_read_b128 v[56:59], v3 offset:49408
  v_mfma_f32_32x32x16_bf16 v[64:79], v[60:63], a[20:23], v[64:79]
  ds_read_b128 v[60:63], v4 offset:49408
  s_waitcnt vmcnt(38)
  s_barrier
  s_mov_b32 s44, 3539328
  s_add_u32 m0, s32, 20480
  s_waitcnt lgkmcnt(3)
  v_mfma_f32_32x32x16_bf16 v[64:79], v[40:43], a[24:27], v[64:79]
  ds_read_b128 v[40:43], v1 offset:12288
  buffer_load_dwordx4 v17, s[12:15], s44 offen offset:0 nt lds
  buffer_load_dwordx4 v18, s[12:15], s44 offen offset:1024 nt lds
  buffer_load_dwordx4 v19, s[12:15], s44 offen offset:2048 nt lds
  s_mov_b32 s45, 576
  s_add_u32 m0, s33, 32768
  v_mfma_f32_32x32x16_bf16 v[64:79], v[44:47], a[28:31], v[64:79]
  ds_read_b128 v[44:47], v2 offset:12288
  buffer_load_dwordx4 v20, s[16:19], s45 offen offset:0 lds
  buffer_load_dwordx4 v21, s[16:19], s45 offen offset:1024 lds
  v_mfma_f32_32x32x16_bf16 v[64:79], v[48:51], a[32:35], v[64:79]
  ds_read_b128 v[48:51], v3 offset:12288
  s_waitcnt lgkmcnt(3)
  v_mfma_f32_32x32x16_bf16 v[64:79], v[52:55], a[36:39], v[64:79]
  ds_read_b128 v[52:55], v4 offset:12288
  v_mfma_f32_32x32x16_bf16 v[64:79], v[56:59], a[40:43], v[64:79]
  ds_read_b128 v[56:59], v1 offset:12416
  v_mfma_f32_32x32x16_bf16 v[64:79], v[60:63], a[44:47], v[64:79]
  ds_read_b128 v[60:63], v2 offset:12416
  s_waitcnt lgkmcnt(3)
  v_mfma_f32_32x32x16_bf16 v[80:95], v[40:43], a[0:3], v[96:111]
  ds_read_b128 v[40:43], v3 offset:12416
  v_mfma_f32_32x32x16_bf16 v[80:95], v[44:47], a[4:7], v[80:95]
  ds_read_b128 v[44:47], v4 offset:12416
  s_nop 5
  v_max3_f32 v28, v64, v65, v66
  v_max3_f32 v29, v67, v68, v69
  v_max3_f32 v28, v28, v70, v71
  v_max3_f32 v29, v29, v72, v73
  v_max3_f32 v28, v28, v74, v75
  v_mfma_f32_32x32x16_bf16 v[80:95], v[48:51], a[8:11], v[80:95]
  ds_read_b128 v[48:51], v1 offset:12544
  v_max3_f32 v29, v29, v76, v77
  v_max3_f32 v28, v28, v78, v79
  v_max_f32 v28, v28, v29
  s_waitcnt lgkmcnt(3)
  v_mfma_f32_32x32x16_bf16 v[80:95], v[52:55], a[12:15], v[80:95]
  ds_read_b128 v[52:55], v2 offset:12544
  v_cmp_lt_f32 vcc, s43, v28
  s_cbranch_vccnz Lrare_13
Lback_14:
  v_exp_f32 v64, v64
  v_mfma_f32_32x32x16_bf16 v[80:95], v[56:59], a[16:19], v[80:95]
  ds_read_b128 v[56:59], v3 offset:12544
  v_exp_f32 v65, v65
  v_add_f32 v22, v22, v64
  v_exp_f32 v66, v66
  v_mfma_f32_32x32x16_bf16 v[80:95], v[60:63], a[20:23], v[80:95]
  ds_read_b128 v[60:63], v4 offset:12544
  s_waitcnt vmcnt(16)
  s_barrier
  s_mov_b32 s44, 98304
  s_add_u32 m0, s32, 114688
  s_waitcnt lgkmcnt(3)
  v_mfma_f32_32x32x16_bf16 v[80:95], v[40:43], a[24:27], v[80:95]
  ds_read_b128 v[112:115], v9 offset:53248
  ds_read_b64_tr_b16 v[40:41], v7 offset:40960
  ds_read_b64_tr_b16 v[42:43], v7 offset:42496
  buffer_load_dwordx4 v11, s[4:7], s44 offen offset:0 nt lds
  buffer_load_dwordx4 v12, s[4:7], s44 offen offset:1024 nt lds
  buffer_load_dwordx4 v13, s[4:7], s44 offen offset:2048 nt lds
  v_mfma_f32_32x32x16_bf16 v[80:95], v[44:47], a[28:31], v[80:95]
  ds_read_b64_tr_b16 v[44:45], v8 offset:40960
  ds_read_b64_tr_b16 v[46:47], v8 offset:42496
  v_add_f32 v23, v23, v65
  v_exp_f32 v67, v67
  v_add_f32 v22, v22, v66
  v_mfma_f32_32x32x16_bf16 v[80:95], v[48:51], a[32:35], v[80:95]
  ds_read_b64_tr_b16 v[48:49], v7 offset:41088
  ds_read_b64_tr_b16 v[50:51], v7 offset:42624
  v_exp_f32 v68, v68
  v_add_f32 v23, v23, v67
  s_waitcnt lgkmcnt(7)
  v_mfma_f32_32x32x16_bf16 v[80:95], v[52:55], a[36:39], v[80:95]
  ds_read_b64_tr_b16 v[52:53], v8 offset:41088
  ds_read_b64_tr_b16 v[54:55], v8 offset:42624
  v_exp_f32 v69, v69
  v_add_f32 v22, v22, v68
  v_mfma_f32_32x32x16_bf16 v[80:95], v[56:59], a[40:43], v[80:95]
  ds_read_b64_tr_b16 v[56:57], v7 offset:41216
  ds_read_b64_tr_b16 v[58:59], v7 offset:42752
  v_exp_f32 v70, v70
  v_add_f32 v23, v23, v69
  v_mfma_f32_32x32x16_bf16 v[80:95], v[60:63], a[44:47], v[80:95]
  ds_read_b64_tr_b16 v[60:61], v8 offset:41216
  ds_read_b64_tr_b16 v[62:63], v8 offset:42752
  v_exp_f32 v71, v71
  v_add_f32 v22, v22, v70
  s_waitcnt lgkmcnt(6)
  v_mfma_f32_32x32x16_bf16 a[96:111], v[40:43], v[112:115], a[96:111]
  ds_read_b128 v[116:119], v10 offset:53248
  ds_read_b64_tr_b16 v[40:41], v7 offset:47104
  ds_read_b64_tr_b16 v[42:43], v7 offset:48640
  v_exp_f32 v72, v72
  v_add_f32 v23, v23, v71
  v_mfma_f32_32x32x16_bf16 a[112:127], v[44:47], v[112:115], a[112:127]
  ds_read_b64_tr_b16 v[44:45], v8 offset:47104
  ds_read_b64_tr_b16 v[46:47], v8 offset:48640
  v_exp_f32 v73, v73
  v_add_f32 v22, v22, v72
  v_cvt_pk_bf16_f32 v64, v64, v65
  v_mfma_f32_32x32x16_bf16 a[128:143], v[48:51], v[112:115], a[128:143]
  ds_read_b64_tr_b16 v[48:49], v7 offset:47232
  ds_read_b64_tr_b16 v[50:51], v7 offset:48768
  v_cvt_pk_bf16_f32 v65, v66, v67
  v_cvt_pk_bf16_f32 v66, v68, v69
  v_cvt_pk_bf16_f32 v67, v70, v71
  s_waitcnt lgkmcnt(7)
  v_mfma_f32_32x32x16_bf16 a[144:159], v[52:55], v[112:115], a[144:159]
  ds_read_b64_tr_b16 v[52:53], v8 offset:47232
  ds_read_b64_tr_b16 v[54:55], v8 offset:48768
  v_exp_f32 v74, v74
  v_add_f32 v23, v23, v73
  v_mfma_f32_32x32x16_bf16 a[160:175], v[56:59], v[112:115], a[160:175]
  ds_read_b64_tr_b16 v[56:57], v7 offset:47360
  ds_read_b64_tr_b16 v[58:59], v7 offset:48896
  v_exp_f32 v75, v75
  v_add_f32 v22, v22, v74
  v_mfma_f32_32x32x16_bf16 a[176:191], v[60:63], v[112:115], a[176:191]
  ds_read_b64_tr_b16 v[60:61], v8 offset:47360
  ds_read_b64_tr_b16 v[62:63], v8 offset:48896
  s_waitcnt vmcnt(43)
  s_barrier
  s_mov_b32 s45, 110592
  s_waitcnt lgkmcnt(6)
  v_mfma_f32_32x32x16_bf16 a[96:111], v[40:43], v[116:119], a[96:111]
  ds_read_b64_tr_b16 v[40:41], v5 offset:49152
  ds_read_b64_tr_b16 v[42:43], v5 offset:52224
  s_add_u32 m0, s32, 77824
  s_nop 0
  buffer_load_dwordx4 v11, s[4:7], s45 offen offset:0 nt lds
  buffer_load_dwordx4 v12, s[4:7], s45 offen offset:1024 nt lds
  buffer_load_dwordx4 v13, s[4:7], s45 offen offset:2048 nt lds
  v_mfma_f32_32x32x16_bf16 a[112:127], v[44:47], v[116:119], a[112:127]
  ds_read_b64_tr_b16 v[44:45], v6 offset:49152
  ds_read_b64_tr_b16 v[46:47], v6 offset:52224
  v_exp_f32 v76, v76
  v_add_f32 v23, v23, v75
  v_mfma_f32_32x32x16_bf16 a[128:143], v[48:51], v[116:119], a[128:143]
  ds_read_b64_tr_b16 v[48:49], v5 offset:49280
  ds_read_b64_tr_b16 v[50:51], v5 offset:52352
  v_exp_f32 v77, v77
  v_add_f32 v22, v22, v76
  s_waitcnt lgkmcnt(6)
  v_mfma_f32_32x32x16_bf16 a[144:159], v[52:55], v[116:119], a[144:159]
  ds_read_b64_tr_b16 v[52:53], v6 offset:49280
  ds_read_b64_tr_b16 v[54:55], v6 offset:52352
  v_exp_f32 v78, v78
  v_add_f32 v23, v23, v77
  v_mfma_f32_32x32x16_bf16 a[160:175], v[56:59], v[116:119], a[160:175]
  ds_read_b64_tr_b16 v[56:57], v5 offset:49408
  ds_read_b64_tr_b16 v[58:59], v5 offset:52480
  v_exp_f32 v79, v79
  v_add_f32 v22, v22, v78
  v_cvt_pk_bf16_f32 v72, v72, v73
  v_mfma_f32_32x32x16_bf16 a[176:191], v[60:63], v[116:119], a[176:191]
  ds_read_b64_tr_b16 v[60:61], v6 offset:49408
  ds_read_b64_tr_b16 v[62:63], v6 offset:52480
  v_add_f32 v23, v23, v79
  v_cvt_pk_bf16_f32 v73, v74, v75
  v_cvt_pk_bf16_f32 v74, v76, v77
  v_cvt_pk_bf16_f32 v75, v78, v79
  s_cmp_lg_u32 s42, 0
  s_cbranch_scc1 LrB_15
LbB_16:
  s_waitcnt lgkmcnt(6)
  v_mfma_f32_32x32x16_bf16 v[160:175], v[40:43], v[64:67], v[160:175]
  ds_read_b64_tr_b16 v[40:41], v5 offset:55296
  ds_read_b64_tr_b16 v[42:43], v5 offset:58368
  v_max3_f32 v28, v80, v81, v82
  v_max3_f32 v29, v83, v84, v85
  v_max3_f32 v28, v28, v86, v87
  v_max3_f32 v29, v29, v88, v89
  v_mfma_f32_32x32x16_bf16 v[176:191], v[44:47], v[64:67], v[176:191]
  ds_read_b64_tr_b16 v[44:45], v6 offset:55296
  ds_read_b64_tr_b16 v[46:47], v6 offset:58368
  v_max3_f32 v28, v28, v90, v91
  v_max3_f32 v29, v29, v92, v93
  v_max3_f32 v28, v28, v94, v95
  v_max_f32 v28, v28, v29
  v_mfma_f32_32x32x16_bf16 v[192:207], v[48:51], v[64:67], v[192:207]
  ds_read_b64_tr_b16 v[48:49], v5 offset:55424
  ds_read_b64_tr_b16 v[50:51], v5 offset:58496
  v_cmp_lt_f32 vcc, s43, v28
  s_cbranch_vccnz Lrare_17
Lback_18:
  s_waitcnt lgkmcnt(6)
  v_mfma_f32_32x32x16_bf16 v[208:223], v[52:55], v[64:67], v[208:223]
  ds_read_b64_tr_b16 v[52:53], v6 offset:55424
  ds_read_b64_tr_b16 v[54:55], v6 offset:58496
  v_exp_f32 v80, v80
  v_exp_f32 v81, v81
  v_mfma_f32_32x32x16_bf16 v[224:239], v[56:59], v[64:67], v[224:239]
  ds_read_b64_tr_b16 v[56:57], v5 offset:55552
  ds_read_b64_tr_b16 v[58:59], v5 offset:58624
  v_add_f32 v22, v22, v80
  v_exp_f32 v82, v82
  v_add_f32 v23, v23, v81
  v_mfma_f32_32x32x16_bf16 v[240:255], v[60:63], v[64:67], v[240:255]
  ds_read_b64_tr_b16 v[60:61], v6 offset:55552
  ds_read_b64_tr_b16 v[62:63], v6 offset:58624
  s_waitcnt vmcnt(14)
  s_barrier
  s_mov_b32 s44, 3932544
  s_waitcnt lgkmcnt(6)
  v_mfma_f32_32x32x16_bf16 v[160:175], v[40:43], v[72:75], v[160:175]
  ds_read_b128 v[112:115], v9 offset:12288
  ds_read_b64_tr_b16 v[40:41], v7 offset:0
  ds_read_b64_tr_b16 v[42:43], v7 offset:1536
  s_add_u32 m0, s32, 40960
  s_nop 0
  buffer_load_dwordx4 v17, s[12:15], s44 offen offset:0 nt lds
  buffer_load_dwordx4 v18, s[12:15], s44 offen offset:1024 nt lds
  v_mfma_f32_32x32x16_bf16 v[176:191], v[44:47], v[72:75], v[176:191]
  ds_read_b64_tr_b16 v[44:45], v8 offset:0
  ds_read_b64_tr_b16 v[46:47], v8 offset:1536
  buffer_load_dwordx4 v19, s[12:15], s44 offen offset:2048 nt lds
  s_mov_b32 s45, 640
  s_add_u32 m0, s33, 53248
  s_nop 0
  buffer_load_dwordx4 v20, s[16:19], s45 offen offset:0 lds
  v_mfma_f32_32x32x16_bf16 v[192:207], v[48:51], v[72:75], v[192:207]
  ds_read_b64_tr_b16 v[48:49], v7 offset:128
  ds_read_b64_tr_b16 v[50:51], v7 offset:1664
  buffer_load_dwordx4 v21, s[16:19], s45 offen offset:1024 lds
  v_exp_f32 v83, v83
  s_waitcnt lgkmcnt(7)
  v_mfma_f32_32x32x16_bf16 v[208:223], v[52:55], v[72:75], v[208:223]
  ds_read_b64_tr_b16 v[52:53], v8 offset:128
  ds_read_b64_tr_b16 v[54:55], v8 offset:1664
  v_add_f32 v22, v22, v82
  v_exp_f32 v84, v84
  v_add_f32 v23, v23, v83
  v_mfma_f32_32x32x16_bf16 v[224:239], v[56:59], v[72:75], v[224:239]
  ds_read_b64_tr_b16 v[56:57], v7 offset:256
  ds_read_b64_tr_b16 v[58:59], v7 offset:1792
  v_exp_f32 v85, v85
  v_add_f32 v22, v22, v84
  v_mfma_f32_32x32x16_bf16 v[240:255], v[60:63], v[72:75], v[240:255]
  ds_read_b64_tr_b16 v[60:61], v8 offset:256
  ds_read_b64_tr_b16 v[62:63], v8 offset:1792
  v_exp_f32 v86, v86
  v_add_f32 v23, v23, v85
  s_waitcnt lgkmcnt(6)
  v_mfma_f32_32x32x16_bf16 a[96:111], v[40:43], v[112:115], a[96:111]
  ds_read_b128 v[116:119], v10 offset:12288
  ds_read_b64_tr_b16 v[40:41], v7 offset:6144
  ds_read_b64_tr_b16 v[42:43], v7 offset:7680
  v_exp_f32 v87, v87
  v_add_f32 v22, v22, v86
  v_mfma_f32_32x32x16_bf16 a[112:127], v[44:47], v[112:115], a[112:127]
  ds_read_b64_tr_b16 v[44:45], v8 offset:6144
  ds_read_b64_tr_b16 v[46:47], v8 offset:7680
  v_exp_f32 v88, v88
  v_add_f32 v23, v23, v87
  v_mfma_f32_32x32x16_bf16 a[128:143], v[48:51], v[112:115], a[128:143]
  ds_read_b64_tr_b16 v[48:49], v7 offset:6272
  ds_read_b64_tr_b16 v[50:51], v7 offset:7808
  v_exp_f32 v89, v89
  v_add_f32 v22, v22, v88
  s_waitcnt lgkmcnt(7)
  v_mfma_f32_32x32x16_bf16 a[144:159], v[52:55], v[112:115], a[144:159]
  ds_read_b64_tr_b16 v[52:53], v8 offset:6272
  ds_read_b64_tr_b16 v[54:55], v8 offset:7808
  v_cvt_pk_bf16_f32 v80, v80, v81
  v_cvt_pk_bf16_f32 v81, v82, v83
  v_cvt_pk_bf16_f32 v82, v84, v85
  v_cvt_pk_bf16_f32 v83, v86, v87
  v_mfma_f32_32x32x16_bf16 a[160:175], v[56:59], v[112:115], a[160:175]
  ds_read_b64_tr_b16 v[56:57], v7 offset:6400
  ds_read_b64_tr_b16 v[58:59], v7 offset:7936
  v_exp_f32 v90, v90
  v_add_f32 v23, v23, v89
  v_mfma_f32_32x32x16_bf16 a[176:191], v[60:63], v[112:115], a[176:191]
  ds_read_b64_tr_b16 v[60:61], v8 offset:6400
  ds_read_b64_tr_b16 v[62:63], v8 offset:7936
  s_waitcnt vmcnt(48)
  s_barrier
  s_mov_b32 s44, 98304
  s_waitcnt lgkmcnt(6)
  v_mfma_f32_32x32x16_bf16 a[96:111], v[40:43], v[116:119], a[96:111]
  ds_read_b128 v[40:43], v1 offset:24576
  s_add_u32 m0, s32, 151552
  s_nop 0
  buffer_load_dwordx4 v14, s[8:11], s44 offen offset:0 nt lds
  buffer_load_dwordx4 v15, s[8:11], s44 offen offset:1024 nt lds
  buffer_load_dwordx4 v16, s[8:11], s44 offen offset:2048 nt lds
  v_mfma_f32_32x32x16_bf16 a[112:127], v[44:47], v[116:119], a[112:127]
  ds_read_b128 v[44:47], v2 offset:24576
  v_exp_f32 v91, v91
  v_add_f32 v22, v22, v90
  v_exp_f32 v92, v92
  v_mfma_f32_32x32x16_bf16 a[128:143], v[48:51], v[116:119], a[128:143]
  ds_read_b128 v[48:51], v3 offset:24576
  v_add_f32 v23, v23, v91
  v_exp_f32 v93, v93
  v_add_f32 v22, v22, v92
  s_waitcnt lgkmcnt(3)
  v_mfma_f32_32x32x16_bf16 a[144:159], v[52:55], v[116:119], a[144:159]
  ds_read_b128 v[52:55], v4 offset:24576
  v_exp_f32 v94, v94
  v_add_f32 v23, v23, v93
  v_exp_f32 v95, v95
  v_mfma_f32_32x32x16_bf16 a[160:175], v[56:59], v[116:119], a[160:175]
  ds_read_b128 v[56:59], v1 offset:24704
  v_add_f32 v22, v22, v94
  v_cvt_pk_bf16_f32 v88, v88, v89
  v_add_f32 v23, v23, v95
  v_cvt_pk_bf16_f32 v89, v90, v91
  v_cvt_pk_bf16_f32 v90, v92, v93
  v_mfma_f32_32x32x16_bf16 a[176:191], v[60:63], v[116:119], a[176:191]
  ds_read_b128 v[60:63], v2 offset:24704
  v_cvt_pk_bf16_f32 v91, v94, v95
  s_waitcnt lgkmcnt(3)
  v_mfma_f32_32x32x16_bf16 v[64:79], v[40:43], a[0:3], v[96:111]
  ds_read_b128 v[40:43], v3 offset:24704
  v_mfma_f32_32x32x16_bf16 v[64:79], v[44:47], a[4:7], v[64:79]
  ds_read_b128 v[44:47], v4 offset:24704
  v_mfma_f32_32x32x16_bf16 v[64:79], v[48:51], a[8:11], v[64:79]
  ds_read_b128 v[48:51], v1 offset:24832
  s_waitcnt lgkmcnt(3)
  v_mfma_f32_32x32x16_bf16 v[64:79], v[52:55], a[12:15], v[64:79]
  ds_read_b128 v[52:55], v2 offset:24832
  v_mfma_f32_32x32x16_bf16 v[64:79], v[56:59], a[16:19], v[64:79]
  ds_read_b128 v[56:59], v3 offset:24832
  v_mfma_f32_32x32x16_bf16 v[64:79], v[60:63], a[20:23], v[64:79]
  ds_read_b128 v[60:63], v4 offset:24832
  s_waitcnt vmcnt(14)
  s_barrier
  s_mov_b32 s45, 4325760
  s_add_u32 m0, s32, 0
  s_waitcnt lgkmcnt(3)
  v_mfma_f32_32x32x16_bf16 v[64:79], v[40:43], a[24:27], v[64:79]
  ds_read_b128 v[112:115], v9 offset:32768
  ds_read_b64_tr_b16 v[40:41], v7 offset:20480
  ds_read_b64_tr_b16 v[42:43], v7 offset:22016
  buffer_load_dwordx4 v17, s[12:15], s45 offen offset:0 nt lds
  buffer_load_dwordx4 v18, s[12:15], s45 offen offset:1024 nt lds
  buffer_load_dwordx4 v19, s[12:15], s45 offen offset:2048 nt lds
  v_mfma_f32_32x32x16_bf16 v[64:79], v[44:47], a[28:31], v[64:79]
  ds_read_b64_tr_b16 v[44:45], v8 offset:20480
  ds_read_b64_tr_b16 v[46:47], v8 offset:22016
  s_mov_b32 s44, 704
  s_add_u32 m0, s33, 12288
  s_nop 0
  buffer_load_dwordx4 v20, s[16:19], s44 offen offset:0 lds
  buffer_load_dwordx4 v21, s[16:19], s44 offen offset:1024 lds
  v_mfma_f32_32x32x16_bf16 v[64:79], v[48:51], a[32:35], v[64:79]
  ds_read_b64_tr_b16 v[48:49], v7 offset:20608
  ds_read_b64_tr_b16 v[50:51], v7 offset:22144
  s_waitcnt lgkmcnt(7)
  v_mfma_f32_32x32x16_bf16 v[64:79], v[52:55], a[36:39], v[64:79]
  ds_read_b64_tr_b16 v[52:53], v8 offset:20608
  ds_read_b64_tr_b16 v[54:55], v8 offset:22144
  v_mfma_f32_32x32x16_bf16 v[64:79], v[56:59], a[40:43], v[64:79]
  ds_read_b64_tr_b16 v[56:57], v7 offset:20736
  ds_read_b64_tr_b16 v[58:59], v7 offset:22272
  v_mfma_f32_32x32x16_bf16 v[64:79], v[60:63], a[44:47], v[64:79]
  ds_read_b64_tr_b16 v[60:61], v8 offset:20736
  ds_read_b64_tr_b16 v[62:63], v8 offset:22272
  s_waitcnt lgkmcnt(6)
  v_mfma_f32_32x32x16_bf16 a[96:111], v[40:43], v[112:115], a[96:111]
  ds_read_b128 v[116:119], v10 offset:32768
  ds_read_b64_tr_b16 v[40:41], v7 offset:26624
  ds_read_b64_tr_b16 v[42:43], v7 offset:28160
  v_mfma_f32_32x32x16_bf16 a[112:127], v[44:47], v[112:115], a[112:127]
  ds_read_b64_tr_b16 v[44:45], v8 offset:26624
  ds_read_b64_tr_b16 v[46:47], v8 offset:28160
  s_nop 1
  v_max3_f32 v28, v64, v65, v66
  v_max3_f32 v29, v67, v68, v69
  v_max3_f32 v28, v28, v70, v71
  v_max3_f32 v29, v29, v72, v73
  v_mfma_f32_32x32x16_bf16 a[128:143], v[48:51], v[112:115], a[128:143]
  ds_read_b64_tr_b16 v[48:49], v7 offset:26752
  ds_read_b64_tr_b16 v[50:51], v7 offset:28288
  v_max3_f32 v28, v28, v74, v75
  v_max3_f32 v29, v29, v76, v77
  v_max3_f32 v28, v28, v78, v79
  s_waitcnt lgkmcnt(7)
  v_mfma_f32_32x32x16_bf16 a[144:159], v[52:55], v[112:115], a[144:159]
  ds_read_b64_tr_b16 v[52:53], v8 offset:26752
  ds_read_b64_tr_b16 v[54:55], v8 offset:28288
  v_max_f32 v28, v28, v29
  v_mfma_f32_32x32x16_bf16 a[160:175], v[56:59], v[112:115], a[160:175]
  ds_read_b64_tr_b16 v[56:57], v7 offset:26880
  ds_read_b64_tr_b16 v[58:59], v7 offset:28416
  v_mfma_f32_32x32x16_bf16 a[176:191], v[60:63], v[112:115], a[176:191]
  ds_read_b64_tr_b16 v[60:61], v8 offset:26880
  ds_read_b64_tr_b16 v[62:63], v8 offset:28416
  s_waitcnt vmcnt(48)
  s_barrier
  s_mov_b32 s45, 122880
  s_waitcnt lgkmcnt(6)
  v_mfma_f32_32x32x16_bf16 a[96:111], v[40:43], v[116:119], a[96:111]
  ds_read_b64_tr_b16 v[40:41], v5 offset:36864
  ds_read_b64_tr_b16 v[42:43], v5 offset:39936
  s_add_u32 m0, s32, 90112
  s_nop 0
  buffer_load_dwordx4 v11, s[4:7], s45 offen offset:0 nt lds
  buffer_load_dwordx4 v12, s[4:7], s45 offen offset:1024 nt lds
  buffer_load_dwordx4 v13, s[4:7], s45 offen offset:2048 nt lds
  v_mfma_f32_32x32x16_bf16 a[112:127], v[44:47], v[116:119], a[112:127]
  ds_read_b64_tr_b16 v[44:45], v6 offset:36864
  ds_read_b64_tr_b16 v[46:47], v6 offset:39936
  v_mfma_f32_32x32x16_bf16 a[128:143], v[48:51], v[116:119], a[128:143]
  ds_read_b64_tr_b16 v[48:49], v5 offset:36992
  ds_read_b64_tr_b16 v[50:51], v5 offset:40064
  s_waitcnt lgkmcnt(6)
  v_mfma_f32_32x32x16_bf16 a[144:159], v[52:55], v[116:119], a[144:159]
  ds_read_b64_tr_b16 v[52:53], v6 offset:36992
  ds_read_b64_tr_b16 v[54:55], v6 offset:40064
  v_mfma_f32_32x32x16_bf16 a[160:175], v[56:59], v[116:119], a[160:175]
  ds_read_b64_tr_b16 v[56:57], v5 offset:37120
  ds_read_b64_tr_b16 v[58:59], v5 offset:40192
  v_mfma_f32_32x32x16_bf16 a[176:191], v[60:63], v[116:119], a[176:191]
  ds_read_b64_tr_b16 v[60:61], v6 offset:37120
  ds_read_b64_tr_b16 v[62:63], v6 offset:40192
  s_cmp_lg_u32 s42, 0
  s_cbranch_scc1 LrB_19
LbB_20:
  s_waitcnt lgkmcnt(6)
  v_mfma_f32_32x32x16_bf16 v[160:175], v[40:43], v[80:83], v[160:175]
  ds_read_b64_tr_b16 v[40:41], v5 offset:43008
  ds_read_b64_tr_b16 v[42:43], v5 offset:46080
  v_cmp_lt_f32 vcc, s43, v28
  s_cbranch_vccnz Lrare_21
Lback_22:
  v_exp_f32 v64, v64
  v_mfma_f32_32x32x16_bf16 v[176:191], v[44:47], v[80:83], v[176:191]
  ds_read_b64_tr_b16 v[44:45], v6 offset:43008
  ds_read_b64_tr_b16 v[46:47], v6 offset:46080
  v_exp_f32 v65, v65
  v_add_f32 v22, v22, v64
  v_mfma_f32_32x32x16_bf16 v[192:207], v[48:51], v[80:83], v[192:207]
  ds_read_b64_tr_b16 v[48:49], v5 offset:43136
  ds_read_b64_tr_b16 v[50:51], v5 offset:46208
  v_exp_f32 v66, v66
  v_add_f32 v23, v23, v65
  s_waitcnt lgkmcnt(6)
  v_mfma_f32_32x32x16_bf16 v[208:223], v[52:55], v[80:83], v[208:223]
  ds_read_b64_tr_b16 v[52:53], v6 offset:43136
  ds_read_b64_tr_b16 v[54:55], v6 offset:46208
  v_exp_f32 v67, v67
  v_add_f32 v22, v22, v66
  v_mfma_f32_32x32x16_bf16 v[224:239], v[56:59], v[80:83], v[224:239]
  ds_read_b64_tr_b16 v[56:57], v5 offset:43264
  ds_read_b64_tr_b16 v[58:59], v5 offset:46336
  v_exp_f32 v68, v68
  v_add_f32 v23, v23, v67
  v_mfma_f32_32x32x16_bf16 v[240:255], v[60:63], v[80:83], v[240:255]
  ds_read_b64_tr_b16 v[60:61], v6 offset:43264
  ds_read_b64_tr_b16 v[62:63], v6 offset:46336
  s_waitcnt vmcnt(11)
  s_barrier
  s_mov_b32 s44, 4718976
  s_waitcnt lgkmcnt(6)
  v_mfma_f32_32x32x16_bf16 v[160:175], v[40:43], v[88:91], v[160:175]
  ds_read_b128 v[112:115], v9 offset:53248
  ds_read_b64_tr_b16 v[40:41], v7 offset:40960
  ds_read_b64_tr_b16 v[42:43], v7 offset:42496
  s_add_u32 m0, s32, 20480
  s_nop 0
  buffer_load_dwordx4 v17, s[12:15], s44 offen offset:0 nt lds
  buffer_load_dwordx4 v18, s[12:15], s44 offen offset:1024 nt lds
  v_mfma_f32_32x32x16_bf16 v[176:191], v[44:47], v[88:91], v[176:191]
  ds_read_b64_tr_b16 v[44:45], v8 offset:40960
  ds_read_b64_tr_b16 v[46:47], v8 offset:42496
  buffer_load_dwordx4 v19, s[12:15], s44 offen offset:2048 nt lds
  s_mov_b32 s45, 768
  s_add_u32 m0, s33, 32768
  s_nop 0
  buffer_load_dwordx4 v20, s[16:19], s45 offen offset:0 lds
  v_mfma_f32_32x32x16_bf16 v[192:207], v[48:51], v[88:91], v[192:207]
  ds_read_b64_tr_b16 v[48:49], v7 offset:41088
  ds_read_b64_tr_b16 v[50:51], v7 offset:42624
  buffer_load_dwordx4 v21, s[16:19], s45 offen offset:1024 lds
  v_exp_f32 v69, v69
  s_waitcnt lgkmcnt(7)
  v_mfma_f32_32x32x16_bf16 v[208:223], v[52:55], v[88:91], v[208:223]
  ds_read_b64_tr_b16 v[52:53], v8 offset:41088
  ds_read_b64_tr_b16 v[54:55], v8 offset:42624
  v_add_f32 v22, v22, v68
  v_exp_f32 v70, v70
  v_add_f32 v23, v23, v69
  v_mfma_f32_32x32x16_bf16 v[224:239], v[56:59], v[88:91], v[224:239]
  ds_read_b64_tr_b16 v[56:57], v7 offset:41216
  ds_read_b64_tr_b16 v[58:59], v7 offset:42752
  v_exp_f32 v71, v71
  v_add_f32 v22, v22, v70
  v_mfma_f32_32x32x16_bf16 v[240:255], v[60:63], v[88:91], v[240:255]
  ds_read_b64_tr_b16 v[60:61], v8 offset:41216
  ds_read_b64_tr_b16 v[62:63], v8 offset:42752
  v_exp_f32 v72, v72
  v_add_f32 v23, v23, v71
  s_waitcnt lgkmcnt(6)
  v_mfma_f32_32x32x16_bf16 a[96:111], v[40:43], v[112:115], a[96:111]
  ds_read_b128 v[116:119], v10 offset:53248
  ds_read_b64_tr_b16 v[40:41], v7 offset:47104
  ds_read_b64_tr_b16 v[42:43], v7 offset:48640
  v_exp_f32 v73, v73
  v_add_f32 v22, v22, v72
  v_mfma_f32_32x32x16_bf16 a[112:127], v[44:47], v[112:115], a[112:127]
  ds_read_b64_tr_b16 v[44:45], v8 offset:47104
  ds_read_b64_tr_b16 v[46:47], v8 offset:48640
  v_cvt_pk_bf16_f32 v64, v64, v65
  v_cvt_pk_bf16_f32 v65, v66, v67
  v_cvt_pk_bf16_f32 v66, v68, v69
  v_cvt_pk_bf16_f32 v67, v70, v71
  v_mfma_f32_32x32x16_bf16 a[128:143], v[48:51], v[112:115], a[128:143]
  ds_read_b64_tr_b16 v[48:49], v7 offset:47232
  ds_read_b64_tr_b16 v[50:51], v7 offset:48768
  v_exp_f32 v74, v74
  v_add_f32 v23, v23, v73
  s_waitcnt lgkmcnt(7)
  v_mfma_f32_32x32x16_bf16 a[144:159], v[52:55], v[112:115], a[144:159]
  ds_read_b64_tr_b16 v[52:53], v8 offset:47232
  ds_read_b64_tr_b16 v[54:55], v8 offset:48768
  v_exp_f32 v75, v75
  v_add_f32 v22, v22, v74
  v_mfma_f32_32x32x16_bf16 a[160:175], v[56:59], v[112:115], a[160:175]
  ds_read_b64_tr_b16 v[56:57], v7 offset:47360
  ds_read_b64_tr_b16 v[58:59], v7 offset:48896
  v_exp_f32 v76, v76
  v_add_f32 v23, v23, v75
  v_mfma_f32_32x32x16_bf16 a[176:191], v[60:63], v[112:115], a[176:191]
  ds_read_b64_tr_b16 v[60:61], v8 offset:47360
  ds_read_b64_tr_b16 v[62:63], v8 offset:48896
  s_waitcnt vmcnt(48)
  s_barrier
  s_mov_b32 s44, 110592
  s_waitcnt lgkmcnt(6)
  v_mfma_f32_32x32x16_bf16 a[96:111], v[40:43], v[116:119], a[96:111]
  ds_read_b128 v[40:43], v1 offset:0
  s_add_u32 m0, s32, 139264
  s_nop 0
  buffer_load_dwordx4 v14, s[8:11], s44 offen offset:0 nt lds
  buffer_load_dwordx4 v15, s[8:11], s44 offen offset:1024 nt lds
  buffer_load_dwordx4 v16, s[8:11], s44 offen offset:2048 nt lds
  v_mfma_f32_32x32x16_bf16 a[112:127], v[44:47], v[116:119], a[112:127]
  ds_read_b128 v[44:47], v2 offset:0
  v_exp_f32 v77, v77
  v_add_f32 v22, v22, v76
  v_exp_f32 v78, v78
  v_mfma_f32_32x32x16_bf16 a[128:143], v[48:51], v[116:119], a[128:143]
  ds_read_b128 v[48:51], v3 offset:0
  v_add_f32 v23, v23, v77
  v_exp_f32 v79, v79
  v_add_f32 v22, v22, v78
  s_waitcnt lgkmcnt(3)
  v_mfma_f32_32x32x16_bf16 a[144:159], v[52:55], v[116:119], a[144:159]
  ds_read_b128 v[52:55], v4 offset:0
  v_cvt_pk_bf16_f32 v72, v72, v73
  v_add_f32 v23, v23, v79
  v_cvt_pk_bf16_f32 v73, v74, v75
  v_cvt_pk_bf16_f32 v74, v76, v77
  v_cvt_pk_bf16_f32 v75, v78, v79
  v_mfma_f32_32x32x16_bf16 a[160:175], v[56:59], v[116:119], a[160:175]
  ds_read_b128 v[56:59], v1 offset:128
  v_mfma_f32_32x32x16_bf16 a[176:191], v[60:63], v[116:119], a[176:191]
  ds_read_b128 v[60:63], v2 offset:128
  s_waitcnt lgkmcnt(3)
  v_mfma_f32_32x32x16_bf16 v[80:95], v[40:43], a[0:3], v[96:111]
  ds_read_b128 v[40:43], v3 offset:128
  v_mfma_f32_32x32x16_bf16 v[80:95], v[44:47], a[4:7], v[80:95]
  ds_read_b128 v[44:47], v4 offset:128
  v_mfma_f32_32x32x16_bf16 v[80:95], v[48:51], a[8:11], v[80:95]
  ds_read_b128 v[48:51], v1 offset:256
  s_waitcnt lgkmcnt(3)
  v_mfma_f32_32x32x16_bf16 v[80:95], v[52:55], a[12:15], v[80:95]
  ds_read_b128 v[52:55], v2 offset:256
  v_mfma_f32_32x32x16_bf16 v[80:95], v[56:59], a[16:19], v[80:95]
  ds_read_b128 v[56:59], v3 offset:256
  v_mfma_f32_32x32x16_bf16 v[80:95], v[60:63], a[20:23], v[80:95]
  ds_read_b128 v[60:63], v4 offset:256
  s_waitcnt vmcnt(11)
  s_barrier
  s_mov_b32 s45, 5112192
  s_add_u32 m0, s32, 40960
  s_waitcnt lgkmcnt(3)
  v_mfma_f32_32x32x16_bf16 v[80:95], v[40:43], a[24:27], v[80:95]
  ds_read_b128 v[112:115], v9 offset:12288
  ds_read_b64_tr_b16 v[40:41], v7 offset:0
  ds_read_b64_tr_b16 v[42:43], v7 offset:1536
  buffer_load_dwordx4 v17, s[12:15], s45 offen offset:0 nt lds
  buffer_load_dwordx4 v18, s[12:15], s45 offen offset:1024 nt lds
  buffer_load_dwordx4 v19, s[12:15], s45 offen offset:2048 nt lds
  v_mfma_f32_32x32x16_bf16 v[80:95], v[44:47], a[28:31], v[80:95]
  ds_read_b64_tr_b16 v[44:45], v8 offset:0
  ds_read_b64_tr_b16 v[46:47], v8 offset:1536
  s_mov_b32 s44, 832
  s_add_u32 m0, s33, 53248
  s_nop 0
  buffer_load_dwordx4 v20, s[16:19], s44 offen offset:0 lds
  buffer_load_dwordx4 v21, s[16:19], s44 offen offset:1024 lds
  v_mfma_f32_32x32x16_bf16 v[80:95], v[48:51], a[32:35], v[80:95]
  ds_read_b64_tr_b16 v[48:49], v7 offset:128
  ds_read_b64_tr_b16 v[50:51], v7 offset:1664
  s_waitcnt lgkmcnt(7)
  v_mfma_f32_32x32x16_bf16 v[80:95], v[52:55], a[36:39], v[80:95]
  ds_read_b64_tr_b16 v[52:53], v8 offset:128
  ds_read_b64_tr_b16 v[54:55], v8 offset:1664
  v_mfma_f32_32x32x16_bf16 v[80:95], v[56:59], a[40:43], v[80:95]
  ds_read_b64_tr_b16 v[56:57], v7 offset:256
  ds_read_b64_tr_b16 v[58:59], v7 offset:1792
  v_mfma_f32_32x32x16_bf16 v[80:95], v[60:63], a[44:47], v[80:95]
  ds_read_b64_tr_b16 v[60:61], v8 offset:256
  ds_read_b64_tr_b16 v[62:63], v8 offset:1792
  s_waitcnt lgkmcnt(6)
  v_mfma_f32_32x32x16_bf16 a[96:111], v[40:43], v[112:115], a[96:111]
  ds_read_b128 v[116:119], v10 offset:12288
  ds_read_b64_tr_b16 v[40:41], v7 offset:6144
  ds_read_b64_tr_b16 v[42:43], v7 offset:7680
  v_mfma_f32_32x32x16_bf16 a[112:127], v[44:47], v[112:115], a[112:127]
  ds_read_b64_tr_b16 v[44:45], v8 offset:6144
  ds_read_b64_tr_b16 v[46:47], v8 offset:7680
  s_nop 1
  v_max3_f32 v28, v80, v81, v82
  v_max3_f32 v29, v83, v84, v85
  v_max3_f32 v28, v28, v86, v87
  v_max3_f32 v29, v29, v88, v89
  v_mfma_f32_32x32x16_bf16 a[128:143], v[48:51], v[112:115], a[128:143]
  ds_read_b64_tr_b16 v[48:49], v7 offset:6272
  ds_read_b64_tr_b16 v[50:51], v7 offset:7808
  v_max3_f32 v28, v28, v90, v91
  v_max3_f32 v29, v29, v92, v93
  v_max3_f32 v28, v28, v94, v95
  s_waitcnt lgkmcnt(7)
  v_mfma_f32_32x32x16_bf16 a[144:159], v[52:55], v[112:115], a[144:159]
  ds_read_b64_tr_b16 v[52:53], v8 offset:6272
  ds_read_b64_tr_b16 v[54:55], v8 offset:7808
  v_max_f32 v28, v28, v29
  v_mfma_f32_32x32x16_bf16 a[160:175], v[56:59], v[112:115], a[160:175]
  ds_read_b64_tr_b16 v[56:57], v7 offset:6400
  ds_read_b64_tr_b16 v[58:59], v7 offset:7936
  v_mfma_f32_32x32x16_bf16 a[176:191], v[60:63], v[112:115], a[176:191]
  ds_read_b64_tr_b16 v[60:61], v8 offset:6400
  ds_read_b64_tr_b16 v[62:63], v8 offset:7936
  s_waitcnt vmcnt(48)
  s_barrier
  s_mov_b32 s45, 135168
  s_waitcnt lgkmcnt(6)
  v_mfma_f32_32x32x16_bf16 a[96:111], v[40:43], v[116:119], a[96:111]
  ds_read_b64_tr_b16 v[40:41], v5 offset:24576
  ds_read_b64_tr_b16 v[42:43], v5 offset:27648
  s_add_u32 m0, s32, 65536
  s_nop 0
  buffer_load_dwordx4 v11, s[4:7], s45 offen offset:0 nt lds
  buffer_load_dwordx4 v12, s[4:7], s45 offen offset:1024 nt lds
  buffer_load_dwordx4 v13, s[4:7], s45 offen offset:2048 nt lds
  v_mfma_f32_32x32x16_bf16 a[112:127], v[44:47], v[116:119], a[112:127]
  ds_read_b64_tr_b16 v[44:45], v6 offset:24576
  ds_read_b64_tr_b16 v[46:47], v6 offset:27648
  v_mfma_f32_32x32x16_bf16 a[128:143], v[48:51], v[116:119], a[128:143]
  ds_read_b64_tr_b16 v[48:49], v5 offset:24704
  ds_read_b64_tr_b16 v[50:51], v5 offset:27776
  s_waitcnt lgkmcnt(6)
  v_mfma_f32_32x32x16_bf16 a[144:159], v[52:55], v[116:119], a[144:159]
  ds_read_b64_tr_b16 v[52:53], v6 offset:24704
  ds_read_b64_tr_b16 v[54:55], v6 offset:27776
  v_mfma_f32_32x32x16_bf16 a[160:175], v[56:59], v[116:119], a[160:175]
  ds_read_b64_tr_b16 v[56:57], v5 offset:24832
  ds_read_b64_tr_b16 v[58:59], v5 offset:27904
  v_mfma_f32_32x32x16_bf16 a[176:191], v[60:63], v[116:119], a[176:191]
  ds_read_b64_tr_b16 v[60:61], v6 offset:24832
  ds_read_b64_tr_b16 v[62:63], v6 offset:27904
  s_cmp_lg_u32 s42, 0
  s_cbranch_scc1 LrB_23
LbB_24:
  s_waitcnt lgkmcnt(6)
  v_mfma_f32_32x32x16_bf16 v[160:175], v[40:43], v[64:67], v[160:175]
  ds_read_b64_tr_b16 v[40:41], v5 offset:30720
  ds_read_b64_tr_b16 v[42:43], v5 offset:33792
  v_cmp_lt_f32 vcc, s43, v28
  s_cbranch_vccnz Lrare_25
Lback_26:
  v_exp_f32 v80, v80
  v_mfma_f32_32x32x16_bf16 v[176:191], v[44:47], v[64:67], v[176:191]
  ds_read_b64_tr_b16 v[44:45], v6 offset:30720
  ds_read_b64_tr_b16 v[46:47], v6 offset:33792
  v_exp_f32 v81, v81
  v_add_f32 v22, v22, v80
  v_mfma_f32_32x32x16_bf16 v[192:207], v[48:51], v[64:67], v[192:207]
  ds_read_b64_tr_b16 v[48:49], v5 offset:30848
  ds_read_b64_tr_b16 v[50:51], v5 offset:33920
  v_exp_f32 v82, v82
  v_add_f32 v23, v23, v81
  s_waitcnt lgkmcnt(6)
  v_mfma_f32_32x32x16_bf16 v[208:223], v[52:55], v[64:67], v[208:223]
  ds_read_b64_tr_b16 v[52:53], v6 offset:30848
  ds_read_b64_tr_b16 v[54:55], v6 offset:33920
  v_exp_f32 v83, v83
  v_add_f32 v22, v22, v82
  v_mfma_f32_32x32x16_bf16 v[224:239], v[56:59], v[64:67], v[224:239]
  ds_read_b64_tr_b16 v[56:57], v5 offset:30976
  ds_read_b64_tr_b16 v[58:59], v5 offset:34048
  v_exp_f32 v84, v84
  v_add_f32 v23, v23, v83
  v_mfma_f32_32x32x16_bf16 v[240:255], v[60:63], v[64:67], v[240:255]
  ds_read_b64_tr_b16 v[60:61], v6 offset:30976
  ds_read_b64_tr_b16 v[62:63], v6 offset:34048
  s_waitcnt vmcnt(11)
  s_barrier
  s_mov_b32 s44, 5505408
  s_waitcnt lgkmcnt(6)
  v_mfma_f32_32x32x16_bf16 v[160:175], v[40:43], v[72:75], v[160:175]
  ds_read_b128 v[112:115], v9 offset:32768
  ds_read_b64_tr_b16 v[40:41], v7 offset:20480
  ds_read_b64_tr_b16 v[42:43], v7 offset:22016
  s_add_u32 m0, s32, 0
  s_nop 0
  buffer_load_dwordx4 v17, s[12:15], s44 offen offset:0 nt lds
  buffer_load_dwordx4 v18, s[12:15], s44 offen offset:1024 nt lds
  v_mfma_f32_32x32x16_bf16 v[176:191], v[44:47], v[72:75], v[176:191]
  ds_read_b64_tr_b16 v[44:45], v8 offset:20480
  ds_read_b64_tr_b16 v[46:47], v8 offset:22016
  buffer_load_dwordx4 v19, s[12:15], s44 offen offset:2048 nt lds
  s_mov_b32 s45, 896
  s_add_u32 m0, s33, 12288
  s_nop 0
  buffer_load_dwordx4 v20, s[16:19], s45 offen offset:0 lds
  v_mfma_f32_32x32x16_bf16 v[192:207], v[48:51], v[72:75], v[192:207]
  ds_read_b64_tr_b16 v[48:49], v7 offset:20608
  ds_read_b64_tr_b16 v[50:51], v7 offset:22144
  buffer_load_dwordx4 v21, s[16:19], s45 offen offset:1024 lds
  v_exp_f32 v85, v85
  s_waitcnt lgkmcnt(7)
  v_mfma_f32_32x32x16_bf16 v[208:223], v[52:55], v[72:75], v[208:223]
  ds_read_b64_tr_b16 v[52:53], v8 offset:20608
  ds_read_b64_tr_b16 v[54:55], v8 offset:22144
  v_add_f32 v22, v22, v84
  v_exp_f32 v86, v86
  v_add_f32 v23, v23, v85
  v_mfma_f32_32x32x16_bf16 v[224:239], v[56:59], v[72:75], v[224:239]
  ds_read_b64_tr_b16 v[56:57], v7 offset:20736
  ds_read_b64_tr_b16 v[58:59], v7 offset:22272
  v_exp_f32 v87, v87
  v_add_f32 v22, v22, v86
  v_mfma_f32_32x32x16_bf16 v[240:255], v[60:63], v[72:75], v[240:255]
  ds_read_b64_tr_b16 v[60:61], v8 offset:20736
  ds_read_b64_tr_b16 v[62:63], v8 offset:22272
  v_exp_f32 v88, v88
  v_add_f32 v23, v23, v87
  s_waitcnt lgkmcnt(6)
  v_mfma_f32_32x32x16_bf16 a[96:111], v[40:43], v[112:115], a[96:111]
  ds_read_b128 v[116:119], v10 offset:32768
  ds_read_b64_tr_b16 v[40:41], v7 offset:26624
  ds_read_b64_tr_b16 v[42:43], v7 offset:28160
  v_exp_f32 v89, v89
  v_add_f32 v22, v22, v88
  v_mfma_f32_32x32x16_bf16 a[112:127], v[44:47], v[112:115], a[112:127]
  ds_read_b64_tr_b16 v[44:45], v8 offset:26624
  ds_read_b64_tr_b16 v[46:47], v8 offset:28160
  v_cvt_pk_bf16_f32 v80, v80, v81
  v_cvt_pk_bf16_f32 v81, v82, v83
  v_cvt_pk_bf16_f32 v82, v84, v85
  v_cvt_pk_bf16_f32 v83, v86, v87
  v_mfma_f32_32x32x16_bf16 a[128:143], v[48:51], v[112:115], a[128:143]
  ds_read_b64_tr_b16 v[48:49], v7 offset:26752
  ds_read_b64_tr_b16 v[50:51], v7 offset:28288
  v_exp_f32 v90, v90
  v_add_f32 v23, v23, v89
  s_waitcnt lgkmcnt(7)
  v_mfma_f32_32x32x16_bf16 a[144:159], v[52:55], v[112:115], a[144:159]
  ds_read_b64_tr_b16 v[52:53], v8 offset:26752
  ds_read_b64_tr_b16 v[54:55], v8 offset:28288
  v_exp_f32 v91, v91
  v_add_f32 v22, v22, v90
  v_mfma_f32_32x32x16_bf16 a[160:175], v[56:59], v[112:115], a[160:175]
  ds_read_b64_tr_b16 v[56:57], v7 offset:26880
  ds_read_b64_tr_b16 v[58:59], v7 offset:28416
  v_exp_f32 v92, v92
  v_add_f32 v23, v23, v91
  v_mfma_f32_32x32x16_bf16 a[176:191], v[60:63], v[112:115], a[176:191]
  ds_read_b64_tr_b16 v[60:61], v8 offset:26880
  ds_read_b64_tr_b16 v[62:63], v8 offset:28416
  s_waitcnt vmcnt(48)
  s_barrier
  s_mov_b32 s44, 122880
  s_waitcnt lgkmcnt(6)
  v_mfma_f32_32x32x16_bf16 a[96:111], v[40:43], v[116:119], a[96:111]
  ds_read_b64_tr_b16 v[40:41], v5 offset:0
  ds_read_b64_tr_b16 v[42:43], v5 offset:3072
  s_add_u32 m0, s32, 126976
  s_nop 0
  buffer_load_dwordx4 v14, s[8:11], s44 offen offset:0 nt lds
  buffer_load_dwordx4 v15, s[8:11], s44 offen offset:1024 nt lds
  buffer_load_dwordx4 v16, s[8:11], s44 offen offset:2048 nt lds
  v_mfma_f32_32x32x16_bf16 a[112:127], v[44:47], v[116:119], a[112:127]
  ds_read_b64_tr_b16 v[44:45], v6 offset:0
  ds_read_b64_tr_b16 v[46:47], v6 offset:3072
  v_exp_f32 v93, v93
  v_add_f32 v22, v22, v92
  v_mfma_f32_32x32x16_bf16 a[128:143], v[48:51], v[116:119], a[128:143]
  ds_read_b64_tr_b16 v[48:49], v5 offset:128
  ds_read_b64_tr_b16 v[50:51], v5 offset:3200
  v_exp_f32 v94, v94
  v_add_f32 v23, v23, v93
  s_waitcnt lgkmcnt(6)
  v_mfma_f32_32x32x16_bf16 a[144:159], v[52:55], v[116:119], a[144:159]
  ds_read_b64_tr_b16 v[52:53], v6 offset:128
  ds_read_b64_tr_b16 v[54:55], v6 offset:3200
  v_exp_f32 v95, v95
  v_add_f32 v22, v22, v94
  v_cvt_pk_bf16_f32 v88, v88, v89
  v_mfma_f32_32x32x16_bf16 a[160:175], v[56:59], v[116:119], a[160:175]
  ds_read_b64_tr_b16 v[56:57], v5 offset:256
  ds_read_b64_tr_b16 v[58:59], v5 offset:3328
  v_add_f32 v23, v23, v95
  v_cvt_pk_bf16_f32 v89, v90, v91
  v_cvt_pk_bf16_f32 v90, v92, v93
  v_cvt_pk_bf16_f32 v91, v94, v95
  v_mfma_f32_32x32x16_bf16 a[176:191], v[60:63], v[116:119], a[176:191]
  ds_read_b64_tr_b16 v[60:61], v6 offset:256
  ds_read_b64_tr_b16 v[62:63], v6 offset:3328
  s_cmp_lg_u32 s42, 0
  s_cbranch_scc1 LrB_27
LbB_28:
  s_waitcnt lgkmcnt(6)
  v_mfma_f32_32x32x16_bf16 v[160:175], v[40:43], v[80:83], v[160:175]
  ds_read_b64_tr_b16 v[40:41], v5 offset:6144
  ds_read_b64_tr_b16 v[42:43], v5 offset:9216
  v_mfma_f32_32x32x16_bf16 v[176:191], v[44:47], v[80:83], v[176:191]
  ds_read_b64_tr_b16 v[44:45], v6 offset:6144
  ds_read_b64_tr_b16 v[46:47], v6 offset:9216
  v_mfma_f32_32x32x16_bf16 v[192:207], v[48:51], v[80:83], v[192:207]
  ds_read_b64_tr_b16 v[48:49], v5 offset:6272
  ds_read_b64_tr_b16 v[50:51], v5 offset:9344
  s_waitcnt lgkmcnt(6)
  v_mfma_f32_32x32x16_bf16 v[208:223], v[52:55], v[80:83], v[208:223]
  ds_read_b64_tr_b16 v[52:53], v6 offset:6272
  ds_read_b64_tr_b16 v[54:55], v6 offset:9344
  v_mfma_f32_32x32x16_bf16 v[224:239], v[56:59], v[80:83], v[224:239]
  ds_read_b64_tr_b16 v[56:57], v5 offset:6400
  ds_read_b64_tr_b16 v[58:59], v5 offset:9472
  v_mfma_f32_32x32x16_bf16 v[240:255], v[60:63], v[80:83], v[240:255]
  ds_read_b64_tr_b16 v[60:61], v6 offset:6400
  ds_read_b64_tr_b16 v[62:63], v6 offset:9472
  s_waitcnt vmcnt(11)
  s_barrier
  s_mov_b32 s45, 5898624
  s_waitcnt lgkmcnt(6)
  v_mfma_f32_32x32x16_bf16 v[160:175], v[40:43], v[88:91], v[160:175]
  ds_read_b128 v[112:115], v9 offset:53248
  ds_read_b64_tr_b16 v[40:41], v7 offset:40960
  ds_read_b64_tr_b16 v[42:43], v7 offset:42496
  s_add_u32 m0, s32, 20480
  s_nop 0
  buffer_load_dwordx4 v17, s[12:15], s45 offen offset:0 nt lds
  buffer_load_dwordx4 v18, s[12:15], s45 offen offset:1024 nt lds
  v_mfma_f32_32x32x16_bf16 v[176:191], v[44:47], v[88:91], v[176:191]
  ds_read_b64_tr_b16 v[44:45], v8 offset:40960
  ds_read_b64_tr_b16 v[46:47], v8 offset:42496
  buffer_load_dwordx4 v19, s[12:15], s45 offen offset:2048 nt lds
  s_mov_b32 s44, 960
  s_add_u32 m0, s33, 32768
  s_nop 0
  buffer_load_dwordx4 v20, s[16:19], s44 offen offset:0 lds
  v_mfma_f32_32x32x16_bf16 v[192:207], v[48:51], v[88:91], v[192:207]
  ds_read_b64_tr_b16 v[48:49], v7 offset:41088
  ds_read_b64_tr_b16 v[50:51], v7 offset:42624
  buffer_load_dwordx4 v21, s[16:19], s44 offen offset:1024 lds
  s_waitcnt lgkmcnt(7)
  v_mfma_f32_32x32x16_bf16 v[208:223], v[52:55], v[88:91], v[208:223]
  ds_read_b64_tr_b16 v[52:53], v8 offset:41088
  ds_read_b64_tr_b16 v[54:55], v8 offset:42624
  v_mfma_f32_32x32x16_bf16 v[224:239], v[56:59], v[88:91], v[224:239]
  ds_read_b64_tr_b16 v[56:57], v7 offset:41216
  ds_read_b64_tr_b16 v[58:59], v7 offset:42752
  v_mfma_f32_32x32x16_bf16 v[240:255], v[60:63], v[88:91], v[240:255]
  ds_read_b64_tr_b16 v[60:61], v8 offset:41216
  ds_read_b64_tr_b16 v[62:63], v8 offset:42752
  s_waitcnt lgkmcnt(6)
  v_mfma_f32_32x32x16_bf16 a[96:111], v[40:43], v[112:115], a[96:111]
  ds_read_b128 v[116:119], v10 offset:53248
  ds_read_b64_tr_b16 v[40:41], v7 offset:47104
  ds_read_b64_tr_b16 v[42:43], v7 offset:48640
  v_mfma_f32_32x32x16_bf16 a[112:127], v[44:47], v[112:115], a[112:127]
  ds_read_b64_tr_b16 v[44:45], v8 offset:47104
  ds_read_b64_tr_b16 v[46:47], v8 offset:48640
  v_mfma_f32_32x32x16_bf16 a[128:143], v[48:51], v[112:115], a[128:143]
  ds_read_b64_tr_b16 v[48:49], v7 offset:47232
  ds_read_b64_tr_b16 v[50:51], v7 offset:48768
  s_waitcnt lgkmcnt(7)
  v_mfma_f32_32x32x16_bf16 a[144:159], v[52:55], v[112:115], a[144:159]
  ds_read_b64_tr_b16 v[52:53], v8 offset:47232
  ds_read_b64_tr_b16 v[54:55], v8 offset:48768
  v_mfma_f32_32x32x16_bf16 a[160:175], v[56:59], v[112:115], a[160:175]
  ds_read_b64_tr_b16 v[56:57], v7 offset:47360
  ds_read_b64_tr_b16 v[58:59], v7 offset:48896
  v_mfma_f32_32x32x16_bf16 a[176:191], v[60:63], v[112:115], a[176:191]
  ds_read_b64_tr_b16 v[60:61], v8 offset:47360
  ds_read_b64_tr_b16 v[62:63], v8 offset:48896
  s_waitcnt vmcnt(48)
  s_barrier
  s_mov_b32 s45, 135168
  s_waitcnt lgkmcnt(6)
  v_mfma_f32_32x32x16_bf16 a[96:111], v[40:43], v[116:119], a[96:111]
  ds_read_b128 v[40:43], v1 offset:49152
  s_add_u32 m0, s32, 102400
  s_nop 0
  buffer_load_dwordx4 v14, s[8:11], s45 offen offset:0 nt lds
  buffer_load_dwordx4 v15, s[8:11], s45 offen offset:1024 nt lds
  buffer_load_dwordx4 v16, s[8:11], s45 offen offset:2048 nt lds
  v_mfma_f32_32x32x16_bf16 a[112:127], v[44:47], v[116:119], a[112:127]
  ds_read_b128 v[44:47], v2 offset:49152
  v_mfma_f32_32x32x16_bf16 a[128:143], v[48:51], v[116:119], a[128:143]
  ds_read_b128 v[48:51], v3 offset:49152
  s_waitcnt lgkmcnt(3)
  v_mfma_f32_32x32x16_bf16 a[144:159], v[52:55], v[116:119], a[144:159]
  ds_read_b128 v[52:55], v4 offset:49152
  v_mfma_f32_32x32x16_bf16 a[160:175], v[56:59], v[116:119], a[160:175]
  ds_read_b128 v[56:59], v1 offset:49280
  v_mfma_f32_32x32x16_bf16 a[176:191], v[60:63], v[116:119], a[176:191]
  ds_read_b128 v[60:63], v2 offset:49280
  s_waitcnt lgkmcnt(3)
  v_mfma_f32_32x32x16_bf16 v[64:79], v[40:43], a[0:3], v[96:111]
  ds_read_b128 v[40:43], v3 offset:49280
  v_mfma_f32_32x32x16_bf16 v[64:79], v[44:47], a[4:7], v[64:79]
  ds_read_b128 v[44:47], v4 offset:49280
  v_mfma_f32_32x32x16_bf16 v[64:79], v[48:51], a[8:11], v[64:79]
  ds_read_b128 v[48:51], v1 offset:49408
  s_waitcnt lgkmcnt(3)
  v_mfma_f32_32x32x16_bf16 v[64:79], v[52:55], a[12:15], v[64:79]
  ds_read_b128 v[52:55], v2 offset:49408
  v_mfma_f32_32x32x16_bf16 v[64:79], v[56:59], a[16:19], v[64:79]
  ds_read_b128 v[56:59], v3 offset:49408
  v_mfma_f32_32x32x16_bf16 v[64:79], v[60:63], a[20:23], v[64:79]
  ds_read_b128 v[60:63], v4 offset:49408
  s_waitcnt vmcnt(48)
  s_barrier
  s_mov_b32 s44, 6291840
  s_add_u32 m0, s32, 40960
  s_waitcnt lgkmcnt(3)
  v_mfma_f32_32x32x16_bf16 v[64:79], v[40:43], a[24:27], v[64:79]
  ds_read_b128 v[40:43], v1 offset:12288
  buffer_load_dwordx4 v17, s[12:15], s44 offen offset:0 nt lds
  buffer_load_dwordx4 v18, s[12:15], s44 offen offset:1024 nt lds
  buffer_load_dwordx4 v19, s[12:15], s44 offen offset:2048 nt lds
  s_mov_b32 s45, 1024
  s_add_u32 m0, s33, 53248
  v_mfma_f32_32x32x16_bf16 v[64:79], v[44:47], a[28:31], v[64:79]
  ds_read_b128 v[44:47], v2 offset:12288
  buffer_load_dwordx4 v20, s[16:19], s45 offen offset:0 lds
  buffer_load_dwordx4 v21, s[16:19], s45 offen offset:1024 lds
  v_mfma_f32_32x32x16_bf16 v[64:79], v[48:51], a[32:35], v[64:79]
  ds_read_b128 v[48:51], v3 offset:12288
  s_waitcnt lgkmcnt(3)
  v_mfma_f32_32x32x16_bf16 v[64:79], v[52:55], a[36:39], v[64:79]
  ds_read_b128 v[52:55], v4 offset:12288
  v_mfma_f32_32x32x16_bf16 v[64:79], v[56:59], a[40:43], v[64:79]
  ds_read_b128 v[56:59], v1 offset:12416
  v_mfma_f32_32x32x16_bf16 v[64:79], v[60:63], a[44:47], v[64:79]
  ds_read_b128 v[60:63], v2 offset:12416
  s_waitcnt lgkmcnt(3)
  v_mfma_f32_32x32x16_bf16 v[80:95], v[40:43], a[0:3], v[96:111]
  ds_read_b128 v[40:43], v3 offset:12416
  v_mfma_f32_32x32x16_bf16 v[80:95], v[44:47], a[4:7], v[80:95]
  ds_read_b128 v[44:47], v4 offset:12416
  s_nop 5
  v_max3_f32 v28, v64, v65, v66
  v_max3_f32 v29, v67, v68, v69
  v_max3_f32 v28, v28, v70, v71
  v_max3_f32 v29, v29, v72, v73
  v_max3_f32 v28, v28, v74, v75
  v_mfma_f32_32x32x16_bf16 v[80:95], v[48:51], a[8:11], v[80:95]
  ds_read_b128 v[48:51], v1 offset:12544
  v_max3_f32 v29, v29, v76, v77
  v_max3_f32 v28, v28, v78, v79
  v_max_f32 v28, v28, v29
  s_waitcnt lgkmcnt(3)
  v_mfma_f32_32x32x16_bf16 v[80:95], v[52:55], a[12:15], v[80:95]
  ds_read_b128 v[52:55], v2 offset:12544
  v_cmp_lt_f32 vcc, s43, v28
  s_cbranch_vccnz Lrare_29
Lback_30:
  v_exp_f32 v64, v64
  v_mfma_f32_32x32x16_bf16 v[80:95], v[56:59], a[16:19], v[80:95]
  ds_read_b128 v[56:59], v3 offset:12544
  v_exp_f32 v65, v65
  v_add_f32 v22, v22, v64
  v_exp_f32 v66, v66
  v_mfma_f32_32x32x16_bf16 v[80:95], v[60:63], a[20:23], v[80:95]
  ds_read_b128 v[60:63], v4 offset:12544
  s_waitcnt vmcnt(16)
  s_barrier
  s_mov_b32 s44, 147456
  s_add_u32 m0, s32, 114688
  s_waitcnt lgkmcnt(3)
  v_mfma_f32_32x32x16_bf16 v[80:95], v[40:43], a[24:27], v[80:95]
  ds_read_b128 v[112:115], v9 offset:12288
  ds_read_b64_tr_b16 v[40:41], v7 offset:0
  ds_read_b64_tr_b16 v[42:43], v7 offset:1536
  buffer_load_dwordx4 v11, s[4:7], s44 offen offset:0 nt lds
  buffer_load_dwordx4 v12, s[4:7], s44 offen offset:1024 nt lds
  buffer_load_dwordx4 v13, s[4:7], s44 offen offset:2048 nt lds
  v_mfma_f32_32x32x16_bf16 v[80:95], v[44:47], a[28:31], v[80:95]
  ds_read_b64_tr_b16 v[44:45], v8 offset:0
  ds_read_b64_tr_b16 v[46:47], v8 offset:1536
  v_add_f32 v23, v23, v65
  v_exp_f32 v67, v67
  v_add_f32 v22, v22, v66
  v_mfma_f32_32x32x16_bf16 v[80:95], v[48:51], a[32:35], v[80:95]
  ds_read_b64_tr_b16 v[48:49], v7 offset:128
  ds_read_b64_tr_b16 v[50:51], v7 offset:1664
  v_exp_f32 v68, v68
  v_add_f32 v23, v23, v67
  s_waitcnt lgkmcnt(7)
  v_mfma_f32_32x32x16_bf16 v[80:95], v[52:55], a[36:39], v[80:95]
  ds_read_b64_tr_b16 v[52:53], v8 offset:128
  ds_read_b64_tr_b16 v[54:55], v8 offset:1664
  v_exp_f32 v69, v69
  v_add_f32 v22, v22, v68
  v_mfma_f32_32x32x16_bf16 v[80:95], v[56:59], a[40:43], v[80:95]
  ds_read_b64_tr_b16 v[56:57], v7 offset:256
  ds_read_b64_tr_b16 v[58:59], v7 offset:1792
  v_exp_f32 v70, v70
  v_add_f32 v23, v23, v69
  v_mfma_f32_32x32x16_bf16 v[80:95], v[60:63], a[44:47], v[80:95]
  ds_read_b64_tr_b16 v[60:61], v8 offset:256
  ds_read_b64_tr_b16 v[62:63], v8 offset:1792
  v_exp_f32 v71, v71
  v_add_f32 v22, v22, v70
  s_waitcnt lgkmcnt(6)
  v_mfma_f32_32x32x16_bf16 a[96:111], v[40:43], v[112:115], a[96:111]
  ds_read_b128 v[116:119], v10 offset:12288
  ds_read_b64_tr_b16 v[40:41], v7 offset:6144
  ds_read_b64_tr_b16 v[42:43], v7 offset:7680
  v_exp_f32 v72, v72
  v_add_f32 v23, v23, v71
  v_mfma_f32_32x32x16_bf16 a[112:127], v[44:47], v[112:115], a[112:127]
  ds_read_b64_tr_b16 v[44:45], v8 offset:6144
  ds_read_b64_tr_b16 v[46:47], v8 offset:7680
  v_exp_f32 v73, v73
  v_add_f32 v22, v22, v72
  v_cvt_pk_bf16_f32 v64, v64, v65
  v_mfma_f32_32x32x16_bf16 a[128:143], v[48:51], v[112:115], a[128:143]
  ds_read_b64_tr_b16 v[48:49], v7 offset:6272
  ds_read_b64_tr_b16 v[50:51], v7 offset:7808
  v_cvt_pk_bf16_f32 v65, v66, v67
  v_cvt_pk_bf16_f32 v66, v68, v69
  v_cvt_pk_bf16_f32 v67, v70, v71
  s_waitcnt lgkmcnt(7)
  v_mfma_f32_32x32x16_bf16 a[144:159], v[52:55], v[112:115], a[144:159]
  ds_read_b64_tr_b16 v[52:53], v8 offset:6272
  ds_read_b64_tr_b16 v[54:55], v8 offset:7808
  v_exp_f32 v74, v74
  v_add_f32 v23, v23, v73
  v_mfma_f32_32x32x16_bf16 a[160:175], v[56:59], v[112:115], a[160:175]
  ds_read_b64_tr_b16 v[56:57], v7 offset:6400
  ds_read_b64_tr_b16 v[58:59], v7 offset:7936
  v_exp_f32 v75, v75
  v_add_f32 v22, v22, v74
  v_mfma_f32_32x32x16_bf16 a[176:191], v[60:63], v[112:115], a[176:191]
  ds_read_b64_tr_b16 v[60:61], v8 offset:6400
  ds_read_b64_tr_b16 v[62:63], v8 offset:7936
  s_waitcnt vmcnt(48)
  s_barrier
  s_mov_b32 s45, 159744
  s_waitcnt lgkmcnt(6)
  v_mfma_f32_32x32x16_bf16 a[96:111], v[40:43], v[116:119], a[96:111]
  ds_read_b64_tr_b16 v[40:41], v5 offset:49152
  ds_read_b64_tr_b16 v[42:43], v5 offset:52224
  s_add_u32 m0, s32, 77824
  s_nop 0
  buffer_load_dwordx4 v11, s[4:7], s45 offen offset:0 nt lds
  buffer_load_dwordx4 v12, s[4:7], s45 offen offset:1024 nt lds
  buffer_load_dwordx4 v13, s[4:7], s45 offen offset:2048 nt lds
  v_mfma_f32_32x32x16_bf16 a[112:127], v[44:47], v[116:119], a[112:127]
  ds_read_b64_tr_b16 v[44:45], v6 offset:49152
  ds_read_b64_tr_b16 v[46:47], v6 offset:52224
  v_exp_f32 v76, v76
  v_add_f32 v23, v23, v75
  v_mfma_f32_32x32x16_bf16 a[128:143], v[48:51], v[116:119], a[128:143]
  ds_read_b64_tr_b16 v[48:49], v5 offset:49280
  ds_read_b64_tr_b16 v[50:51], v5 offset:52352
  v_exp_f32 v77, v77
  v_add_f32 v22, v22, v76
  s_waitcnt lgkmcnt(6)
  v_mfma_f32_32x32x16_bf16 a[144:159], v[52:55], v[116:119], a[144:159]
  ds_read_b64_tr_b16 v[52:53], v6 offset:49280
  ds_read_b64_tr_b16 v[54:55], v6 offset:52352
  v_exp_f32 v78, v78
  v_add_f32 v23, v23, v77
  v_mfma_f32_32x32x16_bf16 a[160:175], v[56:59], v[116:119], a[160:175]
  ds_read_b64_tr_b16 v[56:57], v5 offset:49408
  ds_read_b64_tr_b16 v[58:59], v5 offset:52480
  v_exp_f32 v79, v79
  v_add_f32 v22, v22, v78
  v_cvt_pk_bf16_f32 v72, v72, v73
  v_mfma_f32_32x32x16_bf16 a[176:191], v[60:63], v[116:119], a[176:191]
  ds_read_b64_tr_b16 v[60:61], v6 offset:49408
  ds_read_b64_tr_b16 v[62:63], v6 offset:52480
  v_add_f32 v23, v23, v79
  v_cvt_pk_bf16_f32 v73, v74, v75
  v_cvt_pk_bf16_f32 v74, v76, v77
  v_cvt_pk_bf16_f32 v75, v78, v79
  s_cmp_lg_u32 s42, 0
  s_cbranch_scc1 LrB_31
LbB_32:
  s_waitcnt lgkmcnt(6)
  v_mfma_f32_32x32x16_bf16 v[160:175], v[40:43], v[64:67], v[160:175]
  ds_read_b64_tr_b16 v[40:41], v5 offset:55296
  ds_read_b64_tr_b16 v[42:43], v5 offset:58368
  v_max3_f32 v28, v80, v81, v82
  v_max3_f32 v29, v83, v84, v85
  v_max3_f32 v28, v28, v86, v87
  v_max3_f32 v29, v29, v88, v89
  v_mfma_f32_32x32x16_bf16 v[176:191], v[44:47], v[64:67], v[176:191]
  ds_read_b64_tr_b16 v[44:45], v6 offset:55296
  ds_read_b64_tr_b16 v[46:47], v6 offset:58368
  v_max3_f32 v28, v28, v90, v91
  v_max3_f32 v29, v29, v92, v93
  v_max3_f32 v28, v28, v94, v95
  v_max_f32 v28, v28, v29
  v_mfma_f32_32x32x16_bf16 v[192:207], v[48:51], v[64:67], v[192:207]
  ds_read_b64_tr_b16 v[48:49], v5 offset:55424
  ds_read_b64_tr_b16 v[50:51], v5 offset:58496
  v_cmp_lt_f32 vcc, s43, v28
  s_cbranch_vccnz Lrare_33
Lback_34:
  s_waitcnt lgkmcnt(6)
  v_mfma_f32_32x32x16_bf16 v[208:223], v[52:55], v[64:67], v[208:223]
  ds_read_b64_tr_b16 v[52:53], v6 offset:55424
  ds_read_b64_tr_b16 v[54:55], v6 offset:58496
  v_exp_f32 v80, v80
  v_exp_f32 v81, v81
  v_mfma_f32_32x32x16_bf16 v[224:239], v[56:59], v[64:67], v[224:239]
  ds_read_b64_tr_b16 v[56:57], v5 offset:55552
  ds_read_b64_tr_b16 v[58:59], v5 offset:58624
  v_add_f32 v22, v22, v80
  v_exp_f32 v82, v82
  v_add_f32 v23, v23, v81
  v_mfma_f32_32x32x16_bf16 v[240:255], v[60:63], v[64:67], v[240:255]
  ds_read_b64_tr_b16 v[60:61], v6 offset:55552
  ds_read_b64_tr_b16 v[62:63], v6 offset:58624
  s_waitcnt vmcnt(14)
  s_barrier
  s_mov_b32 s44, 6685056
  s_waitcnt lgkmcnt(6)
  v_mfma_f32_32x32x16_bf16 v[160:175], v[40:43], v[72:75], v[160:175]
  ds_read_b128 v[112:115], v9 offset:32768
  ds_read_b64_tr_b16 v[40:41], v7 offset:20480
  ds_read_b64_tr_b16 v[42:43], v7 offset:22016
  s_add_u32 m0, s32, 0
  s_nop 0
  buffer_load_dwordx4 v17, s[12:15], s44 offen offset:0 nt lds
  buffer_load_dwordx4 v18, s[12:15], s44 offen offset:1024 nt lds
  v_mfma_f32_32x32x16_bf16 v[176:191], v[44:47], v[72:75], v[176:191]
  ds_read_b64_tr_b16 v[44:45], v8 offset:20480
  ds_read_b64_tr_b16 v[46:47], v8 offset:22016
  buffer_load_dwordx4 v19, s[12:15], s44 offen offset:2048 nt lds
  s_mov_b32 s45, 1088
  s_add_u32 m0, s33, 12288
  s_nop 0
  buffer_load_dwordx4 v20, s[16:19], s45 offen offset:0 lds
  v_mfma_f32_32x32x16_bf16 v[192:207], v[48:51], v[72:75], v[192:207]
  ds_read_b64_tr_b16 v[48:49], v7 offset:20608
  ds_read_b64_tr_b16 v[50:51], v7 offset:22144
  buffer_load_dwordx4 v21, s[16:19], s45 offen offset:1024 lds
  v_exp_f32 v83, v83
  s_waitcnt lgkmcnt(7)
  v_mfma_f32_32x32x16_bf16 v[208:223], v[52:55], v[72:75], v[208:223]
  ds_read_b64_tr_b16 v[52:53], v8 offset:20608
  ds_read_b64_tr_b16 v[54:55], v8 offset:22144
  v_add_f32 v22, v22, v82
  v_exp_f32 v84, v84
  v_add_f32 v23, v23, v83
  v_mfma_f32_32x32x16_bf16 v[224:239], v[56:59], v[72:75], v[224:239]
  ds_read_b64_tr_b16 v[56:57], v7 offset:20736
  ds_read_b64_tr_b16 v[58:59], v7 offset:22272
  v_exp_f32 v85, v85
  v_add_f32 v22, v22, v84
  v_mfma_f32_32x32x16_bf16 v[240:255], v[60:63], v[72:75], v[240:255]
  ds_read_b64_tr_b16 v[60:61], v8 offset:20736
  ds_read_b64_tr_b16 v[62:63], v8 offset:22272
  v_exp_f32 v86, v86
  v_add_f32 v23, v23, v85
  s_waitcnt lgkmcnt(6)
  v_mfma_f32_32x32x16_bf16 a[96:111], v[40:43], v[112:115], a[96:111]
  ds_read_b128 v[116:119], v10 offset:32768
  ds_read_b64_tr_b16 v[40:41], v7 offset:26624
  ds_read_b64_tr_b16 v[42:43], v7 offset:28160
  v_exp_f32 v87, v87
  v_add_f32 v22, v22, v86
  v_mfma_f32_32x32x16_bf16 a[112:127], v[44:47], v[112:115], a[112:127]
  ds_read_b64_tr_b16 v[44:45], v8 offset:26624
  ds_read_b64_tr_b16 v[46:47], v8 offset:28160
  v_exp_f32 v88, v88
  v_add_f32 v23, v23, v87
  v_mfma_f32_32x32x16_bf16 a[128:143], v[48:51], v[112:115], a[128:143]
  ds_read_b64_tr_b16 v[48:49], v7 offset:26752
  ds_read_b64_tr_b16 v[50:51], v7 offset:28288
  v_exp_f32 v89, v89
  v_add_f32 v22, v22, v88
  s_waitcnt lgkmcnt(7)
  v_mfma_f32_32x32x16_bf16 a[144:159], v[52:55], v[112:115], a[144:159]
  ds_read_b64_tr_b16 v[52:53], v8 offset:26752
  ds_read_b64_tr_b16 v[54:55], v8 offset:28288
  v_cvt_pk_bf16_f32 v80, v80, v81
  v_cvt_pk_bf16_f32 v81, v82, v83
  v_cvt_pk_bf16_f32 v82, v84, v85
  v_cvt_pk_bf16_f32 v83, v86, v87
  v_mfma_f32_32x32x16_bf16 a[160:175], v[56:59], v[112:115], a[160:175]
  ds_read_b64_tr_b16 v[56:57], v7 offset:26880
  ds_read_b64_tr_b16 v[58:59], v7 offset:28416
  v_exp_f32 v90, v90
  v_add_f32 v23, v23, v89
  v_mfma_f32_32x32x16_bf16 a[176:191], v[60:63], v[112:115], a[176:191]
  ds_read_b64_tr_b16 v[60:61], v8 offset:26880
  ds_read_b64_tr_b16 v[62:63], v8 offset:28416
  s_waitcnt vmcnt(48)
  s_barrier
  s_mov_b32 s44, 147456
  s_waitcnt lgkmcnt(6)
  v_mfma_f32_32x32x16_bf16 a[96:111], v[40:43], v[116:119], a[96:111]
  ds_read_b128 v[40:43], v1 offset:24576
  s_add_u32 m0, s32, 151552
  s_nop 0
  buffer_load_dwordx4 v14, s[8:11], s44 offen offset:0 nt lds
  buffer_load_dwordx4 v15, s[8:11], s44 offen offset:1024 nt lds
  buffer_load_dwordx4 v16, s[8:11], s44 offen offset:2048 nt lds
  v_mfma_f32_32x32x16_bf16 a[112:127], v[44:47], v[116:119], a[112:127]
  ds_read_b128 v[44:47], v2 offset:24576
  v_exp_f32 v91, v91
  v_add_f32 v22, v22, v90
  v_exp_f32 v92, v92
  v_mfma_f32_32x32x16_bf16 a[128:143], v[48:51], v[116:119], a[128:143]
  ds_read_b128 v[48:51], v3 offset:24576
  v_add_f32 v23, v23, v91
  v_exp_f32 v93, v93
  v_add_f32 v22, v22, v92
  s_waitcnt lgkmcnt(3)
  v_mfma_f32_32x32x16_bf16 a[144:159], v[52:55], v[116:119], a[144:159]
  ds_read_b128 v[52:55], v4 offset:24576
  v_exp_f32 v94, v94
  v_add_f32 v23, v23, v93
  v_exp_f32 v95, v95
  v_mfma_f32_32x32x16_bf16 a[160:175], v[56:59], v[116:119], a[160:175]
  ds_read_b128 v[56:59], v1 offset:24704
  v_add_f32 v22, v22, v94
  v_cvt_pk_bf16_f32 v88, v88, v89
  v_add_f32 v23, v23, v95
  v_cvt_pk_bf16_f32 v89, v90, v91
  v_cvt_pk_bf16_f32 v90, v92, v93
  v_mfma_f32_32x32x16_bf16 a[176:191], v[60:63], v[116:119], a[176:191]
  ds_read_b128 v[60:63], v2 offset:24704
  v_cvt_pk_bf16_f32 v91, v94, v95
  s_waitcnt lgkmcnt(3)
  v_mfma_f32_32x32x16_bf16 v[64:79], v[40:43], a[0:3], v[96:111]
  ds_read_b128 v[40:43], v3 offset:24704
  v_mfma_f32_32x32x16_bf16 v[64:79], v[44:47], a[4:7], v[64:79]
  ds_read_b128 v[44:47], v4 offset:24704
  v_mfma_f32_32x32x16_bf16 v[64:79], v[48:51], a[8:11], v[64:79]
  ds_read_b128 v[48:51], v1 offset:24832
  s_waitcnt lgkmcnt(3)
  v_mfma_f32_32x32x16_bf16 v[64:79], v[52:55], a[12:15], v[64:79]
  ds_read_b128 v[52:55], v2 offset:24832
  v_mfma_f32_32x32x16_bf16 v[64:79], v[56:59], a[16:19], v[64:79]
  ds_read_b128 v[56:59], v3 offset:24832
  v_mfma_f32_32x32x16_bf16 v[64:79], v[60:63], a[20:23], v[64:79]
  ds_read_b128 v[60:63], v4 offset:24832
  s_waitcnt vmcnt(14)
  s_barrier
  s_mov_b32 s45, 7078272
  s_add_u32 m0, s32, 20480
  s_waitcnt lgkmcnt(3)
  v_mfma_f32_32x32x16_bf16 v[64:79], v[40:43], a[24:27], v[64:79]
  ds_read_b128 v[112:115], v9 offset:53248
  ds_read_b64_tr_b16 v[40:41], v7 offset:40960
  ds_read_b64_tr_b16 v[42:43], v7 offset:42496
  buffer_load_dwordx4 v17, s[12:15], s45 offen offset:0 nt lds
  buffer_load_dwordx4 v18, s[12:15], s45 offen offset:1024 nt lds
  buffer_load_dwordx4 v19, s[12:15], s45 offen offset:2048 nt lds
  v_mfma_f32_32x32x16_bf16 v[64:79], v[44:47], a[28:31], v[64:79]
  ds_read_b64_tr_b16 v[44:45], v8 offset:40960
  ds_read_b64_tr_b16 v[46:47], v8 offset:42496
  s_mov_b32 s44, 1152
  s_add_u32 m0, s33, 32768
  s_nop 0
  buffer_load_dwordx4 v20, s[16:19], s44 offen offset:0 lds
  buffer_load_dwordx4 v21, s[16:19], s44 offen offset:1024 lds
  v_mfma_f32_32x32x16_bf16 v[64:79], v[48:51], a[32:35], v[64:79]
  ds_read_b64_tr_b16 v[48:49], v7 offset:41088
  ds_read_b64_tr_b16 v[50:51], v7 offset:42624
  s_waitcnt lgkmcnt(7)
  v_mfma_f32_32x32x16_bf16 v[64:79], v[52:55], a[36:39], v[64:79]
  ds_read_b64_tr_b16 v[52:53], v8 offset:41088
  ds_read_b64_tr_b16 v[54:55], v8 offset:42624
  v_mfma_f32_32x32x16_bf16 v[64:79], v[56:59], a[40:43], v[64:79]
  ds_read_b64_tr_b16 v[56:57], v7 offset:41216
  ds_read_b64_tr_b16 v[58:59], v7 offset:42752
  v_mfma_f32_32x32x16_bf16 v[64:79], v[60:63], a[44:47], v[64:79]
  ds_read_b64_tr_b16 v[60:61], v8 offset:41216
  ds_read_b64_tr_b16 v[62:63], v8 offset:42752
  s_waitcnt lgkmcnt(6)
  v_mfma_f32_32x32x16_bf16 a[96:111], v[40:43], v[112:115], a[96:111]
  ds_read_b128 v[116:119], v10 offset:53248
  ds_read_b64_tr_b16 v[40:41], v7 offset:47104
  ds_read_b64_tr_b16 v[42:43], v7 offset:48640
  v_mfma_f32_32x32x16_bf16 a[112:127], v[44:47], v[112:115], a[112:127]
  ds_read_b64_tr_b16 v[44:45], v8 offset:47104
  ds_read_b64_tr_b16 v[46:47], v8 offset:48640
  s_nop 1
  v_max3_f32 v28, v64, v65, v66
  v_max3_f32 v29, v67, v68, v69
  v_max3_f32 v28, v28, v70, v71
  v_max3_f32 v29, v29, v72, v73
  v_mfma_f32_32x32x16_bf16 a[128:143], v[48:51], v[112:115], a[128:143]
  ds_read_b64_tr_b16 v[48:49], v7 offset:47232
  ds_read_b64_tr_b16 v[50:51], v7 offset:48768
  v_max3_f32 v28, v28, v74, v75
  v_max3_f32 v29, v29, v76, v77
  v_max3_f32 v28, v28, v78, v79
  s_waitcnt lgkmcnt(7)
  v_mfma_f32_32x32x16_bf16 a[144:159], v[52:55], v[112:115], a[144:159]
  ds_read_b64_tr_b16 v[52:53], v8 offset:47232
  ds_read_b64_tr_b16 v[54:55], v8 offset:48768
  v_max_f32 v28, v28, v29
  v_mfma_f32_32x32x16_bf16 a[160:175], v[56:59], v[112:115], a[160:175]
  ds_read_b64_tr_b16 v[56:57], v7 offset:47360
  ds_read_b64_tr_b16 v[58:59], v7 offset:48896
  v_mfma_f32_32x32x16_bf16 a[176:191], v[60:63], v[112:115], a[176:191]
  ds_read_b64_tr_b16 v[60:61], v8 offset:47360
  ds_read_b64_tr_b16 v[62:63], v8 offset:48896
  s_waitcnt vmcnt(48)
  s_barrier
  s_mov_b32 s45, 172032
  s_waitcnt lgkmcnt(6)
  v_mfma_f32_32x32x16_bf16 a[96:111], v[40:43], v[116:119], a[96:111]
  ds_read_b64_tr_b16 v[40:41], v5 offset:36864
  ds_read_b64_tr_b16 v[42:43], v5 offset:39936
  s_add_u32 m0, s32, 90112
  s_nop 0
  buffer_load_dwordx4 v11, s[4:7], s45 offen offset:0 nt lds
  buffer_load_dwordx4 v12, s[4:7], s45 offen offset:1024 nt lds
  buffer_load_dwordx4 v13, s[4:7], s45 offen offset:2048 nt lds
  v_mfma_f32_32x32x16_bf16 a[112:127], v[44:47], v[116:119], a[112:127]
  ds_read_b64_tr_b16 v[44:45], v6 offset:36864
  ds_read_b64_tr_b16 v[46:47], v6 offset:39936
  v_mfma_f32_32x32x16_bf16 a[128:143], v[48:51], v[116:119], a[128:143]
  ds_read_b64_tr_b16 v[48:49], v5 offset:36992
  ds_read_b64_tr_b16 v[50:51], v5 offset:40064
  s_waitcnt lgkmcnt(6)
  v_mfma_f32_32x32x16_bf16 a[144:159], v[52:55], v[116:119], a[144:159]
  ds_read_b64_tr_b16 v[52:53], v6 offset:36992
  ds_read_b64_tr_b16 v[54:55], v6 offset:40064
  v_mfma_f32_32x32x16_bf16 a[160:175], v[56:59], v[116:119], a[160:175]
  ds_read_b64_tr_b16 v[56:57], v5 offset:37120
  ds_read_b64_tr_b16 v[58:59], v5 offset:40192
  v_mfma_f32_32x32x16_bf16 a[176:191], v[60:63], v[116:119], a[176:191]
  ds_read_b64_tr_b16 v[60:61], v6 offset:37120
  ds_read_b64_tr_b16 v[62:63], v6 offset:40192
  s_cmp_lg_u32 s42, 0
  s_cbranch_scc1 LrB_35
LbB_36:
  s_waitcnt lgkmcnt(6)
  v_mfma_f32_32x32x16_bf16 v[160:175], v[40:43], v[80:83], v[160:175]
  ds_read_b64_tr_b16 v[40:41], v5 offset:43008
  ds_read_b64_tr_b16 v[42:43], v5 offset:46080
  v_cmp_lt_f32 vcc, s43, v28
  s_cbranch_vccnz Lrare_37
Lback_38:
  v_exp_f32 v64, v64
  v_mfma_f32_32x32x16_bf16 v[176:191], v[44:47], v[80:83], v[176:191]
  ds_read_b64_tr_b16 v[44:45], v6 offset:43008
  ds_read_b64_tr_b16 v[46:47], v6 offset:46080
  v_exp_f32 v65, v65
  v_add_f32 v22, v22, v64
  v_mfma_f32_32x32x16_bf16 v[192:207], v[48:51], v[80:83], v[192:207]
  ds_read_b64_tr_b16 v[48:49], v5 offset:43136
  ds_read_b64_tr_b16 v[50:51], v5 offset:46208
  v_exp_f32 v66, v66
  v_add_f32 v23, v23, v65
  s_waitcnt lgkmcnt(6)
  v_mfma_f32_32x32x16_bf16 v[208:223], v[52:55], v[80:83], v[208:223]
  ds_read_b64_tr_b16 v[52:53], v6 offset:43136
  ds_read_b64_tr_b16 v[54:55], v6 offset:46208
  v_exp_f32 v67, v67
  v_add_f32 v22, v22, v66
  v_mfma_f32_32x32x16_bf16 v[224:239], v[56:59], v[80:83], v[224:239]
  ds_read_b64_tr_b16 v[56:57], v5 offset:43264
  ds_read_b64_tr_b16 v[58:59], v5 offset:46336
  v_exp_f32 v68, v68
  v_add_f32 v23, v23, v67
  v_mfma_f32_32x32x16_bf16 v[240:255], v[60:63], v[80:83], v[240:255]
  ds_read_b64_tr_b16 v[60:61], v6 offset:43264
  ds_read_b64_tr_b16 v[62:63], v6 offset:46336
  s_waitcnt vmcnt(11)
  s_barrier
  s_mov_b32 s44, 7471488
  s_waitcnt lgkmcnt(6)
  v_mfma_f32_32x32x16_bf16 v[160:175], v[40:43], v[88:91], v[160:175]
  ds_read_b128 v[112:115], v9 offset:12288
  ds_read_b64_tr_b16 v[40:41], v7 offset:0
  ds_read_b64_tr_b16 v[42:43], v7 offset:1536
  s_add_u32 m0, s32, 40960
  s_nop 0
  buffer_load_dwordx4 v17, s[12:15], s44 offen offset:0 nt lds
  buffer_load_dwordx4 v18, s[12:15], s44 offen offset:1024 nt lds
  v_mfma_f32_32x32x16_bf16 v[176:191], v[44:47], v[88:91], v[176:191]
  ds_read_b64_tr_b16 v[44:45], v8 offset:0
  ds_read_b64_tr_b16 v[46:47], v8 offset:1536
  buffer_load_dwordx4 v19, s[12:15], s44 offen offset:2048 nt lds
  s_mov_b32 s45, 1216
  s_add_u32 m0, s33, 53248
  s_nop 0
  buffer_load_dwordx4 v20, s[16:19], s45 offen offset:0 lds
  v_mfma_f32_32x32x16_bf16 v[192:207], v[48:51], v[88:91], v[192:207]
  ds_read_b64_tr_b16 v[48:49], v7 offset:128
  ds_read_b64_tr_b16 v[50:51], v7 offset:1664
  buffer_load_dwordx4 v21, s[16:19], s45 offen offset:1024 lds
  v_exp_f32 v69, v69
  s_waitcnt lgkmcnt(7)
  v_mfma_f32_32x32x16_bf16 v[208:223], v[52:55], v[88:91], v[208:223]
  ds_read_b64_tr_b16 v[52:53], v8 offset:128
  ds_read_b64_tr_b16 v[54:55], v8 offset:1664
  v_add_f32 v22, v22, v68
  v_exp_f32 v70, v70
  v_add_f32 v23, v23, v69
  v_mfma_f32_32x32x16_bf16 v[224:239], v[56:59], v[88:91], v[224:239]
  ds_read_b64_tr_b16 v[56:57], v7 offset:256
  ds_read_b64_tr_b16 v[58:59], v7 offset:1792
  v_exp_f32 v71, v71
  v_add_f32 v22, v22, v70
  v_mfma_f32_32x32x16_bf16 v[240:255], v[60:63], v[88:91], v[240:255]
  ds_read_b64_tr_b16 v[60:61], v8 offset:256
  ds_read_b64_tr_b16 v[62:63], v8 offset:1792
  v_exp_f32 v72, v72
  v_add_f32 v23, v23, v71
  s_waitcnt lgkmcnt(6)
  v_mfma_f32_32x32x16_bf16 a[96:111], v[40:43], v[112:115], a[96:111]
  ds_read_b128 v[116:119], v10 offset:12288
  ds_read_b64_tr_b16 v[40:41], v7 offset:6144
  ds_read_b64_tr_b16 v[42:43], v7 offset:7680
  v_exp_f32 v73, v73
  v_add_f32 v22, v22, v72
  v_mfma_f32_32x32x16_bf16 a[112:127], v[44:47], v[112:115], a[112:127]
  ds_read_b64_tr_b16 v[44:45], v8 offset:6144
  ds_read_b64_tr_b16 v[46:47], v8 offset:7680
  v_cvt_pk_bf16_f32 v64, v64, v65
  v_cvt_pk_bf16_f32 v65, v66, v67
  v_cvt_pk_bf16_f32 v66, v68, v69
  v_cvt_pk_bf16_f32 v67, v70, v71
  v_mfma_f32_32x32x16_bf16 a[128:143], v[48:51], v[112:115], a[128:143]
  ds_read_b64_tr_b16 v[48:49], v7 offset:6272
  ds_read_b64_tr_b16 v[50:51], v7 offset:7808
  v_exp_f32 v74, v74
  v_add_f32 v23, v23, v73
  s_waitcnt lgkmcnt(7)
  v_mfma_f32_32x32x16_bf16 a[144:159], v[52:55], v[112:115], a[144:159]
  ds_read_b64_tr_b16 v[52:53], v8 offset:6272
  ds_read_b64_tr_b16 v[54:55], v8 offset:7808
  v_exp_f32 v75, v75
  v_add_f32 v22, v22, v74
  v_mfma_f32_32x32x16_bf16 a[160:175], v[56:59], v[112:115], a[160:175]
  ds_read_b64_tr_b16 v[56:57], v7 offset:6400
  ds_read_b64_tr_b16 v[58:59], v7 offset:7936
  v_exp_f32 v76, v76
  v_add_f32 v23, v23, v75
  v_mfma_f32_32x32x16_bf16 a[176:191], v[60:63], v[112:115], a[176:191]
  ds_read_b64_tr_b16 v[60:61], v8 offset:6400
  ds_read_b64_tr_b16 v[62:63], v8 offset:7936
  v_and_b32 v18, 63, v0
  v_lshrrev_b32 v19, 4, v18
  v_lshlrev_b32 v38, 2, v19
  v_and_b32 v39, 15, v18
  v_xor_b32 v38, v38, v39
  v_lshlrev_b32 v38, 4, v38
  v_mul_u32_u24 v19, 1280, v19
  s_mul_i32 s41, s28, 15360
  v_add3_u32 v17, v19, v38, s41
  v_add_u32 v18, 4096, v17
  v_add_u32 v19, 8192, v17
  s_waitcnt vmcnt(48)
  s_barrier
  s_mov_b32 s44, 159744
  s_waitcnt lgkmcnt(6)
  v_mfma_f32_32x32x16_bf16 a[96:111], v[40:43], v[116:119], a[96:111]
  ds_read_b128 v[40:43], v1 offset:0
  s_add_u32 m0, s32, 139264
  s_nop 0
  buffer_load_dwordx4 v14, s[8:11], s44 offen offset:0 nt lds
  buffer_load_dwordx4 v15, s[8:11], s44 offen offset:1024 nt lds
  buffer_load_dwordx4 v16, s[8:11], s44 offen offset:2048 nt lds
  v_mfma_f32_32x32x16_bf16 a[112:127], v[44:47], v[116:119], a[112:127]
  ds_read_b128 v[44:47], v2 offset:0
  v_exp_f32 v77, v77
  v_add_f32 v22, v22, v76
  v_exp_f32 v78, v78
  v_mfma_f32_32x32x16_bf16 a[128:143], v[48:51], v[116:119], a[128:143]
  ds_read_b128 v[48:51], v3 offset:0
  v_add_f32 v23, v23, v77
  v_exp_f32 v79, v79
  v_add_f32 v22, v22, v78
  s_waitcnt lgkmcnt(3)
  v_mfma_f32_32x32x16_bf16 a[144:159], v[52:55], v[116:119], a[144:159]
  ds_read_b128 v[52:55], v4 offset:0
  v_cvt_pk_bf16_f32 v72, v72, v73
  v_add_f32 v23, v23, v79
  v_cvt_pk_bf16_f32 v73, v74, v75
  v_cvt_pk_bf16_f32 v74, v76, v77
  v_cvt_pk_bf16_f32 v75, v78, v79
  v_mfma_f32_32x32x16_bf16 a[160:175], v[56:59], v[116:119], a[160:175]
  ds_read_b128 v[56:59], v1 offset:128
  v_mfma_f32_32x32x16_bf16 a[176:191], v[60:63], v[116:119], a[176:191]
  ds_read_b128 v[60:63], v2 offset:128
  s_waitcnt lgkmcnt(3)
  v_mfma_f32_32x32x16_bf16 v[80:95], v[40:43], a[0:3], v[96:111]
  ds_read_b128 v[40:43], v3 offset:128
  v_mfma_f32_32x32x16_bf16 v[80:95], v[44:47], a[4:7], v[80:95]
  ds_read_b128 v[44:47], v4 offset:128
  v_mfma_f32_32x32x16_bf16 v[80:95], v[48:51], a[8:11], v[80:95]
  ds_read_b128 v[48:51], v1 offset:256
  s_waitcnt lgkmcnt(3)
  v_mfma_f32_32x32x16_bf16 v[80:95], v[52:55], a[12:15], v[80:95]
  ds_read_b128 v[52:55], v2 offset:256
  v_mfma_f32_32x32x16_bf16 v[80:95], v[56:59], a[16:19], v[80:95]
  ds_read_b128 v[56:59], v3 offset:256
  v_mfma_f32_32x32x16_bf16 v[80:95], v[60:63], a[20:23], v[80:95]
  ds_read_b128 v[60:63], v4 offset:256
  s_waitcnt vmcnt(11)
  s_barrier
  s_mov_b32 s45, 0
  s_add_u32 m0, s32, 0
  s_waitcnt lgkmcnt(3)
  v_mfma_f32_32x32x16_bf16 v[80:95], v[40:43], a[24:27], v[80:95]
  ds_read_b128 v[112:115], v9 offset:32768
  ds_read_b64_tr_b16 v[40:41], v7 offset:20480
  ds_read_b64_tr_b16 v[42:43], v7 offset:22016
  buffer_load_dwordx4 v17, s[20:23], s45 offen offset:0 nt lds
  buffer_load_dwordx4 v18, s[20:23], s45 offen offset:1024 nt lds
  buffer_load_dwordx4 v19, s[20:23], s45 offen offset:2048 nt lds
  v_mfma_f32_32x32x16_bf16 v[80:95], v[44:47], a[28:31], v[80:95]
  ds_read_b64_tr_b16 v[44:45], v8 offset:20480
  ds_read_b64_tr_b16 v[46:47], v8 offset:22016
  v_mfma_f32_32x32x16_bf16 v[80:95], v[48:51], a[32:35], v[80:95]
  ds_read_b64_tr_b16 v[48:49], v7 offset:20608
  ds_read_b64_tr_b16 v[50:51], v7 offset:22144
  s_waitcnt lgkmcnt(7)
  v_mfma_f32_32x32x16_bf16 v[80:95], v[52:55], a[36:39], v[80:95]
  ds_read_b64_tr_b16 v[52:53], v8 offset:20608
  ds_read_b64_tr_b16 v[54:55], v8 offset:22144
  v_mfma_f32_32x32x16_bf16 v[80:95], v[56:59], a[40:43], v[80:95]
  ds_read_b64_tr_b16 v[56:57], v7 offset:20736
  ds_read_b64_tr_b16 v[58:59], v7 offset:22272
  v_mfma_f32_32x32x16_bf16 v[80:95], v[60:63], a[44:47], v[80:95]
  ds_read_b64_tr_b16 v[60:61], v8 offset:20736
  ds_read_b64_tr_b16 v[62:63], v8 offset:22272
  s_waitcnt lgkmcnt(6)
  v_mfma_f32_32x32x16_bf16 a[96:111], v[40:43], v[112:115], a[96:111]
  ds_read_b128 v[116:119], v10 offset:32768
  ds_read_b64_tr_b16 v[40:41], v7 offset:26624
  ds_read_b64_tr_b16 v[42:43], v7 offset:28160
  v_mfma_f32_32x32x16_bf16 a[112:127], v[44:47], v[112:115], a[112:127]
  ds_read_b64_tr_b16 v[44:45], v8 offset:26624
  ds_read_b64_tr_b16 v[46:47], v8 offset:28160
  s_nop 1
  v_max3_f32 v28, v80, v81, v82
  v_max3_f32 v29, v83, v84, v85
  v_max3_f32 v28, v28, v86, v87
  v_max3_f32 v29, v29, v88, v89
  v_mfma_f32_32x32x16_bf16 a[128:143], v[48:51], v[112:115], a[128:143]
  ds_read_b64_tr_b16 v[48:49], v7 offset:26752
  ds_read_b64_tr_b16 v[50:51], v7 offset:28288
  v_max3_f32 v28, v28, v90, v91
  v_max3_f32 v29, v29, v92, v93
  v_max3_f32 v28, v28, v94, v95
  s_waitcnt lgkmcnt(7)
  v_mfma_f32_32x32x16_bf16 a[144:159], v[52:55], v[112:115], a[144:159]
  ds_read_b64_tr_b16 v[52:53], v8 offset:26752
  ds_read_b64_tr_b16 v[54:55], v8 offset:28288
  v_max_f32 v28, v28, v29
  v_mfma_f32_32x32x16_bf16 a[160:175], v[56:59], v[112:115], a[160:175]
  ds_read_b64_tr_b16 v[56:57], v7 offset:26880
  ds_read_b64_tr_b16 v[58:59], v7 offset:28416
  v_mfma_f32_32x32x16_bf16 a[176:191], v[60:63], v[112:115], a[176:191]
  ds_read_b64_tr_b16 v[60:61], v8 offset:26880
  ds_read_b64_tr_b16 v[62:63], v8 offset:28416
  s_waitcnt vmcnt(46)
  s_barrier
  s_mov_b32 s44, 184320
  s_waitcnt lgkmcnt(6)
  v_mfma_f32_32x32x16_bf16 a[96:111], v[40:43], v[116:119], a[96:111]
  ds_read_b64_tr_b16 v[40:41], v5 offset:24576
  ds_read_b64_tr_b16 v[42:43], v5 offset:27648
  s_add_u32 m0, s32, 65536
  s_nop 0
  buffer_load_dwordx4 v11, s[4:7], s44 offen offset:0 nt lds
  buffer_load_dwordx4 v12, s[4:7], s44 offen offset:1024 nt lds
  buffer_load_dwordx4 v13, s[4:7], s44 offen offset:2048 nt lds
  v_mfma_f32_32x32x16_bf16 a[112:127], v[44:47], v[116:119], a[112:127]
  ds_read_b64_tr_b16 v[44:45], v6 offset:24576
  ds_read_b64_tr_b16 v[46:47], v6 offset:27648
  v_mfma_f32_32x32x16_bf16 a[128:143], v[48:51], v[116:119], a[128:143]
  ds_read_b64_tr_b16 v[48:49], v5 offset:24704
  ds_read_b64_tr_b16 v[50:51], v5 offset:27776
  s_waitcnt lgkmcnt(6)
  v_mfma_f32_32x32x16_bf16 a[144:159], v[52:55], v[116:119], a[144:159]
  ds_read_b64_tr_b16 v[52:53], v6 offset:24704
  ds_read_b64_tr_b16 v[54:55], v6 offset:27776
  v_mfma_f32_32x32x16_bf16 a[160:175], v[56:59], v[116:119], a[160:175]
  ds_read_b64_tr_b16 v[56:57], v5 offset:24832
  ds_read_b64_tr_b16 v[58:59], v5 offset:27904
  v_mfma_f32_32x32x16_bf16 a[176:191], v[60:63], v[116:119], a[176:191]
  ds_read_b64_tr_b16 v[60:61], v6 offset:24832
  ds_read_b64_tr_b16 v[62:63], v6 offset:27904
  s_cmp_lg_u32 s42, 0
  s_cbranch_scc1 LrB_39
LbB_40:
  s_waitcnt lgkmcnt(6)
  v_mfma_f32_32x32x16_bf16 v[160:175], v[40:43], v[64:67], v[160:175]
  ds_read_b64_tr_b16 v[40:41], v5 offset:30720
  ds_read_b64_tr_b16 v[42:43], v5 offset:33792
  v_cmp_lt_f32 vcc, s43, v28
  s_cbranch_vccnz Lrare_41
Lback_42:
  v_exp_f32 v80, v80
  v_mfma_f32_32x32x16_bf16 v[176:191], v[44:47], v[64:67], v[176:191]
  ds_read_b64_tr_b16 v[44:45], v6 offset:30720
  ds_read_b64_tr_b16 v[46:47], v6 offset:33792
  v_exp_f32 v81, v81
  v_add_f32 v22, v22, v80
  v_mfma_f32_32x32x16_bf16 v[192:207], v[48:51], v[64:67], v[192:207]
  ds_read_b64_tr_b16 v[48:49], v5 offset:30848
  ds_read_b64_tr_b16 v[50:51], v5 offset:33920
  v_exp_f32 v82, v82
  v_add_f32 v23, v23, v81
  s_waitcnt lgkmcnt(6)
  v_mfma_f32_32x32x16_bf16 v[208:223], v[52:55], v[64:67], v[208:223]
  ds_read_b64_tr_b16 v[52:53], v6 offset:30848
  ds_read_b64_tr_b16 v[54:55], v6 offset:33920
  v_exp_f32 v83, v83
  v_add_f32 v22, v22, v82
  v_mfma_f32_32x32x16_bf16 v[224:239], v[56:59], v[64:67], v[224:239]
  ds_read_b64_tr_b16 v[56:57], v5 offset:30976
  ds_read_b64_tr_b16 v[58:59], v5 offset:34048
  v_exp_f32 v84, v84
  v_add_f32 v23, v23, v83
  v_mfma_f32_32x32x16_bf16 v[240:255], v[60:63], v[64:67], v[240:255]
  ds_read_b64_tr_b16 v[60:61], v6 offset:30976
  ds_read_b64_tr_b16 v[62:63], v6 offset:34048
  s_waitcnt vmcnt(9)
  s_barrier
  s_mov_b32 s45, 61440
  s_waitcnt lgkmcnt(6)
  v_mfma_f32_32x32x16_bf16 v[160:175], v[40:43], v[72:75], v[160:175]
  ds_read_b128 v[112:115], v9 offset:53248
  ds_read_b64_tr_b16 v[40:41], v7 offset:40960
  ds_read_b64_tr_b16 v[42:43], v7 offset:42496
  s_add_u32 m0, s32, 12288
  s_nop 0
  buffer_load_dwordx4 v17, s[20:23], s45 offen offset:0 nt lds
  buffer_load_dwordx4 v18, s[20:23], s45 offen offset:1024 nt lds
  v_mfma_f32_32x32x16_bf16 v[176:191], v[44:47], v[72:75], v[176:191]
  ds_read_b64_tr_b16 v[44:45], v8 offset:40960
  ds_read_b64_tr_b16 v[46:47], v8 offset:42496
  buffer_load_dwordx4 v19, s[20:23], s45 offen offset:2048 nt lds
  s_mov_b32 s44, 122880
  s_add_u32 m0, s32, 24576
  s_nop 0
  buffer_load_dwordx4 v17, s[20:23], s44 offen offset:0 nt lds
  v_mfma_f32_32x32x16_bf16 v[192:207], v[48:51], v[72:75], v[192:207]
  ds_read_b64_tr_b16 v[48:49], v7 offset:41088
  ds_read_b64_tr_b16 v[50:51], v7 offset:42624
  buffer_load_dwordx4 v18, s[20:23], s44 offen offset:1024 nt lds
  buffer_load_dwordx4 v19, s[20:23], s44 offen offset:2048 nt lds
  s_waitcnt lgkmcnt(7)
  v_mfma_f32_32x32x16_bf16 v[208:223], v[52:55], v[72:75], v[208:223]
  ds_read_b64_tr_b16 v[52:53], v8 offset:41088
  ds_read_b64_tr_b16 v[54:55], v8 offset:42624
  v_exp_f32 v85, v85
  v_add_f32 v22, v22, v84
  v_mfma_f32_32x32x16_bf16 v[224:239], v[56:59], v[72:75], v[224:239]
  ds_read_b64_tr_b16 v[56:57], v7 offset:41216
  ds_read_b64_tr_b16 v[58:59], v7 offset:42752
  v_exp_f32 v86, v86
  v_add_f32 v23, v23, v85
  v_mfma_f32_32x32x16_bf16 v[240:255], v[60:63], v[72:75], v[240:255]
  ds_read_b64_tr_b16 v[60:61], v8 offset:41216
  ds_read_b64_tr_b16 v[62:63], v8 offset:42752
  v_exp_f32 v87, v87
  v_add_f32 v22, v22, v86
  s_waitcnt lgkmcnt(6)
  v_mfma_f32_32x32x16_bf16 a[96:111], v[40:43], v[112:115], a[96:111]
  ds_read_b128 v[116:119], v10 offset:53248
  ds_read_b64_tr_b16 v[40:41], v7 offset:47104
  ds_read_b64_tr_b16 v[42:43], v7 offset:48640
  v_exp_f32 v88, v88
  v_add_f32 v23, v23, v87
  v_mfma_f32_32x32x16_bf16 a[112:127], v[44:47], v[112:115], a[112:127]
  ds_read_b64_tr_b16 v[44:45], v8 offset:47104
  ds_read_b64_tr_b16 v[46:47], v8 offset:48640
  v_exp_f32 v89, v89
  v_add_f32 v22, v22, v88
  v_cvt_pk_bf16_f32 v80, v80, v81
  v_mfma_f32_32x32x16_bf16 a[128:143], v[48:51], v[112:115], a[128:143]
  ds_read_b64_tr_b16 v[48:49], v7 offset:47232
  ds_read_b64_tr_b16 v[50:51], v7 offset:48768
  v_cvt_pk_bf16_f32 v81, v82, v83
  v_cvt_pk_bf16_f32 v82, v84, v85
  v_cvt_pk_bf16_f32 v83, v86, v87
  s_waitcnt lgkmcnt(7)
  v_mfma_f32_32x32x16_bf16 a[144:159], v[52:55], v[112:115], a[144:159]
  ds_read_b64_tr_b16 v[52:53], v8 offset:47232
  ds_read_b64_tr_b16 v[54:55], v8 offset:48768
  v_exp_f32 v90, v90
  v_add_f32 v23, v23, v89
  v_mfma_f32_32x32x16_bf16 a[160:175], v[56:59], v[112:115], a[160:175]
  ds_read_b64_tr_b16 v[56:57], v7 offset:47360
  ds_read_b64_tr_b16 v[58:59], v7 offset:48896
  v_exp_f32 v91, v91
  v_add_f32 v22, v22, v90
  v_mfma_f32_32x32x16_bf16 a[176:191], v[60:63], v[112:115], a[176:191]
  ds_read_b64_tr_b16 v[60:61], v8 offset:47360
  ds_read_b64_tr_b16 v[62:63], v8 offset:48896
  v_and_b32 v8, 63, v0
  v_bfe_u32 v9, v8, 4, 1
  v_lshlrev_b32 v9, 5, v9
  v_and_b32 v38, 1, v8
  v_lshl_or_b32 v9, v38, 4, v9
  v_bfe_u32 v38, v8, 1, 1
  v_lshl_or_b32 v9, v38, 3, v9
  v_bfe_u32 v38, v8, 2, 2
  v_lshl_or_b32 v9, v38, 6, v9
  v_lshrrev_b32 v39, 5, v8
  v_lshl_add_u32 v39, v39, 3, v38
  v_lshl_or_b32 v7, v39, 8, v9
  v_xor_b32 v8, 64, v7
  v_xor_b32 v9, 128, v7
  v_xor_b32 v10, 192, v7
  s_waitcnt vmcnt(47)
  s_barrier
  s_mov_b32 s45, 172032
  s_waitcnt lgkmcnt(6)
  v_mfma_f32_32x32x16_bf16 a[96:111], v[40:43], v[116:119], a[96:111]
  ds_read_b64_tr_b16 v[40:41], v5 offset:0
  ds_read_b64_tr_b16 v[42:43], v5 offset:3072
  s_add_u32 m0, s32, 126976
  s_nop 0
  buffer_load_dwordx4 v14, s[8:11], s45 offen offset:0 nt lds
  buffer_load_dwordx4 v15, s[8:11], s45 offen offset:1024 nt lds
  buffer_load_dwordx4 v16, s[8:11], s45 offen offset:2048 nt lds
  v_mfma_f32_32x32x16_bf16 a[112:127], v[44:47], v[116:119], a[112:127]
  ds_read_b64_tr_b16 v[44:45], v6 offset:0
  ds_read_b64_tr_b16 v[46:47], v6 offset:3072
  v_exp_f32 v92, v92
  v_add_f32 v23, v23, v91
  v_mfma_f32_32x32x16_bf16 a[128:143], v[48:51], v[116:119], a[128:143]
  ds_read_b64_tr_b16 v[48:49], v5 offset:128
  ds_read_b64_tr_b16 v[50:51], v5 offset:3200
  v_exp_f32 v93, v93
  v_add_f32 v22, v22, v92
  s_waitcnt lgkmcnt(6)
  v_mfma_f32_32x32x16_bf16 a[144:159], v[52:55], v[116:119], a[144:159]
  ds_read_b64_tr_b16 v[52:53], v6 offset:128
  ds_read_b64_tr_b16 v[54:55], v6 offset:3200
  v_exp_f32 v94, v94
  v_add_f32 v23, v23, v93
  v_mfma_f32_32x32x16_bf16 a[160:175], v[56:59], v[116:119], a[160:175]
  ds_read_b64_tr_b16 v[56:57], v5 offset:256
  ds_read_b64_tr_b16 v[58:59], v5 offset:3328
  v_exp_f32 v95, v95
  v_add_f32 v22, v22, v94
  v_cvt_pk_bf16_f32 v88, v88, v89
  v_mfma_f32_32x32x16_bf16 a[176:191], v[60:63], v[116:119], a[176:191]
  ds_read_b64_tr_b16 v[60:61], v6 offset:256
  ds_read_b64_tr_b16 v[62:63], v6 offset:3328
  v_add_f32 v23, v23, v95
  v_cvt_pk_bf16_f32 v89, v90, v91
  v_cvt_pk_bf16_f32 v90, v92, v93
  v_cvt_pk_bf16_f32 v91, v94, v95
  s_cmp_lg_u32 s42, 0
  s_cbranch_scc1 LrB_43
LbB_44:
  s_waitcnt lgkmcnt(6)
  v_mfma_f32_32x32x16_bf16 v[160:175], v[40:43], v[80:83], v[160:175]
  ds_read_b64_tr_b16 v[40:41], v5 offset:6144
  ds_read_b64_tr_b16 v[42:43], v5 offset:9216
  v_mfma_f32_32x32x16_bf16 v[176:191], v[44:47], v[80:83], v[176:191]
  ds_read_b64_tr_b16 v[44:45], v6 offset:6144
  ds_read_b64_tr_b16 v[46:47], v6 offset:9216
  v_accvgpr_read_b32 v32, a96
  v_accvgpr_read_b32 v33, a97
  v_mul_f32 v32, s31, v32
  v_mul_f32 v33, s31, v33
  v_mfma_f32_32x32x16_bf16 v[192:207], v[48:51], v[80:83], v[192:207]
  ds_read_b64_tr_b16 v[48:49], v5 offset:6272
  ds_read_b64_tr_b16 v[50:51], v5 offset:9344
  v_cvt_pk_bf16_f32 v32, v32, v33
  v_accvgpr_write_b32 a48, v32
  v_accvgpr_read_b32 v34, a98
  s_waitcnt lgkmcnt(6)
  v_mfma_f32_32x32x16_bf16 v[208:223], v[52:55], v[80:83], v[208:223]
  ds_read_b64_tr_b16 v[52:53], v6 offset:6272
  ds_read_b64_tr_b16 v[54:55], v6 offset:9344
  v_accvgpr_read_b32 v35, a99
  v_mul_f32 v34, s31, v34
  v_mul_f32 v35, s31, v35
  v_cvt_pk_bf16_f32 v34, v34, v35
  v_mfma_f32_32x32x16_bf16 v[224:239], v[56:59], v[80:83], v[224:239]
  ds_read_b64_tr_b16 v[56:57], v5 offset:6400
  ds_read_b64_tr_b16 v[58:59], v5 offset:9472
  v_accvgpr_write_b32 a49, v34
  v_accvgpr_read_b32 v36, a100
  v_accvgpr_read_b32 v37, a101
  v_mul_f32 v36, s31, v36
  v_mfma_f32_32x32x16_bf16 v[240:255], v[60:63], v[80:83], v[240:255]
  ds_read_b64_tr_b16 v[60:61], v6 offset:6400
  ds_read_b64_tr_b16 v[62:63], v6 offset:9472
  s_waitcnt vmcnt(42)
  s_barrier
  v_mul_f32 v37, s31, v37
  s_waitcnt lgkmcnt(6)
  v_mfma_f32_32x32x16_bf16 v[160:175], v[40:43], v[88:91], v[160:175]
  ds_read_b128 v[40:43], v1 offset:49152
  v_cvt_pk_bf16_f32 v36, v36, v37
  v_accvgpr_write_b32 a50, v36
  v_accvgpr_read_b32 v32, a102
  v_accvgpr_read_b32 v33, a103
  v_mul_f32 v32, s31, v32
  v_mfma_f32_32x32x16_bf16 v[176:191], v[44:47], v[88:91], v[176:191]
  ds_read_b128 v[44:47], v2 offset:49152
  v_mul_f32 v33, s31, v33
  v_cvt_pk_bf16_f32 v32, v32, v33
  v_accvgpr_write_b32 a51, v32
  v_accvgpr_read_b32 v34, a104
  v_accvgpr_read_b32 v35, a105
  v_mfma_f32_32x32x16_bf16 v[192:207], v[48:51], v[88:91], v[192:207]
  ds_read_b128 v[48:51], v3 offset:49152
  v_mul_f32 v34, s31, v34
  v_mul_f32 v35, s31, v35
  v_cvt_pk_bf16_f32 v34, v34, v35
  v_accvgpr_write_b32 a52, v34
  s_waitcnt lgkmcnt(3)
  v_mfma_f32_32x32x16_bf16 v[208:223], v[52:55], v[88:91], v[208:223]
  ds_read_b128 v[52:55], v4 offset:49152
  v_accvgpr_read_b32 v36, a106
  v_accvgpr_read_b32 v37, a107
  v_mul_f32 v36, s31, v36
  v_mul_f32 v37, s31, v37
  v_cvt_pk_bf16_f32 v36, v36, v37
  v_mfma_f32_32x32x16_bf16 v[224:239], v[56:59], v[88:91], v[224:239]
  ds_read_b128 v[56:59], v1 offset:49280
  v_accvgpr_write_b32 a53, v36
  v_accvgpr_read_b32 v32, a108
  v_accvgpr_read_b32 v33, a109
  v_mul_f32 v32, s31, v32
  v_mul_f32 v33, s31, v33
  v_mfma_f32_32x32x16_bf16 v[240:255], v[60:63], v[88:91], v[240:255]
  ds_read_b128 v[60:63], v2 offset:49280
  v_cvt_pk_bf16_f32 v32, v32, v33
  v_accvgpr_write_b32 a54, v32
  v_accvgpr_read_b32 v34, a110
  v_accvgpr_read_b32 v35, a111
  s_waitcnt lgkmcnt(3)
  v_mfma_f32_32x32x16_bf16 v[64:79], v[40:43], a[0:3], v[96:111]
  ds_read_b128 v[40:43], v3 offset:49280
  v_mul_f32 v34, s31, v34
  v_mul_f32 v35, s31, v35
  v_cvt_pk_bf16_f32 v34, v34, v35
  v_accvgpr_write_b32 a55, v34
  v_accvgpr_read_b32 v36, a112
  v_mfma_f32_32x32x16_bf16 v[64:79], v[44:47], a[4:7], v[64:79]
  ds_read_b128 v[44:47], v4 offset:49280
  v_accvgpr_read_b32 v37, a113
  v_mul_f32 v36, s31, v36
  v_mul_f32 v37, s31, v37
  v_cvt_pk_bf16_f32 v36, v36, v37
  v_accvgpr_write_b32 a56, v36
  v_mfma_f32_32x32x16_bf16 v[64:79], v[48:51], a[8:11], v[64:79]
  ds_read_b128 v[48:51], v1 offset:49408
  v_accvgpr_read_b32 v32, a114
  v_accvgpr_read_b32 v33, a115
  v_mul_f32 v32, s31, v32
  v_mul_f32 v33, s31, v33
  s_waitcnt lgkmcnt(3)
  v_mfma_f32_32x32x16_bf16 v[64:79], v[52:55], a[12:15], v[64:79]
  ds_read_b128 v[52:55], v2 offset:49408
  v_cvt_pk_bf16_f32 v32, v32, v33
  v_accvgpr_write_b32 a57, v32
  v_accvgpr_read_b32 v34, a116
  v_accvgpr_read_b32 v35, a117
  v_mul_f32 v34, s31, v34
  v_mfma_f32_32x32x16_bf16 v[64:79], v[56:59], a[16:19], v[64:79]
  ds_read_b128 v[56:59], v3 offset:49408
  v_mul_f32 v35, s31, v35
  v_cvt_pk_bf16_f32 v34, v34, v35
  v_accvgpr_write_b32 a58, v34
  v_accvgpr_read_b32 v36, a118
  v_accvgpr_read_b32 v37, a119
  v_mfma_f32_32x32x16_bf16 v[64:79], v[60:63], a[20:23], v[64:79]
  ds_read_b128 v[60:63], v4 offset:49408
  s_waitcnt vmcnt(39)
  s_barrier
  s_mov_b32 s44, 184320
  s_add_u32 m0, s32, 102400
  s_waitcnt lgkmcnt(3)
  v_mfma_f32_32x32x16_bf16 v[64:79], v[40:43], a[24:27], v[64:79]
  ds_read_b128 v[40:43], v1 offset:12288
  buffer_load_dwordx4 v14, s[8:11], s44 offen offset:0 nt lds
  buffer_load_dwordx4 v15, s[8:11], s44 offen offset:1024 nt lds
  buffer_load_dwordx4 v16, s[8:11], s44 offen offset:2048 nt lds
  s_mov_b32 s45, 196608
  s_add_u32 m0, s32, 36864
  v_mfma_f32_32x32x16_bf16 v[64:79], v[44:47], a[28:31], v[64:79]
  ds_read_b128 v[44:47], v2 offset:12288
  buffer_load_dwordx4 v11, s[4:7], s45 offen offset:0 nt lds
  buffer_load_dwordx4 v12, s[4:7], s45 offen offset:1024 nt lds
  buffer_load_dwordx4 v13, s[4:7], s45 offen offset:2048 nt lds
  s_mov_b32 s44, 208896
  s_add_u32 m0, s32, 49152
  v_mfma_f32_32x32x16_bf16 v[64:79], v[48:51], a[32:35], v[64:79]
  ds_read_b128 v[48:51], v3 offset:12288
  buffer_load_dwordx4 v11, s[4:7], s44 offen offset:0 nt lds
  buffer_load_dwordx4 v12, s[4:7], s44 offen offset:1024 nt lds
  buffer_load_dwordx4 v13, s[4:7], s44 offen offset:2048 nt lds
  v_mul_f32 v36, s31, v36
  s_waitcnt lgkmcnt(3)
  v_mfma_f32_32x32x16_bf16 v[64:79], v[52:55], a[36:39], v[64:79]
  ds_read_b128 v[52:55], v4 offset:12288
  v_mul_f32 v37, s31, v37
  v_cvt_pk_bf16_f32 v36, v36, v37
  v_accvgpr_write_b32 a59, v36
  v_accvgpr_read_b32 v32, a120
  v_accvgpr_read_b32 v33, a121
  v_mfma_f32_32x32x16_bf16 v[64:79], v[56:59], a[40:43], v[64:79]
  ds_read_b128 v[56:59], v1 offset:12416
  v_mul_f32 v32, s31, v32
  v_mul_f32 v33, s31, v33
  v_cvt_pk_bf16_f32 v32, v32, v33
  v_accvgpr_write_b32 a60, v32
  v_accvgpr_read_b32 v34, a122
  v_mfma_f32_32x32x16_bf16 v[64:79], v[60:63], a[44:47], v[64:79]
  ds_read_b128 v[60:63], v2 offset:12416
  v_accvgpr_read_b32 v35, a123
  v_mul_f32 v34, s31, v34
  v_mul_f32 v35, s31, v35
  v_cvt_pk_bf16_f32 v34, v34, v35
  s_waitcnt lgkmcnt(3)
  v_mfma_f32_32x32x16_bf16 v[80:95], v[40:43], a[0:3], v[96:111]
  ds_read_b128 v[40:43], v3 offset:12416
  v_accvgpr_write_b32 a61, v34
  v_accvgpr_read_b32 v36, a124
  v_accvgpr_read_b32 v37, a125
  v_mul_f32 v36, s31, v36
  v_mul_f32 v37, s31, v37
  v_mfma_f32_32x32x16_bf16 v[80:95], v[44:47], a[4:7], v[80:95]
  ds_read_b128 v[44:47], v4 offset:12416
  v_max3_f32 v28, v64, v65, v66
  v_max3_f32 v29, v67, v68, v69
  v_max3_f32 v28, v28, v70, v71
  v_max3_f32 v29, v29, v72, v73
  v_max3_f32 v28, v28, v74, v75
  v_mfma_f32_32x32x16_bf16 v[80:95], v[48:51], a[8:11], v[80:95]
  ds_read_b128 v[48:51], v1 offset:12544
  v_max3_f32 v29, v29, v76, v77
  v_max3_f32 v28, v28, v78, v79
  v_max_f32 v28, v28, v29
  v_cvt_pk_bf16_f32 v36, v36, v37
  s_waitcnt lgkmcnt(3)
  v_mfma_f32_32x32x16_bf16 v[80:95], v[52:55], a[12:15], v[80:95]
  ds_read_b128 v[52:55], v2 offset:12544
  v_cmp_lt_f32 vcc, s43, v28
  s_cbranch_vccnz Lrare_45
Lback_46:
  v_exp_f32 v64, v64
  v_accvgpr_write_b32 a62, v36
  v_mfma_f32_32x32x16_bf16 v[80:95], v[56:59], a[16:19], v[80:95]
  ds_read_b128 v[56:59], v3 offset:12544
  v_exp_f32 v65, v65
  v_add_f32 v22, v22, v64
  v_exp_f32 v66, v66
  v_mfma_f32_32x32x16_bf16 v[80:95], v[60:63], a[20:23], v[80:95]
  ds_read_b128 v[60:63], v4 offset:12544
  s_waitcnt vmcnt(40)
  s_barrier
  s_mov_b32 s45, 196608
  s_add_u32 m0, s32, 114688
  s_waitcnt lgkmcnt(3)
  v_mfma_f32_32x32x16_bf16 v[80:95], v[40:43], a[24:27], v[80:95]
  ds_read_b64_tr_b16 v[40:41], v5 offset:49152
  ds_read_b64_tr_b16 v[42:43], v5 offset:52224
  buffer_load_dwordx4 v14, s[8:11], s45 offen offset:0 nt lds
  buffer_load_dwordx4 v15, s[8:11], s45 offen offset:1024 nt lds
  buffer_load_dwordx4 v16, s[8:11], s45 offen offset:2048 nt lds
  v_add_f32 v23, v23, v65
  v_mfma_f32_32x32x16_bf16 v[80:95], v[44:47], a[28:31], v[80:95]
  ds_read_b64_tr_b16 v[44:45], v6 offset:49152
  ds_read_b64_tr_b16 v[46:47], v6 offset:52224
  v_exp_f32 v67, v67
  v_add_f32 v22, v22, v66
  v_accvgpr_read_b32 v32, a126
  v_mfma_f32_32x32x16_bf16 v[80:95], v[48:51], a[32:35], v[80:95]
  ds_read_b64_tr_b16 v[48:49], v5 offset:49280
  ds_read_b64_tr_b16 v[50:51], v5 offset:52352
  v_exp_f32 v68, v68
  v_add_f32 v23, v23, v67
  s_waitcnt lgkmcnt(6)
  v_mfma_f32_32x32x16_bf16 v[80:95], v[52:55], a[36:39], v[80:95]
  ds_read_b64_tr_b16 v[52:53], v6 offset:49280
  ds_read_b64_tr_b16 v[54:55], v6 offset:52352
  v_exp_f32 v69, v69
  v_add_f32 v22, v22, v68
  v_accvgpr_read_b32 v33, a127
  v_mfma_f32_32x32x16_bf16 v[80:95], v[56:59], a[40:43], v[80:95]
  ds_read_b64_tr_b16 v[56:57], v5 offset:49408
  ds_read_b64_tr_b16 v[58:59], v5 offset:52480
  v_exp_f32 v70, v70
  v_add_f32 v23, v23, v69
  v_mul_f32 v32, s31, v32
  v_mfma_f32_32x32x16_bf16 v[80:95], v[60:63], a[44:47], v[80:95]
  ds_read_b64_tr_b16 v[60:61], v6 offset:49408
  ds_read_b64_tr_b16 v[62:63], v6 offset:52480
  v_exp_f32 v71, v71
  v_add_f32 v22, v22, v70
  v_exp_f32 v72, v72
  v_add_f32 v23, v23, v71
  v_exp_f32 v73, v73
  v_add_f32 v22, v22, v72
  v_cvt_pk_bf16_f32 v64, v64, v65
  v_cvt_pk_bf16_f32 v65, v66, v67
  v_cvt_pk_bf16_f32 v66, v68, v69
  v_cvt_pk_bf16_f32 v67, v70, v71
  v_exp_f32 v74, v74
  v_add_f32 v23, v23, v73
  v_exp_f32 v75, v75
  v_add_f32 v22, v22, v74
  v_exp_f32 v76, v76
  v_add_f32 v23, v23, v75
  v_exp_f32 v77, v77
  v_add_f32 v22, v22, v76
  v_exp_f32 v78, v78
  v_add_f32 v23, v23, v77
  v_exp_f32 v79, v79
  v_add_f32 v22, v22, v78
  v_cvt_pk_bf16_f32 v72, v72, v73
  v_add_f32 v23, v23, v79
  v_cvt_pk_bf16_f32 v73, v74, v75
  v_cvt_pk_bf16_f32 v74, v76, v77
  v_cvt_pk_bf16_f32 v75, v78, v79
  s_cmp_lg_u32 s42, 0
  s_cbranch_scc1 LrB_47
LbB_48:
  s_waitcnt lgkmcnt(6)
  v_mfma_f32_32x32x16_bf16 v[160:175], v[40:43], v[64:67], v[160:175]
  ds_read_b64_tr_b16 v[40:41], v5 offset:55296
  ds_read_b64_tr_b16 v[42:43], v5 offset:58368
  v_mul_f32 v33, s31, v33
  v_cvt_pk_bf16_f32 v32, v32, v33
  v_accvgpr_write_b32 a63, v32
  v_accvgpr_read_b32 v34, a128
  v_mfma_f32_32x32x16_bf16 v[176:191], v[44:47], v[64:67], v[176:191]
  ds_read_b64_tr_b16 v[44:45], v6 offset:55296
  ds_read_b64_tr_b16 v[46:47], v6 offset:58368
  v_max3_f32 v28, v80, v81, v82
  v_max3_f32 v29, v83, v84, v85
  v_max3_f32 v28, v28, v86, v87
  v_max3_f32 v29, v29, v88, v89
  v_mfma_f32_32x32x16_bf16 v[192:207], v[48:51], v[64:67], v[192:207]
  ds_read_b64_tr_b16 v[48:49], v5 offset:55424
  ds_read_b64_tr_b16 v[50:51], v5 offset:58496
  v_max3_f32 v28, v28, v90, v91
  v_max3_f32 v29, v29, v92, v93
  v_max3_f32 v28, v28, v94, v95
  s_waitcnt lgkmcnt(6)
  v_mfma_f32_32x32x16_bf16 v[208:223], v[52:55], v[64:67], v[208:223]
  ds_read_b64_tr_b16 v[52:53], v6 offset:55424
  ds_read_b64_tr_b16 v[54:55], v6 offset:58496
  v_max_f32 v28, v28, v29
  v_cmp_lt_f32 vcc, s43, v28
  s_cbranch_vccnz Lrare_49
Lback_50:
  v_accvgpr_read_b32 v35, a129
  v_mfma_f32_32x32x16_bf16 v[224:239], v[56:59], v[64:67], v[224:239]
  ds_read_b64_tr_b16 v[56:57], v5 offset:55552
  ds_read_b64_tr_b16 v[58:59], v5 offset:58624
  v_exp_f32 v80, v80
  v_exp_f32 v81, v81
  v_mfma_f32_32x32x16_bf16 v[240:255], v[60:63], v[64:67], v[240:255]
  ds_read_b64_tr_b16 v[60:61], v6 offset:55552
  ds_read_b64_tr_b16 v[62:63], v6 offset:58624
  s_waitcnt vmcnt(35)
  s_barrier
  s_mov_b32 s44, 221184
  s_waitcnt lgkmcnt(6)
  v_mfma_f32_32x32x16_bf16 v[160:175], v[40:43], v[72:75], v[160:175]
  ds_read_b128 v[40:43], v1 offset:24576
  s_add_u32 m0, s32, 77824
  s_nop 0
  buffer_load_dwordx4 v11, s[4:7], s44 offen offset:0 nt lds
  buffer_load_dwordx4 v12, s[4:7], s44 offen offset:1024 nt lds
  buffer_load_dwordx4 v13, s[4:7], s44 offen offset:2048 nt lds
  v_add_f32 v22, v22, v80
  v_mfma_f32_32x32x16_bf16 v[176:191], v[44:47], v[72:75], v[176:191]
  ds_read_b128 v[44:47], v2 offset:24576
  v_exp_f32 v82, v82
  v_add_f32 v23, v23, v81
  v_exp_f32 v83, v83
  v_mfma_f32_32x32x16_bf16 v[192:207], v[48:51], v[72:75], v[192:207]
  ds_read_b128 v[48:51], v3 offset:24576
  v_add_f32 v22, v22, v82
  v_exp_f32 v84, v84
  v_add_f32 v23, v23, v83
  s_waitcnt lgkmcnt(3)
  v_mfma_f32_32x32x16_bf16 v[208:223], v[52:55], v[72:75], v[208:223]
  ds_read_b128 v[52:55], v4 offset:24576
  v_exp_f32 v85, v85
  v_add_f32 v22, v22, v84
  v_exp_f32 v86, v86
  v_mfma_f32_32x32x16_bf16 v[224:239], v[56:59], v[72:75], v[224:239]
  ds_read_b128 v[56:59], v1 offset:24704
  v_add_f32 v23, v23, v85
  v_exp_f32 v87, v87
  v_add_f32 v22, v22, v86
  v_mul_f32 v34, s31, v34
  v_mfma_f32_32x32x16_bf16 v[240:255], v[60:63], v[72:75], v[240:255]
  ds_read_b128 v[60:63], v2 offset:24704
  v_exp_f32 v88, v88
  v_add_f32 v23, v23, v87
  v_mul_f32 v35, s31, v35
  s_waitcnt lgkmcnt(3)
  v_mfma_f32_32x32x16_bf16 v[64:79], v[40:43], a[0:3], v[96:111]
  ds_read_b128 v[40:43], v3 offset:24704
  v_exp_f32 v89, v89
  v_add_f32 v22, v22, v88
  v_cvt_pk_bf16_f32 v80, v80, v81
  v_cvt_pk_bf16_f32 v81, v82, v83
  v_mfma_f32_32x32x16_bf16 v[64:79], v[44:47], a[4:7], v[64:79]
  ds_read_b128 v[44:47], v4 offset:24704
  v_cvt_pk_bf16_f32 v82, v84, v85
  v_cvt_pk_bf16_f32 v83, v86, v87
  v_exp_f32 v90, v90
  v_add_f32 v23, v23, v89
  v_mfma_f32_32x32x16_bf16 v[64:79], v[48:51], a[8:11], v[64:79]
  ds_read_b128 v[48:51], v1 offset:24832
  v_exp_f32 v91, v91
  v_add_f32 v22, v22, v90
  v_cvt_pk_bf16_f32 v34, v34, v35
  s_waitcnt lgkmcnt(3)
  v_mfma_f32_32x32x16_bf16 v[64:79], v[52:55], a[12:15], v[64:79]
  ds_read_b128 v[52:55], v2 offset:24832
  v_exp_f32 v92, v92
  v_add_f32 v23, v23, v91
  v_exp_f32 v93, v93
  v_mfma_f32_32x32x16_bf16 v[64:79], v[56:59], a[16:19], v[64:79]
  ds_read_b128 v[56:59], v3 offset:24832
  v_add_f32 v22, v22, v92
  v_exp_f32 v94, v94
  v_add_f32 v23, v23, v93
  v_accvgpr_write_b32 a64, v34
  v_mfma_f32_32x32x16_bf16 v[64:79], v[60:63], a[20:23], v[64:79]
  ds_read_b128 v[60:63], v4 offset:24832
  s_waitcnt vmcnt(30)
  s_barrier
  s_mov_b32 s45, 208896
  s_add_u32 m0, s32, 151552
  s_waitcnt lgkmcnt(3)
  v_mfma_f32_32x32x16_bf16 v[64:79], v[40:43], a[24:27], v[64:79]
  ds_read_b64_tr_b16 v[40:41], v5 offset:36864
  ds_read_b64_tr_b16 v[42:43], v5 offset:39936
  buffer_load_dwordx4 v14, s[8:11], s45 offen offset:0 nt lds
  buffer_load_dwordx4 v15, s[8:11], s45 offen offset:1024 nt lds
  buffer_load_dwordx4 v16, s[8:11], s45 offen offset:2048 nt lds
  v_accvgpr_read_b32 v36, a130
  v_mfma_f32_32x32x16_bf16 v[64:79], v[44:47], a[28:31], v[64:79]
  ds_read_b64_tr_b16 v[44:45], v6 offset:36864
  ds_read_b64_tr_b16 v[46:47], v6 offset:39936
  v_exp_f32 v95, v95
  v_add_f32 v22, v22, v94
  v_cvt_pk_bf16_f32 v88, v88, v89
  v_mfma_f32_32x32x16_bf16 v[64:79], v[48:51], a[32:35], v[64:79]
  ds_read_b64_tr_b16 v[48:49], v5 offset:36992
  ds_read_b64_tr_b16 v[50:51], v5 offset:40064
  v_add_f32 v23, v23, v95
  v_cvt_pk_bf16_f32 v89, v90, v91
  v_cvt_pk_bf16_f32 v90, v92, v93
  s_waitcnt lgkmcnt(6)
  v_mfma_f32_32x32x16_bf16 v[64:79], v[52:55], a[36:39], v[64:79]
  ds_read_b64_tr_b16 v[52:53], v6 offset:36992
  ds_read_b64_tr_b16 v[54:55], v6 offset:40064
  v_cvt_pk_bf16_f32 v91, v94, v95
  v_accvgpr_read_b32 v37, a131
  v_mul_f32 v36, s31, v36
  v_mul_f32 v37, s31, v37
  v_mfma_f32_32x32x16_bf16 v[64:79], v[56:59], a[40:43], v[64:79]
  ds_read_b64_tr_b16 v[56:57], v5 offset:37120
  ds_read_b64_tr_b16 v[58:59], v5 offset:40192
  v_cvt_pk_bf16_f32 v36, v36, v37
  v_accvgpr_write_b32 a65, v36
  v_accvgpr_read_b32 v32, a132
  v_accvgpr_read_b32 v33, a133
  v_mfma_f32_32x32x16_bf16 v[64:79], v[60:63], a[44:47], v[64:79]
  ds_read_b64_tr_b16 v[60:61], v6 offset:37120
  ds_read_b64_tr_b16 v[62:63], v6 offset:40192
  v_mul_f32 v32, s31, v32
  v_mul_f32 v33, s31, v33
  v_cvt_pk_bf16_f32 v32, v32, v33
  s_cmp_lg_u32 s42, 0
  s_cbranch_scc1 LrB_51
LbB_52:
  s_waitcnt lgkmcnt(6)
  v_mfma_f32_32x32x16_bf16 v[160:175], v[40:43], v[80:83], v[160:175]
  ds_read_b64_tr_b16 v[40:41], v5 offset:43008
  ds_read_b64_tr_b16 v[42:43], v5 offset:46080
  v_accvgpr_write_b32 a66, v32
  v_accvgpr_read_b32 v34, a134
  v_accvgpr_read_b32 v35, a135
  v_mul_f32 v34, s31, v34
  v_mfma_f32_32x32x16_bf16 v[176:191], v[44:47], v[80:83], v[176:191]
  ds_read_b64_tr_b16 v[44:45], v6 offset:43008
  ds_read_b64_tr_b16 v[46:47], v6 offset:46080
  v_max3_f32 v28, v64, v65, v66
  v_max3_f32 v29, v67, v68, v69
  v_max3_f32 v28, v28, v70, v71
  v_max3_f32 v29, v29, v72, v73
  v_mfma_f32_32x32x16_bf16 v[192:207], v[48:51], v[80:83], v[192:207]
  ds_read_b64_tr_b16 v[48:49], v5 offset:43136
  ds_read_b64_tr_b16 v[50:51], v5 offset:46208
  v_max3_f32 v28, v28, v74, v75
  v_max3_f32 v29, v29, v76, v77
  v_max3_f32 v28, v28, v78, v79
  s_waitcnt lgkmcnt(6)
  v_mfma_f32_32x32x16_bf16 v[208:223], v[52:55], v[80:83], v[208:223]
  ds_read_b64_tr_b16 v[52:53], v6 offset:43136
  ds_read_b64_tr_b16 v[54:55], v6 offset:46208
  v_max_f32 v28, v28, v29
  v_cmp_lt_f32 vcc, s43, v28
  s_cbranch_vccnz Lrare_53
Lback_54:
  v_mul_f32 v35, s31, v35
  v_mfma_f32_32x32x16_bf16 v[224:239], v[56:59], v[80:83], v[224:239]
  ds_read_b64_tr_b16 v[56:57], v5 offset:43264
  ds_read_b64_tr_b16 v[58:59], v5 offset:46336
  v_exp_f32 v64, v64
  v_exp_f32 v65, v65
  v_mfma_f32_32x32x16_bf16 v[240:255], v[60:63], v[80:83], v[240:255]
  ds_read_b64_tr_b16 v[60:61], v6 offset:43264
  ds_read_b64_tr_b16 v[62:63], v6 offset:46336
  s_waitcnt vmcnt(27)
  s_barrier
  v_add_f32 v22, v22, v64
  s_waitcnt lgkmcnt(6)
  v_mfma_f32_32x32x16_bf16 v[160:175], v[40:43], v[88:91], v[160:175]
  ds_read_b128 v[40:43], v1 offset:0
  v_exp_f32 v66, v66
  v_add_f32 v23, v23, v65
  v_exp_f32 v67, v67
  v_mfma_f32_32x32x16_bf16 v[176:191], v[44:47], v[88:91], v[176:191]
  ds_read_b128 v[44:47], v2 offset:0
  v_add_f32 v22, v22, v66
  v_exp_f32 v68, v68
  v_add_f32 v23, v23, v67
  v_cvt_pk_bf16_f32 v34, v34, v35
  v_mfma_f32_32x32x16_bf16 v[192:207], v[48:51], v[88:91], v[192:207]
  ds_read_b128 v[48:51], v3 offset:0
  v_exp_f32 v69, v69
  v_add_f32 v22, v22, v68
  v_accvgpr_write_b32 a67, v34
  s_waitcnt lgkmcnt(3)
  v_mfma_f32_32x32x16_bf16 v[208:223], v[52:55], v[88:91], v[208:223]
  ds_read_b128 v[52:55], v4 offset:0
  v_exp_f32 v70, v70
  v_add_f32 v23, v23, v69
  v_exp_f32 v71, v71
  v_mfma_f32_32x32x16_bf16 v[224:239], v[56:59], v[88:91], v[224:239]
  ds_read_b128 v[56:59], v1 offset:128
  v_add_f32 v22, v22, v70
  v_exp_f32 v72, v72
  v_add_f32 v23, v23, v71
  v_accvgpr_read_b32 v36, a136
  v_mfma_f32_32x32x16_bf16 v[240:255], v[60:63], v[88:91], v[240:255]
  ds_read_b128 v[60:63], v2 offset:128
  v_exp_f32 v73, v73
  v_add_f32 v22, v22, v72
  v_cvt_pk_bf16_f32 v64, v64, v65
  s_waitcnt lgkmcnt(3)
  v_mfma_f32_32x32x16_bf16 v[80:95], v[40:43], a[0:3], v[96:111]
  ds_read_b128 v[40:43], v3 offset:128
  v_cvt_pk_bf16_f32 v65, v66, v67
  v_cvt_pk_bf16_f32 v66, v68, v69
  v_cvt_pk_bf16_f32 v67, v70, v71
  v_exp_f32 v74, v74
  v_mfma_f32_32x32x16_bf16 v[80:95], v[44:47], a[4:7], v[80:95]
  ds_read_b128 v[44:47], v4 offset:128
  v_add_f32 v23, v23, v73
  v_exp_f32 v75, v75
  v_add_f32 v22, v22, v74
  v_accvgpr_read_b32 v37, a137
  v_mfma_f32_32x32x16_bf16 v[80:95], v[48:51], a[8:11], v[80:95]
  ds_read_b128 v[48:51], v1 offset:256
  v_exp_f32 v76, v76
  v_add_f32 v23, v23, v75
  v_mul_f32 v36, s31, v36
  s_waitcnt lgkmcnt(3)
  v_mfma_f32_32x32x16_bf16 v[80:95], v[52:55], a[12:15], v[80:95]
  ds_read_b128 v[52:55], v2 offset:256
  v_exp_f32 v77, v77
  v_add_f32 v22, v22, v76
  v_exp_f32 v78, v78
  v_mfma_f32_32x32x16_bf16 v[80:95], v[56:59], a[16:19], v[80:95]
  ds_read_b128 v[56:59], v3 offset:256
  v_add_f32 v23, v23, v77
  v_exp_f32 v79, v79
  v_add_f32 v22, v22, v78
  v_cvt_pk_bf16_f32 v72, v72, v73
  v_mfma_f32_32x32x16_bf16 v[80:95], v[60:63], a[20:23], v[80:95]
  ds_read_b128 v[60:63], v4 offset:256
  s_waitcnt vmcnt(18)
  s_barrier
  v_add_f32 v23, v23, v79
  v_cvt_pk_bf16_f32 v73, v74, v75
  s_waitcnt lgkmcnt(3)
  v_mfma_f32_32x32x16_bf16 v[80:95], v[40:43], a[24:27], v[80:95]
  ds_read_b64_tr_b16 v[40:41], v5 offset:24576
  ds_read_b64_tr_b16 v[42:43], v5 offset:27648
  v_cvt_pk_bf16_f32 v74, v76, v77
  v_cvt_pk_bf16_f32 v75, v78, v79
  v_mul_f32 v37, s31, v37
  v_cvt_pk_bf16_f32 v36, v36, v37
  v_mfma_f32_32x32x16_bf16 v[80:95], v[44:47], a[28:31], v[80:95]
  ds_read_b64_tr_b16 v[44:45], v6 offset:24576
  ds_read_b64_tr_b16 v[46:47], v6 offset:27648
  v_accvgpr_write_b32 a68, v36
  v_accvgpr_read_b32 v32, a138
  v_accvgpr_read_b32 v33, a139
  v_mul_f32 v32, s31, v32
  v_mfma_f32_32x32x16_bf16 v[80:95], v[48:51], a[32:35], v[80:95]
  ds_read_b64_tr_b16 v[48:49], v5 offset:24704
  ds_read_b64_tr_b16 v[50:51], v5 offset:27776
  v_mul_f32 v33, s31, v33
  v_cvt_pk_bf16_f32 v32, v32, v33
  v_accvgpr_write_b32 a69, v32
  s_waitcnt lgkmcnt(6)
  v_mfma_f32_32x32x16_bf16 v[80:95], v[52:55], a[36:39], v[80:95]
  ds_read_b64_tr_b16 v[52:53], v6 offset:24704
  ds_read_b64_tr_b16 v[54:55], v6 offset:27776
  v_accvgpr_read_b32 v34, a140
  v_accvgpr_read_b32 v35, a141
  v_mul_f32 v34, s31, v34
  v_mul_f32 v35, s31, v35
  v_mfma_f32_32x32x16_bf16 v[80:95], v[56:59], a[40:43], v[80:95]
  ds_read_b64_tr_b16 v[56:57], v5 offset:24832
  ds_read_b64_tr_b16 v[58:59], v5 offset:27904
  v_cvt_pk_bf16_f32 v34, v34, v35
  v_accvgpr_write_b32 a70, v34
  v_accvgpr_read_b32 v36, a142
  v_accvgpr_read_b32 v37, a143
  v_mfma_f32_32x32x16_bf16 v[80:95], v[60:63], a[44:47], v[80:95]
  ds_read_b64_tr_b16 v[60:61], v6 offset:24832
  ds_read_b64_tr_b16 v[62:63], v6 offset:27904
  v_mul_f32 v36, s31, v36
  v_mul_f32 v37, s31, v37
  v_cvt_pk_bf16_f32 v36, v36, v37
  s_cmp_lg_u32 s42, 0
  s_cbranch_scc1 LrB_55
LbB_56:
  s_waitcnt lgkmcnt(6)
  v_mfma_f32_32x32x16_bf16 v[160:175], v[40:43], v[64:67], v[160:175]
  ds_read_b64_tr_b16 v[40:41], v5 offset:30720
  ds_read_b64_tr_b16 v[42:43], v5 offset:33792
  v_accvgpr_write_b32 a71, v36
  v_accvgpr_read_b32 v32, a144
  v_accvgpr_read_b32 v33, a145
  v_mul_f32 v32, s31, v32
  v_mfma_f32_32x32x16_bf16 v[176:191], v[44:47], v[64:67], v[176:191]
  ds_read_b64_tr_b16 v[44:45], v6 offset:30720
  ds_read_b64_tr_b16 v[46:47], v6 offset:33792
  v_max3_f32 v28, v80, v81, v82
  v_max3_f32 v29, v83, v84, v85
  v_max3_f32 v28, v28, v86, v87
  v_max3_f32 v29, v29, v88, v89
  v_mfma_f32_32x32x16_bf16 v[192:207], v[48:51], v[64:67], v[192:207]
  ds_read_b64_tr_b16 v[48:49], v5 offset:30848
  ds_read_b64_tr_b16 v[50:51], v5 offset:33920
  v_max3_f32 v28, v28, v90, v91
  v_max3_f32 v29, v29, v92, v93
  v_max3_f32 v28, v28, v94, v95
  s_waitcnt lgkmcnt(6)
  v_mfma_f32_32x32x16_bf16 v[208:223], v[52:55], v[64:67], v[208:223]
  ds_read_b64_tr_b16 v[52:53], v6 offset:30848
  ds_read_b64_tr_b16 v[54:55], v6 offset:33920
  v_max_f32 v28, v28, v29
  v_cmp_lt_f32 vcc, s43, v28
  s_cbranch_vccnz Lrare_57
Lback_58:
  v_mul_f32 v33, s31, v33
  v_mfma_f32_32x32x16_bf16 v[224:239], v[56:59], v[64:67], v[224:239]
  ds_read_b64_tr_b16 v[56:57], v5 offset:30976
  ds_read_b64_tr_b16 v[58:59], v5 offset:34048
  v_exp_f32 v80, v80
  v_exp_f32 v81, v81
  v_mfma_f32_32x32x16_bf16 v[240:255], v[60:63], v[64:67], v[240:255]
  ds_read_b64_tr_b16 v[60:61], v6 offset:30976
  ds_read_b64_tr_b16 v[62:63], v6 offset:34048
  s_waitcnt vmcnt(15)
  s_barrier
  s_mov_b32 s44, 233472
  s_waitcnt lgkmcnt(6)
  v_mfma_f32_32x32x16_bf16 v[160:175], v[40:43], v[72:75], v[160:175]
  ds_read_b64_tr_b16 v[40:41], v5 offset:0
  ds_read_b64_tr_b16 v[42:43], v5 offset:3072
  s_add_u32 m0, s32, 61440
  s_nop 0
  buffer_load_dwordx4 v11, s[4:7], s44 offen offset:0 nt lds
  buffer_load_dwordx4 v12, s[4:7], s44 offen offset:1024 nt lds
  buffer_load_dwordx4 v13, s[4:7], s44 offen offset:2048 nt lds
  v_mfma_f32_32x32x16_bf16 v[176:191], v[44:47], v[72:75], v[176:191]
  ds_read_b64_tr_b16 v[44:45], v6 offset:0
  ds_read_b64_tr_b16 v[46:47], v6 offset:3072
  s_mov_b32 s45, 221184
  s_add_u32 m0, s32, 139264
  s_nop 0
  buffer_load_dwordx4 v14, s[8:11], s45 offen offset:0 nt lds
  buffer_load_dwordx4 v15, s[8:11], s45 offen offset:1024 nt lds
  v_mfma_f32_32x32x16_bf16 v[192:207], v[48:51], v[72:75], v[192:207]
  ds_read_b64_tr_b16 v[48:49], v5 offset:128
  ds_read_b64_tr_b16 v[50:51], v5 offset:3200
  buffer_load_dwordx4 v16, s[8:11], s45 offen offset:2048 nt lds
  v_add_f32 v22, v22, v80
  v_cvt_pk_bf16_f32 v32, v32, v33
  s_waitcnt lgkmcnt(6)
  v_mfma_f32_32x32x16_bf16 v[208:223], v[52:55], v[72:75], v[208:223]
  ds_read_b64_tr_b16 v[52:53], v6 offset:128
  ds_read_b64_tr_b16 v[54:55], v6 offset:3200
  v_exp_f32 v82, v82
  v_add_f32 v23, v23, v81
  v_accvgpr_write_b32 a72, v32
  v_mfma_f32_32x32x16_bf16 v[224:239], v[56:59], v[72:75], v[224:239]
  ds_read_b64_tr_b16 v[56:57], v5 offset:256
  ds_read_b64_tr_b16 v[58:59], v5 offset:3328
  v_exp_f32 v83, v83
  v_add_f32 v22, v22, v82
  v_accvgpr_read_b32 v34, a146
  v_mfma_f32_32x32x16_bf16 v[240:255], v[60:63], v[72:75], v[240:255]
  ds_read_b64_tr_b16 v[60:61], v6 offset:256
  ds_read_b64_tr_b16 v[62:63], v6 offset:3328
  v_exp_f32 v84, v84
  v_add_f32 v23, v23, v83
  v_exp_f32 v85, v85
  v_add_f32 v22, v22, v84
  v_exp_f32 v86, v86
  v_add_f32 v23, v23, v85
  v_exp_f32 v87, v87
  v_add_f32 v22, v22, v86
  v_exp_f32 v88, v88
  v_add_f32 v23, v23, v87
  v_exp_f32 v89, v89
  v_add_f32 v22, v22, v88
  v_cvt_pk_bf16_f32 v80, v80, v81
  v_cvt_pk_bf16_f32 v81, v82, v83
  v_cvt_pk_bf16_f32 v82, v84, v85
  v_cvt_pk_bf16_f32 v83, v86, v87
  v_exp_f32 v90, v90
  v_add_f32 v23, v23, v89
  v_exp_f32 v91, v91
  v_add_f32 v22, v22, v90
  v_exp_f32 v92, v92
  v_add_f32 v23, v23, v91
  v_exp_f32 v93, v93
  v_add_f32 v22, v22, v92
  v_exp_f32 v94, v94
  v_add_f32 v23, v23, v93
  v_exp_f32 v95, v95
  v_add_f32 v22, v22, v94
  v_cvt_pk_bf16_f32 v88, v88, v89
  v_add_f32 v23, v23, v95
  v_cvt_pk_bf16_f32 v89, v90, v91
  v_cvt_pk_bf16_f32 v90, v92, v93
  v_cvt_pk_bf16_f32 v91, v94, v95
  s_cmp_lg_u32 s42, 0
  s_cbranch_scc1 LrB_59
LbB_60:
  s_waitcnt lgkmcnt(6)
  v_mfma_f32_32x32x16_bf16 v[160:175], v[40:43], v[80:83], v[160:175]
  ds_read_b64_tr_b16 v[40:41], v5 offset:6144
  ds_read_b64_tr_b16 v[42:43], v5 offset:9216
  v_accvgpr_read_b32 v35, a147
  v_mul_f32 v34, s31, v34
  v_mul_f32 v35, s31, v35
  v_cvt_pk_bf16_f32 v34, v34, v35
  v_mfma_f32_32x32x16_bf16 v[176:191], v[44:47], v[80:83], v[176:191]
  ds_read_b64_tr_b16 v[44:45], v6 offset:6144
  ds_read_b64_tr_b16 v[46:47], v6 offset:9216
  v_accvgpr_write_b32 a73, v34
  v_accvgpr_read_b32 v36, a148
  v_accvgpr_read_b32 v37, a149
  v_mul_f32 v36, s31, v36
  v_mfma_f32_32x32x16_bf16 v[192:207], v[48:51], v[80:83], v[192:207]
  ds_read_b64_tr_b16 v[48:49], v5 offset:6272
  ds_read_b64_tr_b16 v[50:51], v5 offset:9344
  v_mul_f32 v37, s31, v37
  v_cvt_pk_bf16_f32 v36, v36, v37
  v_accvgpr_write_b32 a74, v36
  s_waitcnt lgkmcnt(6)
  v_mfma_f32_32x32x16_bf16 v[208:223], v[52:55], v[80:83], v[208:223]
  ds_read_b64_tr_b16 v[52:53], v6 offset:6272
  ds_read_b64_tr_b16 v[54:55], v6 offset:9344
  v_accvgpr_read_b32 v32, a150
  v_accvgpr_read_b32 v33, a151
  v_mul_f32 v32, s31, v32
  v_mul_f32 v33, s31, v33
  v_mfma_f32_32x32x16_bf16 v[224:239], v[56:59], v[80:83], v[224:239]
  ds_read_b64_tr_b16 v[56:57], v5 offset:6400
  ds_read_b64_tr_b16 v[58:59], v5 offset:9472
  v_cvt_pk_bf16_f32 v32, v32, v33
  v_accvgpr_write_b32 a75, v32
  v_accvgpr_read_b32 v34, a152
  v_accvgpr_read_b32 v35, a153
  v_mfma_f32_32x32x16_bf16 v[240:255], v[60:63], v[80:83], v[240:255]
  ds_read_b64_tr_b16 v[60:61], v6 offset:6400
  ds_read_b64_tr_b16 v[62:63], v6 offset:9472
  v_subrev_u32 v1, 28672, v1
  v_subrev_u32 v2, 28672, v2
  v_subrev_u32 v3, 28672, v3
  v_subrev_u32 v4, 28672, v4
  v_subrev_u32 v5, 4096, v5
  v_subrev_u32 v6, 4096, v6
  s_waitcnt vmcnt(18)
  s_barrier
  s_mov_b32 s44, 233472
  s_waitcnt lgkmcnt(6)
  v_mfma_f32_32x32x16_bf16 v[160:175], v[40:43], v[88:91], v[160:175]
  ds_read_b128 v[40:43], v1 offset:0
  s_add_u32 m0, s32, 126976
  s_nop 0
  buffer_load_dwordx4 v14, s[8:11], s44 offen offset:0 nt lds
  buffer_load_dwordx4 v15, s[8:11], s44 offen offset:1024 nt lds
  buffer_load_dwordx4 v16, s[8:11], s44 offen offset:2048 nt lds
  v_mul_f32 v34, s31, v34
  v_mfma_f32_32x32x16_bf16 v[176:191], v[44:47], v[88:91], v[176:191]
  ds_read_b128 v[44:47], v2 offset:0
  v_mul_f32 v35, s31, v35
  v_cvt_pk_bf16_f32 v34, v34, v35
  v_accvgpr_write_b32 a76, v34
  v_accvgpr_read_b32 v36, a154
  v_accvgpr_read_b32 v37, a155
  v_mfma_f32_32x32x16_bf16 v[192:207], v[48:51], v[88:91], v[192:207]
  ds_read_b128 v[48:51], v3 offset:0
  v_mul_f32 v36, s31, v36
  v_mul_f32 v37, s31, v37
  v_cvt_pk_bf16_f32 v36, v36, v37
  v_accvgpr_write_b32 a77, v36
  s_waitcnt lgkmcnt(3)
  v_mfma_f32_32x32x16_bf16 v[208:223], v[52:55], v[88:91], v[208:223]
  ds_read_b128 v[52:55], v4 offset:0
  v_accvgpr_read_b32 v32, a156
  v_accvgpr_read_b32 v33, a157
  v_mul_f32 v32, s31, v32
  v_mul_f32 v33, s31, v33
  v_cvt_pk_bf16_f32 v32, v32, v33
  v_mfma_f32_32x32x16_bf16 v[224:239], v[56:59], v[88:91], v[224:239]
  ds_read_b128 v[56:59], v1 offset:128
  v_accvgpr_write_b32 a78, v32
  v_accvgpr_read_b32 v34, a158
  v_accvgpr_read_b32 v35, a159
  v_mul_f32 v34, s31, v34
  v_mul_f32 v35, s31, v35
  v_mfma_f32_32x32x16_bf16 v[240:255], v[60:63], v[88:91], v[240:255]
  ds_read_b128 v[60:63], v2 offset:128
  v_cvt_pk_bf16_f32 v34, v34, v35
  v_accvgpr_write_b32 a79, v34
  v_accvgpr_read_b32 v36, a160
  v_accvgpr_read_b32 v37, a161
  v_add_f32 v26, v22, v23
  v_mov_b32 v31, v26
  s_nop 1
  v_permlane32_swap_b32 v26, v31
  v_add_f32 v26, v26, v31
  v_max_f32 v26, 228737632, v26
  v_rcp_f32 v26, v26
  v_mul_f32 v36, s31, v36
  v_mul_f32 v37, s31, v37
  v_cvt_pk_bf16_f32 v36, v36, v37
  v_accvgpr_write_b32 a80, v36
  v_accvgpr_read_b32 v32, a162
  v_accvgpr_read_b32 v33, a163
  v_mul_f32 v32, s31, v32
  v_mul_f32 v33, s31, v33
  v_cvt_pk_bf16_f32 v32, v32, v33
  v_accvgpr_write_b32 a81, v32
  v_accvgpr_read_b32 v34, a164
  v_accvgpr_read_b32 v35, a165
  v_mul_f32 v34, s31, v34
  v_mul_f32 v35, s31, v35
  v_cvt_pk_bf16_f32 v34, v34, v35
  v_accvgpr_write_b32 a82, v34
  v_accvgpr_read_b32 v36, a166
  v_accvgpr_read_b32 v37, a167
  v_mul_f32 v36, s31, v36
  v_mul_f32 v37, s31, v37
  v_cvt_pk_bf16_f32 v36, v36, v37
  v_accvgpr_write_b32 a83, v36
  v_accvgpr_read_b32 v32, a168
  v_accvgpr_read_b32 v33, a169
  v_mul_f32 v32, s31, v32
  v_mul_f32 v33, s31, v33
  v_cvt_pk_bf16_f32 v32, v32, v33
  v_accvgpr_write_b32 a84, v32
  v_accvgpr_read_b32 v34, a170
  v_accvgpr_read_b32 v35, a171
  v_mul_f32 v34, s31, v34
  v_mul_f32 v35, s31, v35
  v_cvt_pk_bf16_f32 v34, v34, v35
  v_accvgpr_write_b32 a85, v34
  v_accvgpr_read_b32 v36, a172
  v_accvgpr_read_b32 v37, a173
  v_mul_f32 v36, s31, v36
  v_mul_f32 v37, s31, v37
  v_cvt_pk_bf16_f32 v36, v36, v37
  v_accvgpr_write_b32 a86, v36
  v_accvgpr_read_b32 v32, a174
  v_accvgpr_read_b32 v33, a175
  v_mul_f32 v32, s31, v32
  v_mul_f32 v33, s31, v33
  v_cvt_pk_bf16_f32 v32, v32, v33
  v_accvgpr_write_b32 a87, v32
  v_accvgpr_read_b32 v34, a176
  v_accvgpr_read_b32 v35, a177
  v_mul_f32 v34, s31, v34
  v_mul_f32 v35, s31, v35
  v_cvt_pk_bf16_f32 v34, v34, v35
  v_accvgpr_write_b32 a88, v34
  v_accvgpr_read_b32 v36, a178
  v_accvgpr_read_b32 v37, a179
  v_mul_f32 v36, s31, v36
  v_mul_f32 v37, s31, v37
  v_cvt_pk_bf16_f32 v36, v36, v37
  v_accvgpr_write_b32 a89, v36
  v_accvgpr_read_b32 v32, a180
  v_accvgpr_read_b32 v33, a181
  v_mul_f32 v32, s31, v32
  v_mul_f32 v33, s31, v33
  v_cvt_pk_bf16_f32 v32, v32, v33
  v_accvgpr_write_b32 a90, v32
  v_accvgpr_read_b32 v34, a182
  v_accvgpr_read_b32 v35, a183
  v_mul_f32 v34, s31, v34
  v_mul_f32 v35, s31, v35
  v_cvt_pk_bf16_f32 v34, v34, v35
  v_accvgpr_write_b32 a91, v34
  v_accvgpr_read_b32 v36, a184
  v_accvgpr_read_b32 v37, a185
  v_mul_f32 v36, s31, v36
  v_mul_f32 v37, s31, v37
  v_cvt_pk_bf16_f32 v36, v36, v37
  v_accvgpr_write_b32 a92, v36
  v_accvgpr_read_b32 v32, a186
  v_accvgpr_read_b32 v33, a187
  v_mul_f32 v32, s31, v32
  v_mul_f32 v33, s31, v33
  v_cvt_pk_bf16_f32 v32, v32, v33
  v_accvgpr_write_b32 a93, v32
  v_accvgpr_read_b32 v34, a188
  v_accvgpr_read_b32 v35, a189
  v_mul_f32 v34, s31, v34
  v_mul_f32 v35, s31, v35
  v_cvt_pk_bf16_f32 v34, v34, v35
  v_accvgpr_write_b32 a94, v34
  v_accvgpr_read_b32 v36, a190
  v_accvgpr_read_b32 v37, a191
  v_mul_f32 v36, s31, v36
  v_mul_f32 v37, s31, v37
  v_cvt_pk_bf16_f32 v36, v36, v37
  v_accvgpr_write_b32 a95, v36
  s_waitcnt lgkmcnt(3)
  v_mfma_f32_32x32x16_bf16 v[64:79], v[40:43], a[48:51], 0
  ds_read_b128 v[40:43], v3 offset:128
  v_mfma_f32_32x32x16_bf16 v[64:79], v[44:47], a[52:55], v[64:79]
  ds_read_b128 v[44:47], v4 offset:128
  v_mul_f32 v160, v160, v26
  v_mul_f32 v161, v161, v26
  v_cvt_pk_bf16_f32 v32, v160, v161
  v_accvgpr_write_b32 a0, v32
  v_mul_f32 v162, v162, v26
  v_mfma_f32_32x32x16_bf16 v[64:79], v[48:51], a[56:59], v[64:79]
  ds_read_b128 v[48:51], v1 offset:256
  v_mul_f32 v163, v163, v26
  v_cvt_pk_bf16_f32 v33, v162, v163
  v_accvgpr_write_b32 a1, v33
  v_mul_f32 v164, v164, v26
  s_waitcnt lgkmcnt(3)
  v_mfma_f32_32x32x16_bf16 v[64:79], v[52:55], a[60:63], v[64:79]
  ds_read_b128 v[52:55], v2 offset:256
  v_mul_f32 v165, v165, v26
  v_cvt_pk_bf16_f32 v34, v164, v165
  v_accvgpr_write_b32 a2, v34
  v_mul_f32 v166, v166, v26
  v_mul_f32 v167, v167, v26
  v_mfma_f32_32x32x16_bf16 v[64:79], v[56:59], a[64:67], v[64:79]
  ds_read_b128 v[56:59], v3 offset:256
  v_cvt_pk_bf16_f32 v35, v166, v167
  v_accvgpr_write_b32 a3, v35
  v_mul_f32 v168, v168, v26
  v_mul_f32 v169, v169, v26
  v_cvt_pk_bf16_f32 v32, v168, v169
  v_mfma_f32_32x32x16_bf16 v[64:79], v[60:63], a[68:71], v[64:79]
  ds_read_b128 v[60:63], v4 offset:256
  s_waitcnt vmcnt(18)
  s_barrier
  v_accvgpr_write_b32 a4, v32
  v_mul_f32 v170, v170, v26
  s_waitcnt lgkmcnt(3)
  v_mfma_f32_32x32x16_bf16 v[64:79], v[40:43], a[72:75], v[64:79]
  ds_read_b128 v[40:43], v1 offset:12288
  v_mul_f32 v171, v171, v26
  v_cvt_pk_bf16_f32 v33, v170, v171
  v_accvgpr_write_b32 a5, v33
  v_mul_f32 v172, v172, v26
  v_mul_f32 v173, v173, v26
  v_mfma_f32_32x32x16_bf16 v[64:79], v[44:47], a[76:79], v[64:79]
  ds_read_b128 v[44:47], v2 offset:12288
  v_cvt_pk_bf16_f32 v34, v172, v173
  v_accvgpr_write_b32 a6, v34
  v_mul_f32 v174, v174, v26
  v_mul_f32 v175, v175, v26
  v_cvt_pk_bf16_f32 v35, v174, v175
  v_mfma_f32_32x32x16_bf16 v[64:79], v[48:51], a[80:83], v[64:79]
  ds_read_b128 v[48:51], v3 offset:12288
  v_accvgpr_write_b32 a7, v35
  v_mul_f32 v176, v176, v26
  v_mul_f32 v177, v177, v26
  v_cvt_pk_bf16_f32 v32, v176, v177
  s_waitcnt lgkmcnt(3)
  v_mfma_f32_32x32x16_bf16 v[64:79], v[52:55], a[84:87], v[64:79]
  ds_read_b128 v[52:55], v4 offset:12288
  v_accvgpr_write_b32 a8, v32
  v_mul_f32 v178, v178, v26
  v_mul_f32 v179, v179, v26
  v_cvt_pk_bf16_f32 v33, v178, v179
  v_accvgpr_write_b32 a9, v33
  v_mfma_f32_32x32x16_bf16 v[64:79], v[56:59], a[88:91], v[64:79]
  ds_read_b128 v[56:59], v1 offset:12416
  v_mul_f32 v180, v180, v26
  v_mul_f32 v181, v181, v26
  v_cvt_pk_bf16_f32 v34, v180, v181
  v_accvgpr_write_b32 a10, v34
  v_mul_f32 v182, v182, v26
  v_mfma_f32_32x32x16_bf16 v[64:79], v[60:63], a[92:95], v[64:79]
  ds_read_b128 v[60:63], v2 offset:12416
  v_mul_f32 v183, v183, v26
  v_cvt_pk_bf16_f32 v35, v182, v183
  v_accvgpr_write_b32 a11, v35
  v_mul_f32 v184, v184, v26
  s_waitcnt lgkmcnt(3)
  v_mfma_f32_32x32x16_bf16 v[80:95], v[40:43], a[48:51], 0
  ds_read_b128 v[40:43], v3 offset:12416
  v_mul_f32 v185, v185, v26
  v_cvt_pk_bf16_f32 v32, v184, v185
  v_accvgpr_write_b32 a12, v32
  v_mul_f32 v186, v186, v26
  v_mul_f32 v187, v187, v26
  v_mfma_f32_32x32x16_bf16 v[80:95], v[44:47], a[52:55], v[80:95]
  ds_read_b128 v[44:47], v4 offset:12416
  v_max3_f32 v28, v64, v65, v66
  v_max3_f32 v29, v67, v68, v69
  v_max3_f32 v28, v28, v70, v71
  v_max3_f32 v29, v29, v72, v73
  v_max3_f32 v28, v28, v74, v75
  v_mfma_f32_32x32x16_bf16 v[80:95], v[48:51], a[56:59], v[80:95]
  ds_read_b128 v[48:51], v1 offset:12544
  v_max3_f32 v29, v29, v76, v77
  v_max3_f32 v28, v28, v78, v79
  v_max_f32 v28, v28, v29
  v_mov_b32 v29, v28
  s_waitcnt lgkmcnt(3)
  v_mfma_f32_32x32x16_bf16 v[80:95], v[52:55], a[60:63], v[80:95]
  ds_read_b128 v[52:55], v2 offset:12544
  v_mov_b32 v22, 0
  v_mov_b32 v23, 0
  v_permlane32_swap_b32 v28, v29
  v_max3_f32 v28, v28, v29, v127
  v_sub_f32 v96, 0, v28
  v_mfma_f32_32x32x16_bf16 v[80:95], v[56:59], a[64:67], v[80:95]
  ds_read_b128 v[56:59], v3 offset:12544
  v_sub_f32 v97, 0, v28
  v_sub_f32 v98, 0, v28
  v_sub_f32 v99, 0, v28
  v_sub_f32 v100, 0, v28
  v_sub_f32 v101, 0, v28
  v_mfma_f32_32x32x16_bf16 v[80:95], v[60:63], a[68:71], v[80:95]
  ds_read_b128 v[60:63], v4 offset:12544
  s_waitcnt vmcnt(15)
  s_barrier
  s_mov_b32 s45, 245760
  s_add_u32 m0, s32, 36864
  s_waitcnt lgkmcnt(3)
  v_mfma_f32_32x32x16_bf16 v[80:95], v[40:43], a[72:75], v[80:95]
  ds_read_b64_tr_b16 v[40:41], v5 offset:16384
  ds_read_b64_tr_b16 v[42:43], v5 offset:19456
  buffer_load_dwordx4 v11, s[4:7], s45 offen offset:0 nt lds
  buffer_load_dwordx4 v12, s[4:7], s45 offen offset:1024 nt lds
  buffer_load_dwordx4 v13, s[4:7], s45 offen offset:2048 nt lds
  v_sub_f32 v102, 0, v28
  v_mfma_f32_32x32x16_bf16 v[80:95], v[44:47], a[76:79], v[80:95]
  ds_read_b64_tr_b16 v[44:45], v6 offset:16384
  ds_read_b64_tr_b16 v[46:47], v6 offset:19456
  v_sub_f32 v103, 0, v28
  v_sub_f32 v104, 0, v28
  v_sub_f32 v105, 0, v28
  v_sub_f32 v106, 0, v28
  v_mfma_f32_32x32x16_bf16 v[80:95], v[48:51], a[80:83], v[80:95]
  ds_read_b64_tr_b16 v[48:49], v5 offset:16512
  ds_read_b64_tr_b16 v[50:51], v5 offset:19584
  v_sub_f32 v107, 0, v28
  v_sub_f32 v108, 0, v28
  v_sub_f32 v109, 0, v28
  s_waitcnt lgkmcnt(6)
  v_mfma_f32_32x32x16_bf16 v[80:95], v[52:55], a[84:87], v[80:95]
  ds_read_b64_tr_b16 v[52:53], v6 offset:16512
  ds_read_b64_tr_b16 v[54:55], v6 offset:19584
  v_sub_f32 v110, 0, v28
  v_sub_f32 v111, 0, v28
  v_sub_f32 v64, v64, v28
  v_sub_f32 v65, v65, v28
  v_mfma_f32_32x32x16_bf16 v[80:95], v[56:59], a[88:91], v[80:95]
  ds_read_b64_tr_b16 v[56:57], v5 offset:16640
  ds_read_b64_tr_b16 v[58:59], v5 offset:19712
  v_sub_f32 v66, v66, v28
  v_sub_f32 v67, v67, v28
  v_sub_f32 v68, v68, v28
  v_sub_f32 v69, v69, v28
  v_mfma_f32_32x32x16_bf16 v[80:95], v[60:63], a[92:95], v[80:95]
  ds_read_b64_tr_b16 v[60:61], v6 offset:16640
  ds_read_b64_tr_b16 v[62:63], v6 offset:19712
  v_sub_f32 v70, v70, v28
  v_sub_f32 v71, v71, v28
  v_sub_f32 v72, v72, v28
  v_cvt_pk_bf16_f32 v33, v186, v187
  v_accvgpr_write_b32 a13, v33
  v_mul_f32 v188, v188, v26
  v_mul_f32 v189, v189, v26
  v_cvt_pk_bf16_f32 v34, v188, v189
  v_accvgpr_write_b32 a14, v34
  v_mul_f32 v190, v190, v26
  v_mul_f32 v191, v191, v26
  v_cvt_pk_bf16_f32 v35, v190, v191
  v_accvgpr_write_b32 a15, v35
  v_mul_f32 v192, v192, v26
  v_mul_f32 v193, v193, v26
  v_cvt_pk_bf16_f32 v32, v192, v193
  v_accvgpr_write_b32 a16, v32
  v_mul_f32 v194, v194, v26
  v_mul_f32 v195, v195, v26
  v_cvt_pk_bf16_f32 v33, v194, v195
  v_accvgpr_write_b32 a17, v33
  v_mul_f32 v196, v196, v26
  v_mul_f32 v197, v197, v26
  v_cvt_pk_bf16_f32 v34, v196, v197
  v_accvgpr_write_b32 a18, v34
  v_mul_f32 v198, v198, v26
  v_mul_f32 v199, v199, v26
  v_cvt_pk_bf16_f32 v35, v198, v199
  v_accvgpr_write_b32 a19, v35
  v_mul_f32 v200, v200, v26
  v_mul_f32 v201, v201, v26
  v_cvt_pk_bf16_f32 v32, v200, v201
  v_accvgpr_write_b32 a20, v32
  v_mul_f32 v202, v202, v26
  v_mul_f32 v203, v203, v26
  v_cvt_pk_bf16_f32 v33, v202, v203
  v_accvgpr_write_b32 a21, v33
  v_mul_f32 v204, v204, v26
  v_mul_f32 v205, v205, v26
  v_cvt_pk_bf16_f32 v34, v204, v205
  v_accvgpr_write_b32 a22, v34
  v_mul_f32 v206, v206, v26
  v_mul_f32 v207, v207, v26
  v_cvt_pk_bf16_f32 v35, v206, v207
  v_accvgpr_write_b32 a23, v35
  v_mul_f32 v208, v208, v26
  v_mul_f32 v209, v209, v26
  v_cvt_pk_bf16_f32 v32, v208, v209
  v_accvgpr_write_b32 a24, v32
  v_mul_f32 v210, v210, v26
  v_mul_f32 v211, v211, v26
  v_cvt_pk_bf16_f32 v33, v210, v211
  v_accvgpr_write_b32 a25, v33
  v_mul_f32 v212, v212, v26
  v_mul_f32 v213, v213, v26
  v_cvt_pk_bf16_f32 v34, v212, v213
  v_accvgpr_write_b32 a26, v34
  v_mul_f32 v214, v214, v26
  v_mul_f32 v215, v215, v26
  v_cvt_pk_bf16_f32 v35, v214, v215
  v_accvgpr_write_b32 a27, v35
  v_mul_f32 v216, v216, v26
  v_mul_f32 v217, v217, v26
  v_cvt_pk_bf16_f32 v32, v216, v217
  v_accvgpr_write_b32 a28, v32
  v_mul_f32 v218, v218, v26
  v_mul_f32 v219, v219, v26
  v_cvt_pk_bf16_f32 v33, v218, v219
  v_accvgpr_write_b32 a29, v33
  v_mul_f32 v220, v220, v26
  v_mul_f32 v221, v221, v26
  v_cvt_pk_bf16_f32 v34, v220, v221
  v_accvgpr_write_b32 a30, v34
  v_mul_f32 v222, v222, v26
  v_mul_f32 v223, v223, v26
  v_cvt_pk_bf16_f32 v35, v222, v223
  v_accvgpr_write_b32 a31, v35
  v_mul_f32 v224, v224, v26
  v_mul_f32 v225, v225, v26
  v_cvt_pk_bf16_f32 v32, v224, v225
  v_accvgpr_write_b32 a32, v32
  v_mul_f32 v226, v226, v26
  v_mul_f32 v227, v227, v26
  v_cvt_pk_bf16_f32 v33, v226, v227
  v_accvgpr_write_b32 a33, v33
  v_mul_f32 v228, v228, v26
  v_mul_f32 v229, v229, v26
  v_cvt_pk_bf16_f32 v34, v228, v229
  v_accvgpr_write_b32 a34, v34
  v_mul_f32 v230, v230, v26
  v_mul_f32 v231, v231, v26
  v_cvt_pk_bf16_f32 v35, v230, v231
  v_accvgpr_write_b32 a35, v35
  v_mul_f32 v232, v232, v26
  v_mul_f32 v233, v233, v26
  v_cvt_pk_bf16_f32 v32, v232, v233
  v_accvgpr_write_b32 a36, v32
  v_mul_f32 v234, v234, v26
  v_mul_f32 v235, v235, v26
  v_cvt_pk_bf16_f32 v33, v234, v235
  v_accvgpr_write_b32 a37, v33
  v_mul_f32 v236, v236, v26
  v_mul_f32 v237, v237, v26
  v_cvt_pk_bf16_f32 v34, v236, v237
  v_accvgpr_write_b32 a38, v34
  v_mul_f32 v238, v238, v26
  v_mul_f32 v239, v239, v26
  v_cvt_pk_bf16_f32 v35, v238, v239
  v_accvgpr_write_b32 a39, v35
  v_mul_f32 v240, v240, v26
  v_mul_f32 v241, v241, v26
  v_cvt_pk_bf16_f32 v32, v240, v241
  v_accvgpr_write_b32 a40, v32
  v_mul_f32 v242, v242, v26
  v_mul_f32 v243, v243, v26
  v_cvt_pk_bf16_f32 v33, v242, v243
  v_accvgpr_write_b32 a41, v33
  v_mul_f32 v244, v244, v26
  v_mul_f32 v245, v245, v26
  v_cvt_pk_bf16_f32 v34, v244, v245
  v_accvgpr_write_b32 a42, v34
  v_mul_f32 v246, v246, v26
  v_mul_f32 v247, v247, v26
  v_cvt_pk_bf16_f32 v35, v246, v247
  v_accvgpr_write_b32 a43, v35
  v_mul_f32 v248, v248, v26
  v_mul_f32 v249, v249, v26
  v_cvt_pk_bf16_f32 v32, v248, v249
  v_accvgpr_write_b32 a44, v32
  v_mul_f32 v250, v250, v26
  v_mul_f32 v251, v251, v26
  v_cvt_pk_bf16_f32 v33, v250, v251
  v_accvgpr_write_b32 a45, v33
  v_mul_f32 v252, v252, v26
  v_mul_f32 v253, v253, v26
  v_cvt_pk_bf16_f32 v34, v252, v253
  v_accvgpr_write_b32 a46, v34
  v_mul_f32 v254, v254, v26
  v_mul_f32 v255, v255, v26
  v_cvt_pk_bf16_f32 v35, v254, v255
  v_accvgpr_write_b32 a47, v35
  v_sub_f32 v73, v73, v28
  v_sub_f32 v74, v74, v28
  v_sub_f32 v75, v75, v28
  v_sub_f32 v76, v76, v28
  v_sub_f32 v77, v77, v28
  v_sub_f32 v78, v78, v28
  v_sub_f32 v79, v79, v28
  v_exp_f32 v64, v64
  v_exp_f32 v65, v65
  v_add_f32 v22, v22, v64
  v_exp_f32 v66, v66
  v_add_f32 v23, v23, v65
  v_exp_f32 v67, v67
  v_add_f32 v22, v22, v66
  v_exp_f32 v68, v68
  v_add_f32 v23, v23, v67
  v_exp_f32 v69, v69
  v_add_f32 v22, v22, v68
  v_exp_f32 v70, v70
  v_add_f32 v23, v23, v69
  v_exp_f32 v71, v71
  v_add_f32 v22, v22, v70
  v_exp_f32 v72, v72
  v_add_f32 v23, v23, v71
  v_exp_f32 v73, v73
  v_add_f32 v22, v22, v72
  v_cvt_pk_bf16_f32 v64, v64, v65
  v_cvt_pk_bf16_f32 v65, v66, v67
  v_cvt_pk_bf16_f32 v66, v68, v69
  v_cvt_pk_bf16_f32 v67, v70, v71
  v_exp_f32 v74, v74
  v_add_f32 v23, v23, v73
  v_exp_f32 v75, v75
  v_add_f32 v22, v22, v74
  v_exp_f32 v76, v76
  v_add_f32 v23, v23, v75
  v_exp_f32 v77, v77
  v_add_f32 v22, v22, v76
  v_exp_f32 v78, v78
  v_add_f32 v23, v23, v77
  v_exp_f32 v79, v79
  v_add_f32 v22, v22, v78
  v_cvt_pk_bf16_f32 v72, v72, v73
  v_add_f32 v23, v23, v79
  v_cvt_pk_bf16_f32 v73, v74, v75
  v_cvt_pk_bf16_f32 v74, v76, v77
  v_cvt_pk_bf16_f32 v75, v78, v79
  s_waitcnt lgkmcnt(6)
  v_mfma_f32_32x32x16_bf16 v[160:175], v[40:43], v[64:67], 0
  ds_read_b64_tr_b16 v[40:41], v5 offset:22528
  ds_read_b64_tr_b16 v[42:43], v5 offset:25600
  v_mfma_f32_32x32x16_bf16 v[176:191], v[44:47], v[64:67], 0
  ds_read_b64_tr_b16 v[44:45], v6 offset:22528
  ds_read_b64_tr_b16 v[46:47], v6 offset:25600
  v_add_f32 v80, v80, v96
  v_add_f32 v81, v81, v97
  v_add_f32 v82, v82, v98
  v_add_f32 v83, v83, v99
  v_mfma_f32_32x32x16_bf16 v[192:207], v[48:51], v[64:67], 0
  ds_read_b64_tr_b16 v[48:49], v5 offset:22656
  ds_read_b64_tr_b16 v[50:51], v5 offset:25728
  v_add_f32 v84, v84, v100
  v_add_f32 v85, v85, v101
  v_add_f32 v86, v86, v102
  s_waitcnt lgkmcnt(6)
  v_mfma_f32_32x32x16_bf16 v[208:223], v[52:55], v[64:67], 0
  ds_read_b64_tr_b16 v[52:53], v6 offset:22656
  ds_read_b64_tr_b16 v[54:55], v6 offset:25728
  v_add_f32 v87, v87, v103
  v_add_f32 v88, v88, v104
  v_add_f32 v89, v89, v105
  v_add_f32 v90, v90, v106
  v_mfma_f32_32x32x16_bf16 v[224:239], v[56:59], v[64:67], 0
  ds_read_b64_tr_b16 v[56:57], v5 offset:22784
  ds_read_b64_tr_b16 v[58:59], v5 offset:25856
  v_add_f32 v91, v91, v107
  v_add_f32 v92, v92, v108
  v_add_f32 v93, v93, v109
  v_add_f32 v94, v94, v110
  v_mfma_f32_32x32x16_bf16 v[240:255], v[60:63], v[64:67], 0
  ds_read_b64_tr_b16 v[60:61], v6 offset:22784
  ds_read_b64_tr_b16 v[62:63], v6 offset:25856
  s_waitcnt vmcnt(15)
  s_barrier
  s_mov_b32 s44, 258048
  s_waitcnt lgkmcnt(6)
  v_mfma_f32_32x32x16_bf16 v[160:175], v[40:43], v[72:75], v[160:175]
  ds_read_b128 v[40:43], v1 offset:40960
  s_add_u32 m0, s32, 49152
  s_nop 0
  buffer_load_dwordx4 v11, s[4:7], s44 offen offset:0 nt lds
  buffer_load_dwordx4 v12, s[4:7], s44 offen offset:1024 nt lds
  buffer_load_dwordx4 v13, s[4:7], s44 offen offset:2048 nt lds
  s_mov_b32 s45, 245760
  v_mfma_f32_32x32x16_bf16 v[176:191], v[44:47], v[72:75], v[176:191]
  ds_read_b128 v[44:47], v2 offset:40960
  s_add_u32 m0, s32, 102400
  s_nop 0
  buffer_load_dwordx4 v14, s[8:11], s45 offen offset:0 nt lds
  buffer_load_dwordx4 v15, s[8:11], s45 offen offset:1024 nt lds
  buffer_load_dwordx4 v16, s[8:11], s45 offen offset:2048 nt lds
  v_add_f32 v95, v95, v111
  v_mfma_f32_32x32x16_bf16 v[192:207], v[48:51], v[72:75], v[192:207]
  ds_read_b128 v[48:51], v3 offset:40960
  v_max3_f32 v28, v80, v81, v82
  v_max3_f32 v29, v83, v84, v85
  v_max3_f32 v28, v28, v86, v87
  v_max3_f32 v29, v29, v88, v89
  s_waitcnt lgkmcnt(3)
  v_mfma_f32_32x32x16_bf16 v[208:223], v[52:55], v[72:75], v[208:223]
  ds_read_b128 v[52:55], v4 offset:40960
  v_max3_f32 v28, v28, v90, v91
  v_max3_f32 v29, v29, v92, v93
  v_max3_f32 v28, v28, v94, v95
  v_max_f32 v28, v28, v29
  v_mfma_f32_32x32x16_bf16 v[224:239], v[56:59], v[72:75], v[224:239]
  ds_read_b128 v[56:59], v1 offset:41088
  v_cmp_lt_f32 vcc, s43, v28
  s_cbranch_vccnz Lrare_61
Lback_62:
  v_exp_f32 v80, v80
  v_mfma_f32_32x32x16_bf16 v[240:255], v[60:63], v[72:75], v[240:255]
  ds_read_b128 v[60:63], v2 offset:41088
  v_exp_f32 v81, v81
  v_add_f32 v22, v22, v80
  s_waitcnt lgkmcnt(3)
  v_mfma_f32_32x32x16_bf16 v[64:79], v[40:43], a[48:51], v[96:111]
  ds_read_b128 v[40:43], v3 offset:41088
  v_exp_f32 v82, v82
  v_add_f32 v23, v23, v81
  v_exp_f32 v83, v83
  v_mfma_f32_32x32x16_bf16 v[64:79], v[44:47], a[52:55], v[64:79]
  ds_read_b128 v[44:47], v4 offset:41088
  v_add_f32 v22, v22, v82
  v_exp_f32 v84, v84
  v_add_f32 v23, v23, v83
  v_mfma_f32_32x32x16_bf16 v[64:79], v[48:51], a[56:59], v[64:79]
  ds_read_b128 v[48:51], v1 offset:41216
  v_exp_f32 v85, v85
  v_add_f32 v22, v22, v84
  s_waitcnt lgkmcnt(3)
  v_mfma_f32_32x32x16_bf16 v[64:79], v[52:55], a[60:63], v[64:79]
  ds_read_b128 v[52:55], v2 offset:41216
  v_exp_f32 v86, v86
  v_add_f32 v23, v23, v85
  v_exp_f32 v87, v87
  v_mfma_f32_32x32x16_bf16 v[64:79], v[56:59], a[64:67], v[64:79]
  ds_read_b128 v[56:59], v3 offset:41216
  v_add_f32 v22, v22, v86
  v_exp_f32 v88, v88
  v_add_f32 v23, v23, v87
  v_mfma_f32_32x32x16_bf16 v[64:79], v[60:63], a[68:71], v[64:79]
  ds_read_b128 v[60:63], v4 offset:41216
  s_waitcnt vmcnt(48)
  s_barrier
  v_exp_f32 v89, v89
  s_waitcnt lgkmcnt(3)
  v_mfma_f32_32x32x16_bf16 v[64:79], v[40:43], a[72:75], v[64:79]
  ds_read_b64_tr_b16 v[40:41], v7 offset:0
  ds_read_b64_tr_b16 v[42:43], v7 offset:1024
  v_add_f32 v22, v22, v88
  v_cvt_pk_bf16_f32 v80, v80, v81
  v_cvt_pk_bf16_f32 v81, v82, v83
  v_cvt_pk_bf16_f32 v82, v84, v85
  v_mfma_f32_32x32x16_bf16 v[64:79], v[44:47], a[76:79], v[64:79]
  ds_read_b64_tr_b16 v[44:45], v8 offset:0
  ds_read_b64_tr_b16 v[46:47], v8 offset:1024
  v_cvt_pk_bf16_f32 v83, v86, v87
  v_exp_f32 v90, v90
  v_add_f32 v23, v23, v89
  v_mfma_f32_32x32x16_bf16 v[64:79], v[48:51], a[80:83], v[64:79]
  ds_read_b64_tr_b16 v[48:49], v9 offset:0
  ds_read_b64_tr_b16 v[50:51], v9 offset:1024
  v_exp_f32 v91, v91
  v_add_f32 v22, v22, v90
  s_waitcnt lgkmcnt(6)
  v_mfma_f32_32x32x16_bf16 v[64:79], v[52:55], a[84:87], v[64:79]
  ds_read_b64_tr_b16 v[52:53], v10 offset:0
  ds_read_b64_tr_b16 v[54:55], v10 offset:1024
  v_exp_f32 v92, v92
  v_add_f32 v23, v23, v91
  v_mfma_f32_32x32x16_bf16 v[64:79], v[56:59], a[88:91], v[64:79]
  ds_read_b64_tr_b16 v[56:57], v7 offset:4096
  ds_read_b64_tr_b16 v[58:59], v7 offset:5120
  v_exp_f32 v93, v93
  v_add_f32 v22, v22, v92
  v_mfma_f32_32x32x16_bf16 v[64:79], v[60:63], a[92:95], v[64:79]
  ds_read_b64_tr_b16 v[60:61], v8 offset:4096
  ds_read_b64_tr_b16 v[62:63], v8 offset:5120
  v_exp_f32 v94, v94
  v_add_f32 v23, v23, v93
  s_waitcnt lgkmcnt(6)
  v_mfma_f32_32x32x16_bf16 a[96:111], v[40:43], a[0:3], 0
  ds_read_b64_tr_b16 v[40:41], v9 offset:4096
  ds_read_b64_tr_b16 v[42:43], v9 offset:5120
  v_exp_f32 v95, v95
  v_add_f32 v22, v22, v94
  v_cvt_pk_bf16_f32 v88, v88, v89
  v_mfma_f32_32x32x16_bf16 a[112:127], v[44:47], a[0:3], 0
  ds_read_b64_tr_b16 v[44:45], v10 offset:4096
  ds_read_b64_tr_b16 v[46:47], v10 offset:5120
  v_add_f32 v23, v23, v95
  v_cvt_pk_bf16_f32 v89, v90, v91
  v_cvt_pk_bf16_f32 v90, v92, v93
  v_cvt_pk_bf16_f32 v91, v94, v95
  v_mfma_f32_32x32x16_bf16 a[128:143], v[48:51], a[0:3], 0
  ds_read_b64_tr_b16 v[48:49], v7 offset:8192
  ds_read_b64_tr_b16 v[50:51], v7 offset:9216
  v_max3_f32 v28, v64, v65, v66
  v_max3_f32 v29, v67, v68, v69
  v_max3_f32 v28, v28, v70, v71
  s_waitcnt lgkmcnt(6)
  v_mfma_f32_32x32x16_bf16 a[144:159], v[52:55], a[0:3], 0
  ds_read_b64_tr_b16 v[52:53], v8 offset:8192
  ds_read_b64_tr_b16 v[54:55], v8 offset:9216
  v_max3_f32 v29, v29, v72, v73
  v_max3_f32 v28, v28, v74, v75
  v_max3_f32 v29, v29, v76, v77
  v_max3_f32 v28, v28, v78, v79
  v_mfma_f32_32x32x16_bf16 a[96:111], v[56:59], a[4:7], a[96:111]
  ds_read_b64_tr_b16 v[56:57], v9 offset:8192
  ds_read_b64_tr_b16 v[58:59], v9 offset:9216
  v_max_f32 v28, v28, v29
  v_mfma_f32_32x32x16_bf16 a[112:127], v[60:63], a[4:7], a[112:127]
  ds_read_b64_tr_b16 v[60:61], v10 offset:8192
  ds_read_b64_tr_b16 v[62:63], v10 offset:9216
  s_waitcnt vmcnt(18)
  s_barrier
  s_mov_b32 s44, 270336
  s_waitcnt lgkmcnt(6)
  v_mfma_f32_32x32x16_bf16 a[128:143], v[40:43], a[4:7], a[128:143]
  ds_read_b64_tr_b16 v[40:41], v5 offset:53248
  ds_read_b64_tr_b16 v[42:43], v5 offset:56320
  s_add_u32 m0, s32, 73728
  s_nop 0
  buffer_load_dwordx4 v11, s[4:7], s44 offen offset:0 nt lds
  buffer_load_dwordx4 v12, s[4:7], s44 offen offset:1024 nt lds
  buffer_load_dwordx4 v13, s[4:7], s44 offen offset:2048 nt lds
  v_mfma_f32_32x32x16_bf16 a[144:159], v[44:47], a[4:7], a[144:159]
  ds_read_b64_tr_b16 v[44:45], v6 offset:53248
  ds_read_b64_tr_b16 v[46:47], v6 offset:56320
  s_mov_b32 s45, 258048
  s_add_u32 m0, s32, 114688
  s_nop 0
  buffer_load_dwordx4 v14, s[8:11], s45 offen offset:0 nt lds
  buffer_load_dwordx4 v15, s[8:11], s45 offen offset:1024 nt lds
  v_mfma_f32_32x32x16_bf16 a[96:111], v[48:51], a[8:11], a[96:111]
  ds_read_b64_tr_b16 v[48:49], v5 offset:53376
  ds_read_b64_tr_b16 v[50:51], v5 offset:56448
  buffer_load_dwordx4 v16, s[8:11], s45 offen offset:2048 nt lds
  s_mov_b32 s44, 282624
  s_add_u32 m0, s32, 86016
  s_waitcnt lgkmcnt(6)
  v_mfma_f32_32x32x16_bf16 a[112:127], v[52:55], a[8:11], a[112:127]
  ds_read_b64_tr_b16 v[52:53], v6 offset:53376
  ds_read_b64_tr_b16 v[54:55], v6 offset:56448
  buffer_load_dwordx4 v11, s[4:7], s44 offen offset:0 nt lds
  buffer_load_dwordx4 v12, s[4:7], s44 offen offset:1024 nt lds
  buffer_load_dwordx4 v13, s[4:7], s44 offen offset:2048 nt lds
  v_mfma_f32_32x32x16_bf16 a[128:143], v[56:59], a[8:11], a[128:143]
  ds_read_b64_tr_b16 v[56:57], v5 offset:53504
  ds_read_b64_tr_b16 v[58:59], v5 offset:56576
  v_mfma_f32_32x32x16_bf16 a[144:159], v[60:63], a[8:11], a[144:159]
  ds_read_b64_tr_b16 v[60:61], v6 offset:53504
  ds_read_b64_tr_b16 v[62:63], v6 offset:56576
  s_cmp_lg_u32 s42, 0
  s_cbranch_scc1 LrB_63
LbB_64:
  s_waitcnt lgkmcnt(6)
  v_mfma_f32_32x32x16_bf16 v[160:175], v[40:43], v[80:83], v[160:175]
  ds_read_b64_tr_b16 v[40:41], v5 offset:59392
  ds_read_b64_tr_b16 v[42:43], v5 offset:62464
  v_cmp_lt_f32 vcc, s43, v28
  s_cbranch_vccnz Lrare_65
Lback_66:
  v_exp_f32 v64, v64
  v_mfma_f32_32x32x16_bf16 v[176:191], v[44:47], v[80:83], v[176:191]
  ds_read_b64_tr_b16 v[44:45], v6 offset:59392
  ds_read_b64_tr_b16 v[46:47], v6 offset:62464
  v_exp_f32 v65, v65
  v_add_f32 v22, v22, v64
  v_mfma_f32_32x32x16_bf16 v[192:207], v[48:51], v[80:83], v[192:207]
  ds_read_b64_tr_b16 v[48:49], v5 offset:59520
  ds_read_b64_tr_b16 v[50:51], v5 offset:62592
  v_exp_f32 v66, v66
  v_add_f32 v23, v23, v65
  s_waitcnt lgkmcnt(6)
  v_mfma_f32_32x32x16_bf16 v[208:223], v[52:55], v[80:83], v[208:223]
  ds_read_b64_tr_b16 v[52:53], v6 offset:59520
  ds_read_b64_tr_b16 v[54:55], v6 offset:62592
  v_exp_f32 v67, v67
  v_add_f32 v22, v22, v66
  v_mfma_f32_32x32x16_bf16 v[224:239], v[56:59], v[80:83], v[224:239]
  ds_read_b64_tr_b16 v[56:57], v5 offset:59648
  ds_read_b64_tr_b16 v[58:59], v5 offset:62720
  v_exp_f32 v68, v68
  v_add_f32 v23, v23, v67
  v_mfma_f32_32x32x16_bf16 v[240:255], v[60:63], v[80:83], v[240:255]
  ds_read_b64_tr_b16 v[60:61], v6 offset:59648
  ds_read_b64_tr_b16 v[62:63], v6 offset:62720
  s_waitcnt vmcnt(24)
  s_barrier
  s_mov_b32 s45, 184320
  s_waitcnt lgkmcnt(6)
  v_mfma_f32_32x32x16_bf16 v[160:175], v[40:43], v[88:91], v[160:175]
  ds_read_b128 v[40:43], v1 offset:24576
  s_add_u32 m0, s32, 0
  s_nop 0
  buffer_load_dwordx4 v17, s[20:23], s45 offen offset:0 nt lds
  buffer_load_dwordx4 v18, s[20:23], s45 offen offset:1024 nt lds
  buffer_load_dwordx4 v19, s[20:23], s45 offen offset:2048 nt lds
  v_mfma_f32_32x32x16_bf16 v[176:191], v[44:47], v[88:91], v[176:191]
  ds_read_b128 v[44:47], v2 offset:24576
  v_exp_f32 v69, v69
  v_add_f32 v22, v22, v68
  v_exp_f32 v70, v70
  v_mfma_f32_32x32x16_bf16 v[192:207], v[48:51], v[88:91], v[192:207]
  ds_read_b128 v[48:51], v3 offset:24576
  v_add_f32 v23, v23, v69
  v_exp_f32 v71, v71
  v_add_f32 v22, v22, v70
  s_waitcnt lgkmcnt(3)
  v_mfma_f32_32x32x16_bf16 v[208:223], v[52:55], v[88:91], v[208:223]
  ds_read_b128 v[52:55], v4 offset:24576
  v_exp_f32 v72, v72
  v_add_f32 v23, v23, v71
  v_exp_f32 v73, v73
  v_mfma_f32_32x32x16_bf16 v[224:239], v[56:59], v[88:91], v[224:239]
  ds_read_b128 v[56:59], v1 offset:24704
  v_add_f32 v22, v22, v72
  v_cvt_pk_bf16_f32 v64, v64, v65
  v_cvt_pk_bf16_f32 v65, v66, v67
  v_cvt_pk_bf16_f32 v66, v68, v69
  v_cvt_pk_bf16_f32 v67, v70, v71
  v_mfma_f32_32x32x16_bf16 v[240:255], v[60:63], v[88:91], v[240:255]
  ds_read_b128 v[60:63], v2 offset:24704
  v_exp_f32 v74, v74
  v_add_f32 v23, v23, v73
  s_waitcnt lgkmcnt(3)
  v_mfma_f32_32x32x16_bf16 v[80:95], v[40:43], a[48:51], v[96:111]
  ds_read_b128 v[40:43], v3 offset:24704
  v_exp_f32 v75, v75
  v_add_f32 v22, v22, v74
  v_exp_f32 v76, v76
  v_mfma_f32_32x32x16_bf16 v[80:95], v[44:47], a[52:55], v[80:95]
  ds_read_b128 v[44:47], v4 offset:24704
  v_add_f32 v23, v23, v75
  v_exp_f32 v77, v77
  v_add_f32 v22, v22, v76
  v_mfma_f32_32x32x16_bf16 v[80:95], v[48:51], a[56:59], v[80:95]
  ds_read_b128 v[48:51], v1 offset:24832
  v_exp_f32 v78, v78
  v_add_f32 v23, v23, v77
  s_waitcnt lgkmcnt(3)
  v_mfma_f32_32x32x16_bf16 v[80:95], v[52:55], a[60:63], v[80:95]
  ds_read_b128 v[52:55], v2 offset:24832
  v_exp_f32 v79, v79
  v_add_f32 v22, v22, v78
  v_cvt_pk_bf16_f32 v72, v72, v73
  v_add_f32 v23, v23, v79
  v_mfma_f32_32x32x16_bf16 v[80:95], v[56:59], a[64:67], v[80:95]
  ds_read_b128 v[56:59], v3 offset:24832
  v_cvt_pk_bf16_f32 v73, v74, v75
  v_cvt_pk_bf16_f32 v74, v76, v77
  v_cvt_pk_bf16_f32 v75, v78, v79
  v_mfma_f32_32x32x16_bf16 v[80:95], v[60:63], a[68:71], v[80:95]
  ds_read_b128 v[60:63], v4 offset:24832
  s_waitcnt vmcnt(24)
  s_barrier
  s_mov_b32 s44, 270336
  s_add_u32 m0, s32, 151552
  s_waitcnt lgkmcnt(3)
  v_mfma_f32_32x32x16_bf16 v[80:95], v[40:43], a[72:75], v[80:95]
  ds_read_b64_tr_b16 v[40:41], v5 offset:40960
  ds_read_b64_tr_b16 v[42:43], v5 offset:44032
  buffer_load_dwordx4 v14, s[8:11], s44 offen offset:0 nt lds
  buffer_load_dwordx4 v15, s[8:11], s44 offen offset:1024 nt lds
  buffer_load_dwordx4 v16, s[8:11], s44 offen offset:2048 nt lds
  v_mfma_f32_32x32x16_bf16 v[80:95], v[44:47], a[76:79], v[80:95]
  ds_read_b64_tr_b16 v[44:45], v6 offset:40960
  ds_read_b64_tr_b16 v[46:47], v6 offset:44032
  v_mfma_f32_32x32x16_bf16 v[80:95], v[48:51], a[80:83], v[80:95]
  ds_read_b64_tr_b16 v[48:49], v5 offset:41088
  ds_read_b64_tr_b16 v[50:51], v5 offset:44160
  s_waitcnt lgkmcnt(6)
  v_mfma_f32_32x32x16_bf16 v[80:95], v[52:55], a[84:87], v[80:95]
  ds_read_b64_tr_b16 v[52:53], v6 offset:41088
  ds_read_b64_tr_b16 v[54:55], v6 offset:44160
  v_mfma_f32_32x32x16_bf16 v[80:95], v[56:59], a[88:91], v[80:95]
  ds_read_b64_tr_b16 v[56:57], v5 offset:41216
  ds_read_b64_tr_b16 v[58:59], v5 offset:44288
  v_mfma_f32_32x32x16_bf16 v[80:95], v[60:63], a[92:95], v[80:95]
  ds_read_b64_tr_b16 v[60:61], v6 offset:41216
  ds_read_b64_tr_b16 v[62:63], v6 offset:44288
  s_cmp_lg_u32 s42, 0
  s_cbranch_scc1 LrB_67
LbB_68:
  s_waitcnt lgkmcnt(6)
  v_mfma_f32_32x32x16_bf16 v[160:175], v[40:43], v[64:67], v[160:175]
  ds_read_b64_tr_b16 v[40:41], v5 offset:47104
  ds_read_b64_tr_b16 v[42:43], v5 offset:50176
  v_mfma_f32_32x32x16_bf16 v[176:191], v[44:47], v[64:67], v[176:191]
  ds_read_b64_tr_b16 v[44:45], v6 offset:47104
  ds_read_b64_tr_b16 v[46:47], v6 offset:50176
  s_nop 0
  v_max3_f32 v28, v80, v81, v82
  v_max3_f32 v29, v83, v84, v85
  v_max3_f32 v28, v28, v86, v87
  v_max3_f32 v29, v29, v88, v89
  v_mfma_f32_32x32x16_bf16 v[192:207], v[48:51], v[64:67], v[192:207]
  ds_read_b64_tr_b16 v[48:49], v5 offset:47232
  ds_read_b64_tr_b16 v[50:51], v5 offset:50304
  v_max3_f32 v28, v28, v90, v91
  v_max3_f32 v29, v29, v92, v93
  v_max3_f32 v28, v28, v94, v95
  s_waitcnt lgkmcnt(6)
  v_mfma_f32_32x32x16_bf16 v[208:223], v[52:55], v[64:67], v[208:223]
  ds_read_b64_tr_b16 v[52:53], v6 offset:47232
  ds_read_b64_tr_b16 v[54:55], v6 offset:50304
  v_max_f32 v28, v28, v29
  v_cmp_lt_f32 vcc, s43, v28
  s_cbranch_vccnz Lrare_69
Lback_70:
  v_mfma_f32_32x32x16_bf16 v[224:239], v[56:59], v[64:67], v[224:239]
  ds_read_b64_tr_b16 v[56:57], v5 offset:47360
  ds_read_b64_tr_b16 v[58:59], v5 offset:50432
  v_exp_f32 v80, v80
  v_exp_f32 v81, v81
  v_mfma_f32_32x32x16_bf16 v[240:255], v[60:63], v[64:67], v[240:255]
  ds_read_b64_tr_b16 v[60:61], v6 offset:47360
  ds_read_b64_tr_b16 v[62:63], v6 offset:50432
  s_waitcnt vmcnt(57)
  s_barrier
  v_add_f32 v22, v22, v80
  s_waitcnt lgkmcnt(6)
  v_mfma_f32_32x32x16_bf16 v[160:175], v[40:43], v[72:75], v[160:175]
  ds_read_b64_tr_b16 v[40:41], v7 offset:12288
  ds_read_b64_tr_b16 v[42:43], v7 offset:13312
  v_exp_f32 v82, v82
  v_add_f32 v23, v23, v81
  v_mfma_f32_32x32x16_bf16 v[176:191], v[44:47], v[72:75], v[176:191]
  ds_read_b64_tr_b16 v[44:45], v8 offset:12288
  ds_read_b64_tr_b16 v[46:47], v8 offset:13312
  v_exp_f32 v83, v83
  v_add_f32 v22, v22, v82
  v_mfma_f32_32x32x16_bf16 v[192:207], v[48:51], v[72:75], v[192:207]
  ds_read_b64_tr_b16 v[48:49], v9 offset:12288
  ds_read_b64_tr_b16 v[50:51], v9 offset:13312
  v_exp_f32 v84, v84
  v_add_f32 v23, v23, v83
  s_waitcnt lgkmcnt(6)
  v_mfma_f32_32x32x16_bf16 v[208:223], v[52:55], v[72:75], v[208:223]
  ds_read_b64_tr_b16 v[52:53], v10 offset:12288
  ds_read_b64_tr_b16 v[54:55], v10 offset:13312
  v_exp_f32 v85, v85
  v_add_f32 v22, v22, v84
  v_mfma_f32_32x32x16_bf16 v[224:239], v[56:59], v[72:75], v[224:239]
  ds_read_b64_tr_b16 v[56:57], v7 offset:16384
  ds_read_b64_tr_b16 v[58:59], v7 offset:17408
  v_exp_f32 v86, v86
  v_add_f32 v23, v23, v85
  v_mfma_f32_32x32x16_bf16 v[240:255], v[60:63], v[72:75], v[240:255]
  ds_read_b64_tr_b16 v[60:61], v8 offset:16384
  ds_read_b64_tr_b16 v[62:63], v8 offset:17408
  v_exp_f32 v87, v87
  v_add_f32 v22, v22, v86
  s_waitcnt lgkmcnt(6)
  v_mfma_f32_32x32x16_bf16 a[96:111], v[40:43], a[12:15], a[96:111]
  ds_read_b64_tr_b16 v[40:41], v9 offset:16384
  ds_read_b64_tr_b16 v[42:43], v9 offset:17408
  v_exp_f32 v88, v88
  v_add_f32 v23, v23, v87
  v_mfma_f32_32x32x16_bf16 a[112:127], v[44:47], a[12:15], a[112:127]
  ds_read_b64_tr_b16 v[44:45], v10 offset:16384
  ds_read_b64_tr_b16 v[46:47], v10 offset:17408
  v_exp_f32 v89, v89
  v_add_f32 v22, v22, v88
  v_cvt_pk_bf16_f32 v80, v80, v81
  v_mfma_f32_32x32x16_bf16 a[128:143], v[48:51], a[12:15], a[128:143]
  ds_read_b64_tr_b16 v[48:49], v7 offset:20480
  ds_read_b64_tr_b16 v[50:51], v7 offset:21504
  v_cvt_pk_bf16_f32 v81, v82, v83
  v_cvt_pk_bf16_f32 v82, v84, v85
  v_cvt_pk_bf16_f32 v83, v86, v87
  s_waitcnt lgkmcnt(6)
  v_mfma_f32_32x32x16_bf16 a[144:159], v[52:55], a[12:15], a[144:159]
  ds_read_b64_tr_b16 v[52:53], v8 offset:20480
  ds_read_b64_tr_b16 v[54:55], v8 offset:21504
  v_exp_f32 v90, v90
  v_add_f32 v23, v23, v89
  v_mfma_f32_32x32x16_bf16 a[96:111], v[56:59], a[16:19], a[96:111]
  ds_read_b64_tr_b16 v[56:57], v9 offset:20480
  ds_read_b64_tr_b16 v[58:59], v9 offset:21504
  v_exp_f32 v91, v91
  v_add_f32 v22, v22, v90
  v_mfma_f32_32x32x16_bf16 a[112:127], v[60:63], a[16:19], a[112:127]
  ds_read_b64_tr_b16 v[60:61], v10 offset:20480
  ds_read_b64_tr_b16 v[62:63], v10 offset:21504
  s_waitcnt vmcnt(24)
  s_barrier
  s_mov_b32 s45, 282624
  s_waitcnt lgkmcnt(6)
  v_mfma_f32_32x32x16_bf16 a[128:143], v[40:43], a[16:19], a[128:143]
  ds_read_b64_tr_b16 v[40:41], v5 offset:28672
  ds_read_b64_tr_b16 v[42:43], v5 offset:31744
  s_add_u32 m0, s32, 139264
  s_nop 0
  buffer_load_dwordx4 v14, s[8:11], s45 offen offset:0 nt lds
  buffer_load_dwordx4 v15, s[8:11], s45 offen offset:1024 nt lds
  buffer_load_dwordx4 v16, s[8:11], s45 offen offset:2048 nt lds
  v_mfma_f32_32x32x16_bf16 a[144:159], v[44:47], a[16:19], a[144:159]
  ds_read_b64_tr_b16 v[44:45], v6 offset:28672
  ds_read_b64_tr_b16 v[46:47], v6 offset:31744
  s_mov_b32 s44, 294912
  s_add_u32 m0, s32, 61440
  s_nop 0
  buffer_load_dwordx4 v11, s[4:7], s44 offen offset:0 nt lds
  buffer_load_dwordx4 v12, s[4:7], s44 offen offset:1024 nt lds
  v_mfma_f32_32x32x16_bf16 a[96:111], v[48:51], a[20:23], a[96:111]
  ds_read_b64_tr_b16 v[48:49], v5 offset:28800
  ds_read_b64_tr_b16 v[50:51], v5 offset:31872
  buffer_load_dwordx4 v13, s[4:7], s44 offen offset:2048 nt lds
  v_exp_f32 v92, v92
  s_waitcnt lgkmcnt(6)
  v_mfma_f32_32x32x16_bf16 a[112:127], v[52:55], a[20:23], a[112:127]
  ds_read_b64_tr_b16 v[52:53], v6 offset:28800
  ds_read_b64_tr_b16 v[54:55], v6 offset:31872
  v_add_f32 v23, v23, v91
  v_exp_f32 v93, v93
  v_add_f32 v22, v22, v92
  v_mfma_f32_32x32x16_bf16 a[128:143], v[56:59], a[20:23], a[128:143]
  ds_read_b64_tr_b16 v[56:57], v5 offset:28928
  ds_read_b64_tr_b16 v[58:59], v5 offset:32000
  v_exp_f32 v94, v94
  v_add_f32 v23, v23, v93
  v_mfma_f32_32x32x16_bf16 a[144:159], v[60:63], a[20:23], a[144:159]
  ds_read_b64_tr_b16 v[60:61], v6 offset:28928
  ds_read_b64_tr_b16 v[62:63], v6 offset:32000
  v_exp_f32 v95, v95
  v_add_f32 v22, v22, v94
  v_cvt_pk_bf16_f32 v88, v88, v89
  v_add_f32 v23, v23, v95
  v_cvt_pk_bf16_f32 v89, v90, v91
  v_cvt_pk_bf16_f32 v90, v92, v93
  v_cvt_pk_bf16_f32 v91, v94, v95
  s_cmp_lg_u32 s42, 0
  s_cbranch_scc1 LrB_71
LbB_72:
  s_waitcnt lgkmcnt(6)
  v_mfma_f32_32x32x16_bf16 v[160:175], v[40:43], v[80:83], v[160:175]
  ds_read_b64_tr_b16 v[40:41], v5 offset:34816
  ds_read_b64_tr_b16 v[42:43], v5 offset:37888
  v_mfma_f32_32x32x16_bf16 v[176:191], v[44:47], v[80:83], v[176:191]
  ds_read_b64_tr_b16 v[44:45], v6 offset:34816
  ds_read_b64_tr_b16 v[46:47], v6 offset:37888
  v_mfma_f32_32x32x16_bf16 v[192:207], v[48:51], v[80:83], v[192:207]
  ds_read_b64_tr_b16 v[48:49], v5 offset:34944
  ds_read_b64_tr_b16 v[50:51], v5 offset:38016
  s_waitcnt lgkmcnt(6)
  v_mfma_f32_32x32x16_bf16 v[208:223], v[52:55], v[80:83], v[208:223]
  ds_read_b64_tr_b16 v[52:53], v6 offset:34944
  ds_read_b64_tr_b16 v[54:55], v6 offset:38016
  v_mfma_f32_32x32x16_bf16 v[224:239], v[56:59], v[80:83], v[224:239]
  ds_read_b64_tr_b16 v[56:57], v5 offset:35072
  ds_read_b64_tr_b16 v[58:59], v5 offset:38144
  v_mfma_f32_32x32x16_bf16 v[240:255], v[60:63], v[80:83], v[240:255]
  ds_read_b64_tr_b16 v[60:61], v6 offset:35072
  ds_read_b64_tr_b16 v[62:63], v6 offset:38144
  s_waitcnt vmcnt(27)
  s_barrier
  s_mov_b32 s45, 256
  s_waitcnt lgkmcnt(6)
  v_mfma_f32_32x32x16_bf16 v[160:175], v[40:43], v[88:91], v[160:175]
  ds_read_b128 v[40:43], v1 offset:0
  s_add_u32 m0, s32, 12288
  s_nop 0
  buffer_load_dwordx4 v17, s[20:23], s45 offen offset:0 nt lds
  buffer_load_dwordx4 v18, s[20:23], s45 offen offset:1024 nt lds
  buffer_load_dwordx4 v19, s[20:23], s45 offen offset:2048 nt lds
  v_mfma_f32_32x32x16_bf16 v[176:191], v[44:47], v[88:91], v[176:191]
  ds_read_b128 v[44:47], v2 offset:0
  v_mfma_f32_32x32x16_bf16 v[192:207], v[48:51], v[88:91], v[192:207]
  ds_read_b128 v[48:51], v3 offset:0
  s_waitcnt lgkmcnt(3)
  v_mfma_f32_32x32x16_bf16 v[208:223], v[52:55], v[88:91], v[208:223]
  ds_read_b128 v[52:55], v4 offset:0
  v_mfma_f32_32x32x16_bf16 v[224:239], v[56:59], v[88:91], v[224:239]
  ds_read_b128 v[56:59], v1 offset:128
  v_mfma_f32_32x32x16_bf16 v[240:255], v[60:63], v[88:91], v[240:255]
  ds_read_b128 v[60:63], v2 offset:128
  s_waitcnt lgkmcnt(3)
  v_mfma_f32_32x32x16_bf16 v[64:79], v[40:43], a[48:51], v[96:111]
  ds_read_b128 v[40:43], v3 offset:128
  v_mfma_f32_32x32x16_bf16 v[64:79], v[44:47], a[52:55], v[64:79]
  ds_read_b128 v[44:47], v4 offset:128
  v_mfma_f32_32x32x16_bf16 v[64:79], v[48:51], a[56:59], v[64:79]
  ds_read_b128 v[48:51], v1 offset:256
  s_waitcnt lgkmcnt(3)
  v_mfma_f32_32x32x16_bf16 v[64:79], v[52:55], a[60:63], v[64:79]
  ds_read_b128 v[52:55], v2 offset:256
  v_mfma_f32_32x32x16_bf16 v[64:79], v[56:59], a[64:67], v[64:79]
  ds_read_b128 v[56:59], v3 offset:256
  v_mfma_f32_32x32x16_bf16 v[64:79], v[60:63], a[68:71], v[64:79]
  ds_read_b128 v[60:63], v4 offset:256
  s_waitcnt vmcnt(27)
  s_barrier
  s_waitcnt lgkmcnt(3)
  v_mfma_f32_32x32x16_bf16 v[64:79], v[40:43], a[72:75], v[64:79]
  ds_read_b128 v[40:43], v1 offset:12288
  v_mfma_f32_32x32x16_bf16 v[64:79], v[44:47], a[76:79], v[64:79]
  ds_read_b128 v[44:47], v2 offset:12288
  v_mfma_f32_32x32x16_bf16 v[64:79], v[48:51], a[80:83], v[64:79]
  ds_read_b128 v[48:51], v3 offset:12288
  s_waitcnt lgkmcnt(3)
  v_mfma_f32_32x32x16_bf16 v[64:79], v[52:55], a[84:87], v[64:79]
  ds_read_b128 v[52:55], v4 offset:12288
  v_mfma_f32_32x32x16_bf16 v[64:79], v[56:59], a[88:91], v[64:79]
  ds_read_b128 v[56:59], v1 offset:12416
  v_mfma_f32_32x32x16_bf16 v[64:79], v[60:63], a[92:95], v[64:79]
  ds_read_b128 v[60:63], v2 offset:12416
  s_waitcnt lgkmcnt(3)
  v_mfma_f32_32x32x16_bf16 v[80:95], v[40:43], a[48:51], v[96:111]
  ds_read_b128 v[40:43], v3 offset:12416
  v_mfma_f32_32x32x16_bf16 v[80:95], v[44:47], a[52:55], v[80:95]
  ds_read_b128 v[44:47], v4 offset:12416
  s_nop 5
  v_max3_f32 v28, v64, v65, v66
  v_max3_f32 v29, v67, v68, v69
  v_max3_f32 v28, v28, v70, v71
  v_max3_f32 v29, v29, v72, v73
  v_max3_f32 v28, v28, v74, v75
  v_mfma_f32_32x32x16_bf16 v[80:95], v[48:51], a[56:59], v[80:95]
  ds_read_b128 v[48:51], v1 offset:12544
  v_max3_f32 v29, v29, v76, v77
  v_max3_f32 v28, v28, v78, v79
  v_max_f32 v28, v28, v29
  s_waitcnt lgkmcnt(3)
  v_mfma_f32_32x32x16_bf16 v[80:95], v[52:55], a[60:63], v[80:95]
  ds_read_b128 v[52:55], v2 offset:12544
  v_cmp_lt_f32 vcc, s43, v28
  s_cbranch_vccnz Lrare_73
Lback_74:
  v_exp_f32 v64, v64
  v_mfma_f32_32x32x16_bf16 v[80:95], v[56:59], a[64:67], v[80:95]
  ds_read_b128 v[56:59], v3 offset:12544
  v_exp_f32 v65, v65
  v_add_f32 v22, v22, v64
  v_exp_f32 v66, v66
  v_mfma_f32_32x32x16_bf16 v[80:95], v[60:63], a[68:71], v[80:95]
  ds_read_b128 v[60:63], v4 offset:12544
  s_waitcnt vmcnt(24)
  s_barrier
  s_mov_b32 s44, 307200
  s_add_u32 m0, s32, 36864
  s_waitcnt lgkmcnt(3)
  v_mfma_f32_32x32x16_bf16 v[80:95], v[40:43], a[72:75], v[80:95]
  ds_read_b64_tr_b16 v[40:41], v5 offset:4096
  ds_read_b64_tr_b16 v[42:43], v5 offset:7168
  buffer_load_dwordx4 v11, s[4:7], s44 offen offset:0 nt lds
  buffer_load_dwordx4 v12, s[4:7], s44 offen offset:1024 nt lds
  buffer_load_dwordx4 v13, s[4:7], s44 offen offset:2048 nt lds
  s_mov_b32 s45, 294912
  v_mfma_f32_32x32x16_bf16 v[80:95], v[44:47], a[76:79], v[80:95]
  ds_read_b64_tr_b16 v[44:45], v6 offset:4096
  ds_read_b64_tr_b16 v[46:47], v6 offset:7168
  s_add_u32 m0, s32, 126976
  s_nop 0
  buffer_load_dwordx4 v14, s[8:11], s45 offen offset:0 nt lds
  buffer_load_dwordx4 v15, s[8:11], s45 offen offset:1024 nt lds
  buffer_load_dwordx4 v16, s[8:11], s45 offen offset:2048 nt lds
  v_mfma_f32_32x32x16_bf16 v[80:95], v[48:51], a[80:83], v[80:95]
  ds_read_b64_tr_b16 v[48:49], v5 offset:4224
  ds_read_b64_tr_b16 v[50:51], v5 offset:7296
  v_add_f32 v23, v23, v65
  v_exp_f32 v67, v67
  s_waitcnt lgkmcnt(6)
  v_mfma_f32_32x32x16_bf16 v[80:95], v[52:55], a[84:87], v[80:95]
  ds_read_b64_tr_b16 v[52:53], v6 offset:4224
  ds_read_b64_tr_b16 v[54:55], v6 offset:7296
  v_add_f32 v22, v22, v66
  v_exp_f32 v68, v68
  v_add_f32 v23, v23, v67
  v_mfma_f32_32x32x16_bf16 v[80:95], v[56:59], a[88:91], v[80:95]
  ds_read_b64_tr_b16 v[56:57], v5 offset:4352
  ds_read_b64_tr_b16 v[58:59], v5 offset:7424
  v_exp_f32 v69, v69
  v_add_f32 v22, v22, v68
  v_mfma_f32_32x32x16_bf16 v[80:95], v[60:63], a[92:95], v[80:95]
  ds_read_b64_tr_b16 v[60:61], v6 offset:4352
  ds_read_b64_tr_b16 v[62:63], v6 offset:7424
  v_exp_f32 v70, v70
  v_add_f32 v23, v23, v69
  v_exp_f32 v71, v71
  v_add_f32 v22, v22, v70
  v_exp_f32 v72, v72
  v_add_f32 v23, v23, v71
  v_exp_f32 v73, v73
  v_add_f32 v22, v22, v72
  v_cvt_pk_bf16_f32 v64, v64, v65
  v_cvt_pk_bf16_f32 v65, v66, v67
  v_cvt_pk_bf16_f32 v66, v68, v69
  v_cvt_pk_bf16_f32 v67, v70, v71
  v_exp_f32 v74, v74
  v_add_f32 v23, v23, v73
  v_exp_f32 v75, v75
  v_add_f32 v22, v22, v74
  v_exp_f32 v76, v76
  v_add_f32 v23, v23, v75
  v_exp_f32 v77, v77
  v_add_f32 v22, v22, v76
  v_exp_f32 v78, v78
  v_add_f32 v23, v23, v77
  v_exp_f32 v79, v79
  v_add_f32 v22, v22, v78
  v_cvt_pk_bf16_f32 v72, v72, v73
  v_add_f32 v23, v23, v79
  v_cvt_pk_bf16_f32 v73, v74, v75
  v_cvt_pk_bf16_f32 v74, v76, v77
  v_cvt_pk_bf16_f32 v75, v78, v79
  s_cmp_lg_u32 s42, 0
  s_cbranch_scc1 LrB_75
LbB_76:
  s_waitcnt lgkmcnt(6)
  v_mfma_f32_32x32x16_bf16 v[160:175], v[40:43], v[64:67], v[160:175]
  ds_read_b64_tr_b16 v[40:41], v5 offset:10240
  ds_read_b64_tr_b16 v[42:43], v5 offset:13312
  v_mfma_f32_32x32x16_bf16 v[176:191], v[44:47], v[64:67], v[176:191]
  ds_read_b64_tr_b16 v[44:45], v6 offset:10240
  ds_read_b64_tr_b16 v[46:47], v6 offset:13312
  v_max3_f32 v28, v80, v81, v82
  v_max3_f32 v29, v83, v84, v85
  v_max3_f32 v28, v28, v86, v87
  v_max3_f32 v29, v29, v88, v89
  v_mfma_f32_32x32x16_bf16 v[192:207], v[48:51], v[64:67], v[192:207]
  ds_read_b64_tr_b16 v[48:49], v5 offset:10368
  ds_read_b64_tr_b16 v[50:51], v5 offset:13440
  v_max3_f32 v28, v28, v90, v91
  v_max3_f32 v29, v29, v92, v93
  v_max3_f32 v28, v28, v94, v95
  s_waitcnt lgkmcnt(6)
  v_mfma_f32_32x32x16_bf16 v[208:223], v[52:55], v[64:67], v[208:223]
  ds_read_b64_tr_b16 v[52:53], v6 offset:10368
  ds_read_b64_tr_b16 v[54:55], v6 offset:13440
  v_max_f32 v28, v28, v29
  v_cmp_lt_f32 vcc, s43, v28
  s_cbranch_vccnz Lrare_77
Lback_78:
  v_mfma_f32_32x32x16_bf16 v[224:239], v[56:59], v[64:67], v[224:239]
  ds_read_b64_tr_b16 v[56:57], v5 offset:10496
  ds_read_b64_tr_b16 v[58:59], v5 offset:13568
  v_exp_f32 v80, v80
  v_exp_f32 v81, v81
  v_mfma_f32_32x32x16_bf16 v[240:255], v[60:63], v[64:67], v[240:255]
  ds_read_b64_tr_b16 v[60:61], v6 offset:10496
  ds_read_b64_tr_b16 v[62:63], v6 offset:13568
  s_waitcnt vmcnt(27)
  s_barrier
  s_mov_b32 s44, 319488
  s_waitcnt lgkmcnt(6)
  v_mfma_f32_32x32x16_bf16 v[160:175], v[40:43], v[72:75], v[160:175]
  ds_read_b128 v[40:43], v1 offset:36864
  s_add_u32 m0, s32, 49152
  s_nop 0
  buffer_load_dwordx4 v11, s[4:7], s44 offen offset:0 nt lds
  buffer_load_dwordx4 v12, s[4:7], s44 offen offset:1024 nt lds
  buffer_load_dwordx4 v13, s[4:7], s44 offen offset:2048 nt lds
  v_add_f32 v22, v22, v80
  v_mfma_f32_32x32x16_bf16 v[176:191], v[44:47], v[72:75], v[176:191]
  ds_read_b128 v[44:47], v2 offset:36864
  v_exp_f32 v82, v82
  v_add_f32 v23, v23, v81
  v_exp_f32 v83, v83
  v_mfma_f32_32x32x16_bf16 v[192:207], v[48:51], v[72:75], v[192:207]
  ds_read_b128 v[48:51], v3 offset:36864
  v_add_f32 v22, v22, v82
  v_exp_f32 v84, v84
  v_add_f32 v23, v23, v83
  s_waitcnt lgkmcnt(3)
  v_mfma_f32_32x32x16_bf16 v[208:223], v[52:55], v[72:75], v[208:223]
  ds_read_b128 v[52:55], v4 offset:36864
  v_exp_f32 v85, v85
  v_add_f32 v22, v22, v84
  v_exp_f32 v86, v86
  v_mfma_f32_32x32x16_bf16 v[224:239], v[56:59], v[72:75], v[224:239]
  ds_read_b128 v[56:59], v1 offset:36992
  v_add_f32 v23, v23, v85
  v_exp_f32 v87, v87
  v_add_f32 v22, v22, v86
  v_mfma_f32_32x32x16_bf16 v[240:255], v[60:63], v[72:75], v[240:255]
  ds_read_b128 v[60:63], v2 offset:36992
  v_exp_f32 v88, v88
  v_add_f32 v23, v23, v87
  s_waitcnt lgkmcnt(3)
  v_mfma_f32_32x32x16_bf16 v[64:79], v[40:43], a[48:51], v[96:111]
  ds_read_b128 v[40:43], v3 offset:36992
  v_exp_f32 v89, v89
  v_add_f32 v22, v22, v88
  v_cvt_pk_bf16_f32 v80, v80, v81
  v_cvt_pk_bf16_f32 v81, v82, v83
  v_mfma_f32_32x32x16_bf16 v[64:79], v[44:47], a[52:55], v[64:79]
  ds_read_b128 v[44:47], v4 offset:36992
  v_cvt_pk_bf16_f32 v82, v84, v85
  v_cvt_pk_bf16_f32 v83, v86, v87
  v_exp_f32 v90, v90
  v_add_f32 v23, v23, v89
  v_mfma_f32_32x32x16_bf16 v[64:79], v[48:51], a[56:59], v[64:79]
  ds_read_b128 v[48:51], v1 offset:37120
  v_exp_f32 v91, v91
  v_add_f32 v22, v22, v90
  s_waitcnt lgkmcnt(3)
  v_mfma_f32_32x32x16_bf16 v[64:79], v[52:55], a[60:63], v[64:79]
  ds_read_b128 v[52:55], v2 offset:37120
  v_exp_f32 v92, v92
  v_add_f32 v23, v23, v91
  v_exp_f32 v93, v93
  v_mfma_f32_32x32x16_bf16 v[64:79], v[56:59], a[64:67], v[64:79]
  ds_read_b128 v[56:59], v3 offset:37120
  v_add_f32 v22, v22, v92
  v_exp_f32 v94, v94
  v_add_f32 v23, v23, v93
  v_mfma_f32_32x32x16_bf16 v[64:79], v[60:63], a[68:71], v[64:79]
  ds_read_b128 v[60:63], v4 offset:37120
  s_waitcnt vmcnt(63)
  s_barrier
  s_mov_b32 s45, 307200
  s_add_u32 m0, s32, 102400
  s_waitcnt lgkmcnt(3)
  v_mfma_f32_32x32x16_bf16 v[64:79], v[40:43], a[72:75], v[64:79]
  ds_read_b64_tr_b16 v[40:41], v7 offset:24576
  ds_read_b64_tr_b16 v[42:43], v7 offset:25600
  buffer_load_dwordx4 v14, s[8:11], s45 offen offset:0 nt lds
  buffer_load_dwordx4 v15, s[8:11], s45 offen offset:1024 nt lds
  buffer_load_dwordx4 v16, s[8:11], s45 offen offset:2048 nt lds
  v_mfma_f32_32x32x16_bf16 v[64:79], v[44:47], a[76:79], v[64:79]
  ds_read_b64_tr_b16 v[44:45], v8 offset:24576
  ds_read_b64_tr_b16 v[46:47], v8 offset:25600
  v_exp_f32 v95, v95
  v_add_f32 v22, v22, v94
  v_cvt_pk_bf16_f32 v88, v88, v89
  v_mfma_f32_32x32x16_bf16 v[64:79], v[48:51], a[80:83], v[64:79]
  ds_read_b64_tr_b16 v[48:49], v9 offset:24576
  ds_read_b64_tr_b16 v[50:51], v9 offset:25600
  v_add_f32 v23, v23, v95
  v_cvt_pk_bf16_f32 v89, v90, v91
  v_cvt_pk_bf16_f32 v90, v92, v93
  s_waitcnt lgkmcnt(6)
  v_mfma_f32_32x32x16_bf16 v[64:79], v[52:55], a[84:87], v[64:79]
  ds_read_b64_tr_b16 v[52:53], v10 offset:24576
  ds_read_b64_tr_b16 v[54:55], v10 offset:25600
  v_cvt_pk_bf16_f32 v91, v94, v95
  v_mfma_f32_32x32x16_bf16 v[64:79], v[56:59], a[88:91], v[64:79]
  ds_read_b64_tr_b16 v[56:57], v7 offset:28672
  ds_read_b64_tr_b16 v[58:59], v7 offset:29696
  v_mfma_f32_32x32x16_bf16 v[64:79], v[60:63], a[92:95], v[64:79]
  ds_read_b64_tr_b16 v[60:61], v8 offset:28672
  ds_read_b64_tr_b16 v[62:63], v8 offset:29696
  s_waitcnt lgkmcnt(6)
  v_mfma_f32_32x32x16_bf16 a[96:111], v[40:43], a[24:27], a[96:111]
  ds_read_b64_tr_b16 v[40:41], v9 offset:28672
  ds_read_b64_tr_b16 v[42:43], v9 offset:29696
  v_mfma_f32_32x32x16_bf16 a[112:127], v[44:47], a[24:27], a[112:127]
  ds_read_b64_tr_b16 v[44:45], v10 offset:28672
  ds_read_b64_tr_b16 v[46:47], v10 offset:29696
  s_nop 2
  v_max3_f32 v28, v64, v65, v66
  v_max3_f32 v29, v67, v68, v69
  v_max3_f32 v28, v28, v70, v71
  v_max3_f32 v29, v29, v72, v73
  v_mfma_f32_32x32x16_bf16 a[128:143], v[48:51], a[24:27], a[128:143]
  ds_read_b64_tr_b16 v[48:49], v7 offset:32768
  ds_read_b64_tr_b16 v[50:51], v7 offset:33792
  v_max3_f32 v28, v28, v74, v75
  v_max3_f32 v29, v29, v76, v77
  v_max3_f32 v28, v28, v78, v79
  s_waitcnt lgkmcnt(6)
  v_mfma_f32_32x32x16_bf16 a[144:159], v[52:55], a[24:27], a[144:159]
  ds_read_b64_tr_b16 v[52:53], v8 offset:32768
  ds_read_b64_tr_b16 v[54:55], v8 offset:33792
  v_max_f32 v28, v28, v29
  v_mfma_f32_32x32x16_bf16 a[96:111], v[56:59], a[28:31], a[96:111]
  ds_read_b64_tr_b16 v[56:57], v9 offset:32768
  ds_read_b64_tr_b16 v[58:59], v9 offset:33792
  v_mfma_f32_32x32x16_bf16 a[112:127], v[60:63], a[28:31], a[112:127]
  ds_read_b64_tr_b16 v[60:61], v10 offset:32768
  ds_read_b64_tr_b16 v[62:63], v10 offset:33792
  s_waitcnt vmcnt(30)
  s_barrier
  s_mov_b32 s44, 331776
  s_waitcnt lgkmcnt(6)
  v_mfma_f32_32x32x16_bf16 a[128:143], v[40:43], a[28:31], a[128:143]
  ds_read_b64_tr_b16 v[40:41], v5 offset:16384
  ds_read_b64_tr_b16 v[42:43], v5 offset:19456
  s_add_u32 m0, s32, 73728
  s_nop 0
  buffer_load_dwordx4 v11, s[4:7], s44 offen offset:0 nt lds
  buffer_load_dwordx4 v12, s[4:7], s44 offen offset:1024 nt lds
  buffer_load_dwordx4 v13, s[4:7], s44 offen offset:2048 nt lds
  v_mfma_f32_32x32x16_bf16 a[144:159], v[44:47], a[28:31], a[144:159]
  ds_read_b64_tr_b16 v[44:45], v6 offset:16384
  ds_read_b64_tr_b16 v[46:47], v6 offset:19456
  v_mfma_f32_32x32x16_bf16 a[96:111], v[48:51], a[32:35], a[96:111]
  ds_read_b64_tr_b16 v[48:49], v5 offset:16512
  ds_read_b64_tr_b16 v[50:51], v5 offset:19584
  s_waitcnt lgkmcnt(6)
  v_mfma_f32_32x32x16_bf16 a[112:127], v[52:55], a[32:35], a[112:127]
  ds_read_b64_tr_b16 v[52:53], v6 offset:16512
  ds_read_b64_tr_b16 v[54:55], v6 offset:19584
  v_mfma_f32_32x32x16_bf16 a[128:143], v[56:59], a[32:35], a[128:143]
  ds_read_b64_tr_b16 v[56:57], v5 offset:16640
  ds_read_b64_tr_b16 v[58:59], v5 offset:19712
  v_mfma_f32_32x32x16_bf16 a[144:159], v[60:63], a[32:35], a[144:159]
  ds_read_b64_tr_b16 v[60:61], v6 offset:16640
  ds_read_b64_tr_b16 v[62:63], v6 offset:19712
  s_cmp_lg_u32 s42, 0
  s_cbranch_scc1 LrB_79
LbB_80:
  s_waitcnt lgkmcnt(6)
  v_mfma_f32_32x32x16_bf16 v[160:175], v[40:43], v[80:83], v[160:175]
  ds_read_b64_tr_b16 v[40:41], v5 offset:22528
  ds_read_b64_tr_b16 v[42:43], v5 offset:25600
  v_cmp_lt_f32 vcc, s43, v28
  s_cbranch_vccnz Lrare_81
Lback_82:
  v_exp_f32 v64, v64
  v_mfma_f32_32x32x16_bf16 v[176:191], v[44:47], v[80:83], v[176:191]
  ds_read_b64_tr_b16 v[44:45], v6 offset:22528
  ds_read_b64_tr_b16 v[46:47], v6 offset:25600
  v_exp_f32 v65, v65
  v_add_f32 v22, v22, v64
  v_mfma_f32_32x32x16_bf16 v[192:207], v[48:51], v[80:83], v[192:207]
  ds_read_b64_tr_b16 v[48:49], v5 offset:22656
  ds_read_b64_tr_b16 v[50:51], v5 offset:25728
  v_exp_f32 v66, v66
  v_add_f32 v23, v23, v65
  s_waitcnt lgkmcnt(6)
  v_mfma_f32_32x32x16_bf16 v[208:223], v[52:55], v[80:83], v[208:223]
  ds_read_b64_tr_b16 v[52:53], v6 offset:22656
  ds_read_b64_tr_b16 v[54:55], v6 offset:25728
  v_exp_f32 v67, v67
  v_add_f32 v22, v22, v66
  v_mfma_f32_32x32x16_bf16 v[224:239], v[56:59], v[80:83], v[224:239]
  ds_read_b64_tr_b16 v[56:57], v5 offset:22784
  ds_read_b64_tr_b16 v[58:59], v5 offset:25856
  v_exp_f32 v68, v68
  v_add_f32 v23, v23, v67
  v_mfma_f32_32x32x16_bf16 v[240:255], v[60:63], v[80:83], v[240:255]
  ds_read_b64_tr_b16 v[60:61], v6 offset:22784
  ds_read_b64_tr_b16 v[62:63], v6 offset:25856
  s_waitcnt vmcnt(30)
  s_barrier
  s_mov_b32 s45, 61696
  s_waitcnt lgkmcnt(6)
  v_mfma_f32_32x32x16_bf16 v[160:175], v[40:43], v[88:91], v[160:175]
  ds_read_b128 v[40:43], v1 offset:49152
  s_add_u32 m0, s32, 24576
  s_nop 0
  buffer_load_dwordx4 v17, s[20:23], s45 offen offset:0 nt lds
  buffer_load_dwordx4 v18, s[20:23], s45 offen offset:1024 nt lds
  buffer_load_dwordx4 v19, s[20:23], s45 offen offset:2048 nt lds
  v_mfma_f32_32x32x16_bf16 v[176:191], v[44:47], v[88:91], v[176:191]
  ds_read_b128 v[44:47], v2 offset:49152
  v_exp_f32 v69, v69
  v_add_f32 v22, v22, v68
  v_exp_f32 v70, v70
  v_mfma_f32_32x32x16_bf16 v[192:207], v[48:51], v[88:91], v[192:207]
  ds_read_b128 v[48:51], v3 offset:49152
  v_add_f32 v23, v23, v69
  v_exp_f32 v71, v71
  v_add_f32 v22, v22, v70
  s_waitcnt lgkmcnt(3)
  v_mfma_f32_32x32x16_bf16 v[208:223], v[52:55], v[88:91], v[208:223]
  ds_read_b128 v[52:55], v4 offset:49152
  v_exp_f32 v72, v72
  v_add_f32 v23, v23, v71
  v_exp_f32 v73, v73
  v_mfma_f32_32x32x16_bf16 v[224:239], v[56:59], v[88:91], v[224:239]
  ds_read_b128 v[56:59], v1 offset:49280
  v_add_f32 v22, v22, v72
  v_cvt_pk_bf16_f32 v64, v64, v65
  v_cvt_pk_bf16_f32 v65, v66, v67
  v_cvt_pk_bf16_f32 v66, v68, v69
  v_cvt_pk_bf16_f32 v67, v70, v71
  v_mfma_f32_32x32x16_bf16 v[240:255], v[60:63], v[88:91], v[240:255]
  ds_read_b128 v[60:63], v2 offset:49280
  v_exp_f32 v74, v74
  v_add_f32 v23, v23, v73
  s_waitcnt lgkmcnt(3)
  v_mfma_f32_32x32x16_bf16 v[80:95], v[40:43], a[48:51], v[96:111]
  ds_read_b128 v[40:43], v3 offset:49280
  v_exp_f32 v75, v75
  v_add_f32 v22, v22, v74
  v_exp_f32 v76, v76
  v_mfma_f32_32x32x16_bf16 v[80:95], v[44:47], a[52:55], v[80:95]
  ds_read_b128 v[44:47], v4 offset:49280
  v_add_f32 v23, v23, v75
  v_exp_f32 v77, v77
  v_add_f32 v22, v22, v76
  v_mfma_f32_32x32x16_bf16 v[80:95], v[48:51], a[56:59], v[80:95]
  ds_read_b128 v[48:51], v1 offset:49408
  v_exp_f32 v78, v78
  v_add_f32 v23, v23, v77
  s_waitcnt lgkmcnt(3)
  v_mfma_f32_32x32x16_bf16 v[80:95], v[52:55], a[60:63], v[80:95]
  ds_read_b128 v[52:55], v2 offset:49408
  v_exp_f32 v79, v79
  v_add_f32 v22, v22, v78
  v_cvt_pk_bf16_f32 v72, v72, v73
  v_add_f32 v23, v23, v79
  v_mfma_f32_32x32x16_bf16 v[80:95], v[56:59], a[64:67], v[80:95]
  ds_read_b128 v[56:59], v3 offset:49408
  v_cvt_pk_bf16_f32 v73, v74, v75
  v_cvt_pk_bf16_f32 v74, v76, v77
  v_cvt_pk_bf16_f32 v75, v78, v79
  v_mfma_f32_32x32x16_bf16 v[80:95], v[60:63], a[68:71], v[80:95]
  ds_read_b128 v[60:63], v4 offset:49408
  s_waitcnt vmcnt(27)
  s_barrier
  s_mov_b32 s44, 319488
  s_add_u32 m0, s32, 114688
  s_waitcnt lgkmcnt(3)
  v_mfma_f32_32x32x16_bf16 v[80:95], v[40:43], a[72:75], v[80:95]
  ds_read_b64_tr_b16 v[40:41], v5 offset:53248
  ds_read_b64_tr_b16 v[42:43], v5 offset:56320
  buffer_load_dwordx4 v14, s[8:11], s44 offen offset:0 nt lds
  buffer_load_dwordx4 v15, s[8:11], s44 offen offset:1024 nt lds
  buffer_load_dwordx4 v16, s[8:11], s44 offen offset:2048 nt lds
  v_mfma_f32_32x32x16_bf16 v[80:95], v[44:47], a[76:79], v[80:95]
  ds_read_b64_tr_b16 v[44:45], v6 offset:53248
  ds_read_b64_tr_b16 v[46:47], v6 offset:56320
  v_mfma_f32_32x32x16_bf16 v[80:95], v[48:51], a[80:83], v[80:95]
  ds_read_b64_tr_b16 v[48:49], v5 offset:53376
  ds_read_b64_tr_b16 v[50:51], v5 offset:56448
  s_waitcnt lgkmcnt(6)
  v_mfma_f32_32x32x16_bf16 v[80:95], v[52:55], a[84:87], v[80:95]
  ds_read_b64_tr_b16 v[52:53], v6 offset:53376
  ds_read_b64_tr_b16 v[54:55], v6 offset:56448
  v_mfma_f32_32x32x16_bf16 v[80:95], v[56:59], a[88:91], v[80:95]
  ds_read_b64_tr_b16 v[56:57], v5 offset:53504
  ds_read_b64_tr_b16 v[58:59], v5 offset:56576
  v_mfma_f32_32x32x16_bf16 v[80:95], v[60:63], a[92:95], v[80:95]
  ds_read_b64_tr_b16 v[60:61], v6 offset:53504
  ds_read_b64_tr_b16 v[62:63], v6 offset:56576
  s_cmp_lg_u32 s42, 0
  s_cbranch_scc1 LrB_83
LbB_84:
  s_waitcnt lgkmcnt(6)
  v_mfma_f32_32x32x16_bf16 v[160:175], v[40:43], v[64:67], v[160:175]
  ds_read_b64_tr_b16 v[40:41], v5 offset:59392
  ds_read_b64_tr_b16 v[42:43], v5 offset:62464
  v_mfma_f32_32x32x16_bf16 v[176:191], v[44:47], v[64:67], v[176:191]
  ds_read_b64_tr_b16 v[44:45], v6 offset:59392
  ds_read_b64_tr_b16 v[46:47], v6 offset:62464
  s_nop 0
  v_max3_f32 v28, v80, v81, v82
  v_max3_f32 v29, v83, v84, v85
  v_max3_f32 v28, v28, v86, v87
  v_max3_f32 v29, v29, v88, v89
  v_mfma_f32_32x32x16_bf16 v[192:207], v[48:51], v[64:67], v[192:207]
  ds_read_b64_tr_b16 v[48:49], v5 offset:59520
  ds_read_b64_tr_b16 v[50:51], v5 offset:62592
  v_max3_f32 v28, v28, v90, v91
  v_max3_f32 v29, v29, v92, v93
  v_max3_f32 v28, v28, v94, v95
  s_waitcnt lgkmcnt(6)
  v_mfma_f32_32x32x16_bf16 v[208:223], v[52:55], v[64:67], v[208:223]
  ds_read_b64_tr_b16 v[52:53], v6 offset:59520
  ds_read_b64_tr_b16 v[54:55], v6 offset:62592
  v_max_f32 v28, v28, v29
  v_cmp_lt_f32 vcc, s43, v28
  s_cbranch_vccnz Lrare_85
Lback_86:
  v_mfma_f32_32x32x16_bf16 v[224:239], v[56:59], v[64:67], v[224:239]
  ds_read_b64_tr_b16 v[56:57], v5 offset:59648
  ds_read_b64_tr_b16 v[58:59], v5 offset:62720
  v_exp_f32 v80, v80
  v_exp_f32 v81, v81
  v_mfma_f32_32x32x16_bf16 v[240:255], v[60:63], v[64:67], v[240:255]
  ds_read_b64_tr_b16 v[60:61], v6 offset:59648
  ds_read_b64_tr_b16 v[62:63], v6 offset:62720
  s_waitcnt vmcnt(33)
  s_barrier
  v_add_f32 v22, v22, v80
  s_waitcnt lgkmcnt(6)
  v_mfma_f32_32x32x16_bf16 v[160:175], v[40:43], v[72:75], v[160:175]
  ds_read_b64_tr_b16 v[40:41], v7 offset:0
  ds_read_b64_tr_b16 v[42:43], v7 offset:1024
  v_exp_f32 v82, v82
  v_add_f32 v23, v23, v81
  v_mfma_f32_32x32x16_bf16 v[176:191], v[44:47], v[72:75], v[176:191]
  ds_read_b64_tr_b16 v[44:45], v8 offset:0
  ds_read_b64_tr_b16 v[46:47], v8 offset:1024
  v_exp_f32 v83, v83
  v_add_f32 v22, v22, v82
  v_mfma_f32_32x32x16_bf16 v[192:207], v[48:51], v[72:75], v[192:207]
  ds_read_b64_tr_b16 v[48:49], v9 offset:0
  ds_read_b64_tr_b16 v[50:51], v9 offset:1024
  v_exp_f32 v84, v84
  v_add_f32 v23, v23, v83
  s_waitcnt lgkmcnt(6)
  v_mfma_f32_32x32x16_bf16 v[208:223], v[52:55], v[72:75], v[208:223]
  ds_read_b64_tr_b16 v[52:53], v10 offset:0
  ds_read_b64_tr_b16 v[54:55], v10 offset:1024
  v_exp_f32 v85, v85
  v_add_f32 v22, v22, v84
  v_mfma_f32_32x32x16_bf16 v[224:239], v[56:59], v[72:75], v[224:239]
  ds_read_b64_tr_b16 v[56:57], v7 offset:4096
  ds_read_b64_tr_b16 v[58:59], v7 offset:5120
  v_exp_f32 v86, v86
  v_add_f32 v23, v23, v85
  v_mfma_f32_32x32x16_bf16 v[240:255], v[60:63], v[72:75], v[240:255]
  ds_read_b64_tr_b16 v[60:61], v8 offset:4096
  ds_read_b64_tr_b16 v[62:63], v8 offset:5120
  v_exp_f32 v87, v87
  v_add_f32 v22, v22, v86
  s_waitcnt lgkmcnt(6)
  v_mfma_f32_32x32x16_bf16 a[96:111], v[40:43], a[36:39], a[96:111]
  ds_read_b64_tr_b16 v[40:41], v9 offset:4096
  ds_read_b64_tr_b16 v[42:43], v9 offset:5120
  v_exp_f32 v88, v88
  v_add_f32 v23, v23, v87
  v_mfma_f32_32x32x16_bf16 a[112:127], v[44:47], a[36:39], a[112:127]
  ds_read_b64_tr_b16 v[44:45], v10 offset:4096
  ds_read_b64_tr_b16 v[46:47], v10 offset:5120
  v_exp_f32 v89, v89
  v_add_f32 v22, v22, v88
  v_cvt_pk_bf16_f32 v80, v80, v81
  v_mfma_f32_32x32x16_bf16 a[128:143], v[48:51], a[36:39], a[128:143]
  ds_read_b64_tr_b16 v[48:49], v7 offset:8192
  ds_read_b64_tr_b16 v[50:51], v7 offset:9216
  v_cvt_pk_bf16_f32 v81, v82, v83
  v_cvt_pk_bf16_f32 v82, v84, v85
  v_cvt_pk_bf16_f32 v83, v86, v87
  s_waitcnt lgkmcnt(6)
  v_mfma_f32_32x32x16_bf16 a[144:159], v[52:55], a[36:39], a[144:159]
  ds_read_b64_tr_b16 v[52:53], v8 offset:8192
  ds_read_b64_tr_b16 v[54:55], v8 offset:9216
  v_exp_f32 v90, v90
  v_add_f32 v23, v23, v89
  v_mfma_f32_32x32x16_bf16 a[96:111], v[56:59], a[40:43], a[96:111]
  ds_read_b64_tr_b16 v[56:57], v9 offset:8192
  ds_read_b64_tr_b16 v[58:59], v9 offset:9216
  v_exp_f32 v91, v91
  v_add_f32 v22, v22, v90
  v_mfma_f32_32x32x16_bf16 a[112:127], v[60:63], a[40:43], a[112:127]
  ds_read_b64_tr_b16 v[60:61], v10 offset:8192
  ds_read_b64_tr_b16 v[62:63], v10 offset:9216
  s_waitcnt vmcnt(27)
  s_barrier
  s_mov_b32 s45, 331776
  s_waitcnt lgkmcnt(6)
  v_mfma_f32_32x32x16_bf16 a[128:143], v[40:43], a[40:43], a[128:143]
  ds_read_b64_tr_b16 v[40:41], v5 offset:40960
  ds_read_b64_tr_b16 v[42:43], v5 offset:44032
  s_add_u32 m0, s32, 151552
  s_nop 0
  buffer_load_dwordx4 v14, s[8:11], s45 offen offset:0 nt lds
  buffer_load_dwordx4 v15, s[8:11], s45 offen offset:1024 nt lds
  buffer_load_dwordx4 v16, s[8:11], s45 offen offset:2048 nt lds
  v_mfma_f32_32x32x16_bf16 a[144:159], v[44:47], a[40:43], a[144:159]
  ds_read_b64_tr_b16 v[44:45], v6 offset:40960
  ds_read_b64_tr_b16 v[46:47], v6 offset:44032
  s_mov_b32 s44, 344064
  s_add_u32 m0, s32, 86016
  s_nop 0
  buffer_load_dwordx4 v11, s[4:7], s44 offen offset:0 nt lds
  buffer_load_dwordx4 v12, s[4:7], s44 offen offset:1024 nt lds
  v_mfma_f32_32x32x16_bf16 a[96:111], v[48:51], a[44:47], a[96:111]
  ds_read_b64_tr_b16 v[48:49], v5 offset:41088
  ds_read_b64_tr_b16 v[50:51], v5 offset:44160
  buffer_load_dwordx4 v13, s[4:7], s44 offen offset:2048 nt lds
  v_exp_f32 v92, v92
  s_waitcnt lgkmcnt(6)
  v_mfma_f32_32x32x16_bf16 a[112:127], v[52:55], a[44:47], a[112:127]
  ds_read_b64_tr_b16 v[52:53], v6 offset:41088
  ds_read_b64_tr_b16 v[54:55], v6 offset:44160
  v_add_f32 v23, v23, v91
  v_exp_f32 v93, v93
  v_add_f32 v22, v22, v92
  v_mfma_f32_32x32x16_bf16 a[128:143], v[56:59], a[44:47], a[128:143]
  ds_read_b64_tr_b16 v[56:57], v5 offset:41216
  ds_read_b64_tr_b16 v[58:59], v5 offset:44288
  v_exp_f32 v94, v94
  v_add_f32 v23, v23, v93
  v_mfma_f32_32x32x16_bf16 a[144:159], v[60:63], a[44:47], a[144:159]
  ds_read_b64_tr_b16 v[60:61], v6 offset:41216
  ds_read_b64_tr_b16 v[62:63], v6 offset:44288
  v_exp_f32 v95, v95
  v_add_f32 v22, v22, v94
  v_cvt_pk_bf16_f32 v88, v88, v89
  v_add_f32 v23, v23, v95
  v_cvt_pk_bf16_f32 v89, v90, v91
  v_cvt_pk_bf16_f32 v90, v92, v93
  v_cvt_pk_bf16_f32 v91, v94, v95
  s_cmp_lg_u32 s42, 0
  s_cbranch_scc1 LrB_87
LbB_88:
  s_waitcnt lgkmcnt(6)
  v_mfma_f32_32x32x16_bf16 v[160:175], v[40:43], v[80:83], v[160:175]
  ds_read_b64_tr_b16 v[40:41], v5 offset:47104
  ds_read_b64_tr_b16 v[42:43], v5 offset:50176
  v_mfma_f32_32x32x16_bf16 v[176:191], v[44:47], v[80:83], v[176:191]
  ds_read_b64_tr_b16 v[44:45], v6 offset:47104
  ds_read_b64_tr_b16 v[46:47], v6 offset:50176
  v_mfma_f32_32x32x16_bf16 v[192:207], v[48:51], v[80:83], v[192:207]
  ds_read_b64_tr_b16 v[48:49], v5 offset:47232
  ds_read_b64_tr_b16 v[50:51], v5 offset:50304
  s_waitcnt lgkmcnt(6)
  v_mfma_f32_32x32x16_bf16 v[208:223], v[52:55], v[80:83], v[208:223]
  ds_read_b64_tr_b16 v[52:53], v6 offset:47232
  ds_read_b64_tr_b16 v[54:55], v6 offset:50304
  v_mfma_f32_32x32x16_bf16 v[224:239], v[56:59], v[80:83], v[224:239]
  ds_read_b64_tr_b16 v[56:57], v5 offset:47360
  ds_read_b64_tr_b16 v[58:59], v5 offset:50432
  v_mfma_f32_32x32x16_bf16 v[240:255], v[60:63], v[80:83], v[240:255]
  ds_read_b64_tr_b16 v[60:61], v6 offset:47360
  ds_read_b64_tr_b16 v[62:63], v6 offset:50432
  s_waitcnt vmcnt(30)
  s_barrier
  s_mov_b32 s45, 123136
  s_waitcnt lgkmcnt(6)
  v_mfma_f32_32x32x16_bf16 v[160:175], v[40:43], v[88:91], v[160:175]
  ds_read_b128 v[40:43], v1 offset:24576
  s_add_u32 m0, s32, 0
  s_nop 0
  buffer_load_dwordx4 v17, s[20:23], s45 offen offset:0 nt lds
  buffer_load_dwordx4 v18, s[20:23], s45 offen offset:1024 nt lds
  buffer_load_dwordx4 v19, s[20:23], s45 offen offset:2048 nt lds
  v_mfma_f32_32x32x16_bf16 v[176:191], v[44:47], v[88:91], v[176:191]
  ds_read_b128 v[44:47], v2 offset:24576
  v_mfma_f32_32x32x16_bf16 v[192:207], v[48:51], v[88:91], v[192:207]
  ds_read_b128 v[48:51], v3 offset:24576
  s_waitcnt lgkmcnt(3)
  v_mfma_f32_32x32x16_bf16 v[208:223], v[52:55], v[88:91], v[208:223]
  ds_read_b128 v[52:55], v4 offset:24576
  v_mfma_f32_32x32x16_bf16 v[224:239], v[56:59], v[88:91], v[224:239]
  ds_read_b128 v[56:59], v1 offset:24704
  v_mfma_f32_32x32x16_bf16 v[240:255], v[60:63], v[88:91], v[240:255]
  ds_read_b128 v[60:63], v2 offset:24704
  s_waitcnt lgkmcnt(3)
  v_mfma_f32_32x32x16_bf16 v[64:79], v[40:43], a[48:51], v[96:111]
  ds_read_b128 v[40:43], v3 offset:24704
  v_mfma_f32_32x32x16_bf16 v[64:79], v[44:47], a[52:55], v[64:79]
  ds_read_b128 v[44:47], v4 offset:24704
  v_mfma_f32_32x32x16_bf16 v[64:79], v[48:51], a[56:59], v[64:79]
  ds_read_b128 v[48:51], v1 offset:24832
  s_waitcnt lgkmcnt(3)
  v_mfma_f32_32x32x16_bf16 v[64:79], v[52:55], a[60:63], v[64:79]
  ds_read_b128 v[52:55], v2 offset:24832
  v_mfma_f32_32x32x16_bf16 v[64:79], v[56:59], a[64:67], v[64:79]
  ds_read_b128 v[56:59], v3 offset:24832
  v_mfma_f32_32x32x16_bf16 v[64:79], v[60:63], a[68:71], v[64:79]
  ds_read_b128 v[60:63], v4 offset:24832
  s_waitcnt vmcnt(27)
  s_barrier
  s_waitcnt lgkmcnt(3)
  v_mfma_f32_32x32x16_bf16 v[64:79], v[40:43], a[72:75], v[64:79]
  ds_read_b128 v[40:43], v1 offset:0
  v_mfma_f32_32x32x16_bf16 v[64:79], v[44:47], a[76:79], v[64:79]
  ds_read_b128 v[44:47], v2 offset:0
  v_mfma_f32_32x32x16_bf16 v[64:79], v[48:51], a[80:83], v[64:79]
  ds_read_b128 v[48:51], v3 offset:0
  s_waitcnt lgkmcnt(3)
  v_mfma_f32_32x32x16_bf16 v[64:79], v[52:55], a[84:87], v[64:79]
  ds_read_b128 v[52:55], v4 offset:0
  v_mfma_f32_32x32x16_bf16 v[64:79], v[56:59], a[88:91], v[64:79]
  ds_read_b128 v[56:59], v1 offset:128
  v_mfma_f32_32x32x16_bf16 v[64:79], v[60:63], a[92:95], v[64:79]
  ds_read_b128 v[60:63], v2 offset:128
  s_waitcnt lgkmcnt(3)
  v_mfma_f32_32x32x16_bf16 v[80:95], v[40:43], a[48:51], v[96:111]
  ds_read_b128 v[40:43], v3 offset:128
  v_mfma_f32_32x32x16_bf16 v[80:95], v[44:47], a[52:55], v[80:95]
  ds_read_b128 v[44:47], v4 offset:128
  s_nop 5
  v_max3_f32 v28, v64, v65, v66
  v_max3_f32 v29, v67, v68, v69
  v_max3_f32 v28, v28, v70, v71
  v_max3_f32 v29, v29, v72, v73
  v_max3_f32 v28, v28, v74, v75
  v_mfma_f32_32x32x16_bf16 v[80:95], v[48:51], a[56:59], v[80:95]
  ds_read_b128 v[48:51], v1 offset:256
  v_max3_f32 v29, v29, v76, v77
  v_max3_f32 v28, v28, v78, v79
  v_max_f32 v28, v28, v29
  s_waitcnt lgkmcnt(3)
  v_mfma_f32_32x32x16_bf16 v[80:95], v[52:55], a[60:63], v[80:95]
  ds_read_b128 v[52:55], v2 offset:256
  v_cmp_lt_f32 vcc, s43, v28
  s_cbranch_vccnz Lrare_89
Lback_90:
  v_exp_f32 v64, v64
  v_mfma_f32_32x32x16_bf16 v[80:95], v[56:59], a[64:67], v[80:95]
  ds_read_b128 v[56:59], v3 offset:256
  v_exp_f32 v65, v65
  v_add_f32 v22, v22, v64
  v_exp_f32 v66, v66
  v_mfma_f32_32x32x16_bf16 v[80:95], v[60:63], a[68:71], v[80:95]
  ds_read_b128 v[60:63], v4 offset:256
  s_waitcnt vmcnt(24)
  s_barrier
  s_mov_b32 s44, 356352
  s_add_u32 m0, s32, 61440
  s_waitcnt lgkmcnt(3)
  v_mfma_f32_32x32x16_bf16 v[80:95], v[40:43], a[72:75], v[80:95]
  ds_read_b64_tr_b16 v[40:41], v5 offset:28672
  ds_read_b64_tr_b16 v[42:43], v5 offset:31744
  buffer_load_dwordx4 v11, s[4:7], s44 offen offset:0 nt lds
  buffer_load_dwordx4 v12, s[4:7], s44 offen offset:1024 nt lds
  buffer_load_dwordx4 v13, s[4:7], s44 offen offset:2048 nt lds
  s_mov_b32 s45, 344064
  v_mfma_f32_32x32x16_bf16 v[80:95], v[44:47], a[76:79], v[80:95]
  ds_read_b64_tr_b16 v[44:45], v6 offset:28672
  ds_read_b64_tr_b16 v[46:47], v6 offset:31744
  s_add_u32 m0, s32, 139264
  s_nop 0
  buffer_load_dwordx4 v14, s[8:11], s45 offen offset:0 nt lds
  buffer_load_dwordx4 v15, s[8:11], s45 offen offset:1024 nt lds
  buffer_load_dwordx4 v16, s[8:11], s45 offen offset:2048 nt lds
  v_mfma_f32_32x32x16_bf16 v[80:95], v[48:51], a[80:83], v[80:95]
  ds_read_b64_tr_b16 v[48:49], v5 offset:28800
  ds_read_b64_tr_b16 v[50:51], v5 offset:31872
  v_add_f32 v23, v23, v65
  v_exp_f32 v67, v67
  s_waitcnt lgkmcnt(6)
  v_mfma_f32_32x32x16_bf16 v[80:95], v[52:55], a[84:87], v[80:95]
  ds_read_b64_tr_b16 v[52:53], v6 offset:28800
  ds_read_b64_tr_b16 v[54:55], v6 offset:31872
  v_add_f32 v22, v22, v66
  v_exp_f32 v68, v68
  v_add_f32 v23, v23, v67
  v_mfma_f32_32x32x16_bf16 v[80:95], v[56:59], a[88:91], v[80:95]
  ds_read_b64_tr_b16 v[56:57], v5 offset:28928
  ds_read_b64_tr_b16 v[58:59], v5 offset:32000
  v_exp_f32 v69, v69
  v_add_f32 v22, v22, v68
  v_mfma_f32_32x32x16_bf16 v[80:95], v[60:63], a[92:95], v[80:95]
  ds_read_b64_tr_b16 v[60:61], v6 offset:28928
  ds_read_b64_tr_b16 v[62:63], v6 offset:32000
  v_exp_f32 v70, v70
  v_add_f32 v23, v23, v69
  v_exp_f32 v71, v71
  v_add_f32 v22, v22, v70
  v_exp_f32 v72, v72
  v_add_f32 v23, v23, v71
  v_exp_f32 v73, v73
  v_add_f32 v22, v22, v72
  v_cvt_pk_bf16_f32 v64, v64, v65
  v_cvt_pk_bf16_f32 v65, v66, v67
  v_cvt_pk_bf16_f32 v66, v68, v69
  v_cvt_pk_bf16_f32 v67, v70, v71
  v_exp_f32 v74, v74
  v_add_f32 v23, v23, v73
  v_exp_f32 v75, v75
  v_add_f32 v22, v22, v74
  v_exp_f32 v76, v76
  v_add_f32 v23, v23, v75
  v_exp_f32 v77, v77
  v_add_f32 v22, v22, v76
  v_exp_f32 v78, v78
  v_add_f32 v23, v23, v77
  v_exp_f32 v79, v79
  v_add_f32 v22, v22, v78
  v_cvt_pk_bf16_f32 v72, v72, v73
  v_add_f32 v23, v23, v79
  v_cvt_pk_bf16_f32 v73, v74, v75
  v_cvt_pk_bf16_f32 v74, v76, v77
  v_cvt_pk_bf16_f32 v75, v78, v79
  s_cmp_lg_u32 s42, 0
  s_cbranch_scc1 LrB_91
LbB_92:
  s_waitcnt lgkmcnt(6)
  v_mfma_f32_32x32x16_bf16 v[160:175], v[40:43], v[64:67], v[160:175]
  ds_read_b64_tr_b16 v[40:41], v5 offset:34816
  ds_read_b64_tr_b16 v[42:43], v5 offset:37888
  v_mfma_f32_32x32x16_bf16 v[176:191], v[44:47], v[64:67], v[176:191]
  ds_read_b64_tr_b16 v[44:45], v6 offset:34816
  ds_read_b64_tr_b16 v[46:47], v6 offset:37888
  v_max3_f32 v28, v80, v81, v82
  v_max3_f32 v29, v83, v84, v85
  v_max3_f32 v28, v28, v86, v87
  v_max3_f32 v29, v29, v88, v89
  v_mfma_f32_32x32x16_bf16 v[192:207], v[48:51], v[64:67], v[192:207]
  ds_read_b64_tr_b16 v[48:49], v5 offset:34944
  ds_read_b64_tr_b16 v[50:51], v5 offset:38016
  v_max3_f32 v28, v28, v90, v91
  v_max3_f32 v29, v29, v92, v93
  v_max3_f32 v28, v28, v94, v95
  s_waitcnt lgkmcnt(6)
  v_mfma_f32_32x32x16_bf16 v[208:223], v[52:55], v[64:67], v[208:223]
  ds_read_b64_tr_b16 v[52:53], v6 offset:34944
  ds_read_b64_tr_b16 v[54:55], v6 offset:38016
  v_max_f32 v28, v28, v29
  v_cmp_lt_f32 vcc, s43, v28
  s_cbranch_vccnz Lrare_93
Lback_94:
  v_mfma_f32_32x32x16_bf16 v[224:239], v[56:59], v[64:67], v[224:239]
  ds_read_b64_tr_b16 v[56:57], v5 offset:35072
  ds_read_b64_tr_b16 v[58:59], v5 offset:38144
  v_exp_f32 v80, v80
  v_exp_f32 v81, v81
  v_mfma_f32_32x32x16_bf16 v[240:255], v[60:63], v[64:67], v[240:255]
  ds_read_b64_tr_b16 v[60:61], v6 offset:35072
  ds_read_b64_tr_b16 v[62:63], v6 offset:38144
  s_waitcnt vmcnt(27)
  s_barrier
  s_mov_b32 s44, 368640
  s_waitcnt lgkmcnt(6)
  v_mfma_f32_32x32x16_bf16 v[160:175], v[40:43], v[72:75], v[160:175]
  ds_read_b128 v[40:43], v1 offset:12288
  s_add_u32 m0, s32, 36864
  s_nop 0
  buffer_load_dwordx4 v11, s[4:7], s44 offen offset:0 nt lds
  buffer_load_dwordx4 v12, s[4:7], s44 offen offset:1024 nt lds
  buffer_load_dwordx4 v13, s[4:7], s44 offen offset:2048 nt lds
  v_add_f32 v22, v22, v80
  v_mfma_f32_32x32x16_bf16 v[176:191], v[44:47], v[72:75], v[176:191]
  ds_read_b128 v[44:47], v2 offset:12288
  v_exp_f32 v82, v82
  v_add_f32 v23, v23, v81
  v_exp_f32 v83, v83
  v_mfma_f32_32x32x16_bf16 v[192:207], v[48:51], v[72:75], v[192:207]
  ds_read_b128 v[48:51], v3 offset:12288
  v_add_f32 v22, v22, v82
  v_exp_f32 v84, v84
  v_add_f32 v23, v23, v83
  s_waitcnt lgkmcnt(3)
  v_mfma_f32_32x32x16_bf16 v[208:223], v[52:55], v[72:75], v[208:223]
  ds_read_b128 v[52:55], v4 offset:12288
  v_exp_f32 v85, v85
  v_add_f32 v22, v22, v84
  v_exp_f32 v86, v86
  v_mfma_f32_32x32x16_bf16 v[224:239], v[56:59], v[72:75], v[224:239]
  ds_read_b128 v[56:59], v1 offset:12416
  v_add_f32 v23, v23, v85
  v_exp_f32 v87, v87
  v_add_f32 v22, v22, v86
  v_mfma_f32_32x32x16_bf16 v[240:255], v[60:63], v[72:75], v[240:255]
  ds_read_b128 v[60:63], v2 offset:12416
  v_exp_f32 v88, v88
  v_add_f32 v23, v23, v87
  s_waitcnt lgkmcnt(3)
  v_mfma_f32_32x32x16_bf16 v[64:79], v[40:43], a[48:51], v[96:111]
  ds_read_b128 v[40:43], v3 offset:12416
  v_exp_f32 v89, v89
  v_add_f32 v22, v22, v88
  v_cvt_pk_bf16_f32 v80, v80, v81
  v_cvt_pk_bf16_f32 v81, v82, v83
  v_mfma_f32_32x32x16_bf16 v[64:79], v[44:47], a[52:55], v[64:79]
  ds_read_b128 v[44:47], v4 offset:12416
  v_cvt_pk_bf16_f32 v82, v84, v85
  v_cvt_pk_bf16_f32 v83, v86, v87
  v_exp_f32 v90, v90
  v_add_f32 v23, v23, v89
  v_mfma_f32_32x32x16_bf16 v[64:79], v[48:51], a[56:59], v[64:79]
  ds_read_b128 v[48:51], v1 offset:12544
  v_exp_f32 v91, v91
  v_add_f32 v22, v22, v90
  s_waitcnt lgkmcnt(3)
  v_mfma_f32_32x32x16_bf16 v[64:79], v[52:55], a[60:63], v[64:79]
  ds_read_b128 v[52:55], v2 offset:12544
  v_exp_f32 v92, v92
  v_add_f32 v23, v23, v91
  v_exp_f32 v93, v93
  v_mfma_f32_32x32x16_bf16 v[64:79], v[56:59], a[64:67], v[64:79]
  ds_read_b128 v[56:59], v3 offset:12544
  v_add_f32 v22, v22, v92
  v_exp_f32 v94, v94
  v_add_f32 v23, v23, v93
  v_mfma_f32_32x32x16_bf16 v[64:79], v[60:63], a[68:71], v[64:79]
  ds_read_b128 v[60:63], v4 offset:12544
  s_waitcnt vmcnt(39)
  s_barrier
  s_mov_b32 s45, 356352
  s_add_u32 m0, s32, 126976
  s_waitcnt lgkmcnt(3)
  v_mfma_f32_32x32x16_bf16 v[64:79], v[40:43], a[72:75], v[64:79]
  ds_read_b64_tr_b16 v[40:41], v7 offset:12288
  ds_read_b64_tr_b16 v[42:43], v7 offset:13312
  buffer_load_dwordx4 v14, s[8:11], s45 offen offset:0 nt lds
  buffer_load_dwordx4 v15, s[8:11], s45 offen offset:1024 nt lds
  buffer_load_dwordx4 v16, s[8:11], s45 offen offset:2048 nt lds
  v_mfma_f32_32x32x16_bf16 v[64:79], v[44:47], a[76:79], v[64:79]
  ds_read_b64_tr_b16 v[44:45], v8 offset:12288
  ds_read_b64_tr_b16 v[46:47], v8 offset:13312
  v_exp_f32 v95, v95
  v_add_f32 v22, v22, v94
  v_cvt_pk_bf16_f32 v88, v88, v89
  v_mfma_f32_32x32x16_bf16 v[64:79], v[48:51], a[80:83], v[64:79]
  ds_read_b64_tr_b16 v[48:49], v9 offset:12288
  ds_read_b64_tr_b16 v[50:51], v9 offset:13312
  v_add_f32 v23, v23, v95
  v_cvt_pk_bf16_f32 v89, v90, v91
  v_cvt_pk_bf16_f32 v90, v92, v93
  s_waitcnt lgkmcnt(6)
  v_mfma_f32_32x32x16_bf16 v[64:79], v[52:55], a[84:87], v[64:79]
  ds_read_b64_tr_b16 v[52:53], v10 offset:12288
  ds_read_b64_tr_b16 v[54:55], v10 offset:13312
  v_cvt_pk_bf16_f32 v91, v94, v95
  v_mfma_f32_32x32x16_bf16 v[64:79], v[56:59], a[88:91], v[64:79]
  ds_read_b64_tr_b16 v[56:57], v7 offset:16384
  ds_read_b64_tr_b16 v[58:59], v7 offset:17408
  v_mfma_f32_32x32x16_bf16 v[64:79], v[60:63], a[92:95], v[64:79]
  ds_read_b64_tr_b16 v[60:61], v8 offset:16384
  ds_read_b64_tr_b16 v[62:63], v8 offset:17408
  s_waitcnt lgkmcnt(6)
  v_mfma_f32_32x32x16_bf16 a[160:175], v[40:43], a[0:3], 0
  ds_read_b64_tr_b16 v[40:41], v9 offset:16384
  ds_read_b64_tr_b16 v[42:43], v9 offset:17408
  v_mfma_f32_32x32x16_bf16 a[176:191], v[44:47], a[0:3], 0
  ds_read_b64_tr_b16 v[44:45], v10 offset:16384
  ds_read_b64_tr_b16 v[46:47], v10 offset:17408
  s_nop 2
  v_max3_f32 v28, v64, v65, v66
  v_max3_f32 v29, v67, v68, v69
  v_max3_f32 v28, v28, v70, v71
  v_max3_f32 v29, v29, v72, v73
  v_mfma_f32_32x32x16_bf16 a[192:207], v[48:51], a[0:3], 0
  ds_read_b64_tr_b16 v[48:49], v7 offset:20480
  ds_read_b64_tr_b16 v[50:51], v7 offset:21504
  v_max3_f32 v28, v28, v74, v75
  v_max3_f32 v29, v29, v76, v77
  v_max3_f32 v28, v28, v78, v79
  s_waitcnt lgkmcnt(6)
  v_mfma_f32_32x32x16_bf16 a[208:223], v[52:55], a[0:3], 0
  ds_read_b64_tr_b16 v[52:53], v8 offset:20480
  ds_read_b64_tr_b16 v[54:55], v8 offset:21504
  v_max_f32 v28, v28, v29
  v_mfma_f32_32x32x16_bf16 a[160:175], v[56:59], a[4:7], a[160:175]
  ds_read_b64_tr_b16 v[56:57], v9 offset:20480
  ds_read_b64_tr_b16 v[58:59], v9 offset:21504
  v_mfma_f32_32x32x16_bf16 a[176:191], v[60:63], a[4:7], a[176:191]
  ds_read_b64_tr_b16 v[60:61], v10 offset:20480
  ds_read_b64_tr_b16 v[62:63], v10 offset:21504
  s_waitcnt vmcnt(30)
  s_barrier
  s_mov_b32 s44, 380928
  s_waitcnt lgkmcnt(6)
  v_mfma_f32_32x32x16_bf16 a[192:207], v[40:43], a[4:7], a[192:207]
  ds_read_b64_tr_b16 v[40:41], v5 offset:4096
  ds_read_b64_tr_b16 v[42:43], v5 offset:7168
  s_add_u32 m0, s32, 49152
  s_nop 0
  buffer_load_dwordx4 v11, s[4:7], s44 offen offset:0 nt lds
  buffer_load_dwordx4 v12, s[4:7], s44 offen offset:1024 nt lds
  buffer_load_dwordx4 v13, s[4:7], s44 offen offset:2048 nt lds
  v_mfma_f32_32x32x16_bf16 a[208:223], v[44:47], a[4:7], a[208:223]
  ds_read_b64_tr_b16 v[44:45], v6 offset:4096
  ds_read_b64_tr_b16 v[46:47], v6 offset:7168
  v_mfma_f32_32x32x16_bf16 a[160:175], v[48:51], a[8:11], a[160:175]
  ds_read_b64_tr_b16 v[48:49], v5 offset:4224
  ds_read_b64_tr_b16 v[50:51], v5 offset:7296
  s_waitcnt lgkmcnt(6)
  v_mfma_f32_32x32x16_bf16 a[176:191], v[52:55], a[8:11], a[176:191]
  ds_read_b64_tr_b16 v[52:53], v6 offset:4224
  ds_read_b64_tr_b16 v[54:55], v6 offset:7296
  v_mfma_f32_32x32x16_bf16 a[192:207], v[56:59], a[8:11], a[192:207]
  ds_read_b64_tr_b16 v[56:57], v5 offset:4352
  ds_read_b64_tr_b16 v[58:59], v5 offset:7424
  v_mfma_f32_32x32x16_bf16 a[208:223], v[60:63], a[8:11], a[208:223]
  ds_read_b64_tr_b16 v[60:61], v6 offset:4352
  ds_read_b64_tr_b16 v[62:63], v6 offset:7424
  s_cmp_lg_u32 s42, 0
  s_cbranch_scc1 LrB_95
LbB_96:
  s_waitcnt lgkmcnt(6)
  v_mfma_f32_32x32x16_bf16 v[160:175], v[40:43], v[80:83], v[160:175]
  ds_read_b64_tr_b16 v[40:41], v5 offset:10240
  ds_read_b64_tr_b16 v[42:43], v5 offset:13312
  v_cmp_lt_f32 vcc, s43, v28
  s_cbranch_vccnz Lrare_97
Lback_98:
  v_exp_f32 v64, v64
  v_mfma_f32_32x32x16_bf16 v[176:191], v[44:47], v[80:83], v[176:191]
  ds_read_b64_tr_b16 v[44:45], v6 offset:10240
  ds_read_b64_tr_b16 v[46:47], v6 offset:13312
  v_exp_f32 v65, v65
  v_add_f32 v22, v22, v64
  v_mfma_f32_32x32x16_bf16 v[192:207], v[48:51], v[80:83], v[192:207]
  ds_read_b64_tr_b16 v[48:49], v5 offset:10368
  ds_read_b64_tr_b16 v[50:51], v5 offset:13440
  v_exp_f32 v66, v66
  v_add_f32 v23, v23, v65
  s_waitcnt lgkmcnt(6)
  v_mfma_f32_32x32x16_bf16 v[208:223], v[52:55], v[80:83], v[208:223]
  ds_read_b64_tr_b16 v[52:53], v6 offset:10368
  ds_read_b64_tr_b16 v[54:55], v6 offset:13440
  v_exp_f32 v67, v67
  v_add_f32 v22, v22, v66
  v_mfma_f32_32x32x16_bf16 v[224:239], v[56:59], v[80:83], v[224:239]
  ds_read_b64_tr_b16 v[56:57], v5 offset:10496
  ds_read_b64_tr_b16 v[58:59], v5 offset:13568
  v_exp_f32 v68, v68
  v_add_f32 v23, v23, v67
  v_mfma_f32_32x32x16_bf16 v[240:255], v[60:63], v[80:83], v[240:255]
  ds_read_b64_tr_b16 v[60:61], v6 offset:10496
  ds_read_b64_tr_b16 v[62:63], v6 offset:13568
  s_waitcnt vmcnt(30)
  s_barrier
  s_mov_b32 s45, 184576
  s_waitcnt lgkmcnt(6)
  v_mfma_f32_32x32x16_bf16 v[160:175], v[40:43], v[88:91], v[160:175]
  ds_read_b128 v[40:43], v1 offset:36864
  s_add_u32 m0, s32, 12288
  s_nop 0
  buffer_load_dwordx4 v17, s[20:23], s45 offen offset:0 nt lds
  buffer_load_dwordx4 v18, s[20:23], s45 offen offset:1024 nt lds
  buffer_load_dwordx4 v19, s[20:23], s45 offen offset:2048 nt lds
  v_mfma_f32_32x32x16_bf16 v[176:191], v[44:47], v[88:91], v[176:191]
  ds_read_b128 v[44:47], v2 offset:36864
  v_exp_f32 v69, v69
  v_add_f32 v22, v22, v68
  v_exp_f32 v70, v70
  v_mfma_f32_32x32x16_bf16 v[192:207], v[48:51], v[88:91], v[192:207]
  ds_read_b128 v[48:51], v3 offset:36864
  v_add_f32 v23, v23, v69
  v_exp_f32 v71, v71
  v_add_f32 v22, v22, v70
  s_waitcnt lgkmcnt(3)
  v_mfma_f32_32x32x16_bf16 v[208:223], v[52:55], v[88:91], v[208:223]
  ds_read_b128 v[52:55], v4 offset:36864
  v_exp_f32 v72, v72
  v_add_f32 v23, v23, v71
  v_exp_f32 v73, v73
  v_mfma_f32_32x32x16_bf16 v[224:239], v[56:59], v[88:91], v[224:239]
  ds_read_b128 v[56:59], v1 offset:36992
  v_add_f32 v22, v22, v72
  v_cvt_pk_bf16_f32 v64, v64, v65
  v_cvt_pk_bf16_f32 v65, v66, v67
  v_cvt_pk_bf16_f32 v66, v68, v69
  v_cvt_pk_bf16_f32 v67, v70, v71
  v_mfma_f32_32x32x16_bf16 v[240:255], v[60:63], v[88:91], v[240:255]
  ds_read_b128 v[60:63], v2 offset:36992
  v_exp_f32 v74, v74
  v_add_f32 v23, v23, v73
  s_waitcnt lgkmcnt(3)
  v_mfma_f32_32x32x16_bf16 v[80:95], v[40:43], a[48:51], v[96:111]
  ds_read_b128 v[40:43], v3 offset:36992
  v_exp_f32 v75, v75
  v_add_f32 v22, v22, v74
  v_exp_f32 v76, v76
  v_mfma_f32_32x32x16_bf16 v[80:95], v[44:47], a[52:55], v[80:95]
  ds_read_b128 v[44:47], v4 offset:36992
  v_add_f32 v23, v23, v75
  v_exp_f32 v77, v77
  v_add_f32 v22, v22, v76
  v_mfma_f32_32x32x16_bf16 v[80:95], v[48:51], a[56:59], v[80:95]
  ds_read_b128 v[48:51], v1 offset:37120
  v_exp_f32 v78, v78
  v_add_f32 v23, v23, v77
  s_waitcnt lgkmcnt(3)
  v_mfma_f32_32x32x16_bf16 v[80:95], v[52:55], a[60:63], v[80:95]
  ds_read_b128 v[52:55], v2 offset:37120
  v_exp_f32 v79, v79
  v_add_f32 v22, v22, v78
  v_cvt_pk_bf16_f32 v72, v72, v73
  v_add_f32 v23, v23, v79
  v_mfma_f32_32x32x16_bf16 v[80:95], v[56:59], a[64:67], v[80:95]
  ds_read_b128 v[56:59], v3 offset:37120
  v_cvt_pk_bf16_f32 v73, v74, v75
  v_cvt_pk_bf16_f32 v74, v76, v77
  v_cvt_pk_bf16_f32 v75, v78, v79
  v_mfma_f32_32x32x16_bf16 v[80:95], v[60:63], a[68:71], v[80:95]
  ds_read_b128 v[60:63], v4 offset:37120
  s_waitcnt vmcnt(27)
  s_barrier
  s_mov_b32 s44, 368640
  s_add_u32 m0, s32, 102400
  s_waitcnt lgkmcnt(3)
  v_mfma_f32_32x32x16_bf16 v[80:95], v[40:43], a[72:75], v[80:95]
  ds_read_b64_tr_b16 v[40:41], v5 offset:16384
  ds_read_b64_tr_b16 v[42:43], v5 offset:19456
  buffer_load_dwordx4 v14, s[8:11], s44 offen offset:0 nt lds
  buffer_load_dwordx4 v15, s[8:11], s44 offen offset:1024 nt lds
  buffer_load_dwordx4 v16, s[8:11], s44 offen offset:2048 nt lds
  v_mfma_f32_32x32x16_bf16 v[80:95], v[44:47], a[76:79], v[80:95]
  ds_read_b64_tr_b16 v[44:45], v6 offset:16384
  ds_read_b64_tr_b16 v[46:47], v6 offset:19456
  v_mfma_f32_32x32x16_bf16 v[80:95], v[48:51], a[80:83], v[80:95]
  ds_read_b64_tr_b16 v[48:49], v5 offset:16512
  ds_read_b64_tr_b16 v[50:51], v5 offset:19584
  s_waitcnt lgkmcnt(6)
  v_mfma_f32_32x32x16_bf16 v[80:95], v[52:55], a[84:87], v[80:95]
  ds_read_b64_tr_b16 v[52:53], v6 offset:16512
  ds_read_b64_tr_b16 v[54:55], v6 offset:19584
  v_mfma_f32_32x32x16_bf16 v[80:95], v[56:59], a[88:91], v[80:95]
  ds_read_b64_tr_b16 v[56:57], v5 offset:16640
  ds_read_b64_tr_b16 v[58:59], v5 offset:19712
  v_mfma_f32_32x32x16_bf16 v[80:95], v[60:63], a[92:95], v[80:95]
  ds_read_b64_tr_b16 v[60:61], v6 offset:16640
  ds_read_b64_tr_b16 v[62:63], v6 offset:19712
  s_cmp_lg_u32 s42, 0
  s_cbranch_scc1 LrB_99
LbB_100:
  s_waitcnt lgkmcnt(6)
  v_mfma_f32_32x32x16_bf16 v[160:175], v[40:43], v[64:67], v[160:175]
  ds_read_b64_tr_b16 v[40:41], v5 offset:22528
  ds_read_b64_tr_b16 v[42:43], v5 offset:25600
  v_mfma_f32_32x32x16_bf16 v[176:191], v[44:47], v[64:67], v[176:191]
  ds_read_b64_tr_b16 v[44:45], v6 offset:22528
  ds_read_b64_tr_b16 v[46:47], v6 offset:25600
  s_nop 0
  v_max3_f32 v28, v80, v81, v82
  v_max3_f32 v29, v83, v84, v85
  v_max3_f32 v28, v28, v86, v87
  v_max3_f32 v29, v29, v88, v89
  v_mfma_f32_32x32x16_bf16 v[192:207], v[48:51], v[64:67], v[192:207]
  ds_read_b64_tr_b16 v[48:49], v5 offset:22656
  ds_read_b64_tr_b16 v[50:51], v5 offset:25728
  v_max3_f32 v28, v28, v90, v91
  v_max3_f32 v29, v29, v92, v93
  v_max3_f32 v28, v28, v94, v95
  s_waitcnt lgkmcnt(6)
  v_mfma_f32_32x32x16_bf16 v[208:223], v[52:55], v[64:67], v[208:223]
  ds_read_b64_tr_b16 v[52:53], v6 offset:22656
  ds_read_b64_tr_b16 v[54:55], v6 offset:25728
  v_max_f32 v28, v28, v29
  v_cmp_lt_f32 vcc, s43, v28
  s_cbranch_vccnz Lrare_101
Lback_102:
  v_mfma_f32_32x32x16_bf16 v[224:239], v[56:59], v[64:67], v[224:239]
  ds_read_b64_tr_b16 v[56:57], v5 offset:22784
  ds_read_b64_tr_b16 v[58:59], v5 offset:25856
  v_exp_f32 v80, v80
  v_exp_f32 v81, v81
  v_mfma_f32_32x32x16_bf16 v[240:255], v[60:63], v[64:67], v[240:255]
  ds_read_b64_tr_b16 v[60:61], v6 offset:22784
  ds_read_b64_tr_b16 v[62:63], v6 offset:25856
  s_waitcnt vmcnt(33)
  s_barrier
  v_add_f32 v22, v22, v80
  s_waitcnt lgkmcnt(6)
  v_mfma_f32_32x32x16_bf16 v[160:175], v[40:43], v[72:75], v[160:175]
  ds_read_b64_tr_b16 v[40:41], v7 offset:24576
  ds_read_b64_tr_b16 v[42:43], v7 offset:25600
  v_exp_f32 v82, v82
  v_add_f32 v23, v23, v81
  v_mfma_f32_32x32x16_bf16 v[176:191], v[44:47], v[72:75], v[176:191]
  ds_read_b64_tr_b16 v[44:45], v8 offset:24576
  ds_read_b64_tr_b16 v[46:47], v8 offset:25600
  v_exp_f32 v83, v83
  v_add_f32 v22, v22, v82
  v_mfma_f32_32x32x16_bf16 v[192:207], v[48:51], v[72:75], v[192:207]
  ds_read_b64_tr_b16 v[48:49], v9 offset:24576
  ds_read_b64_tr_b16 v[50:51], v9 offset:25600
  v_exp_f32 v84, v84
  v_add_f32 v23, v23, v83
  s_waitcnt lgkmcnt(6)
  v_mfma_f32_32x32x16_bf16 v[208:223], v[52:55], v[72:75], v[208:223]
  ds_read_b64_tr_b16 v[52:53], v10 offset:24576
  ds_read_b64_tr_b16 v[54:55], v10 offset:25600
  v_exp_f32 v85, v85
  v_add_f32 v22, v22, v84
  v_mfma_f32_32x32x16_bf16 v[224:239], v[56:59], v[72:75], v[224:239]
  ds_read_b64_tr_b16 v[56:57], v7 offset:28672
  ds_read_b64_tr_b16 v[58:59], v7 offset:29696
  v_exp_f32 v86, v86
  v_add_f32 v23, v23, v85
  v_mfma_f32_32x32x16_bf16 v[240:255], v[60:63], v[72:75], v[240:255]
  ds_read_b64_tr_b16 v[60:61], v8 offset:28672
  ds_read_b64_tr_b16 v[62:63], v8 offset:29696
  v_exp_f32 v87, v87
  v_add_f32 v22, v22, v86
  s_waitcnt lgkmcnt(6)
  v_mfma_f32_32x32x16_bf16 a[160:175], v[40:43], a[12:15], a[160:175]
  ds_read_b64_tr_b16 v[40:41], v9 offset:28672
  ds_read_b64_tr_b16 v[42:43], v9 offset:29696
  v_exp_f32 v88, v88
  v_add_f32 v23, v23, v87
  v_mfma_f32_32x32x16_bf16 a[176:191], v[44:47], a[12:15], a[176:191]
  ds_read_b64_tr_b16 v[44:45], v10 offset:28672
  ds_read_b64_tr_b16 v[46:47], v10 offset:29696
  v_exp_f32 v89, v89
  v_add_f32 v22, v22, v88
  v_cvt_pk_bf16_f32 v80, v80, v81
  v_mfma_f32_32x32x16_bf16 a[192:207], v[48:51], a[12:15], a[192:207]
  ds_read_b64_tr_b16 v[48:49], v7 offset:32768
  ds_read_b64_tr_b16 v[50:51], v7 offset:33792
  v_cvt_pk_bf16_f32 v81, v82, v83
  v_cvt_pk_bf16_f32 v82, v84, v85
  v_cvt_pk_bf16_f32 v83, v86, v87
  s_waitcnt lgkmcnt(6)
  v_mfma_f32_32x32x16_bf16 a[208:223], v[52:55], a[12:15], a[208:223]
  ds_read_b64_tr_b16 v[52:53], v8 offset:32768
  ds_read_b64_tr_b16 v[54:55], v8 offset:33792
  v_exp_f32 v90, v90
  v_add_f32 v23, v23, v89
  v_mfma_f32_32x32x16_bf16 a[160:175], v[56:59], a[16:19], a[160:175]
  ds_read_b64_tr_b16 v[56:57], v9 offset:32768
  ds_read_b64_tr_b16 v[58:59], v9 offset:33792
  v_exp_f32 v91, v91
  v_add_f32 v22, v22, v90
  v_mfma_f32_32x32x16_bf16 a[176:191], v[60:63], a[16:19], a[176:191]
  ds_read_b64_tr_b16 v[60:61], v10 offset:32768
  ds_read_b64_tr_b16 v[62:63], v10 offset:33792
  s_waitcnt vmcnt(27)
  s_barrier
  s_mov_b32 s45, 380928
  s_waitcnt lgkmcnt(6)
  v_mfma_f32_32x32x16_bf16 a[192:207], v[40:43], a[16:19], a[192:207]
  ds_read_b64_tr_b16 v[40:41], v5 offset:53248
  ds_read_b64_tr_b16 v[42:43], v5 offset:56320
  s_add_u32 m0, s32, 114688
  s_nop 0
  buffer_load_dwordx4 v14, s[8:11], s45 offen offset:0 nt lds
  buffer_load_dwordx4 v15, s[8:11], s45 offen offset:1024 nt lds
  buffer_load_dwordx4 v16, s[8:11], s45 offen offset:2048 nt lds
  v_mfma_f32_32x32x16_bf16 a[208:223], v[44:47], a[16:19], a[208:223]
  ds_read_b64_tr_b16 v[44:45], v6 offset:53248
  ds_read_b64_tr_b16 v[46:47], v6 offset:56320
  s_mov_b32 s44, 512
  s_add_u32 m0, s32, 73728
  s_nop 0
  buffer_load_dwordx4 v17, s[20:23], s44 offen offset:0 nt lds
  buffer_load_dwordx4 v18, s[20:23], s44 offen offset:1024 nt lds
  v_mfma_f32_32x32x16_bf16 a[160:175], v[48:51], a[20:23], a[160:175]
  ds_read_b64_tr_b16 v[48:49], v5 offset:53376
  ds_read_b64_tr_b16 v[50:51], v5 offset:56448
  buffer_load_dwordx4 v19, s[20:23], s44 offen offset:2048 nt lds
  v_exp_f32 v92, v92
  s_waitcnt lgkmcnt(6)
  v_mfma_f32_32x32x16_bf16 a[176:191], v[52:55], a[20:23], a[176:191]
  ds_read_b64_tr_b16 v[52:53], v6 offset:53376
  ds_read_b64_tr_b16 v[54:55], v6 offset:56448
  v_add_f32 v23, v23, v91
  v_exp_f32 v93, v93
  v_add_f32 v22, v22, v92
  v_mfma_f32_32x32x16_bf16 a[192:207], v[56:59], a[20:23], a[192:207]
  ds_read_b64_tr_b16 v[56:57], v5 offset:53504
  ds_read_b64_tr_b16 v[58:59], v5 offset:56576
  v_exp_f32 v94, v94
  v_add_f32 v23, v23, v93
  v_mfma_f32_32x32x16_bf16 a[208:223], v[60:63], a[20:23], a[208:223]
  ds_read_b64_tr_b16 v[60:61], v6 offset:53504
  ds_read_b64_tr_b16 v[62:63], v6 offset:56576
  v_exp_f32 v95, v95
  v_add_f32 v22, v22, v94
  v_cvt_pk_bf16_f32 v88, v88, v89
  v_add_f32 v23, v23, v95
  v_cvt_pk_bf16_f32 v89, v90, v91
  v_cvt_pk_bf16_f32 v90, v92, v93
  v_cvt_pk_bf16_f32 v91, v94, v95
  s_cmp_lg_u32 s42, 0
  s_cbranch_scc1 LrB_103
LbB_104:
  s_waitcnt lgkmcnt(6)
  v_mfma_f32_32x32x16_bf16 v[160:175], v[40:43], v[80:83], v[160:175]
  ds_read_b64_tr_b16 v[40:41], v5 offset:59392
  ds_read_b64_tr_b16 v[42:43], v5 offset:62464
  v_mfma_f32_32x32x16_bf16 v[176:191], v[44:47], v[80:83], v[176:191]
  ds_read_b64_tr_b16 v[44:45], v6 offset:59392
  ds_read_b64_tr_b16 v[46:47], v6 offset:62464
  v_mfma_f32_32x32x16_bf16 v[192:207], v[48:51], v[80:83], v[192:207]
  ds_read_b64_tr_b16 v[48:49], v5 offset:59520
  ds_read_b64_tr_b16 v[50:51], v5 offset:62592
  s_waitcnt lgkmcnt(6)
  v_mfma_f32_32x32x16_bf16 v[208:223], v[52:55], v[80:83], v[208:223]
  ds_read_b64_tr_b16 v[52:53], v6 offset:59520
  ds_read_b64_tr_b16 v[54:55], v6 offset:62592
  v_mfma_f32_32x32x16_bf16 v[224:239], v[56:59], v[80:83], v[224:239]
  ds_read_b64_tr_b16 v[56:57], v5 offset:59648
  ds_read_b64_tr_b16 v[58:59], v5 offset:62720
  v_mfma_f32_32x32x16_bf16 v[240:255], v[60:63], v[80:83], v[240:255]
  ds_read_b64_tr_b16 v[60:61], v6 offset:59648
  ds_read_b64_tr_b16 v[62:63], v6 offset:62720
  s_waitcnt vmcnt(30)
  s_barrier
  s_mov_b32 s45, 61952
  s_waitcnt lgkmcnt(6)
  v_mfma_f32_32x32x16_bf16 v[160:175], v[40:43], v[88:91], v[160:175]
  ds_read_b128 v[40:43], v1 offset:49152
  s_add_u32 m0, s32, 24576
  s_nop 0
  buffer_load_dwordx4 v17, s[20:23], s45 offen offset:0 nt lds
  buffer_load_dwordx4 v18, s[20:23], s45 offen offset:1024 nt lds
  buffer_load_dwordx4 v19, s[20:23], s45 offen offset:2048 nt lds
  v_mfma_f32_32x32x16_bf16 v[176:191], v[44:47], v[88:91], v[176:191]
  ds_read_b128 v[44:47], v2 offset:49152
  v_mfma_f32_32x32x16_bf16 v[192:207], v[48:51], v[88:91], v[192:207]
  ds_read_b128 v[48:51], v3 offset:49152
  s_waitcnt lgkmcnt(3)
  v_mfma_f32_32x32x16_bf16 v[208:223], v[52:55], v[88:91], v[208:223]
  ds_read_b128 v[52:55], v4 offset:49152
  v_mfma_f32_32x32x16_bf16 v[224:239], v[56:59], v[88:91], v[224:239]
  ds_read_b128 v[56:59], v1 offset:49280
  v_mfma_f32_32x32x16_bf16 v[240:255], v[60:63], v[88:91], v[240:255]
  ds_read_b128 v[60:63], v2 offset:49280
  s_waitcnt lgkmcnt(3)
  v_mfma_f32_32x32x16_bf16 v[64:79], v[40:43], a[48:51], v[96:111]
  ds_read_b128 v[40:43], v3 offset:49280
  v_mfma_f32_32x32x16_bf16 v[64:79], v[44:47], a[52:55], v[64:79]
  ds_read_b128 v[44:47], v4 offset:49280
  v_mfma_f32_32x32x16_bf16 v[64:79], v[48:51], a[56:59], v[64:79]
  ds_read_b128 v[48:51], v1 offset:49408
  s_waitcnt lgkmcnt(3)
  v_mfma_f32_32x32x16_bf16 v[64:79], v[52:55], a[60:63], v[64:79]
  ds_read_b128 v[52:55], v2 offset:49408
  v_mfma_f32_32x32x16_bf16 v[64:79], v[56:59], a[64:67], v[64:79]
  ds_read_b128 v[56:59], v3 offset:49408
  v_mfma_f32_32x32x16_bf16 v[64:79], v[60:63], a[68:71], v[64:79]
  ds_read_b128 v[60:63], v4 offset:49408
  s_waitcnt vmcnt(27)
  s_barrier
  s_mov_b32 s44, 123392
  s_add_u32 m0, s32, 151552
  s_waitcnt lgkmcnt(3)
  v_mfma_f32_32x32x16_bf16 v[64:79], v[40:43], a[72:75], v[64:79]
  ds_read_b128 v[40:43], v1 offset:24576
  buffer_load_dwordx4 v17, s[20:23], s44 offen offset:0 nt lds
  buffer_load_dwordx4 v18, s[20:23], s44 offen offset:1024 nt lds
  buffer_load_dwordx4 v19, s[20:23], s44 offen offset:2048 nt lds
  v_mfma_f32_32x32x16_bf16 v[64:79], v[44:47], a[76:79], v[64:79]
  ds_read_b128 v[44:47], v2 offset:24576
  v_mfma_f32_32x32x16_bf16 v[64:79], v[48:51], a[80:83], v[64:79]
  ds_read_b128 v[48:51], v3 offset:24576
  s_waitcnt lgkmcnt(3)
  v_mfma_f32_32x32x16_bf16 v[64:79], v[52:55], a[84:87], v[64:79]
  ds_read_b128 v[52:55], v4 offset:24576
  v_mfma_f32_32x32x16_bf16 v[64:79], v[56:59], a[88:91], v[64:79]
  ds_read_b128 v[56:59], v1 offset:24704
  v_mfma_f32_32x32x16_bf16 v[64:79], v[60:63], a[92:95], v[64:79]
  ds_read_b128 v[60:63], v2 offset:24704
  s_waitcnt lgkmcnt(3)
  v_mfma_f32_32x32x16_bf16 v[80:95], v[40:43], a[48:51], v[96:111]
  ds_read_b128 v[40:43], v3 offset:24704
  v_mfma_f32_32x32x16_bf16 v[80:95], v[44:47], a[52:55], v[80:95]
  ds_read_b128 v[44:47], v4 offset:24704
  s_nop 5
  v_max3_f32 v28, v64, v65, v66
  v_max3_f32 v29, v67, v68, v69
  v_max3_f32 v28, v28, v70, v71
  v_max3_f32 v29, v29, v72, v73
  v_max3_f32 v28, v28, v74, v75
  v_mfma_f32_32x32x16_bf16 v[80:95], v[48:51], a[56:59], v[80:95]
  ds_read_b128 v[48:51], v1 offset:24832
  v_max3_f32 v29, v29, v76, v77
  v_max3_f32 v28, v28, v78, v79
  v_max_f32 v28, v28, v29
  s_waitcnt lgkmcnt(3)
  v_mfma_f32_32x32x16_bf16 v[80:95], v[52:55], a[60:63], v[80:95]
  ds_read_b128 v[52:55], v2 offset:24832
  v_cmp_lt_f32 vcc, s43, v28
  s_cbranch_vccnz Lrare_105
Lback_106:
  v_exp_f32 v64, v64
  v_mfma_f32_32x32x16_bf16 v[80:95], v[56:59], a[64:67], v[80:95]
  ds_read_b128 v[56:59], v3 offset:24832
  v_exp_f32 v65, v65
  v_add_f32 v22, v22, v64
  v_exp_f32 v66, v66
  v_mfma_f32_32x32x16_bf16 v[80:95], v[60:63], a[68:71], v[80:95]
  ds_read_b128 v[60:63], v4 offset:24832
  s_waitcnt vmcnt(27)
  s_barrier
  s_mov_b32 s45, 184832
  s_add_u32 m0, s32, 86016
  s_waitcnt lgkmcnt(3)
  v_mfma_f32_32x32x16_bf16 v[80:95], v[40:43], a[72:75], v[80:95]
  ds_read_b64_tr_b16 v[40:41], v5 offset:40960
  ds_read_b64_tr_b16 v[42:43], v5 offset:44032
  buffer_load_dwordx4 v17, s[20:23], s45 offen offset:0 nt lds
  buffer_load_dwordx4 v18, s[20:23], s45 offen offset:1024 nt lds
  buffer_load_dwordx4 v19, s[20:23], s45 offen offset:2048 nt lds
  v_add_f32 v23, v23, v65
  v_mfma_f32_32x32x16_bf16 v[80:95], v[44:47], a[76:79], v[80:95]
  ds_read_b64_tr_b16 v[44:45], v6 offset:40960
  ds_read_b64_tr_b16 v[46:47], v6 offset:44032
  v_exp_f32 v67, v67
  v_add_f32 v22, v22, v66
  v_mfma_f32_32x32x16_bf16 v[80:95], v[48:51], a[80:83], v[80:95]
  ds_read_b64_tr_b16 v[48:49], v5 offset:41088
  ds_read_b64_tr_b16 v[50:51], v5 offset:44160
  v_exp_f32 v68, v68
  v_add_f32 v23, v23, v67
  s_waitcnt lgkmcnt(6)
  v_mfma_f32_32x32x16_bf16 v[80:95], v[52:55], a[84:87], v[80:95]
  ds_read_b64_tr_b16 v[52:53], v6 offset:41088
  ds_read_b64_tr_b16 v[54:55], v6 offset:44160
  v_exp_f32 v69, v69
  v_add_f32 v22, v22, v68
  v_mfma_f32_32x32x16_bf16 v[80:95], v[56:59], a[88:91], v[80:95]
  ds_read_b64_tr_b16 v[56:57], v5 offset:41216
  ds_read_b64_tr_b16 v[58:59], v5 offset:44288
  v_exp_f32 v70, v70
  v_add_f32 v23, v23, v69
  v_mfma_f32_32x32x16_bf16 v[80:95], v[60:63], a[92:95], v[80:95]
  ds_read_b64_tr_b16 v[60:61], v6 offset:41216
  ds_read_b64_tr_b16 v[62:63], v6 offset:44288
  v_exp_f32 v71, v71
  v_add_f32 v22, v22, v70
  v_exp_f32 v72, v72
  v_add_f32 v23, v23, v71
  v_exp_f32 v73, v73
  v_add_f32 v22, v22, v72
  v_cvt_pk_bf16_f32 v64, v64, v65
  v_cvt_pk_bf16_f32 v65, v66, v67
  v_cvt_pk_bf16_f32 v66, v68, v69
  v_cvt_pk_bf16_f32 v67, v70, v71
  v_exp_f32 v74, v74
  v_add_f32 v23, v23, v73
  v_exp_f32 v75, v75
  v_add_f32 v22, v22, v74
  v_exp_f32 v76, v76
  v_add_f32 v23, v23, v75
  v_exp_f32 v77, v77
  v_add_f32 v22, v22, v76
  v_exp_f32 v78, v78
  v_add_f32 v23, v23, v77
  v_exp_f32 v79, v79
  v_add_f32 v22, v22, v78
  v_cvt_pk_bf16_f32 v72, v72, v73
  v_add_f32 v23, v23, v79
  v_cvt_pk_bf16_f32 v73, v74, v75
  v_cvt_pk_bf16_f32 v74, v76, v77
  v_cvt_pk_bf16_f32 v75, v78, v79
  s_cmp_lg_u32 s42, 0
  s_cbranch_scc1 LrB_107
LbB_108:
  s_waitcnt lgkmcnt(6)
  v_mfma_f32_32x32x16_bf16 v[160:175], v[40:43], v[64:67], v[160:175]
  ds_read_b64_tr_b16 v[40:41], v5 offset:47104
  ds_read_b64_tr_b16 v[42:43], v5 offset:50176
  v_mfma_f32_32x32x16_bf16 v[176:191], v[44:47], v[64:67], v[176:191]
  ds_read_b64_tr_b16 v[44:45], v6 offset:47104
  ds_read_b64_tr_b16 v[46:47], v6 offset:50176
  v_max3_f32 v28, v80, v81, v82
  v_max3_f32 v29, v83, v84, v85
  v_max3_f32 v28, v28, v86, v87
  v_max3_f32 v29, v29, v88, v89
  v_mfma_f32_32x32x16_bf16 v[192:207], v[48:51], v[64:67], v[192:207]
  ds_read_b64_tr_b16 v[48:49], v5 offset:47232
  ds_read_b64_tr_b16 v[50:51], v5 offset:50304
  v_max3_f32 v28, v28, v90, v91
  v_max3_f32 v29, v29, v92, v93
  v_max3_f32 v28, v28, v94, v95
  s_waitcnt lgkmcnt(6)
  v_mfma_f32_32x32x16_bf16 v[208:223], v[52:55], v[64:67], v[208:223]
  ds_read_b64_tr_b16 v[52:53], v6 offset:47232
  ds_read_b64_tr_b16 v[54:55], v6 offset:50304
  v_max_f32 v28, v28, v29
  v_cmp_lt_f32 vcc, s43, v28
  s_cbranch_vccnz Lrare_109
Lback_110:
  v_mfma_f32_32x32x16_bf16 v[224:239], v[56:59], v[64:67], v[224:239]
  ds_read_b64_tr_b16 v[56:57], v5 offset:47360
  ds_read_b64_tr_b16 v[58:59], v5 offset:50432
  v_exp_f32 v80, v80
  v_exp_f32 v81, v81
  v_mfma_f32_32x32x16_bf16 v[240:255], v[60:63], v[64:67], v[240:255]
  ds_read_b64_tr_b16 v[60:61], v6 offset:47360
  ds_read_b64_tr_b16 v[62:63], v6 offset:50432
  s_waitcnt vmcnt(27)
  s_barrier
  s_mov_b32 s44, 246272
  s_waitcnt lgkmcnt(6)
  v_mfma_f32_32x32x16_bf16 v[160:175], v[40:43], v[72:75], v[160:175]
  ds_read_b128 v[40:43], v1 offset:0
  s_add_u32 m0, s32, 61440
  s_nop 0
  buffer_load_dwordx4 v17, s[20:23], s44 offen offset:0 nt lds
  buffer_load_dwordx4 v18, s[20:23], s44 offen offset:1024 nt lds
  buffer_load_dwordx4 v19, s[20:23], s44 offen offset:2048 nt lds
  v_add_f32 v22, v22, v80
  v_mfma_f32_32x32x16_bf16 v[176:191], v[44:47], v[72:75], v[176:191]
  ds_read_b128 v[44:47], v2 offset:0
  v_exp_f32 v82, v82
  v_add_f32 v23, v23, v81
  v_exp_f32 v83, v83
  v_mfma_f32_32x32x16_bf16 v[192:207], v[48:51], v[72:75], v[192:207]
  ds_read_b128 v[48:51], v3 offset:0
  v_add_f32 v22, v22, v82
  v_exp_f32 v84, v84
  v_add_f32 v23, v23, v83
  s_waitcnt lgkmcnt(3)
  v_mfma_f32_32x32x16_bf16 v[208:223], v[52:55], v[72:75], v[208:223]
  ds_read_b128 v[52:55], v4 offset:0
  v_exp_f32 v85, v85
  v_add_f32 v22, v22, v84
  v_exp_f32 v86, v86
  v_mfma_f32_32x32x16_bf16 v[224:239], v[56:59], v[72:75], v[224:239]
  ds_read_b128 v[56:59], v1 offset:128
  v_add_f32 v23, v23, v85
  v_exp_f32 v87, v87
  v_add_f32 v22, v22, v86
  v_mfma_f32_32x32x16_bf16 v[240:255], v[60:63], v[72:75], v[240:255]
  ds_read_b128 v[60:63], v2 offset:128
  v_exp_f32 v88, v88
  v_add_f32 v23, v23, v87
  s_waitcnt lgkmcnt(3)
  v_mfma_f32_32x32x16_bf16 v[64:79], v[40:43], a[48:51], v[96:111]
  ds_read_b128 v[40:43], v3 offset:128
  v_exp_f32 v89, v89
  v_add_f32 v22, v22, v88
  v_cvt_pk_bf16_f32 v80, v80, v81
  v_cvt_pk_bf16_f32 v81, v82, v83
  v_mfma_f32_32x32x16_bf16 v[64:79], v[44:47], a[52:55], v[64:79]
  ds_read_b128 v[44:47], v4 offset:128
  v_cvt_pk_bf16_f32 v82, v84, v85
  v_cvt_pk_bf16_f32 v83, v86, v87
  v_exp_f32 v90, v90
  v_add_f32 v23, v23, v89
  v_mfma_f32_32x32x16_bf16 v[64:79], v[48:51], a[56:59], v[64:79]
  ds_read_b128 v[48:51], v1 offset:256
  v_exp_f32 v91, v91
  v_add_f32 v22, v22, v90
  s_waitcnt lgkmcnt(3)
  v_mfma_f32_32x32x16_bf16 v[64:79], v[52:55], a[60:63], v[64:79]
  ds_read_b128 v[52:55], v2 offset:256
  v_exp_f32 v92, v92
  v_add_f32 v23, v23, v91
  v_exp_f32 v93, v93
  v_mfma_f32_32x32x16_bf16 v[64:79], v[56:59], a[64:67], v[64:79]
  ds_read_b128 v[56:59], v3 offset:256
  v_add_f32 v22, v22, v92
  v_exp_f32 v94, v94
  v_add_f32 v23, v23, v93
  v_mfma_f32_32x32x16_bf16 v[64:79], v[60:63], a[68:71], v[64:79]
  ds_read_b128 v[60:63], v4 offset:256
  s_waitcnt vmcnt(39)
  s_barrier
  s_mov_b32 s45, 307712
  s_add_u32 m0, s32, 139264
  s_waitcnt lgkmcnt(3)
  v_mfma_f32_32x32x16_bf16 v[64:79], v[40:43], a[72:75], v[64:79]
  ds_read_b64_tr_b16 v[40:41], v7 offset:0
  ds_read_b64_tr_b16 v[42:43], v7 offset:1024
  buffer_load_dwordx4 v17, s[20:23], s45 offen offset:0 nt lds
  buffer_load_dwordx4 v18, s[20:23], s45 offen offset:1024 nt lds
  buffer_load_dwordx4 v19, s[20:23], s45 offen offset:2048 nt lds
  v_mfma_f32_32x32x16_bf16 v[64:79], v[44:47], a[76:79], v[64:79]
  ds_read_b64_tr_b16 v[44:45], v8 offset:0
  ds_read_b64_tr_b16 v[46:47], v8 offset:1024
  v_exp_f32 v95, v95
  v_add_f32 v22, v22, v94
  v_cvt_pk_bf16_f32 v88, v88, v89
  v_mfma_f32_32x32x16_bf16 v[64:79], v[48:51], a[80:83], v[64:79]
  ds_read_b64_tr_b16 v[48:49], v9 offset:0
  ds_read_b64_tr_b16 v[50:51], v9 offset:1024
  v_add_f32 v23, v23, v95
  v_cvt_pk_bf16_f32 v89, v90, v91
  v_cvt_pk_bf16_f32 v90, v92, v93
  s_waitcnt lgkmcnt(6)
  v_mfma_f32_32x32x16_bf16 v[64:79], v[52:55], a[84:87], v[64:79]
  ds_read_b64_tr_b16 v[52:53], v10 offset:0
  ds_read_b64_tr_b16 v[54:55], v10 offset:1024
  v_cvt_pk_bf16_f32 v91, v94, v95
  v_mfma_f32_32x32x16_bf16 v[64:79], v[56:59], a[88:91], v[64:79]
  ds_read_b64_tr_b16 v[56:57], v7 offset:4096
  ds_read_b64_tr_b16 v[58:59], v7 offset:5120
  v_mfma_f32_32x32x16_bf16 v[64:79], v[60:63], a[92:95], v[64:79]
  ds_read_b64_tr_b16 v[60:61], v8 offset:4096
  ds_read_b64_tr_b16 v[62:63], v8 offset:5120
  s_waitcnt lgkmcnt(6)
  v_mfma_f32_32x32x16_bf16 a[160:175], v[40:43], a[24:27], a[160:175]
  ds_read_b64_tr_b16 v[40:41], v9 offset:4096
  ds_read_b64_tr_b16 v[42:43], v9 offset:5120
  v_mfma_f32_32x32x16_bf16 a[176:191], v[44:47], a[24:27], a[176:191]
  ds_read_b64_tr_b16 v[44:45], v10 offset:4096
  ds_read_b64_tr_b16 v[46:47], v10 offset:5120
  s_nop 2
  v_max3_f32 v28, v64, v65, v66
  v_max3_f32 v29, v67, v68, v69
  v_max3_f32 v28, v28, v70, v71
  v_max3_f32 v29, v29, v72, v73
  v_mfma_f32_32x32x16_bf16 a[192:207], v[48:51], a[24:27], a[192:207]
  ds_read_b64_tr_b16 v[48:49], v7 offset:8192
  ds_read_b64_tr_b16 v[50:51], v7 offset:9216
  v_max3_f32 v28, v28, v74, v75
  v_max3_f32 v29, v29, v76, v77
  v_max3_f32 v28, v28, v78, v79
  s_waitcnt lgkmcnt(6)
  v_mfma_f32_32x32x16_bf16 a[208:223], v[52:55], a[24:27], a[208:223]
  ds_read_b64_tr_b16 v[52:53], v8 offset:8192
  ds_read_b64_tr_b16 v[54:55], v8 offset:9216
  v_max_f32 v28, v28, v29
  v_mfma_f32_32x32x16_bf16 a[160:175], v[56:59], a[28:31], a[160:175]
  ds_read_b64_tr_b16 v[56:57], v9 offset:8192
  ds_read_b64_tr_b16 v[58:59], v9 offset:9216
  v_mfma_f32_32x32x16_bf16 a[176:191], v[60:63], a[28:31], a[176:191]
  ds_read_b64_tr_b16 v[60:61], v10 offset:8192
  ds_read_b64_tr_b16 v[62:63], v10 offset:9216
  s_waitcnt vmcnt(30)
  s_barrier
  s_mov_b32 s44, 369152
  s_waitcnt lgkmcnt(6)
  v_mfma_f32_32x32x16_bf16 a[192:207], v[40:43], a[28:31], a[192:207]
  ds_read_b64_tr_b16 v[40:41], v5 offset:28672
  ds_read_b64_tr_b16 v[42:43], v5 offset:31744
  s_add_u32 m0, s32, 36864
  s_nop 0
  buffer_load_dwordx4 v17, s[20:23], s44 offen offset:0 nt lds
  buffer_load_dwordx4 v18, s[20:23], s44 offen offset:1024 nt lds
  buffer_load_dwordx4 v19, s[20:23], s44 offen offset:2048 nt lds
  v_mfma_f32_32x32x16_bf16 a[208:223], v[44:47], a[28:31], a[208:223]
  ds_read_b64_tr_b16 v[44:45], v6 offset:28672
  ds_read_b64_tr_b16 v[46:47], v6 offset:31744
  v_mfma_f32_32x32x16_bf16 a[160:175], v[48:51], a[32:35], a[160:175]
  ds_read_b64_tr_b16 v[48:49], v5 offset:28800
  ds_read_b64_tr_b16 v[50:51], v5 offset:31872
  s_waitcnt lgkmcnt(6)
  v_mfma_f32_32x32x16_bf16 a[176:191], v[52:55], a[32:35], a[176:191]
  ds_read_b64_tr_b16 v[52:53], v6 offset:28800
  ds_read_b64_tr_b16 v[54:55], v6 offset:31872
  v_mfma_f32_32x32x16_bf16 a[192:207], v[56:59], a[32:35], a[192:207]
  ds_read_b64_tr_b16 v[56:57], v5 offset:28928
  ds_read_b64_tr_b16 v[58:59], v5 offset:32000
  v_mfma_f32_32x32x16_bf16 a[208:223], v[60:63], a[32:35], a[208:223]
  ds_read_b64_tr_b16 v[60:61], v6 offset:28928
  ds_read_b64_tr_b16 v[62:63], v6 offset:32000
  s_cmp_lg_u32 s42, 0
  s_cbranch_scc1 LrB_111
LbB_112:
  s_waitcnt lgkmcnt(6)
  v_mfma_f32_32x32x16_bf16 v[160:175], v[40:43], v[80:83], v[160:175]
  ds_read_b64_tr_b16 v[40:41], v5 offset:34816
  ds_read_b64_tr_b16 v[42:43], v5 offset:37888
  v_cmp_lt_f32 vcc, s43, v28
  s_cbranch_vccnz Lrare_113
Lback_114:
  v_exp_f32 v64, v64
  v_mfma_f32_32x32x16_bf16 v[176:191], v[44:47], v[80:83], v[176:191]
  ds_read_b64_tr_b16 v[44:45], v6 offset:34816
  ds_read_b64_tr_b16 v[46:47], v6 offset:37888
  v_exp_f32 v65, v65
  v_add_f32 v22, v22, v64
  v_mfma_f32_32x32x16_bf16 v[192:207], v[48:51], v[80:83], v[192:207]
  ds_read_b64_tr_b16 v[48:49], v5 offset:34944
  ds_read_b64_tr_b16 v[50:51], v5 offset:38016
  v_exp_f32 v66, v66
  v_add_f32 v23, v23, v65
  s_waitcnt lgkmcnt(6)
  v_mfma_f32_32x32x16_bf16 v[208:223], v[52:55], v[80:83], v[208:223]
  ds_read_b64_tr_b16 v[52:53], v6 offset:34944
  ds_read_b64_tr_b16 v[54:55], v6 offset:38016
  v_exp_f32 v67, v67
  v_add_f32 v22, v22, v66
  v_mfma_f32_32x32x16_bf16 v[224:239], v[56:59], v[80:83], v[224:239]
  ds_read_b64_tr_b16 v[56:57], v5 offset:35072
  ds_read_b64_tr_b16 v[58:59], v5 offset:38144
  v_exp_f32 v68, v68
  v_add_f32 v23, v23, v67
  v_mfma_f32_32x32x16_bf16 v[240:255], v[60:63], v[80:83], v[240:255]
  ds_read_b64_tr_b16 v[60:61], v6 offset:35072
  ds_read_b64_tr_b16 v[62:63], v6 offset:38144
  s_waitcnt vmcnt(30)
  s_barrier
  s_mov_b32 s45, 430592
  s_waitcnt lgkmcnt(6)
  v_mfma_f32_32x32x16_bf16 v[160:175], v[40:43], v[88:91], v[160:175]
  ds_read_b128 v[40:43], v1 offset:12288
  s_add_u32 m0, s32, 0
  s_nop 0
  buffer_load_dwordx4 v17, s[20:23], s45 offen offset:0 nt lds
  buffer_load_dwordx4 v18, s[20:23], s45 offen offset:1024 nt lds
  buffer_load_dwordx4 v19, s[20:23], s45 offen offset:2048 nt lds
  v_mfma_f32_32x32x16_bf16 v[176:191], v[44:47], v[88:91], v[176:191]
  ds_read_b128 v[44:47], v2 offset:12288
  v_exp_f32 v69, v69
  v_add_f32 v22, v22, v68
  v_exp_f32 v70, v70
  v_mfma_f32_32x32x16_bf16 v[192:207], v[48:51], v[88:91], v[192:207]
  ds_read_b128 v[48:51], v3 offset:12288
  v_add_f32 v23, v23, v69
  v_exp_f32 v71, v71
  v_add_f32 v22, v22, v70
  s_waitcnt lgkmcnt(3)
  v_mfma_f32_32x32x16_bf16 v[208:223], v[52:55], v[88:91], v[208:223]
  ds_read_b128 v[52:55], v4 offset:12288
  v_exp_f32 v72, v72
  v_add_f32 v23, v23, v71
  v_exp_f32 v73, v73
  v_mfma_f32_32x32x16_bf16 v[224:239], v[56:59], v[88:91], v[224:239]
  ds_read_b128 v[56:59], v1 offset:12416
  v_add_f32 v22, v22, v72
  v_cvt_pk_bf16_f32 v64, v64, v65
  v_cvt_pk_bf16_f32 v65, v66, v67
  v_cvt_pk_bf16_f32 v66, v68, v69
  v_cvt_pk_bf16_f32 v67, v70, v71
  v_mfma_f32_32x32x16_bf16 v[240:255], v[60:63], v[88:91], v[240:255]
  ds_read_b128 v[60:63], v2 offset:12416
  v_exp_f32 v74, v74
  v_add_f32 v23, v23, v73
  s_waitcnt lgkmcnt(3)
  v_mfma_f32_32x32x16_bf16 v[80:95], v[40:43], a[48:51], v[96:111]
  ds_read_b128 v[40:43], v3 offset:12416
  v_exp_f32 v75, v75
  v_add_f32 v22, v22, v74
  v_exp_f32 v76, v76
  v_mfma_f32_32x32x16_bf16 v[80:95], v[44:47], a[52:55], v[80:95]
  ds_read_b128 v[44:47], v4 offset:12416
  v_add_f32 v23, v23, v75
  v_exp_f32 v77, v77
  v_add_f32 v22, v22, v76
  v_mfma_f32_32x32x16_bf16 v[80:95], v[48:51], a[56:59], v[80:95]
  ds_read_b128 v[48:51], v1 offset:12544
  v_exp_f32 v78, v78
  v_add_f32 v23, v23, v77
  s_waitcnt lgkmcnt(3)
  v_mfma_f32_32x32x16_bf16 v[80:95], v[52:55], a[60:63], v[80:95]
  ds_read_b128 v[52:55], v2 offset:12544
  v_exp_f32 v79, v79
  v_add_f32 v22, v22, v78
  v_cvt_pk_bf16_f32 v72, v72, v73
  v_add_f32 v23, v23, v79
  v_mfma_f32_32x32x16_bf16 v[80:95], v[56:59], a[64:67], v[80:95]
  ds_read_b128 v[56:59], v3 offset:12544
  v_cvt_pk_bf16_f32 v73, v74, v75
  v_cvt_pk_bf16_f32 v74, v76, v77
  v_cvt_pk_bf16_f32 v75, v78, v79
  v_mfma_f32_32x32x16_bf16 v[80:95], v[60:63], a[68:71], v[80:95]
  ds_read_b128 v[60:63], v4 offset:12544
  s_waitcnt vmcnt(27)
  s_barrier
  s_mov_b32 s44, 768
  s_add_u32 m0, s32, 126976
  s_waitcnt lgkmcnt(3)
  v_mfma_f32_32x32x16_bf16 v[80:95], v[40:43], a[72:75], v[80:95]
  ds_read_b64_tr_b16 v[40:41], v5 offset:4096
  ds_read_b64_tr_b16 v[42:43], v5 offset:7168
  buffer_load_dwordx4 v17, s[20:23], s44 offen offset:0 nt lds
  buffer_load_dwordx4 v18, s[20:23], s44 offen offset:1024 nt lds
  buffer_load_dwordx4 v19, s[20:23], s44 offen offset:2048 nt lds
  v_mfma_f32_32x32x16_bf16 v[80:95], v[44:47], a[76:79], v[80:95]
  ds_read_b64_tr_b16 v[44:45], v6 offset:4096
  ds_read_b64_tr_b16 v[46:47], v6 offset:7168
  v_mfma_f32_32x32x16_bf16 v[80:95], v[48:51], a[80:83], v[80:95]
  ds_read_b64_tr_b16 v[48:49], v5 offset:4224
  ds_read_b64_tr_b16 v[50:51], v5 offset:7296
  s_waitcnt lgkmcnt(6)
  v_mfma_f32_32x32x16_bf16 v[80:95], v[52:55], a[84:87], v[80:95]
  ds_read_b64_tr_b16 v[52:53], v6 offset:4224
  ds_read_b64_tr_b16 v[54:55], v6 offset:7296
  v_mfma_f32_32x32x16_bf16 v[80:95], v[56:59], a[88:91], v[80:95]
  ds_read_b64_tr_b16 v[56:57], v5 offset:4352
  ds_read_b64_tr_b16 v[58:59], v5 offset:7424
  v_mfma_f32_32x32x16_bf16 v[80:95], v[60:63], a[92:95], v[80:95]
  ds_read_b64_tr_b16 v[60:61], v6 offset:4352
  ds_read_b64_tr_b16 v[62:63], v6 offset:7424
  s_cmp_lg_u32 s42, 0
  s_cbranch_scc1 LrB_115
LbB_116:
  s_waitcnt lgkmcnt(6)
  v_mfma_f32_32x32x16_bf16 v[160:175], v[40:43], v[64:67], v[160:175]
  ds_read_b64_tr_b16 v[40:41], v5 offset:10240
  ds_read_b64_tr_b16 v[42:43], v5 offset:13312
  v_mfma_f32_32x32x16_bf16 v[176:191], v[44:47], v[64:67], v[176:191]
  ds_read_b64_tr_b16 v[44:45], v6 offset:10240
  ds_read_b64_tr_b16 v[46:47], v6 offset:13312
  s_nop 0
  v_max3_f32 v28, v80, v81, v82
  v_max3_f32 v29, v83, v84, v85
  v_max3_f32 v28, v28, v86, v87
  v_max3_f32 v29, v29, v88, v89
  v_mfma_f32_32x32x16_bf16 v[192:207], v[48:51], v[64:67], v[192:207]
  ds_read_b64_tr_b16 v[48:49], v5 offset:10368
  ds_read_b64_tr_b16 v[50:51], v5 offset:13440
  v_max3_f32 v28, v28, v90, v91
  v_max3_f32 v29, v29, v92, v93
  v_max3_f32 v28, v28, v94, v95
  s_waitcnt lgkmcnt(6)
  v_mfma_f32_32x32x16_bf16 v[208:223], v[52:55], v[64:67], v[208:223]
  ds_read_b64_tr_b16 v[52:53], v6 offset:10368
  ds_read_b64_tr_b16 v[54:55], v6 offset:13440
  v_max_f32 v28, v28, v29
  v_cmp_lt_f32 vcc, s43, v28
  s_cbranch_vccnz Lrare_117
Lback_118:
  v_mfma_f32_32x32x16_bf16 v[224:239], v[56:59], v[64:67], v[224:239]
  ds_read_b64_tr_b16 v[56:57], v5 offset:10496
  ds_read_b64_tr_b16 v[58:59], v5 offset:13568
  v_exp_f32 v80, v80
  v_exp_f32 v81, v81
  v_mfma_f32_32x32x16_bf16 v[240:255], v[60:63], v[64:67], v[240:255]
  ds_read_b64_tr_b16 v[60:61], v6 offset:10496
  ds_read_b64_tr_b16 v[62:63], v6 offset:13568
  s_waitcnt vmcnt(33)
  s_barrier
  v_add_f32 v22, v22, v80
  s_waitcnt lgkmcnt(6)
  v_mfma_f32_32x32x16_bf16 v[160:175], v[40:43], v[72:75], v[160:175]
  ds_read_b64_tr_b16 v[40:41], v7 offset:12288
  ds_read_b64_tr_b16 v[42:43], v7 offset:13312
  v_exp_f32 v82, v82
  v_add_f32 v23, v23, v81
  v_mfma_f32_32x32x16_bf16 v[176:191], v[44:47], v[72:75], v[176:191]
  ds_read_b64_tr_b16 v[44:45], v8 offset:12288
  ds_read_b64_tr_b16 v[46:47], v8 offset:13312
  v_exp_f32 v83, v83
  v_add_f32 v22, v22, v82
  v_mfma_f32_32x32x16_bf16 v[192:207], v[48:51], v[72:75], v[192:207]
  ds_read_b64_tr_b16 v[48:49], v9 offset:12288
  ds_read_b64_tr_b16 v[50:51], v9 offset:13312
  v_exp_f32 v84, v84
  v_add_f32 v23, v23, v83
  s_waitcnt lgkmcnt(6)
  v_mfma_f32_32x32x16_bf16 v[208:223], v[52:55], v[72:75], v[208:223]
  ds_read_b64_tr_b16 v[52:53], v10 offset:12288
  ds_read_b64_tr_b16 v[54:55], v10 offset:13312
  v_exp_f32 v85, v85
  v_add_f32 v22, v22, v84
  v_mfma_f32_32x32x16_bf16 v[224:239], v[56:59], v[72:75], v[224:239]
  ds_read_b64_tr_b16 v[56:57], v7 offset:16384
  ds_read_b64_tr_b16 v[58:59], v7 offset:17408
  v_exp_f32 v86, v86
  v_add_f32 v23, v23, v85
  v_mfma_f32_32x32x16_bf16 v[240:255], v[60:63], v[72:75], v[240:255]
  ds_read_b64_tr_b16 v[60:61], v8 offset:16384
  ds_read_b64_tr_b16 v[62:63], v8 offset:17408
  v_exp_f32 v87, v87
  v_add_f32 v22, v22, v86
  s_waitcnt lgkmcnt(6)
  v_mfma_f32_32x32x16_bf16 a[160:175], v[40:43], a[36:39], a[160:175]
  ds_read_b64_tr_b16 v[40:41], v9 offset:16384
  ds_read_b64_tr_b16 v[42:43], v9 offset:17408
  v_exp_f32 v88, v88
  v_add_f32 v23, v23, v87
  v_mfma_f32_32x32x16_bf16 a[176:191], v[44:47], a[36:39], a[176:191]
  ds_read_b64_tr_b16 v[44:45], v10 offset:16384
  ds_read_b64_tr_b16 v[46:47], v10 offset:17408
  v_exp_f32 v89, v89
  v_add_f32 v22, v22, v88
  v_cvt_pk_bf16_f32 v80, v80, v81
  v_mfma_f32_32x32x16_bf16 a[192:207], v[48:51], a[36:39], a[192:207]
  ds_read_b64_tr_b16 v[48:49], v7 offset:20480
  ds_read_b64_tr_b16 v[50:51], v7 offset:21504
  v_cvt_pk_bf16_f32 v81, v82, v83
  v_cvt_pk_bf16_f32 v82, v84, v85
  v_cvt_pk_bf16_f32 v83, v86, v87
  s_waitcnt lgkmcnt(6)
  v_mfma_f32_32x32x16_bf16 a[208:223], v[52:55], a[36:39], a[208:223]
  ds_read_b64_tr_b16 v[52:53], v8 offset:20480
  ds_read_b64_tr_b16 v[54:55], v8 offset:21504
  v_exp_f32 v90, v90
  v_add_f32 v23, v23, v89
  v_mfma_f32_32x32x16_bf16 a[160:175], v[56:59], a[40:43], a[160:175]
  ds_read_b64_tr_b16 v[56:57], v9 offset:20480
  ds_read_b64_tr_b16 v[58:59], v9 offset:21504
  v_exp_f32 v91, v91
  v_add_f32 v22, v22, v90
  v_mfma_f32_32x32x16_bf16 a[176:191], v[60:63], a[40:43], a[176:191]
  ds_read_b64_tr_b16 v[60:61], v10 offset:20480
  ds_read_b64_tr_b16 v[62:63], v10 offset:21504
  s_waitcnt vmcnt(27)
  s_barrier
  s_waitcnt lgkmcnt(6)
  v_mfma_f32_32x32x16_bf16 a[192:207], v[40:43], a[40:43], a[192:207]
  ds_read_b64_tr_b16 v[40:41], v5 offset:16384
  ds_read_b64_tr_b16 v[42:43], v5 offset:19456
  v_exp_f32 v92, v92
  v_add_f32 v23, v23, v91
  v_mfma_f32_32x32x16_bf16 a[208:223], v[44:47], a[40:43], a[208:223]
  ds_read_b64_tr_b16 v[44:45], v6 offset:16384
  ds_read_b64_tr_b16 v[46:47], v6 offset:19456
  v_exp_f32 v93, v93
  v_add_f32 v22, v22, v92
  v_mfma_f32_32x32x16_bf16 a[160:175], v[48:51], a[44:47], a[160:175]
  ds_read_b64_tr_b16 v[48:49], v5 offset:16512
  ds_read_b64_tr_b16 v[50:51], v5 offset:19584
  v_exp_f32 v94, v94
  v_add_f32 v23, v23, v93
  s_waitcnt lgkmcnt(6)
  v_mfma_f32_32x32x16_bf16 a[176:191], v[52:55], a[44:47], a[176:191]
  ds_read_b64_tr_b16 v[52:53], v6 offset:16512
  ds_read_b64_tr_b16 v[54:55], v6 offset:19584
  v_exp_f32 v95, v95
  v_add_f32 v22, v22, v94
  v_cvt_pk_bf16_f32 v88, v88, v89
  v_mfma_f32_32x32x16_bf16 a[192:207], v[56:59], a[44:47], a[192:207]
  ds_read_b64_tr_b16 v[56:57], v5 offset:16640
  ds_read_b64_tr_b16 v[58:59], v5 offset:19712
  v_add_f32 v23, v23, v95
  v_cvt_pk_bf16_f32 v89, v90, v91
  v_cvt_pk_bf16_f32 v90, v92, v93
  v_cvt_pk_bf16_f32 v91, v94, v95
  v_mfma_f32_32x32x16_bf16 a[208:223], v[60:63], a[44:47], a[208:223]
  ds_read_b64_tr_b16 v[60:61], v6 offset:16640
  ds_read_b64_tr_b16 v[62:63], v6 offset:19712
  s_cmp_lg_u32 s42, 0
  s_cbranch_scc1 LrB_119
LbB_120:
  s_waitcnt lgkmcnt(6)
  v_mfma_f32_32x32x16_bf16 v[160:175], v[40:43], v[80:83], v[160:175]
  ds_read_b64_tr_b16 v[40:41], v5 offset:22528
  ds_read_b64_tr_b16 v[42:43], v5 offset:25600
  v_mfma_f32_32x32x16_bf16 v[176:191], v[44:47], v[80:83], v[176:191]
  ds_read_b64_tr_b16 v[44:45], v6 offset:22528
  ds_read_b64_tr_b16 v[46:47], v6 offset:25600
  v_mfma_f32_32x32x16_bf16 v[192:207], v[48:51], v[80:83], v[192:207]
  ds_read_b64_tr_b16 v[48:49], v5 offset:22656
  ds_read_b64_tr_b16 v[50:51], v5 offset:25728
  s_waitcnt lgkmcnt(6)
  v_mfma_f32_32x32x16_bf16 v[208:223], v[52:55], v[80:83], v[208:223]
  ds_read_b64_tr_b16 v[52:53], v6 offset:22656
  ds_read_b64_tr_b16 v[54:55], v6 offset:25728
  v_mfma_f32_32x32x16_bf16 v[224:239], v[56:59], v[80:83], v[224:239]
  ds_read_b64_tr_b16 v[56:57], v5 offset:22784
  ds_read_b64_tr_b16 v[58:59], v5 offset:25856
  v_mfma_f32_32x32x16_bf16 v[240:255], v[60:63], v[80:83], v[240:255]
  ds_read_b64_tr_b16 v[60:61], v6 offset:22784
  ds_read_b64_tr_b16 v[62:63], v6 offset:25856
  v_add_u32 v72, 49152, v7
  v_add_u32 v73, 49152, v8
  v_add_u32 v74, 49152, v9
  v_add_u32 v75, 49152, v10
  v_add_u32 v76, 98304, v7
  v_add_u32 v77, 98304, v8
  v_add_u32 v78, 98304, v9
  v_add_u32 v79, 98304, v10
  s_waitcnt vmcnt(24)
  s_barrier
  s_mov_b32 s45, 62208
  s_waitcnt lgkmcnt(6)
  v_mfma_f32_32x32x16_bf16 v[160:175], v[40:43], v[88:91], v[160:175]
  ds_read_b64_tr_b16 v[40:41], v72 offset:24576
  ds_read_b64_tr_b16 v[42:43], v72 offset:25600
  s_add_u32 m0, s32, 12288
  s_nop 0
  buffer_load_dwordx4 v17, s[20:23], s45 offen offset:0 nt lds
  buffer_load_dwordx4 v18, s[20:23], s45 offen offset:1024 nt lds
  buffer_load_dwordx4 v19, s[20:23], s45 offen offset:2048 nt lds
  v_mfma_f32_32x32x16_bf16 v[176:191], v[44:47], v[88:91], v[176:191]
  ds_read_b64_tr_b16 v[44:45], v73 offset:24576
  ds_read_b64_tr_b16 v[46:47], v73 offset:25600
  v_mfma_f32_32x32x16_bf16 v[192:207], v[48:51], v[88:91], v[192:207]
  ds_read_b64_tr_b16 v[48:49], v74 offset:24576
  ds_read_b64_tr_b16 v[50:51], v74 offset:25600
  s_waitcnt lgkmcnt(6)
  v_mfma_f32_32x32x16_bf16 v[208:223], v[52:55], v[88:91], v[208:223]
  ds_read_b64_tr_b16 v[52:53], v75 offset:24576
  ds_read_b64_tr_b16 v[54:55], v75 offset:25600
  v_mfma_f32_32x32x16_bf16 v[224:239], v[56:59], v[88:91], v[224:239]
  ds_read_b64_tr_b16 v[56:57], v72 offset:28672
  ds_read_b64_tr_b16 v[58:59], v72 offset:29696
  v_mfma_f32_32x32x16_bf16 v[240:255], v[60:63], v[88:91], v[240:255]
  ds_read_b64_tr_b16 v[60:61], v73 offset:28672
  ds_read_b64_tr_b16 v[62:63], v73 offset:29696
  v_add_f32 v26, v22, v23
  v_mov_b32 v31, v26
  s_nop 1
  v_permlane32_swap_b32 v26, v31
  v_add_f32 v26, v26, v31
  v_max_f32 v26, 228737632, v26
  v_rcp_f32 v26, v26
  s_waitcnt lgkmcnt(6)
  v_mfma_f32_32x32x16_bf16 v[96:111], v[40:43], a[0:3], 0
  ds_read_b64_tr_b16 v[40:41], v74 offset:28672
  ds_read_b64_tr_b16 v[42:43], v74 offset:29696
  v_mfma_f32_32x32x16_bf16 v[112:127], v[44:47], a[0:3], 0
  ds_read_b64_tr_b16 v[44:45], v75 offset:28672
  ds_read_b64_tr_b16 v[46:47], v75 offset:29696
  v_mul_f32 v160, v160, v26
  v_mul_f32 v161, v161, v26
  v_cvt_pk_bf16_f32 v32, v160, v161
  v_accvgpr_write_b32 a48, v32
  v_mfma_f32_32x32x16_bf16 v[128:143], v[48:51], a[0:3], 0
  ds_read_b64_tr_b16 v[48:49], v72 offset:32768
  ds_read_b64_tr_b16 v[50:51], v72 offset:33792
  v_mul_f32 v162, v162, v26
  v_mul_f32 v163, v163, v26
  v_cvt_pk_bf16_f32 v33, v162, v163
  s_waitcnt lgkmcnt(6)
  v_mfma_f32_32x32x16_bf16 v[144:159], v[52:55], a[0:3], 0
  ds_read_b64_tr_b16 v[52:53], v73 offset:32768
  ds_read_b64_tr_b16 v[54:55], v73 offset:33792
  v_accvgpr_write_b32 a49, v33
  v_mul_f32 v164, v164, v26
  v_mul_f32 v165, v165, v26
  v_cvt_pk_bf16_f32 v34, v164, v165
  v_mfma_f32_32x32x16_bf16 v[96:111], v[56:59], a[4:7], v[96:111]
  ds_read_b64_tr_b16 v[56:57], v74 offset:32768
  ds_read_b64_tr_b16 v[58:59], v74 offset:33792
  v_accvgpr_write_b32 a50, v34
  v_mul_f32 v166, v166, v26
  v_mul_f32 v167, v167, v26
  v_cvt_pk_bf16_f32 v35, v166, v167
  v_mfma_f32_32x32x16_bf16 v[112:127], v[60:63], a[4:7], v[112:127]
  ds_read_b64_tr_b16 v[60:61], v75 offset:32768
  ds_read_b64_tr_b16 v[62:63], v75 offset:33792
  s_waitcnt vmcnt(24)
  s_barrier
  v_accvgpr_write_b32 a51, v35
  s_waitcnt lgkmcnt(6)
  v_mfma_f32_32x32x16_bf16 v[128:143], v[40:43], a[4:7], v[128:143]
  ds_read_b64_tr_b16 v[40:41], v7 offset:24576
  ds_read_b64_tr_b16 v[42:43], v7 offset:25600
  v_mul_f32 v168, v168, v26
  v_mul_f32 v169, v169, v26
  v_cvt_pk_bf16_f32 v32, v168, v169
  v_accvgpr_write_b32 a52, v32
  v_mfma_f32_32x32x16_bf16 v[144:159], v[44:47], a[4:7], v[144:159]
  ds_read_b64_tr_b16 v[44:45], v8 offset:24576
  ds_read_b64_tr_b16 v[46:47], v8 offset:25600
  v_mul_f32 v170, v170, v26
  v_mul_f32 v171, v171, v26
  v_cvt_pk_bf16_f32 v33, v170, v171
  v_accvgpr_write_b32 a53, v33
  v_mfma_f32_32x32x16_bf16 v[96:111], v[48:51], a[8:11], v[96:111]
  ds_read_b64_tr_b16 v[48:49], v9 offset:24576
  ds_read_b64_tr_b16 v[50:51], v9 offset:25600
  v_mul_f32 v172, v172, v26
  v_mul_f32 v173, v173, v26
  v_cvt_pk_bf16_f32 v34, v172, v173
  s_waitcnt lgkmcnt(6)
  v_mfma_f32_32x32x16_bf16 v[112:127], v[52:55], a[8:11], v[112:127]
  ds_read_b64_tr_b16 v[52:53], v10 offset:24576
  ds_read_b64_tr_b16 v[54:55], v10 offset:25600
  v_accvgpr_write_b32 a54, v34
  v_mul_f32 v174, v174, v26
  v_mul_f32 v175, v175, v26
  v_cvt_pk_bf16_f32 v35, v174, v175
  v_mfma_f32_32x32x16_bf16 v[128:143], v[56:59], a[8:11], v[128:143]
  ds_read_b64_tr_b16 v[56:57], v7 offset:28672
  ds_read_b64_tr_b16 v[58:59], v7 offset:29696
  v_accvgpr_write_b32 a55, v35
  v_mul_f32 v176, v176, v26
  v_mul_f32 v177, v177, v26
  v_cvt_pk_bf16_f32 v32, v176, v177
  v_mfma_f32_32x32x16_bf16 v[144:159], v[60:63], a[8:11], v[144:159]
  ds_read_b64_tr_b16 v[60:61], v8 offset:28672
  ds_read_b64_tr_b16 v[62:63], v8 offset:29696
  v_accvgpr_write_b32 a56, v32
  v_mul_f32 v178, v178, v26
  v_mul_f32 v179, v179, v26
  s_waitcnt lgkmcnt(6)
  v_mfma_f32_32x32x16_bf16 v[96:111], v[40:43], a[12:15], v[96:111]
  ds_read_b64_tr_b16 v[40:41], v9 offset:28672
  ds_read_b64_tr_b16 v[42:43], v9 offset:29696
  v_cvt_pk_bf16_f32 v33, v178, v179
  v_accvgpr_write_b32 a57, v33
  v_mul_f32 v180, v180, v26
  v_mul_f32 v181, v181, v26
  v_mfma_f32_32x32x16_bf16 v[112:127], v[44:47], a[12:15], v[112:127]
  ds_read_b64_tr_b16 v[44:45], v10 offset:28672
  ds_read_b64_tr_b16 v[46:47], v10 offset:29696
  v_cvt_pk_bf16_f32 v34, v180, v181
  v_accvgpr_write_b32 a58, v34
  v_mul_f32 v182, v182, v26
  v_mul_f32 v183, v183, v26
  v_mfma_f32_32x32x16_bf16 v[128:143], v[48:51], a[12:15], v[128:143]
  ds_read_b64_tr_b16 v[48:49], v7 offset:32768
  ds_read_b64_tr_b16 v[50:51], v7 offset:33792
  v_cvt_pk_bf16_f32 v35, v182, v183
  v_accvgpr_write_b32 a59, v35
  v_mul_f32 v184, v184, v26
  s_waitcnt lgkmcnt(6)
  v_mfma_f32_32x32x16_bf16 v[144:159], v[52:55], a[12:15], v[144:159]
  ds_read_b64_tr_b16 v[52:53], v8 offset:32768
  ds_read_b64_tr_b16 v[54:55], v8 offset:33792
  v_mul_f32 v185, v185, v26
  v_cvt_pk_bf16_f32 v32, v184, v185
  v_accvgpr_write_b32 a60, v32
  v_mul_f32 v186, v186, v26
  v_mfma_f32_32x32x16_bf16 v[96:111], v[56:59], a[16:19], v[96:111]
  ds_read_b64_tr_b16 v[56:57], v9 offset:32768
  ds_read_b64_tr_b16 v[58:59], v9 offset:33792
  v_mul_f32 v187, v187, v26
  v_cvt_pk_bf16_f32 v33, v186, v187
  v_accvgpr_write_b32 a61, v33
  v_mul_f32 v188, v188, v26
  v_mfma_f32_32x32x16_bf16 v[112:127], v[60:63], a[16:19], v[112:127]
  ds_read_b64_tr_b16 v[60:61], v10 offset:32768
  ds_read_b64_tr_b16 v[62:63], v10 offset:33792
  s_waitcnt vmcnt(21)
  s_barrier
  s_mov_b32 s44, 123648
  s_waitcnt lgkmcnt(6)
  v_mfma_f32_32x32x16_bf16 v[128:143], v[40:43], a[16:19], v[128:143]
  ds_read_b64_tr_b16 v[40:41], v76 offset:53248
  ds_read_b64_tr_b16 v[42:43], v76 offset:54272
  s_add_u32 m0, s32, 49152
  s_nop 0
  buffer_load_dwordx4 v17, s[20:23], s44 offen offset:0 nt lds
  buffer_load_dwordx4 v18, s[20:23], s44 offen offset:1024 nt lds
  buffer_load_dwordx4 v19, s[20:23], s44 offen offset:2048 nt lds
  v_mfma_f32_32x32x16_bf16 v[144:159], v[44:47], a[16:19], v[144:159]
  ds_read_b64_tr_b16 v[44:45], v77 offset:53248
  ds_read_b64_tr_b16 v[46:47], v77 offset:54272
  v_mul_f32 v189, v189, v26
  v_cvt_pk_bf16_f32 v34, v188, v189
  v_accvgpr_write_b32 a62, v34
  v_mul_f32 v190, v190, v26
  v_mfma_f32_32x32x16_bf16 v[96:111], v[48:51], a[20:23], v[96:111]
  ds_read_b64_tr_b16 v[48:49], v78 offset:53248
  ds_read_b64_tr_b16 v[50:51], v78 offset:54272
  v_mul_f32 v191, v191, v26
  v_cvt_pk_bf16_f32 v35, v190, v191
  v_accvgpr_write_b32 a63, v35
  s_waitcnt lgkmcnt(6)
  v_mfma_f32_32x32x16_bf16 v[112:127], v[52:55], a[20:23], v[112:127]
  ds_read_b64_tr_b16 v[52:53], v79 offset:53248
  ds_read_b64_tr_b16 v[54:55], v79 offset:54272
  v_mul_f32 v192, v192, v26
  v_mul_f32 v193, v193, v26
  v_cvt_pk_bf16_f32 v32, v192, v193
  v_accvgpr_write_b32 a64, v32
  v_mfma_f32_32x32x16_bf16 v[128:143], v[56:59], a[20:23], v[128:143]
  ds_read_b64_tr_b16 v[56:57], v76 offset:57344
  ds_read_b64_tr_b16 v[58:59], v76 offset:58368
  v_mul_f32 v194, v194, v26
  v_mul_f32 v195, v195, v26
  v_cvt_pk_bf16_f32 v33, v194, v195
  v_accvgpr_write_b32 a65, v33
  v_mfma_f32_32x32x16_bf16 v[144:159], v[60:63], a[20:23], v[144:159]
  ds_read_b64_tr_b16 v[60:61], v77 offset:57344
  ds_read_b64_tr_b16 v[62:63], v77 offset:58368
  v_mul_f32 v196, v196, v26
  v_mul_f32 v197, v197, v26
  v_cvt_pk_bf16_f32 v34, v196, v197
  s_waitcnt lgkmcnt(6)
  v_mfma_f32_32x32x16_bf16 v[96:111], v[40:43], a[24:27], v[96:111]
  ds_read_b64_tr_b16 v[40:41], v78 offset:57344
  ds_read_b64_tr_b16 v[42:43], v78 offset:58368
  v_accvgpr_write_b32 a66, v34
  v_mul_f32 v198, v198, v26
  v_mul_f32 v199, v199, v26
  v_cvt_pk_bf16_f32 v35, v198, v199
  v_mfma_f32_32x32x16_bf16 v[112:127], v[44:47], a[24:27], v[112:127]
  ds_read_b64_tr_b16 v[44:45], v79 offset:57344
  ds_read_b64_tr_b16 v[46:47], v79 offset:58368
  v_accvgpr_write_b32 a67, v35
  v_mul_f32 v200, v200, v26
  v_mul_f32 v201, v201, v26
  v_cvt_pk_bf16_f32 v32, v200, v201
  v_mfma_f32_32x32x16_bf16 v[128:143], v[48:51], a[24:27], v[128:143]
  ds_read_b64_tr_b16 v[48:49], v76 offset:61440
  ds_read_b64_tr_b16 v[50:51], v76 offset:62464
  v_accvgpr_write_b32 a68, v32
  v_mul_f32 v202, v202, v26
  v_mul_f32 v203, v203, v26
  s_waitcnt lgkmcnt(6)
  v_mfma_f32_32x32x16_bf16 v[144:159], v[52:55], a[24:27], v[144:159]
  ds_read_b64_tr_b16 v[52:53], v77 offset:61440
  ds_read_b64_tr_b16 v[54:55], v77 offset:62464
  v_cvt_pk_bf16_f32 v33, v202, v203
  v_accvgpr_write_b32 a69, v33
  v_mul_f32 v204, v204, v26
  v_mul_f32 v205, v205, v26
  v_mfma_f32_32x32x16_bf16 v[96:111], v[56:59], a[28:31], v[96:111]
  ds_read_b64_tr_b16 v[56:57], v78 offset:61440
  ds_read_b64_tr_b16 v[58:59], v78 offset:62464
  v_cvt_pk_bf16_f32 v34, v204, v205
  v_accvgpr_write_b32 a70, v34
  v_mul_f32 v206, v206, v26
  v_mul_f32 v207, v207, v26
  v_mfma_f32_32x32x16_bf16 v[112:127], v[60:63], a[28:31], v[112:127]
  ds_read_b64_tr_b16 v[60:61], v79 offset:61440
  ds_read_b64_tr_b16 v[62:63], v79 offset:62464
  s_waitcnt vmcnt(21)
  s_barrier
  s_mov_b32 s45, 185088
  s_waitcnt lgkmcnt(6)
  v_mfma_f32_32x32x16_bf16 v[128:143], v[40:43], a[28:31], v[128:143]
  ds_read_b64_tr_b16 v[40:41], v72 offset:36864
  ds_read_b64_tr_b16 v[42:43], v72 offset:37888
  s_add_u32 m0, s32, 24576
  s_nop 0
  buffer_load_dwordx4 v17, s[20:23], s45 offen offset:0 nt lds
  buffer_load_dwordx4 v18, s[20:23], s45 offen offset:1024 nt lds
  buffer_load_dwordx4 v19, s[20:23], s45 offen offset:2048 nt lds
  v_mfma_f32_32x32x16_bf16 v[144:159], v[44:47], a[28:31], v[144:159]
  ds_read_b64_tr_b16 v[44:45], v73 offset:36864
  ds_read_b64_tr_b16 v[46:47], v73 offset:37888
  v_cvt_pk_bf16_f32 v35, v206, v207
  v_accvgpr_write_b32 a71, v35
  v_mul_f32 v208, v208, v26
  v_mul_f32 v209, v209, v26
  v_mfma_f32_32x32x16_bf16 v[96:111], v[48:51], a[32:35], v[96:111]
  ds_read_b64_tr_b16 v[48:49], v74 offset:36864
  ds_read_b64_tr_b16 v[50:51], v74 offset:37888
  v_cvt_pk_bf16_f32 v32, v208, v209
  v_accvgpr_write_b32 a72, v32
  v_mul_f32 v210, v210, v26
  s_waitcnt lgkmcnt(6)
  v_mfma_f32_32x32x16_bf16 v[112:127], v[52:55], a[32:35], v[112:127]
  ds_read_b64_tr_b16 v[52:53], v75 offset:36864
  ds_read_b64_tr_b16 v[54:55], v75 offset:37888
  v_mul_f32 v211, v211, v26
  v_cvt_pk_bf16_f32 v33, v210, v211
  v_accvgpr_write_b32 a73, v33
  v_mul_f32 v212, v212, v26
  v_mfma_f32_32x32x16_bf16 v[128:143], v[56:59], a[32:35], v[128:143]
  ds_read_b64_tr_b16 v[56:57], v72 offset:40960
  ds_read_b64_tr_b16 v[58:59], v72 offset:41984
  v_mul_f32 v213, v213, v26
  v_cvt_pk_bf16_f32 v34, v212, v213
  v_accvgpr_write_b32 a74, v34
  v_mul_f32 v214, v214, v26
  v_mfma_f32_32x32x16_bf16 v[144:159], v[60:63], a[32:35], v[144:159]
  ds_read_b64_tr_b16 v[60:61], v73 offset:40960
  ds_read_b64_tr_b16 v[62:63], v73 offset:41984
  v_mul_f32 v215, v215, v26
  v_cvt_pk_bf16_f32 v35, v214, v215
  v_accvgpr_write_b32 a75, v35
  s_waitcnt lgkmcnt(6)
  v_mfma_f32_32x32x16_bf16 v[96:111], v[40:43], a[36:39], v[96:111]
  ds_read_b64_tr_b16 v[40:41], v74 offset:40960
  ds_read_b64_tr_b16 v[42:43], v74 offset:41984
  v_mul_f32 v216, v216, v26
  v_mul_f32 v217, v217, v26
  v_cvt_pk_bf16_f32 v32, v216, v217
  v_accvgpr_write_b32 a76, v32
  v_mfma_f32_32x32x16_bf16 v[112:127], v[44:47], a[36:39], v[112:127]
  ds_read_b64_tr_b16 v[44:45], v75 offset:40960
  ds_read_b64_tr_b16 v[46:47], v75 offset:41984
  v_mul_f32 v218, v218, v26
  v_mul_f32 v219, v219, v26
  v_cvt_pk_bf16_f32 v33, v218, v219
  v_accvgpr_write_b32 a77, v33
  v_mfma_f32_32x32x16_bf16 v[128:143], v[48:51], a[36:39], v[128:143]
  ds_read_b64_tr_b16 v[48:49], v72 offset:45056
  ds_read_b64_tr_b16 v[50:51], v72 offset:46080
  v_mul_f32 v220, v220, v26
  v_mul_f32 v221, v221, v26
  v_cvt_pk_bf16_f32 v34, v220, v221
  s_waitcnt lgkmcnt(6)
  v_mfma_f32_32x32x16_bf16 v[144:159], v[52:55], a[36:39], v[144:159]
  ds_read_b64_tr_b16 v[52:53], v73 offset:45056
  ds_read_b64_tr_b16 v[54:55], v73 offset:46080
  v_accvgpr_write_b32 a78, v34
  v_mul_f32 v222, v222, v26
  v_mul_f32 v223, v223, v26
  v_cvt_pk_bf16_f32 v35, v222, v223
  v_mfma_f32_32x32x16_bf16 v[96:111], v[56:59], a[40:43], v[96:111]
  ds_read_b64_tr_b16 v[56:57], v74 offset:45056
  ds_read_b64_tr_b16 v[58:59], v74 offset:46080
  v_accvgpr_write_b32 a79, v35
  v_mul_f32 v224, v224, v26
  v_mul_f32 v225, v225, v26
  v_cvt_pk_bf16_f32 v32, v224, v225
  v_mfma_f32_32x32x16_bf16 v[112:127], v[60:63], a[40:43], v[112:127]
  ds_read_b64_tr_b16 v[60:61], v75 offset:45056
  ds_read_b64_tr_b16 v[62:63], v75 offset:46080
  s_waitcnt vmcnt(21)
  s_barrier
  s_mov_b32 s44, 246528
  s_waitcnt lgkmcnt(6)
  v_mfma_f32_32x32x16_bf16 v[128:143], v[40:43], a[40:43], v[128:143]
  ds_read_b64_tr_b16 v[40:41], v72 offset:12288
  ds_read_b64_tr_b16 v[42:43], v72 offset:13312
  s_add_u32 m0, s32, 73728
  s_nop 0
  buffer_load_dwordx4 v17, s[20:23], s44 offen offset:0 nt lds
  buffer_load_dwordx4 v18, s[20:23], s44 offen offset:1024 nt lds
  buffer_load_dwordx4 v19, s[20:23], s44 offen offset:2048 nt lds
  v_mfma_f32_32x32x16_bf16 v[144:159], v[44:47], a[40:43], v[144:159]
  ds_read_b64_tr_b16 v[44:45], v73 offset:12288
  ds_read_b64_tr_b16 v[46:47], v73 offset:13312
  v_accvgpr_write_b32 a80, v32
  v_mul_f32 v226, v226, v26
  v_mul_f32 v227, v227, v26
  v_cvt_pk_bf16_f32 v33, v226, v227
  v_mfma_f32_32x32x16_bf16 v[96:111], v[48:51], a[44:47], v[96:111]
  ds_read_b64_tr_b16 v[48:49], v74 offset:12288
  ds_read_b64_tr_b16 v[50:51], v74 offset:13312
  v_accvgpr_write_b32 a81, v33
  v_mul_f32 v228, v228, v26
  v_mul_f32 v229, v229, v26
  s_waitcnt lgkmcnt(6)
  v_mfma_f32_32x32x16_bf16 v[112:127], v[52:55], a[44:47], v[112:127]
  ds_read_b64_tr_b16 v[52:53], v75 offset:12288
  ds_read_b64_tr_b16 v[54:55], v75 offset:13312
  v_cvt_pk_bf16_f32 v34, v228, v229
  v_accvgpr_write_b32 a82, v34
  v_mul_f32 v230, v230, v26
  v_mul_f32 v231, v231, v26
  v_mfma_f32_32x32x16_bf16 v[128:143], v[56:59], a[44:47], v[128:143]
  ds_read_b64_tr_b16 v[56:57], v72 offset:16384
  ds_read_b64_tr_b16 v[58:59], v72 offset:17408
  v_cvt_pk_bf16_f32 v35, v230, v231
  v_accvgpr_write_b32 a83, v35
  v_mul_f32 v232, v232, v26
  v_mul_f32 v233, v233, v26
  v_mfma_f32_32x32x16_bf16 v[144:159], v[60:63], a[44:47], v[144:159]
  ds_read_b64_tr_b16 v[60:61], v73 offset:16384
  ds_read_b64_tr_b16 v[62:63], v73 offset:17408
  v_cvt_pk_bf16_f32 v32, v232, v233
  v_accvgpr_write_b32 a84, v32
  v_mul_f32 v234, v234, v26
  v_mul_f32 v235, v235, v26
  v_cvt_pk_bf16_f32 v33, v234, v235
  v_accvgpr_write_b32 a85, v33
  v_mul_f32 v236, v236, v26
  v_mul_f32 v237, v237, v26
  v_cvt_pk_bf16_f32 v34, v236, v237
  v_accvgpr_write_b32 a86, v34
  v_mul_f32 v238, v238, v26
  v_mul_f32 v239, v239, v26
  v_cvt_pk_bf16_f32 v35, v238, v239
  v_accvgpr_write_b32 a87, v35
  v_mul_f32 v240, v240, v26
  v_mul_f32 v241, v241, v26
  v_cvt_pk_bf16_f32 v32, v240, v241
  v_accvgpr_write_b32 a88, v32
  v_mul_f32 v242, v242, v26
  v_mul_f32 v243, v243, v26
  v_cvt_pk_bf16_f32 v33, v242, v243
  v_accvgpr_write_b32 a89, v33
  v_mul_f32 v244, v244, v26
  v_mul_f32 v245, v245, v26
  v_cvt_pk_bf16_f32 v34, v244, v245
  v_accvgpr_write_b32 a90, v34
  v_mul_f32 v246, v246, v26
  v_mul_f32 v247, v247, v26
  v_cvt_pk_bf16_f32 v35, v246, v247
  v_accvgpr_write_b32 a91, v35
  v_mul_f32 v248, v248, v26
  v_mul_f32 v249, v249, v26
  v_cvt_pk_bf16_f32 v32, v248, v249
  v_accvgpr_write_b32 a92, v32
  v_mul_f32 v250, v250, v26
  v_mul_f32 v251, v251, v26
  v_cvt_pk_bf16_f32 v33, v250, v251
  v_accvgpr_write_b32 a93, v33
  v_mul_f32 v252, v252, v26
  v_mul_f32 v253, v253, v26
  v_cvt_pk_bf16_f32 v34, v252, v253
  v_accvgpr_write_b32 a94, v34
  v_mul_f32 v254, v254, v26
  v_mul_f32 v255, v255, v26
  v_cvt_pk_bf16_f32 v35, v254, v255
  v_accvgpr_write_b32 a95, v35
  s_waitcnt lgkmcnt(6)
  v_mfma_f32_32x32x16_bf16 v[96:111], v[40:43], a[48:51], v[96:111]
  ds_read_b64_tr_b16 v[40:41], v74 offset:16384
  ds_read_b64_tr_b16 v[42:43], v74 offset:17408
  v_mfma_f32_32x32x16_bf16 v[112:127], v[44:47], a[48:51], v[112:127]
  ds_read_b64_tr_b16 v[44:45], v75 offset:16384
  ds_read_b64_tr_b16 v[46:47], v75 offset:17408
  v_mfma_f32_32x32x16_bf16 v[128:143], v[48:51], a[48:51], v[128:143]
  ds_read_b64_tr_b16 v[48:49], v72 offset:20480
  ds_read_b64_tr_b16 v[50:51], v72 offset:21504
  s_waitcnt lgkmcnt(6)
  v_mfma_f32_32x32x16_bf16 v[144:159], v[52:55], a[48:51], v[144:159]
  ds_read_b64_tr_b16 v[52:53], v73 offset:20480
  ds_read_b64_tr_b16 v[54:55], v73 offset:21504
  v_mfma_f32_32x32x16_bf16 v[96:111], v[56:59], a[52:55], v[96:111]
  ds_read_b64_tr_b16 v[56:57], v74 offset:20480
  ds_read_b64_tr_b16 v[58:59], v74 offset:21504
  v_mfma_f32_32x32x16_bf16 v[112:127], v[60:63], a[52:55], v[112:127]
  ds_read_b64_tr_b16 v[60:61], v75 offset:20480
  ds_read_b64_tr_b16 v[62:63], v75 offset:21504
  s_waitcnt vmcnt(21)
  s_barrier
  s_mov_b32 s45, 307968
  s_waitcnt lgkmcnt(6)
  v_mfma_f32_32x32x16_bf16 v[128:143], v[40:43], a[52:55], v[128:143]
  ds_read_b64_tr_b16 v[40:41], v76 offset:40960
  ds_read_b64_tr_b16 v[42:43], v76 offset:41984
  s_add_u32 m0, s32, 86016
  s_nop 0
  buffer_load_dwordx4 v17, s[20:23], s45 offen offset:0 nt lds
  buffer_load_dwordx4 v18, s[20:23], s45 offen offset:1024 nt lds
  buffer_load_dwordx4 v19, s[20:23], s45 offen offset:2048 nt lds
  v_mfma_f32_32x32x16_bf16 v[144:159], v[44:47], a[52:55], v[144:159]
  ds_read_b64_tr_b16 v[44:45], v77 offset:40960
  ds_read_b64_tr_b16 v[46:47], v77 offset:41984
  v_mfma_f32_32x32x16_bf16 v[96:111], v[48:51], a[56:59], v[96:111]
  ds_read_b64_tr_b16 v[48:49], v78 offset:40960
  ds_read_b64_tr_b16 v[50:51], v78 offset:41984
  s_waitcnt lgkmcnt(6)
  v_mfma_f32_32x32x16_bf16 v[112:127], v[52:55], a[56:59], v[112:127]
  ds_read_b64_tr_b16 v[52:53], v79 offset:40960
  ds_read_b64_tr_b16 v[54:55], v79 offset:41984
  v_mfma_f32_32x32x16_bf16 v[128:143], v[56:59], a[56:59], v[128:143]
  ds_read_b64_tr_b16 v[56:57], v76 offset:45056
  ds_read_b64_tr_b16 v[58:59], v76 offset:46080
  v_mfma_f32_32x32x16_bf16 v[144:159], v[60:63], a[56:59], v[144:159]
  ds_read_b64_tr_b16 v[60:61], v77 offset:45056
  ds_read_b64_tr_b16 v[62:63], v77 offset:46080
  s_waitcnt lgkmcnt(6)
  v_mfma_f32_32x32x16_bf16 v[96:111], v[40:43], a[60:63], v[96:111]
  ds_read_b64_tr_b16 v[40:41], v78 offset:45056
  ds_read_b64_tr_b16 v[42:43], v78 offset:46080
  v_mfma_f32_32x32x16_bf16 v[112:127], v[44:47], a[60:63], v[112:127]
  ds_read_b64_tr_b16 v[44:45], v79 offset:45056
  ds_read_b64_tr_b16 v[46:47], v79 offset:46080
  v_mfma_f32_32x32x16_bf16 v[128:143], v[48:51], a[60:63], v[128:143]
  ds_read_b64_tr_b16 v[48:49], v76 offset:49152
  ds_read_b64_tr_b16 v[50:51], v76 offset:50176
  s_waitcnt lgkmcnt(6)
  v_mfma_f32_32x32x16_bf16 v[144:159], v[52:55], a[60:63], v[144:159]
  ds_read_b64_tr_b16 v[52:53], v77 offset:49152
  ds_read_b64_tr_b16 v[54:55], v77 offset:50176
  v_mfma_f32_32x32x16_bf16 v[96:111], v[56:59], a[64:67], v[96:111]
  ds_read_b64_tr_b16 v[56:57], v78 offset:49152
  ds_read_b64_tr_b16 v[58:59], v78 offset:50176
  v_mfma_f32_32x32x16_bf16 v[112:127], v[60:63], a[64:67], v[112:127]
  ds_read_b64_tr_b16 v[60:61], v79 offset:49152
  ds_read_b64_tr_b16 v[62:63], v79 offset:50176
  s_waitcnt vmcnt(21)
  s_barrier
  s_mov_b32 s44, 369408
  s_waitcnt lgkmcnt(6)
  v_mfma_f32_32x32x16_bf16 v[128:143], v[40:43], a[64:67], v[128:143]
  ds_read_b64_tr_b16 v[40:41], v7 offset:36864
  ds_read_b64_tr_b16 v[42:43], v7 offset:37888
  s_add_u32 m0, s32, 61440
  s_nop 0
  buffer_load_dwordx4 v17, s[20:23], s44 offen offset:0 nt lds
  buffer_load_dwordx4 v18, s[20:23], s44 offen offset:1024 nt lds
  buffer_load_dwordx4 v19, s[20:23], s44 offen offset:2048 nt lds
  v_mfma_f32_32x32x16_bf16 v[144:159], v[44:47], a[64:67], v[144:159]
  ds_read_b64_tr_b16 v[44:45], v8 offset:36864
  ds_read_b64_tr_b16 v[46:47], v8 offset:37888
  v_mfma_f32_32x32x16_bf16 v[96:111], v[48:51], a[68:71], v[96:111]
  ds_read_b64_tr_b16 v[48:49], v9 offset:36864
  ds_read_b64_tr_b16 v[50:51], v9 offset:37888
  s_waitcnt lgkmcnt(6)
  v_mfma_f32_32x32x16_bf16 v[112:127], v[52:55], a[68:71], v[112:127]
  ds_read_b64_tr_b16 v[52:53], v10 offset:36864
  ds_read_b64_tr_b16 v[54:55], v10 offset:37888
  v_mfma_f32_32x32x16_bf16 v[128:143], v[56:59], a[68:71], v[128:143]
  ds_read_b64_tr_b16 v[56:57], v7 offset:40960
  ds_read_b64_tr_b16 v[58:59], v7 offset:41984
  v_mfma_f32_32x32x16_bf16 v[144:159], v[60:63], a[68:71], v[144:159]
  ds_read_b64_tr_b16 v[60:61], v8 offset:40960
  ds_read_b64_tr_b16 v[62:63], v8 offset:41984
  s_waitcnt lgkmcnt(6)
  v_mfma_f32_32x32x16_bf16 v[96:111], v[40:43], a[72:75], v[96:111]
  ds_read_b64_tr_b16 v[40:41], v9 offset:40960
  ds_read_b64_tr_b16 v[42:43], v9 offset:41984
  v_mfma_f32_32x32x16_bf16 v[112:127], v[44:47], a[72:75], v[112:127]
  ds_read_b64_tr_b16 v[44:45], v10 offset:40960
  ds_read_b64_tr_b16 v[46:47], v10 offset:41984
  v_mfma_f32_32x32x16_bf16 v[128:143], v[48:51], a[72:75], v[128:143]
  ds_read_b64_tr_b16 v[48:49], v7 offset:45056
  ds_read_b64_tr_b16 v[50:51], v7 offset:46080
  s_waitcnt lgkmcnt(6)
  v_mfma_f32_32x32x16_bf16 v[144:159], v[52:55], a[72:75], v[144:159]
  ds_read_b64_tr_b16 v[52:53], v8 offset:45056
  ds_read_b64_tr_b16 v[54:55], v8 offset:46080
  v_mfma_f32_32x32x16_bf16 v[96:111], v[56:59], a[76:79], v[96:111]
  ds_read_b64_tr_b16 v[56:57], v9 offset:45056
  ds_read_b64_tr_b16 v[58:59], v9 offset:46080
  v_mfma_f32_32x32x16_bf16 v[112:127], v[60:63], a[76:79], v[112:127]
  ds_read_b64_tr_b16 v[60:61], v10 offset:45056
  ds_read_b64_tr_b16 v[62:63], v10 offset:46080
  s_waitcnt vmcnt(21)
  s_barrier
  s_mov_b32 s45, 430848
  s_waitcnt lgkmcnt(6)
  v_mfma_f32_32x32x16_bf16 v[128:143], v[40:43], a[76:79], v[128:143]
  ds_read_b64_tr_b16 v[40:41], v7 offset:0
  ds_read_b64_tr_b16 v[42:43], v7 offset:1024
  s_add_u32 m0, s32, 98304
  s_nop 0
  buffer_load_dwordx4 v17, s[20:23], s45 offen offset:0 nt lds
  buffer_load_dwordx4 v18, s[20:23], s45 offen offset:1024 nt lds
  buffer_load_dwordx4 v19, s[20:23], s45 offen offset:2048 nt lds
  v_mfma_f32_32x32x16_bf16 v[144:159], v[44:47], a[76:79], v[144:159]
  ds_read_b64_tr_b16 v[44:45], v8 offset:0
  ds_read_b64_tr_b16 v[46:47], v8 offset:1024
  v_mfma_f32_32x32x16_bf16 v[96:111], v[48:51], a[80:83], v[96:111]
  ds_read_b64_tr_b16 v[48:49], v9 offset:0
  ds_read_b64_tr_b16 v[50:51], v9 offset:1024
  s_waitcnt lgkmcnt(6)
  v_mfma_f32_32x32x16_bf16 v[112:127], v[52:55], a[80:83], v[112:127]
  ds_read_b64_tr_b16 v[52:53], v10 offset:0
  ds_read_b64_tr_b16 v[54:55], v10 offset:1024
  v_mfma_f32_32x32x16_bf16 v[128:143], v[56:59], a[80:83], v[128:143]
  ds_read_b64_tr_b16 v[56:57], v7 offset:4096
  ds_read_b64_tr_b16 v[58:59], v7 offset:5120
  v_mfma_f32_32x32x16_bf16 v[144:159], v[60:63], a[80:83], v[144:159]
  ds_read_b64_tr_b16 v[60:61], v8 offset:4096
  ds_read_b64_tr_b16 v[62:63], v8 offset:5120
  s_waitcnt lgkmcnt(6)
  v_mfma_f32_32x32x16_bf16 v[96:111], v[40:43], a[84:87], v[96:111]
  ds_read_b64_tr_b16 v[40:41], v9 offset:4096
  ds_read_b64_tr_b16 v[42:43], v9 offset:5120
  v_mfma_f32_32x32x16_bf16 v[112:127], v[44:47], a[84:87], v[112:127]
  ds_read_b64_tr_b16 v[44:45], v10 offset:4096
  ds_read_b64_tr_b16 v[46:47], v10 offset:5120
  v_mfma_f32_32x32x16_bf16 v[128:143], v[48:51], a[84:87], v[128:143]
  ds_read_b64_tr_b16 v[48:49], v7 offset:8192
  ds_read_b64_tr_b16 v[50:51], v7 offset:9216
  s_waitcnt lgkmcnt(6)
  v_mfma_f32_32x32x16_bf16 v[144:159], v[52:55], a[84:87], v[144:159]
  ds_read_b64_tr_b16 v[52:53], v8 offset:8192
  ds_read_b64_tr_b16 v[54:55], v8 offset:9216
  v_mfma_f32_32x32x16_bf16 v[96:111], v[56:59], a[88:91], v[96:111]
  ds_read_b64_tr_b16 v[56:57], v9 offset:8192
  ds_read_b64_tr_b16 v[58:59], v9 offset:9216
  v_mfma_f32_32x32x16_bf16 v[112:127], v[60:63], a[88:91], v[112:127]
  ds_read_b64_tr_b16 v[60:61], v10 offset:8192
  ds_read_b64_tr_b16 v[62:63], v10 offset:9216
  s_waitcnt vmcnt(21)
  s_barrier
  s_mov_b32 s44, 1024
  s_waitcnt lgkmcnt(6)
  v_mfma_f32_32x32x16_bf16 v[128:143], v[40:43], a[88:91], v[128:143]
  ds_read_b64_tr_b16 v[40:41], v76 offset:28672
  ds_read_b64_tr_b16 v[42:43], v76 offset:29696
  s_add_u32 m0, s32, 36864
  s_nop 0
  buffer_load_dwordx4 v17, s[20:23], s44 offen offset:0 nt lds
  buffer_load_dwordx4 v18, s[20:23], s44 offen offset:1024 nt lds
  buffer_load_dwordx4 v19, s[20:23], s44 offen offset:2048 nt lds
  v_mfma_f32_32x32x16_bf16 v[144:159], v[44:47], a[88:91], v[144:159]
  ds_read_b64_tr_b16 v[44:45], v77 offset:28672
  ds_read_b64_tr_b16 v[46:47], v77 offset:29696
  v_mfma_f32_32x32x16_bf16 v[96:111], v[48:51], a[92:95], v[96:111]
  ds_read_b64_tr_b16 v[48:49], v78 offset:28672
  ds_read_b64_tr_b16 v[50:51], v78 offset:29696
  s_waitcnt lgkmcnt(6)
  v_mfma_f32_32x32x16_bf16 v[112:127], v[52:55], a[92:95], v[112:127]
  ds_read_b64_tr_b16 v[52:53], v79 offset:28672
  ds_read_b64_tr_b16 v[54:55], v79 offset:29696
  v_mfma_f32_32x32x16_bf16 v[128:143], v[56:59], a[92:95], v[128:143]
  ds_read_b64_tr_b16 v[56:57], v76 offset:32768
  ds_read_b64_tr_b16 v[58:59], v76 offset:33792
  v_mfma_f32_32x32x16_bf16 v[144:159], v[60:63], a[92:95], v[144:159]
  ds_read_b64_tr_b16 v[60:61], v77 offset:32768
  ds_read_b64_tr_b16 v[62:63], v77 offset:33792
  s_waitcnt lgkmcnt(6)
  v_mfma_f32_32x32x16_bf16 v[160:175], v[40:43], a[0:3], 0
  ds_read_b64_tr_b16 v[40:41], v78 offset:32768
  ds_read_b64_tr_b16 v[42:43], v78 offset:33792
  v_mfma_f32_32x32x16_bf16 v[176:191], v[44:47], a[0:3], 0
  ds_read_b64_tr_b16 v[44:45], v79 offset:32768
  ds_read_b64_tr_b16 v[46:47], v79 offset:33792
  v_cvt_pk_bf16_f32 v96, v96, v97
  v_cvt_pk_bf16_f32 v97, v98, v99
  v_cvt_pk_bf16_f32 v98, v100, v101
  v_cvt_pk_bf16_f32 v99, v102, v103
  v_mfma_f32_32x32x16_bf16 v[192:207], v[48:51], a[0:3], 0
  ds_read_b64_tr_b16 v[48:49], v76 offset:36864
  ds_read_b64_tr_b16 v[50:51], v76 offset:37888
  s_mov_b32 s46, 16384
  buffer_store_dwordx4 v[96:99], v25, s[24:27], s46 offen
  v_cvt_pk_bf16_f32 v104, v104, v105
  s_waitcnt lgkmcnt(6)
  v_mfma_f32_32x32x16_bf16 v[208:223], v[52:55], a[0:3], 0
  ds_read_b64_tr_b16 v[52:53], v77 offset:36864
  ds_read_b64_tr_b16 v[54:55], v77 offset:37888
  v_cvt_pk_bf16_f32 v105, v106, v107
  v_cvt_pk_bf16_f32 v106, v108, v109
  v_cvt_pk_bf16_f32 v107, v110, v111
  v_mfma_f32_32x32x16_bf16 v[160:175], v[56:59], a[4:7], v[160:175]
  ds_read_b64_tr_b16 v[56:57], v78 offset:36864
  ds_read_b64_tr_b16 v[58:59], v78 offset:37888
  s_mov_b32 s46, 17408
  buffer_store_dwordx4 v[104:107], v25, s[24:27], s46 offen
  v_cvt_pk_bf16_f32 v112, v112, v113
  v_cvt_pk_bf16_f32 v113, v114, v115
  v_mfma_f32_32x32x16_bf16 v[176:191], v[60:63], a[4:7], v[176:191]
  ds_read_b64_tr_b16 v[60:61], v79 offset:36864
  ds_read_b64_tr_b16 v[62:63], v79 offset:37888
  s_waitcnt vmcnt(23)
  s_barrier
  s_mov_b32 s45, 62464
  s_waitcnt lgkmcnt(6)
  v_mfma_f32_32x32x16_bf16 v[192:207], v[40:43], a[4:7], v[192:207]
  ds_read_b64_tr_b16 v[40:41], v7 offset:12288
  ds_read_b64_tr_b16 v[42:43], v7 offset:13312
  s_add_u32 m0, s32, 0
  s_nop 0
  buffer_load_dwordx4 v17, s[20:23], s45 offen offset:0 nt lds
  buffer_load_dwordx4 v18, s[20:23], s45 offen offset:1024 nt lds
  buffer_load_dwordx4 v19, s[20:23], s45 offen offset:2048 nt lds
  v_mfma_f32_32x32x16_bf16 v[208:223], v[44:47], a[4:7], v[208:223]
  ds_read_b64_tr_b16 v[44:45], v8 offset:12288
  ds_read_b64_tr_b16 v[46:47], v8 offset:13312
  v_cvt_pk_bf16_f32 v114, v116, v117
  v_cvt_pk_bf16_f32 v115, v118, v119
  s_mov_b32 s46, 18432
  buffer_store_dwordx4 v[112:115], v25, s[24:27], s46 offen
  v_mfma_f32_32x32x16_bf16 v[160:175], v[48:51], a[8:11], v[160:175]
  ds_read_b64_tr_b16 v[48:49], v9 offset:12288
  ds_read_b64_tr_b16 v[50:51], v9 offset:13312
  v_cvt_pk_bf16_f32 v120, v120, v121
  v_cvt_pk_bf16_f32 v121, v122, v123
  v_cvt_pk_bf16_f32 v122, v124, v125
  s_waitcnt lgkmcnt(6)
  v_mfma_f32_32x32x16_bf16 v[176:191], v[52:55], a[8:11], v[176:191]
  ds_read_b64_tr_b16 v[52:53], v10 offset:12288
  ds_read_b64_tr_b16 v[54:55], v10 offset:13312
  v_cvt_pk_bf16_f32 v123, v126, v127
  s_mov_b32 s46, 19456
  buffer_store_dwordx4 v[120:123], v25, s[24:27], s46 offen
  v_cvt_pk_bf16_f32 v128, v128, v129
  v_mfma_f32_32x32x16_bf16 v[192:207], v[56:59], a[8:11], v[192:207]
  ds_read_b64_tr_b16 v[56:57], v7 offset:16384
  ds_read_b64_tr_b16 v[58:59], v7 offset:17408
  v_cvt_pk_bf16_f32 v129, v130, v131
  v_cvt_pk_bf16_f32 v130, v132, v133
  v_cvt_pk_bf16_f32 v131, v134, v135
  v_mfma_f32_32x32x16_bf16 v[208:223], v[60:63], a[8:11], v[208:223]
  ds_read_b64_tr_b16 v[60:61], v8 offset:16384
  ds_read_b64_tr_b16 v[62:63], v8 offset:17408
  s_mov_b32 s46, 20480
  buffer_store_dwordx4 v[128:131], v25, s[24:27], s46 offen
  v_cvt_pk_bf16_f32 v136, v136, v137
  s_waitcnt lgkmcnt(6)
  v_mfma_f32_32x32x16_bf16 v[160:175], v[40:43], a[12:15], v[160:175]
  ds_read_b64_tr_b16 v[40:41], v9 offset:16384
  ds_read_b64_tr_b16 v[42:43], v9 offset:17408
  v_cvt_pk_bf16_f32 v137, v138, v139
  v_cvt_pk_bf16_f32 v138, v140, v141
  v_cvt_pk_bf16_f32 v139, v142, v143
  v_mfma_f32_32x32x16_bf16 v[176:191], v[44:47], a[12:15], v[176:191]
  ds_read_b64_tr_b16 v[44:45], v10 offset:16384
  ds_read_b64_tr_b16 v[46:47], v10 offset:17408
  s_mov_b32 s46, 21504
  buffer_store_dwordx4 v[136:139], v25, s[24:27], s46 offen
  v_cvt_pk_bf16_f32 v144, v144, v145
  v_cvt_pk_bf16_f32 v145, v146, v147
  v_mfma_f32_32x32x16_bf16 v[192:207], v[48:51], a[12:15], v[192:207]
  ds_read_b64_tr_b16 v[48:49], v7 offset:20480
  ds_read_b64_tr_b16 v[50:51], v7 offset:21504
  v_cvt_pk_bf16_f32 v146, v148, v149
  v_cvt_pk_bf16_f32 v147, v150, v151
  s_waitcnt lgkmcnt(6)
  v_mfma_f32_32x32x16_bf16 v[208:223], v[52:55], a[12:15], v[208:223]
  ds_read_b64_tr_b16 v[52:53], v8 offset:20480
  ds_read_b64_tr_b16 v[54:55], v8 offset:21504
  s_mov_b32 s46, 22528
  buffer_store_dwordx4 v[144:147], v25, s[24:27], s46 offen
  v_cvt_pk_bf16_f32 v152, v152, v153
  v_cvt_pk_bf16_f32 v153, v154, v155
  v_mfma_f32_32x32x16_bf16 v[160:175], v[56:59], a[16:19], v[160:175]
  ds_read_b64_tr_b16 v[56:57], v9 offset:20480
  ds_read_b64_tr_b16 v[58:59], v9 offset:21504
  v_cvt_pk_bf16_f32 v154, v156, v157
  v_cvt_pk_bf16_f32 v155, v158, v159
  s_mov_b32 s46, 23552
  buffer_store_dwordx4 v[152:155], v25, s[24:27], s46 offen
  v_mfma_f32_32x32x16_bf16 v[176:191], v[60:63], a[16:19], v[176:191]
  ds_read_b64_tr_b16 v[60:61], v10 offset:20480
  ds_read_b64_tr_b16 v[62:63], v10 offset:21504
  s_waitcnt vmcnt(29)
  s_barrier
  s_mov_b32 s44, 123904
  s_waitcnt lgkmcnt(6)
  v_mfma_f32_32x32x16_bf16 v[192:207], v[40:43], a[16:19], v[192:207]
  ds_read_b64_tr_b16 v[40:41], v7 offset:49152
  ds_read_b64_tr_b16 v[42:43], v7 offset:50176
  s_add_u32 m0, s32, 110592
  s_nop 0
  buffer_load_dwordx4 v17, s[20:23], s44 offen offset:0 nt lds
  buffer_load_dwordx4 v18, s[20:23], s44 offen offset:1024 nt lds
  buffer_load_dwordx4 v19, s[20:23], s44 offen offset:2048 nt lds
  v_mfma_f32_32x32x16_bf16 v[208:223], v[44:47], a[16:19], v[208:223]
  ds_read_b64_tr_b16 v[44:45], v8 offset:49152
  ds_read_b64_tr_b16 v[46:47], v8 offset:50176
  v_mfma_f32_32x32x16_bf16 v[160:175], v[48:51], a[20:23], v[160:175]
  ds_read_b64_tr_b16 v[48:49], v9 offset:49152
  ds_read_b64_tr_b16 v[50:51], v9 offset:50176
  s_waitcnt lgkmcnt(6)
  v_mfma_f32_32x32x16_bf16 v[176:191], v[52:55], a[20:23], v[176:191]
  ds_read_b64_tr_b16 v[52:53], v10 offset:49152
  ds_read_b64_tr_b16 v[54:55], v10 offset:50176
  v_mfma_f32_32x32x16_bf16 v[192:207], v[56:59], a[20:23], v[192:207]
  ds_read_b64_tr_b16 v[56:57], v7 offset:53248
  ds_read_b64_tr_b16 v[58:59], v7 offset:54272
  v_mfma_f32_32x32x16_bf16 v[208:223], v[60:63], a[20:23], v[208:223]
  ds_read_b64_tr_b16 v[60:61], v8 offset:53248
  ds_read_b64_tr_b16 v[62:63], v8 offset:54272
  s_waitcnt lgkmcnt(6)
  v_mfma_f32_32x32x16_bf16 v[160:175], v[40:43], a[24:27], v[160:175]
  ds_read_b64_tr_b16 v[40:41], v9 offset:53248
  ds_read_b64_tr_b16 v[42:43], v9 offset:54272
  v_mfma_f32_32x32x16_bf16 v[176:191], v[44:47], a[24:27], v[176:191]
  ds_read_b64_tr_b16 v[44:45], v10 offset:53248
  ds_read_b64_tr_b16 v[46:47], v10 offset:54272
  v_mfma_f32_32x32x16_bf16 v[192:207], v[48:51], a[24:27], v[192:207]
  ds_read_b64_tr_b16 v[48:49], v7 offset:57344
  ds_read_b64_tr_b16 v[50:51], v7 offset:58368
  s_waitcnt lgkmcnt(6)
  v_mfma_f32_32x32x16_bf16 v[208:223], v[52:55], a[24:27], v[208:223]
  ds_read_b64_tr_b16 v[52:53], v8 offset:57344
  ds_read_b64_tr_b16 v[54:55], v8 offset:58368
  v_mfma_f32_32x32x16_bf16 v[160:175], v[56:59], a[28:31], v[160:175]
  ds_read_b64_tr_b16 v[56:57], v9 offset:57344
  ds_read_b64_tr_b16 v[58:59], v9 offset:58368
  v_mfma_f32_32x32x16_bf16 v[176:191], v[60:63], a[28:31], v[176:191]
  ds_read_b64_tr_b16 v[60:61], v10 offset:57344
  ds_read_b64_tr_b16 v[62:63], v10 offset:58368
  s_waitcnt vmcnt(29)
  s_barrier
  s_mov_b32 s45, 185344
  s_waitcnt lgkmcnt(6)
  v_mfma_f32_32x32x16_bf16 v[192:207], v[40:43], a[28:31], v[192:207]
  ds_read_b64_tr_b16 v[40:41], v7 offset:24576
  ds_read_b64_tr_b16 v[42:43], v7 offset:25600
  s_add_u32 m0, s32, 12288
  s_nop 0
  buffer_load_dwordx4 v17, s[20:23], s45 offen offset:0 nt lds
  buffer_load_dwordx4 v18, s[20:23], s45 offen offset:1024 nt lds
  buffer_load_dwordx4 v19, s[20:23], s45 offen offset:2048 nt lds
  v_mfma_f32_32x32x16_bf16 v[208:223], v[44:47], a[28:31], v[208:223]
  ds_read_b64_tr_b16 v[44:45], v8 offset:24576
  ds_read_b64_tr_b16 v[46:47], v8 offset:25600
  v_mfma_f32_32x32x16_bf16 v[160:175], v[48:51], a[32:35], v[160:175]
  ds_read_b64_tr_b16 v[48:49], v9 offset:24576
  ds_read_b64_tr_b16 v[50:51], v9 offset:25600
  s_waitcnt lgkmcnt(6)
  v_mfma_f32_32x32x16_bf16 v[176:191], v[52:55], a[32:35], v[176:191]
  ds_read_b64_tr_b16 v[52:53], v10 offset:24576
  ds_read_b64_tr_b16 v[54:55], v10 offset:25600
  v_mfma_f32_32x32x16_bf16 v[192:207], v[56:59], a[32:35], v[192:207]
  ds_read_b64_tr_b16 v[56:57], v7 offset:28672
  ds_read_b64_tr_b16 v[58:59], v7 offset:29696
  v_mfma_f32_32x32x16_bf16 v[208:223], v[60:63], a[32:35], v[208:223]
  ds_read_b64_tr_b16 v[60:61], v8 offset:28672
  ds_read_b64_tr_b16 v[62:63], v8 offset:29696
  s_waitcnt lgkmcnt(6)
  v_mfma_f32_32x32x16_bf16 v[160:175], v[40:43], a[36:39], v[160:175]
  ds_read_b64_tr_b16 v[40:41], v9 offset:28672
  ds_read_b64_tr_b16 v[42:43], v9 offset:29696
  v_mfma_f32_32x32x16_bf16 v[176:191], v[44:47], a[36:39], v[176:191]
  ds_read_b64_tr_b16 v[44:45], v10 offset:28672
  ds_read_b64_tr_b16 v[46:47], v10 offset:29696
  v_mfma_f32_32x32x16_bf16 v[192:207], v[48:51], a[36:39], v[192:207]
  ds_read_b64_tr_b16 v[48:49], v7 offset:32768
  ds_read_b64_tr_b16 v[50:51], v7 offset:33792
  s_waitcnt lgkmcnt(6)
  v_mfma_f32_32x32x16_bf16 v[208:223], v[52:55], a[36:39], v[208:223]
  ds_read_b64_tr_b16 v[52:53], v8 offset:32768
  ds_read_b64_tr_b16 v[54:55], v8 offset:33792
  v_mfma_f32_32x32x16_bf16 v[160:175], v[56:59], a[40:43], v[160:175]
  ds_read_b64_tr_b16 v[56:57], v9 offset:32768
  ds_read_b64_tr_b16 v[58:59], v9 offset:33792
  v_mfma_f32_32x32x16_bf16 v[176:191], v[60:63], a[40:43], v[176:191]
  ds_read_b64_tr_b16 v[60:61], v10 offset:32768
  ds_read_b64_tr_b16 v[62:63], v10 offset:33792
  s_waitcnt vmcnt(29)
  s_barrier
  s_mov_b32 s44, 246784
  s_waitcnt lgkmcnt(6)
  v_mfma_f32_32x32x16_bf16 v[192:207], v[40:43], a[40:43], v[192:207]
  ds_read_b64_tr_b16 v[40:41], v72 offset:24576
  ds_read_b64_tr_b16 v[42:43], v72 offset:25600
  s_add_u32 m0, s32, 49152
  s_nop 0
  buffer_load_dwordx4 v17, s[20:23], s44 offen offset:0 nt lds
  buffer_load_dwordx4 v18, s[20:23], s44 offen offset:1024 nt lds
  buffer_load_dwordx4 v19, s[20:23], s44 offen offset:2048 nt lds
  v_mfma_f32_32x32x16_bf16 v[208:223], v[44:47], a[40:43], v[208:223]
  ds_read_b64_tr_b16 v[44:45], v73 offset:24576
  ds_read_b64_tr_b16 v[46:47], v73 offset:25600
  v_mfma_f32_32x32x16_bf16 v[160:175], v[48:51], a[44:47], v[160:175]
  ds_read_b64_tr_b16 v[48:49], v74 offset:24576
  ds_read_b64_tr_b16 v[50:51], v74 offset:25600
  s_waitcnt lgkmcnt(6)
  v_mfma_f32_32x32x16_bf16 v[176:191], v[52:55], a[44:47], v[176:191]
  ds_read_b64_tr_b16 v[52:53], v75 offset:24576
  ds_read_b64_tr_b16 v[54:55], v75 offset:25600
  v_mfma_f32_32x32x16_bf16 v[192:207], v[56:59], a[44:47], v[192:207]
  ds_read_b64_tr_b16 v[56:57], v72 offset:28672
  ds_read_b64_tr_b16 v[58:59], v72 offset:29696
  v_mfma_f32_32x32x16_bf16 v[208:223], v[60:63], a[44:47], v[208:223]
  ds_read_b64_tr_b16 v[60:61], v73 offset:28672
  ds_read_b64_tr_b16 v[62:63], v73 offset:29696
  s_waitcnt lgkmcnt(6)
  v_mfma_f32_32x32x16_bf16 v[160:175], v[40:43], a[48:51], v[160:175]
  ds_read_b64_tr_b16 v[40:41], v74 offset:28672
  ds_read_b64_tr_b16 v[42:43], v74 offset:29696
  v_mfma_f32_32x32x16_bf16 v[176:191], v[44:47], a[48:51], v[176:191]
  ds_read_b64_tr_b16 v[44:45], v75 offset:28672
  ds_read_b64_tr_b16 v[46:47], v75 offset:29696
  v_mfma_f32_32x32x16_bf16 v[192:207], v[48:51], a[48:51], v[192:207]
  ds_read_b64_tr_b16 v[48:49], v72 offset:32768
  ds_read_b64_tr_b16 v[50:51], v72 offset:33792
  s_waitcnt lgkmcnt(6)
  v_mfma_f32_32x32x16_bf16 v[208:223], v[52:55], a[48:51], v[208:223]
  ds_read_b64_tr_b16 v[52:53], v73 offset:32768
  ds_read_b64_tr_b16 v[54:55], v73 offset:33792
  v_mfma_f32_32x32x16_bf16 v[160:175], v[56:59], a[52:55], v[160:175]
  ds_read_b64_tr_b16 v[56:57], v74 offset:32768
  ds_read_b64_tr_b16 v[58:59], v74 offset:33792
  v_mfma_f32_32x32x16_bf16 v[176:191], v[60:63], a[52:55], v[176:191]
  ds_read_b64_tr_b16 v[60:61], v75 offset:32768
  ds_read_b64_tr_b16 v[62:63], v75 offset:33792
  s_waitcnt vmcnt(29)
  s_barrier
  s_mov_b32 s45, 308224
  s_waitcnt lgkmcnt(6)
  v_mfma_f32_32x32x16_bf16 v[192:207], v[40:43], a[52:55], v[192:207]
  ds_read_b64_tr_b16 v[40:41], v72 offset:36864
  ds_read_b64_tr_b16 v[42:43], v72 offset:37888
  s_add_u32 m0, s32, 24576
  s_nop 0
  buffer_load_dwordx4 v17, s[20:23], s45 offen offset:0 nt lds
  buffer_load_dwordx4 v18, s[20:23], s45 offen offset:1024 nt lds
  buffer_load_dwordx4 v19, s[20:23], s45 offen offset:2048 nt lds
  v_mfma_f32_32x32x16_bf16 v[208:223], v[44:47], a[52:55], v[208:223]
  ds_read_b64_tr_b16 v[44:45], v73 offset:36864
  ds_read_b64_tr_b16 v[46:47], v73 offset:37888
  v_mfma_f32_32x32x16_bf16 v[160:175], v[48:51], a[56:59], v[160:175]
  ds_read_b64_tr_b16 v[48:49], v74 offset:36864
  ds_read_b64_tr_b16 v[50:51], v74 offset:37888
  s_waitcnt lgkmcnt(6)
  v_mfma_f32_32x32x16_bf16 v[176:191], v[52:55], a[56:59], v[176:191]
  ds_read_b64_tr_b16 v[52:53], v75 offset:36864
  ds_read_b64_tr_b16 v[54:55], v75 offset:37888
  v_mfma_f32_32x32x16_bf16 v[192:207], v[56:59], a[56:59], v[192:207]
  ds_read_b64_tr_b16 v[56:57], v72 offset:40960
  ds_read_b64_tr_b16 v[58:59], v72 offset:41984
  v_mfma_f32_32x32x16_bf16 v[208:223], v[60:63], a[56:59], v[208:223]
  ds_read_b64_tr_b16 v[60:61], v73 offset:40960
  ds_read_b64_tr_b16 v[62:63], v73 offset:41984
  s_waitcnt lgkmcnt(6)
  v_mfma_f32_32x32x16_bf16 v[160:175], v[40:43], a[60:63], v[160:175]
  ds_read_b64_tr_b16 v[40:41], v74 offset:40960
  ds_read_b64_tr_b16 v[42:43], v74 offset:41984
  v_mfma_f32_32x32x16_bf16 v[176:191], v[44:47], a[60:63], v[176:191]
  ds_read_b64_tr_b16 v[44:45], v75 offset:40960
  ds_read_b64_tr_b16 v[46:47], v75 offset:41984
  v_mfma_f32_32x32x16_bf16 v[192:207], v[48:51], a[60:63], v[192:207]
  ds_read_b64_tr_b16 v[48:49], v72 offset:45056
  ds_read_b64_tr_b16 v[50:51], v72 offset:46080
  s_waitcnt lgkmcnt(6)
  v_mfma_f32_32x32x16_bf16 v[208:223], v[52:55], a[60:63], v[208:223]
  ds_read_b64_tr_b16 v[52:53], v73 offset:45056
  ds_read_b64_tr_b16 v[54:55], v73 offset:46080
  v_mfma_f32_32x32x16_bf16 v[160:175], v[56:59], a[64:67], v[160:175]
  ds_read_b64_tr_b16 v[56:57], v74 offset:45056
  ds_read_b64_tr_b16 v[58:59], v74 offset:46080
  v_mfma_f32_32x32x16_bf16 v[176:191], v[60:63], a[64:67], v[176:191]
  ds_read_b64_tr_b16 v[60:61], v75 offset:45056
  ds_read_b64_tr_b16 v[62:63], v75 offset:46080
  s_waitcnt vmcnt(29)
  s_barrier
  s_mov_b32 s44, 369664
  s_waitcnt lgkmcnt(6)
  v_mfma_f32_32x32x16_bf16 v[192:207], v[40:43], a[64:67], v[192:207]
  ds_read_b64_tr_b16 v[40:41], v72 offset:12288
  ds_read_b64_tr_b16 v[42:43], v72 offset:13312
  s_add_u32 m0, s32, 73728
  s_nop 0
  buffer_load_dwordx4 v17, s[20:23], s44 offen offset:0 nt lds
  buffer_load_dwordx4 v18, s[20:23], s44 offen offset:1024 nt lds
  buffer_load_dwordx4 v19, s[20:23], s44 offen offset:2048 nt lds
  v_mfma_f32_32x32x16_bf16 v[208:223], v[44:47], a[64:67], v[208:223]
  ds_read_b64_tr_b16 v[44:45], v73 offset:12288
  ds_read_b64_tr_b16 v[46:47], v73 offset:13312
  v_mfma_f32_32x32x16_bf16 v[160:175], v[48:51], a[68:71], v[160:175]
  ds_read_b64_tr_b16 v[48:49], v74 offset:12288
  ds_read_b64_tr_b16 v[50:51], v74 offset:13312
  s_waitcnt lgkmcnt(6)
  v_mfma_f32_32x32x16_bf16 v[176:191], v[52:55], a[68:71], v[176:191]
  ds_read_b64_tr_b16 v[52:53], v75 offset:12288
  ds_read_b64_tr_b16 v[54:55], v75 offset:13312
  v_mfma_f32_32x32x16_bf16 v[192:207], v[56:59], a[68:71], v[192:207]
  ds_read_b64_tr_b16 v[56:57], v72 offset:16384
  ds_read_b64_tr_b16 v[58:59], v72 offset:17408
  v_mfma_f32_32x32x16_bf16 v[208:223], v[60:63], a[68:71], v[208:223]
  ds_read_b64_tr_b16 v[60:61], v73 offset:16384
  ds_read_b64_tr_b16 v[62:63], v73 offset:17408
  s_waitcnt lgkmcnt(6)
  v_mfma_f32_32x32x16_bf16 v[160:175], v[40:43], a[72:75], v[160:175]
  ds_read_b64_tr_b16 v[40:41], v74 offset:16384
  ds_read_b64_tr_b16 v[42:43], v74 offset:17408
  v_mfma_f32_32x32x16_bf16 v[176:191], v[44:47], a[72:75], v[176:191]
  ds_read_b64_tr_b16 v[44:45], v75 offset:16384
  ds_read_b64_tr_b16 v[46:47], v75 offset:17408
  v_mfma_f32_32x32x16_bf16 v[192:207], v[48:51], a[72:75], v[192:207]
  ds_read_b64_tr_b16 v[48:49], v72 offset:20480
  ds_read_b64_tr_b16 v[50:51], v72 offset:21504
  s_waitcnt lgkmcnt(6)
  v_mfma_f32_32x32x16_bf16 v[208:223], v[52:55], a[72:75], v[208:223]
  ds_read_b64_tr_b16 v[52:53], v73 offset:20480
  ds_read_b64_tr_b16 v[54:55], v73 offset:21504
  v_mfma_f32_32x32x16_bf16 v[160:175], v[56:59], a[76:79], v[160:175]
  ds_read_b64_tr_b16 v[56:57], v74 offset:20480
  ds_read_b64_tr_b16 v[58:59], v74 offset:21504
  v_mfma_f32_32x32x16_bf16 v[176:191], v[60:63], a[76:79], v[176:191]
  ds_read_b64_tr_b16 v[60:61], v75 offset:20480
  ds_read_b64_tr_b16 v[62:63], v75 offset:21504
  s_waitcnt vmcnt(29)
  s_barrier
  s_mov_b32 s45, 431104
  s_waitcnt lgkmcnt(6)
  v_mfma_f32_32x32x16_bf16 v[192:207], v[40:43], a[76:79], v[192:207]
  ds_read_b64_tr_b16 v[40:41], v76 offset:0
  ds_read_b64_tr_b16 v[42:43], v76 offset:1024
  s_add_u32 m0, s32, 86016
  s_nop 0
  buffer_load_dwordx4 v17, s[20:23], s45 offen offset:0 nt lds
  buffer_load_dwordx4 v18, s[20:23], s45 offen offset:1024 nt lds
  buffer_load_dwordx4 v19, s[20:23], s45 offen offset:2048 nt lds
  v_mfma_f32_32x32x16_bf16 v[208:223], v[44:47], a[76:79], v[208:223]
  ds_read_b64_tr_b16 v[44:45], v77 offset:0
  ds_read_b64_tr_b16 v[46:47], v77 offset:1024
  v_mfma_f32_32x32x16_bf16 v[160:175], v[48:51], a[80:83], v[160:175]
  ds_read_b64_tr_b16 v[48:49], v78 offset:0
  ds_read_b64_tr_b16 v[50:51], v78 offset:1024
  s_waitcnt lgkmcnt(6)
  v_mfma_f32_32x32x16_bf16 v[176:191], v[52:55], a[80:83], v[176:191]
  ds_read_b64_tr_b16 v[52:53], v79 offset:0
  ds_read_b64_tr_b16 v[54:55], v79 offset:1024
  v_mfma_f32_32x32x16_bf16 v[192:207], v[56:59], a[80:83], v[192:207]
  ds_read_b64_tr_b16 v[56:57], v76 offset:4096
  ds_read_b64_tr_b16 v[58:59], v76 offset:5120
  v_mfma_f32_32x32x16_bf16 v[208:223], v[60:63], a[80:83], v[208:223]
  ds_read_b64_tr_b16 v[60:61], v77 offset:4096
  ds_read_b64_tr_b16 v[62:63], v77 offset:5120
  s_waitcnt lgkmcnt(6)
  v_mfma_f32_32x32x16_bf16 v[160:175], v[40:43], a[84:87], v[160:175]
  ds_read_b64_tr_b16 v[40:41], v78 offset:4096
  ds_read_b64_tr_b16 v[42:43], v78 offset:5120
  v_mfma_f32_32x32x16_bf16 v[176:191], v[44:47], a[84:87], v[176:191]
  ds_read_b64_tr_b16 v[44:45], v79 offset:4096
  ds_read_b64_tr_b16 v[46:47], v79 offset:5120
  v_mfma_f32_32x32x16_bf16 v[192:207], v[48:51], a[84:87], v[192:207]
  ds_read_b64_tr_b16 v[48:49], v76 offset:8192
  ds_read_b64_tr_b16 v[50:51], v76 offset:9216
  s_waitcnt lgkmcnt(6)
  v_mfma_f32_32x32x16_bf16 v[208:223], v[52:55], a[84:87], v[208:223]
  ds_read_b64_tr_b16 v[52:53], v77 offset:8192
  ds_read_b64_tr_b16 v[54:55], v77 offset:9216
  v_mfma_f32_32x32x16_bf16 v[160:175], v[56:59], a[88:91], v[160:175]
  ds_read_b64_tr_b16 v[56:57], v78 offset:8192
  ds_read_b64_tr_b16 v[58:59], v78 offset:9216
  v_mfma_f32_32x32x16_bf16 v[176:191], v[60:63], a[88:91], v[176:191]
  ds_read_b64_tr_b16 v[60:61], v79 offset:8192
  ds_read_b64_tr_b16 v[62:63], v79 offset:9216
  s_waitcnt vmcnt(29)
  s_barrier
  s_mov_b32 s44, 245760
  s_waitcnt lgkmcnt(6)
  v_mfma_f32_32x32x16_bf16 v[192:207], v[40:43], a[88:91], v[192:207]
  ds_read_b64_tr_b16 v[40:41], v7 offset:36864
  ds_read_b64_tr_b16 v[42:43], v7 offset:37888
  s_add_u32 m0, s32, 61440
  s_nop 0
  buffer_load_dwordx4 v17, s[20:23], s44 offen offset:0 nt lds
  buffer_load_dwordx4 v18, s[20:23], s44 offen offset:1024 nt lds
  buffer_load_dwordx4 v19, s[20:23], s44 offen offset:2048 nt lds
  v_mfma_f32_32x32x16_bf16 v[208:223], v[44:47], a[88:91], v[208:223]
  ds_read_b64_tr_b16 v[44:45], v8 offset:36864
  ds_read_b64_tr_b16 v[46:47], v8 offset:37888
  v_mfma_f32_32x32x16_bf16 v[160:175], v[48:51], a[92:95], v[160:175]
  ds_read_b64_tr_b16 v[48:49], v9 offset:36864
  ds_read_b64_tr_b16 v[50:51], v9 offset:37888
  s_waitcnt lgkmcnt(6)
  v_mfma_f32_32x32x16_bf16 v[176:191], v[52:55], a[92:95], v[176:191]
  ds_read_b64_tr_b16 v[52:53], v10 offset:36864
  ds_read_b64_tr_b16 v[54:55], v10 offset:37888
  v_mfma_f32_32x32x16_bf16 v[192:207], v[56:59], a[92:95], v[192:207]
  ds_read_b64_tr_b16 v[56:57], v7 offset:40960
  ds_read_b64_tr_b16 v[58:59], v7 offset:41984
  v_mfma_f32_32x32x16_bf16 v[208:223], v[60:63], a[92:95], v[208:223]
  ds_read_b64_tr_b16 v[60:61], v8 offset:40960
  ds_read_b64_tr_b16 v[62:63], v8 offset:41984
  s_waitcnt lgkmcnt(6)
  v_mfma_f32_32x32x16_bf16 v[96:111], v[40:43], a[0:3], 0
  ds_read_b64_tr_b16 v[40:41], v9 offset:40960
  ds_read_b64_tr_b16 v[42:43], v9 offset:41984
  v_mfma_f32_32x32x16_bf16 v[112:127], v[44:47], a[0:3], 0
  ds_read_b64_tr_b16 v[44:45], v10 offset:40960
  ds_read_b64_tr_b16 v[46:47], v10 offset:41984
  v_cvt_pk_bf16_f32 v160, v160, v161
  v_cvt_pk_bf16_f32 v161, v162, v163
  v_cvt_pk_bf16_f32 v162, v164, v165
  v_cvt_pk_bf16_f32 v163, v166, v167
  v_mfma_f32_32x32x16_bf16 v[128:143], v[48:51], a[0:3], 0
  ds_read_b64_tr_b16 v[48:49], v7 offset:45056
  ds_read_b64_tr_b16 v[50:51], v7 offset:46080
  s_mov_b32 s46, 24576
  buffer_store_dwordx4 v[160:163], v25, s[24:27], s46 offen
  v_cvt_pk_bf16_f32 v168, v168, v169
  s_waitcnt lgkmcnt(6)
  v_mfma_f32_32x32x16_bf16 v[144:159], v[52:55], a[0:3], 0
  ds_read_b64_tr_b16 v[52:53], v8 offset:45056
  ds_read_b64_tr_b16 v[54:55], v8 offset:46080
  v_cvt_pk_bf16_f32 v169, v170, v171
  v_cvt_pk_bf16_f32 v170, v172, v173
  v_cvt_pk_bf16_f32 v171, v174, v175
  v_mfma_f32_32x32x16_bf16 v[96:111], v[56:59], a[4:7], v[96:111]
  ds_read_b64_tr_b16 v[56:57], v9 offset:45056
  ds_read_b64_tr_b16 v[58:59], v9 offset:46080
  s_mov_b32 s46, 25600
  buffer_store_dwordx4 v[168:171], v25, s[24:27], s46 offen
  v_cvt_pk_bf16_f32 v176, v176, v177
  v_cvt_pk_bf16_f32 v177, v178, v179
  v_mfma_f32_32x32x16_bf16 v[112:127], v[60:63], a[4:7], v[112:127]
  ds_read_b64_tr_b16 v[60:61], v10 offset:45056
  ds_read_b64_tr_b16 v[62:63], v10 offset:46080
  s_waitcnt vmcnt(29)
  s_barrier
  s_mov_b32 s45, 307200
  s_waitcnt lgkmcnt(6)
  v_mfma_f32_32x32x16_bf16 v[128:143], v[40:43], a[4:7], v[128:143]
  ds_read_b64_tr_b16 v[40:41], v7 offset:0
  ds_read_b64_tr_b16 v[42:43], v7 offset:1024
  s_add_u32 m0, s32, 98304
  s_nop 0
  buffer_load_dwordx4 v17, s[20:23], s45 offen offset:0 nt lds
  buffer_load_dwordx4 v18, s[20:23], s45 offen offset:1024 nt lds
  buffer_load_dwordx4 v19, s[20:23], s45 offen offset:2048 nt lds
  v_mfma_f32_32x32x16_bf16 v[144:159], v[44:47], a[4:7], v[144:159]
  ds_read_b64_tr_b16 v[44:45], v8 offset:0
  ds_read_b64_tr_b16 v[46:47], v8 offset:1024
  v_cvt_pk_bf16_f32 v178, v180, v181
  v_cvt_pk_bf16_f32 v179, v182, v183
  s_mov_b32 s46, 26624
  buffer_store_dwordx4 v[176:179], v25, s[24:27], s46 offen
  v_mfma_f32_32x32x16_bf16 v[96:111], v[48:51], a[8:11], v[96:111]
  ds_read_b64_tr_b16 v[48:49], v9 offset:0
  ds_read_b64_tr_b16 v[50:51], v9 offset:1024
  v_cvt_pk_bf16_f32 v184, v184, v185
  v_cvt_pk_bf16_f32 v185, v186, v187
  v_cvt_pk_bf16_f32 v186, v188, v189
  s_waitcnt lgkmcnt(6)
  v_mfma_f32_32x32x16_bf16 v[112:127], v[52:55], a[8:11], v[112:127]
  ds_read_b64_tr_b16 v[52:53], v10 offset:0
  ds_read_b64_tr_b16 v[54:55], v10 offset:1024
  v_cvt_pk_bf16_f32 v187, v190, v191
  s_mov_b32 s46, 27648
  buffer_store_dwordx4 v[184:187], v25, s[24:27], s46 offen
  v_cvt_pk_bf16_f32 v192, v192, v193
  v_mfma_f32_32x32x16_bf16 v[128:143], v[56:59], a[8:11], v[128:143]
  ds_read_b64_tr_b16 v[56:57], v7 offset:4096
  ds_read_b64_tr_b16 v[58:59], v7 offset:5120
  v_cvt_pk_bf16_f32 v193, v194, v195
  v_cvt_pk_bf16_f32 v194, v196, v197
  v_cvt_pk_bf16_f32 v195, v198, v199
  v_mfma_f32_32x32x16_bf16 v[144:159], v[60:63], a[8:11], v[144:159]
  ds_read_b64_tr_b16 v[60:61], v8 offset:4096
  ds_read_b64_tr_b16 v[62:63], v8 offset:5120
  s_mov_b32 s46, 28672
  buffer_store_dwordx4 v[192:195], v25, s[24:27], s46 offen
  v_cvt_pk_bf16_f32 v200, v200, v201
  s_waitcnt lgkmcnt(6)
  v_mfma_f32_32x32x16_bf16 v[96:111], v[40:43], a[12:15], v[96:111]
  ds_read_b64_tr_b16 v[40:41], v9 offset:4096
  ds_read_b64_tr_b16 v[42:43], v9 offset:5120
  v_cvt_pk_bf16_f32 v201, v202, v203
  v_cvt_pk_bf16_f32 v202, v204, v205
  v_cvt_pk_bf16_f32 v203, v206, v207
  v_mfma_f32_32x32x16_bf16 v[112:127], v[44:47], a[12:15], v[112:127]
  ds_read_b64_tr_b16 v[44:45], v10 offset:4096
  ds_read_b64_tr_b16 v[46:47], v10 offset:5120
  s_mov_b32 s46, 29696
  buffer_store_dwordx4 v[200:203], v25, s[24:27], s46 offen
  v_cvt_pk_bf16_f32 v208, v208, v209
  v_cvt_pk_bf16_f32 v209, v210, v211
  v_mfma_f32_32x32x16_bf16 v[128:143], v[48:51], a[12:15], v[128:143]
  ds_read_b64_tr_b16 v[48:49], v7 offset:8192
  ds_read_b64_tr_b16 v[50:51], v7 offset:9216
  v_cvt_pk_bf16_f32 v210, v212, v213
  v_cvt_pk_bf16_f32 v211, v214, v215
  s_waitcnt lgkmcnt(6)
  v_mfma_f32_32x32x16_bf16 v[144:159], v[52:55], a[12:15], v[144:159]
  ds_read_b64_tr_b16 v[52:53], v8 offset:8192
  ds_read_b64_tr_b16 v[54:55], v8 offset:9216
  s_mov_b32 s46, 30720
  buffer_store_dwordx4 v[208:211], v25, s[24:27], s46 offen
  v_cvt_pk_bf16_f32 v216, v216, v217
  v_cvt_pk_bf16_f32 v217, v218, v219
  v_mfma_f32_32x32x16_bf16 v[96:111], v[56:59], a[16:19], v[96:111]
  ds_read_b64_tr_b16 v[56:57], v9 offset:8192
  ds_read_b64_tr_b16 v[58:59], v9 offset:9216
  v_cvt_pk_bf16_f32 v218, v220, v221
  v_cvt_pk_bf16_f32 v219, v222, v223
  s_mov_b32 s46, 31744
  buffer_store_dwordx4 v[216:219], v25, s[24:27], s46 offen
  v_mfma_f32_32x32x16_bf16 v[112:127], v[60:63], a[16:19], v[112:127]
  ds_read_b64_tr_b16 v[60:61], v10 offset:8192
  ds_read_b64_tr_b16 v[62:63], v10 offset:9216
  s_waitcnt vmcnt(29)
  s_barrier
  s_mov_b32 s44, 368640
  s_waitcnt lgkmcnt(6)
  v_mfma_f32_32x32x16_bf16 v[128:143], v[40:43], a[16:19], v[128:143]
  ds_read_b64_tr_b16 v[40:41], v76 offset:12288
  ds_read_b64_tr_b16 v[42:43], v76 offset:13312
  s_add_u32 m0, s32, 36864
  s_nop 0
  buffer_load_dwordx4 v17, s[20:23], s44 offen offset:0 nt lds
  buffer_load_dwordx4 v18, s[20:23], s44 offen offset:1024 nt lds
  buffer_load_dwordx4 v19, s[20:23], s44 offen offset:2048 nt lds
  v_mfma_f32_32x32x16_bf16 v[144:159], v[44:47], a[16:19], v[144:159]
  ds_read_b64_tr_b16 v[44:45], v77 offset:12288
  ds_read_b64_tr_b16 v[46:47], v77 offset:13312
  v_mfma_f32_32x32x16_bf16 v[96:111], v[48:51], a[20:23], v[96:111]
  ds_read_b64_tr_b16 v[48:49], v78 offset:12288
  ds_read_b64_tr_b16 v[50:51], v78 offset:13312
  s_waitcnt lgkmcnt(6)
  v_mfma_f32_32x32x16_bf16 v[112:127], v[52:55], a[20:23], v[112:127]
  ds_read_b64_tr_b16 v[52:53], v79 offset:12288
  ds_read_b64_tr_b16 v[54:55], v79 offset:13312
  v_mfma_f32_32x32x16_bf16 v[128:143], v[56:59], a[20:23], v[128:143]
  ds_read_b64_tr_b16 v[56:57], v76 offset:16384
  ds_read_b64_tr_b16 v[58:59], v76 offset:17408
  v_mfma_f32_32x32x16_bf16 v[144:159], v[60:63], a[20:23], v[144:159]
  ds_read_b64_tr_b16 v[60:61], v77 offset:16384
  ds_read_b64_tr_b16 v[62:63], v77 offset:17408
  s_waitcnt lgkmcnt(6)
  v_mfma_f32_32x32x16_bf16 v[96:111], v[40:43], a[24:27], v[96:111]
  ds_read_b64_tr_b16 v[40:41], v78 offset:16384
  ds_read_b64_tr_b16 v[42:43], v78 offset:17408
  v_mfma_f32_32x32x16_bf16 v[112:127], v[44:47], a[24:27], v[112:127]
  ds_read_b64_tr_b16 v[44:45], v79 offset:16384
  ds_read_b64_tr_b16 v[46:47], v79 offset:17408
  v_mfma_f32_32x32x16_bf16 v[128:143], v[48:51], a[24:27], v[128:143]
  ds_read_b64_tr_b16 v[48:49], v76 offset:20480
  ds_read_b64_tr_b16 v[50:51], v76 offset:21504
  s_waitcnt lgkmcnt(6)
  v_mfma_f32_32x32x16_bf16 v[144:159], v[52:55], a[24:27], v[144:159]
  ds_read_b64_tr_b16 v[52:53], v77 offset:20480
  ds_read_b64_tr_b16 v[54:55], v77 offset:21504
  v_mfma_f32_32x32x16_bf16 v[96:111], v[56:59], a[28:31], v[96:111]
  ds_read_b64_tr_b16 v[56:57], v78 offset:20480
  ds_read_b64_tr_b16 v[58:59], v78 offset:21504
  v_mfma_f32_32x32x16_bf16 v[112:127], v[60:63], a[28:31], v[112:127]
  ds_read_b64_tr_b16 v[60:61], v79 offset:20480
  ds_read_b64_tr_b16 v[62:63], v79 offset:21504
  s_waitcnt vmcnt(29)
  s_barrier
  s_mov_b32 s45, 430080
  s_waitcnt lgkmcnt(6)
  v_mfma_f32_32x32x16_bf16 v[128:143], v[40:43], a[28:31], v[128:143]
  ds_read_b64_tr_b16 v[40:41], v7 offset:12288
  ds_read_b64_tr_b16 v[42:43], v7 offset:13312
  s_add_u32 m0, s32, 0
  s_nop 0
  buffer_load_dwordx4 v17, s[20:23], s45 offen offset:0 nt lds
  buffer_load_dwordx4 v18, s[20:23], s45 offen offset:1024 nt lds
  buffer_load_dwordx4 v19, s[20:23], s45 offen offset:2048 nt lds
  v_mfma_f32_32x32x16_bf16 v[144:159], v[44:47], a[28:31], v[144:159]
  ds_read_b64_tr_b16 v[44:45], v8 offset:12288
  ds_read_b64_tr_b16 v[46:47], v8 offset:13312
  v_mfma_f32_32x32x16_bf16 v[96:111], v[48:51], a[32:35], v[96:111]
  ds_read_b64_tr_b16 v[48:49], v9 offset:12288
  ds_read_b64_tr_b16 v[50:51], v9 offset:13312
  s_waitcnt lgkmcnt(6)
  v_mfma_f32_32x32x16_bf16 v[112:127], v[52:55], a[32:35], v[112:127]
  ds_read_b64_tr_b16 v[52:53], v10 offset:12288
  ds_read_b64_tr_b16 v[54:55], v10 offset:13312
  v_mfma_f32_32x32x16_bf16 v[128:143], v[56:59], a[32:35], v[128:143]
  ds_read_b64_tr_b16 v[56:57], v7 offset:16384
  ds_read_b64_tr_b16 v[58:59], v7 offset:17408
  v_mfma_f32_32x32x16_bf16 v[144:159], v[60:63], a[32:35], v[144:159]
  ds_read_b64_tr_b16 v[60:61], v8 offset:16384
  ds_read_b64_tr_b16 v[62:63], v8 offset:17408
  s_waitcnt lgkmcnt(6)
  v_mfma_f32_32x32x16_bf16 v[96:111], v[40:43], a[36:39], v[96:111]
  ds_read_b64_tr_b16 v[40:41], v9 offset:16384
  ds_read_b64_tr_b16 v[42:43], v9 offset:17408
  v_mfma_f32_32x32x16_bf16 v[112:127], v[44:47], a[36:39], v[112:127]
  ds_read_b64_tr_b16 v[44:45], v10 offset:16384
  ds_read_b64_tr_b16 v[46:47], v10 offset:17408
  v_mfma_f32_32x32x16_bf16 v[128:143], v[48:51], a[36:39], v[128:143]
  ds_read_b64_tr_b16 v[48:49], v7 offset:20480
  ds_read_b64_tr_b16 v[50:51], v7 offset:21504
  s_waitcnt lgkmcnt(6)
  v_mfma_f32_32x32x16_bf16 v[144:159], v[52:55], a[36:39], v[144:159]
  ds_read_b64_tr_b16 v[52:53], v8 offset:20480
  ds_read_b64_tr_b16 v[54:55], v8 offset:21504
  v_mfma_f32_32x32x16_bf16 v[96:111], v[56:59], a[40:43], v[96:111]
  ds_read_b64_tr_b16 v[56:57], v9 offset:20480
  ds_read_b64_tr_b16 v[58:59], v9 offset:21504
  v_mfma_f32_32x32x16_bf16 v[112:127], v[60:63], a[40:43], v[112:127]
  ds_read_b64_tr_b16 v[60:61], v10 offset:20480
  ds_read_b64_tr_b16 v[62:63], v10 offset:21504
  s_waitcnt vmcnt(29)
  s_barrier
  s_mov_b32 s44, 246016
  s_waitcnt lgkmcnt(6)
  v_mfma_f32_32x32x16_bf16 v[128:143], v[40:43], a[40:43], v[128:143]
  ds_read_b64_tr_b16 v[40:41], v7 offset:49152
  ds_read_b64_tr_b16 v[42:43], v7 offset:50176
  s_add_u32 m0, s32, 110592
  s_nop 0
  buffer_load_dwordx4 v17, s[20:23], s44 offen offset:0 nt lds
  buffer_load_dwordx4 v18, s[20:23], s44 offen offset:1024 nt lds
  buffer_load_dwordx4 v19, s[20:23], s44 offen offset:2048 nt lds
  v_mfma_f32_32x32x16_bf16 v[144:159], v[44:47], a[40:43], v[144:159]
  ds_read_b64_tr_b16 v[44:45], v8 offset:49152
  ds_read_b64_tr_b16 v[46:47], v8 offset:50176
  v_mfma_f32_32x32x16_bf16 v[96:111], v[48:51], a[44:47], v[96:111]
  ds_read_b64_tr_b16 v[48:49], v9 offset:49152
  ds_read_b64_tr_b16 v[50:51], v9 offset:50176
  s_waitcnt lgkmcnt(6)
  v_mfma_f32_32x32x16_bf16 v[112:127], v[52:55], a[44:47], v[112:127]
  ds_read_b64_tr_b16 v[52:53], v10 offset:49152
  ds_read_b64_tr_b16 v[54:55], v10 offset:50176
  v_mfma_f32_32x32x16_bf16 v[128:143], v[56:59], a[44:47], v[128:143]
  ds_read_b64_tr_b16 v[56:57], v7 offset:53248
  ds_read_b64_tr_b16 v[58:59], v7 offset:54272
  v_mfma_f32_32x32x16_bf16 v[144:159], v[60:63], a[44:47], v[144:159]
  ds_read_b64_tr_b16 v[60:61], v8 offset:53248
  ds_read_b64_tr_b16 v[62:63], v8 offset:54272
  s_waitcnt lgkmcnt(6)
  v_mfma_f32_32x32x16_bf16 v[96:111], v[40:43], a[48:51], v[96:111]
  ds_read_b64_tr_b16 v[40:41], v9 offset:53248
  ds_read_b64_tr_b16 v[42:43], v9 offset:54272
  v_mfma_f32_32x32x16_bf16 v[112:127], v[44:47], a[48:51], v[112:127]
  ds_read_b64_tr_b16 v[44:45], v10 offset:53248
  ds_read_b64_tr_b16 v[46:47], v10 offset:54272
  v_mfma_f32_32x32x16_bf16 v[128:143], v[48:51], a[48:51], v[128:143]
  ds_read_b64_tr_b16 v[48:49], v7 offset:57344
  ds_read_b64_tr_b16 v[50:51], v7 offset:58368
  s_waitcnt lgkmcnt(6)
  v_mfma_f32_32x32x16_bf16 v[144:159], v[52:55], a[48:51], v[144:159]
  ds_read_b64_tr_b16 v[52:53], v8 offset:57344
  ds_read_b64_tr_b16 v[54:55], v8 offset:58368
  v_mfma_f32_32x32x16_bf16 v[96:111], v[56:59], a[52:55], v[96:111]
  ds_read_b64_tr_b16 v[56:57], v9 offset:57344
  ds_read_b64_tr_b16 v[58:59], v9 offset:58368
  v_mfma_f32_32x32x16_bf16 v[112:127], v[60:63], a[52:55], v[112:127]
  ds_read_b64_tr_b16 v[60:61], v10 offset:57344
  ds_read_b64_tr_b16 v[62:63], v10 offset:58368
  s_waitcnt vmcnt(29)
  s_barrier
  s_mov_b32 s45, 307456
  s_waitcnt lgkmcnt(6)
  v_mfma_f32_32x32x16_bf16 v[128:143], v[40:43], a[52:55], v[128:143]
  ds_read_b64_tr_b16 v[40:41], v7 offset:24576
  ds_read_b64_tr_b16 v[42:43], v7 offset:25600
  s_add_u32 m0, s32, 12288
  s_nop 0
  buffer_load_dwordx4 v17, s[20:23], s45 offen offset:0 nt lds
  buffer_load_dwordx4 v18, s[20:23], s45 offen offset:1024 nt lds
  buffer_load_dwordx4 v19, s[20:23], s45 offen offset:2048 nt lds
  v_mfma_f32_32x32x16_bf16 v[144:159], v[44:47], a[52:55], v[144:159]
  ds_read_b64_tr_b16 v[44:45], v8 offset:24576
  ds_read_b64_tr_b16 v[46:47], v8 offset:25600
  v_mfma_f32_32x32x16_bf16 v[96:111], v[48:51], a[56:59], v[96:111]
  ds_read_b64_tr_b16 v[48:49], v9 offset:24576
  ds_read_b64_tr_b16 v[50:51], v9 offset:25600
  s_waitcnt lgkmcnt(6)
  v_mfma_f32_32x32x16_bf16 v[112:127], v[52:55], a[56:59], v[112:127]
  ds_read_b64_tr_b16 v[52:53], v10 offset:24576
  ds_read_b64_tr_b16 v[54:55], v10 offset:25600
  v_mfma_f32_32x32x16_bf16 v[128:143], v[56:59], a[56:59], v[128:143]
  ds_read_b64_tr_b16 v[56:57], v7 offset:28672
  ds_read_b64_tr_b16 v[58:59], v7 offset:29696
  v_mfma_f32_32x32x16_bf16 v[144:159], v[60:63], a[56:59], v[144:159]
  ds_read_b64_tr_b16 v[60:61], v8 offset:28672
  ds_read_b64_tr_b16 v[62:63], v8 offset:29696
  s_waitcnt lgkmcnt(6)
  v_mfma_f32_32x32x16_bf16 v[96:111], v[40:43], a[60:63], v[96:111]
  ds_read_b64_tr_b16 v[40:41], v9 offset:28672
  ds_read_b64_tr_b16 v[42:43], v9 offset:29696
  v_mfma_f32_32x32x16_bf16 v[112:127], v[44:47], a[60:63], v[112:127]
  ds_read_b64_tr_b16 v[44:45], v10 offset:28672
  ds_read_b64_tr_b16 v[46:47], v10 offset:29696
  v_mfma_f32_32x32x16_bf16 v[128:143], v[48:51], a[60:63], v[128:143]
  ds_read_b64_tr_b16 v[48:49], v7 offset:32768
  ds_read_b64_tr_b16 v[50:51], v7 offset:33792
  s_waitcnt lgkmcnt(6)
  v_mfma_f32_32x32x16_bf16 v[144:159], v[52:55], a[60:63], v[144:159]
  ds_read_b64_tr_b16 v[52:53], v8 offset:32768
  ds_read_b64_tr_b16 v[54:55], v8 offset:33792
  v_mfma_f32_32x32x16_bf16 v[96:111], v[56:59], a[64:67], v[96:111]
  ds_read_b64_tr_b16 v[56:57], v9 offset:32768
  ds_read_b64_tr_b16 v[58:59], v9 offset:33792
  v_mfma_f32_32x32x16_bf16 v[112:127], v[60:63], a[64:67], v[112:127]
  ds_read_b64_tr_b16 v[60:61], v10 offset:32768
  ds_read_b64_tr_b16 v[62:63], v10 offset:33792
  s_waitcnt vmcnt(29)
  s_barrier
  s_mov_b32 s44, 368896
  s_waitcnt lgkmcnt(6)
  v_mfma_f32_32x32x16_bf16 v[128:143], v[40:43], a[64:67], v[128:143]
  ds_read_b64_tr_b16 v[40:41], v72 offset:24576
  ds_read_b64_tr_b16 v[42:43], v72 offset:25600
  s_add_u32 m0, s32, 49152
  s_nop 0
  buffer_load_dwordx4 v17, s[20:23], s44 offen offset:0 nt lds
  buffer_load_dwordx4 v18, s[20:23], s44 offen offset:1024 nt lds
  buffer_load_dwordx4 v19, s[20:23], s44 offen offset:2048 nt lds
  v_mfma_f32_32x32x16_bf16 v[144:159], v[44:47], a[64:67], v[144:159]
  ds_read_b64_tr_b16 v[44:45], v73 offset:24576
  ds_read_b64_tr_b16 v[46:47], v73 offset:25600
  v_mfma_f32_32x32x16_bf16 v[96:111], v[48:51], a[68:71], v[96:111]
  ds_read_b64_tr_b16 v[48:49], v74 offset:24576
  ds_read_b64_tr_b16 v[50:51], v74 offset:25600
  s_waitcnt lgkmcnt(6)
  v_mfma_f32_32x32x16_bf16 v[112:127], v[52:55], a[68:71], v[112:127]
  ds_read_b64_tr_b16 v[52:53], v75 offset:24576
  ds_read_b64_tr_b16 v[54:55], v75 offset:25600
  v_mfma_f32_32x32x16_bf16 v[128:143], v[56:59], a[68:71], v[128:143]
  ds_read_b64_tr_b16 v[56:57], v72 offset:28672
  ds_read_b64_tr_b16 v[58:59], v72 offset:29696
  v_mfma_f32_32x32x16_bf16 v[144:159], v[60:63], a[68:71], v[144:159]
  ds_read_b64_tr_b16 v[60:61], v73 offset:28672
  ds_read_b64_tr_b16 v[62:63], v73 offset:29696
  s_waitcnt lgkmcnt(6)
  v_mfma_f32_32x32x16_bf16 v[96:111], v[40:43], a[72:75], v[96:111]
  ds_read_b64_tr_b16 v[40:41], v74 offset:28672
  ds_read_b64_tr_b16 v[42:43], v74 offset:29696
  v_mfma_f32_32x32x16_bf16 v[112:127], v[44:47], a[72:75], v[112:127]
  ds_read_b64_tr_b16 v[44:45], v75 offset:28672
  ds_read_b64_tr_b16 v[46:47], v75 offset:29696
  v_mfma_f32_32x32x16_bf16 v[128:143], v[48:51], a[72:75], v[128:143]
  ds_read_b64_tr_b16 v[48:49], v72 offset:32768
  ds_read_b64_tr_b16 v[50:51], v72 offset:33792
  s_waitcnt lgkmcnt(6)
  v_mfma_f32_32x32x16_bf16 v[144:159], v[52:55], a[72:75], v[144:159]
  ds_read_b64_tr_b16 v[52:53], v73 offset:32768
  ds_read_b64_tr_b16 v[54:55], v73 offset:33792
  v_mfma_f32_32x32x16_bf16 v[96:111], v[56:59], a[76:79], v[96:111]
  ds_read_b64_tr_b16 v[56:57], v74 offset:32768
  ds_read_b64_tr_b16 v[58:59], v74 offset:33792
  v_mfma_f32_32x32x16_bf16 v[112:127], v[60:63], a[76:79], v[112:127]
  ds_read_b64_tr_b16 v[60:61], v75 offset:32768
  ds_read_b64_tr_b16 v[62:63], v75 offset:33792
  s_waitcnt vmcnt(29)
  s_barrier
  s_mov_b32 s45, 430336
  s_waitcnt lgkmcnt(6)
  v_mfma_f32_32x32x16_bf16 v[128:143], v[40:43], a[76:79], v[128:143]
  ds_read_b64_tr_b16 v[40:41], v72 offset:36864
  ds_read_b64_tr_b16 v[42:43], v72 offset:37888
  s_add_u32 m0, s32, 24576
  s_nop 0
  buffer_load_dwordx4 v17, s[20:23], s45 offen offset:0 nt lds
  buffer_load_dwordx4 v18, s[20:23], s45 offen offset:1024 nt lds
  buffer_load_dwordx4 v19, s[20:23], s45 offen offset:2048 nt lds
  v_mfma_f32_32x32x16_bf16 v[144:159], v[44:47], a[76:79], v[144:159]
  ds_read_b64_tr_b16 v[44:45], v73 offset:36864
  ds_read_b64_tr_b16 v[46:47], v73 offset:37888
  v_mfma_f32_32x32x16_bf16 v[96:111], v[48:51], a[80:83], v[96:111]
  ds_read_b64_tr_b16 v[48:49], v74 offset:36864
  ds_read_b64_tr_b16 v[50:51], v74 offset:37888
  s_waitcnt lgkmcnt(6)
  v_mfma_f32_32x32x16_bf16 v[112:127], v[52:55], a[80:83], v[112:127]
  ds_read_b64_tr_b16 v[52:53], v75 offset:36864
  ds_read_b64_tr_b16 v[54:55], v75 offset:37888
  v_mfma_f32_32x32x16_bf16 v[128:143], v[56:59], a[80:83], v[128:143]
  ds_read_b64_tr_b16 v[56:57], v72 offset:40960
  ds_read_b64_tr_b16 v[58:59], v72 offset:41984
  v_mfma_f32_32x32x16_bf16 v[144:159], v[60:63], a[80:83], v[144:159]
  ds_read_b64_tr_b16 v[60:61], v73 offset:40960
  ds_read_b64_tr_b16 v[62:63], v73 offset:41984
  s_waitcnt lgkmcnt(6)
  v_mfma_f32_32x32x16_bf16 v[96:111], v[40:43], a[84:87], v[96:111]
  ds_read_b64_tr_b16 v[40:41], v74 offset:40960
  ds_read_b64_tr_b16 v[42:43], v74 offset:41984
  v_mfma_f32_32x32x16_bf16 v[112:127], v[44:47], a[84:87], v[112:127]
  ds_read_b64_tr_b16 v[44:45], v75 offset:40960
  ds_read_b64_tr_b16 v[46:47], v75 offset:41984
  v_mfma_f32_32x32x16_bf16 v[128:143], v[48:51], a[84:87], v[128:143]
  ds_read_b64_tr_b16 v[48:49], v72 offset:45056
  ds_read_b64_tr_b16 v[50:51], v72 offset:46080
  s_waitcnt lgkmcnt(6)
  v_mfma_f32_32x32x16_bf16 v[144:159], v[52:55], a[84:87], v[144:159]
  ds_read_b64_tr_b16 v[52:53], v73 offset:45056
  ds_read_b64_tr_b16 v[54:55], v73 offset:46080
  v_mfma_f32_32x32x16_bf16 v[96:111], v[56:59], a[88:91], v[96:111]
  ds_read_b64_tr_b16 v[56:57], v74 offset:45056
  ds_read_b64_tr_b16 v[58:59], v74 offset:46080
  v_mfma_f32_32x32x16_bf16 v[112:127], v[60:63], a[88:91], v[112:127]
  ds_read_b64_tr_b16 v[60:61], v75 offset:45056
  ds_read_b64_tr_b16 v[62:63], v75 offset:46080
  s_waitcnt vmcnt(29)
  s_barrier
  s_waitcnt lgkmcnt(6)
  v_mfma_f32_32x32x16_bf16 v[128:143], v[40:43], a[88:91], v[128:143]
  ds_read_b64_tr_b16 v[40:41], v72 offset:12288
  ds_read_b64_tr_b16 v[42:43], v72 offset:13312
  v_mfma_f32_32x32x16_bf16 v[144:159], v[44:47], a[88:91], v[144:159]
  ds_read_b64_tr_b16 v[44:45], v73 offset:12288
  ds_read_b64_tr_b16 v[46:47], v73 offset:13312
  v_mfma_f32_32x32x16_bf16 v[96:111], v[48:51], a[92:95], v[96:111]
  ds_read_b64_tr_b16 v[48:49], v74 offset:12288
  ds_read_b64_tr_b16 v[50:51], v74 offset:13312
  s_waitcnt lgkmcnt(6)
  v_mfma_f32_32x32x16_bf16 v[112:127], v[52:55], a[92:95], v[112:127]
  ds_read_b64_tr_b16 v[52:53], v75 offset:12288
  ds_read_b64_tr_b16 v[54:55], v75 offset:13312
  v_mfma_f32_32x32x16_bf16 v[128:143], v[56:59], a[92:95], v[128:143]
  ds_read_b64_tr_b16 v[56:57], v72 offset:16384
  ds_read_b64_tr_b16 v[58:59], v72 offset:17408
  v_mfma_f32_32x32x16_bf16 v[144:159], v[60:63], a[92:95], v[144:159]
  ds_read_b64_tr_b16 v[60:61], v73 offset:16384
  ds_read_b64_tr_b16 v[62:63], v73 offset:17408
  s_waitcnt lgkmcnt(6)
  v_mfma_f32_32x32x16_bf16 a[96:111], v[40:43], a[48:51], a[96:111]
  ds_read_b64_tr_b16 v[40:41], v74 offset:16384
  ds_read_b64_tr_b16 v[42:43], v74 offset:17408
  v_mfma_f32_32x32x16_bf16 a[112:127], v[44:47], a[48:51], a[112:127]
  ds_read_b64_tr_b16 v[44:45], v75 offset:16384
  ds_read_b64_tr_b16 v[46:47], v75 offset:17408
  v_cvt_pk_bf16_f32 v96, v96, v97
  v_cvt_pk_bf16_f32 v97, v98, v99
  v_cvt_pk_bf16_f32 v98, v100, v101
  v_cvt_pk_bf16_f32 v99, v102, v103
  v_mfma_f32_32x32x16_bf16 a[128:143], v[48:51], a[48:51], a[128:143]
  ds_read_b64_tr_b16 v[48:49], v72 offset:20480
  ds_read_b64_tr_b16 v[50:51], v72 offset:21504
  s_mov_b32 s46, 32768
  buffer_store_dwordx4 v[96:99], v25, s[24:27], s46 offen
  v_cvt_pk_bf16_f32 v104, v104, v105
  s_waitcnt lgkmcnt(6)
  v_mfma_f32_32x32x16_bf16 a[144:159], v[52:55], a[48:51], a[144:159]
  ds_read_b64_tr_b16 v[52:53], v73 offset:20480
  ds_read_b64_tr_b16 v[54:55], v73 offset:21504
  v_cvt_pk_bf16_f32 v105, v106, v107
  v_cvt_pk_bf16_f32 v106, v108, v109
  v_cvt_pk_bf16_f32 v107, v110, v111
  v_mfma_f32_32x32x16_bf16 a[96:111], v[56:59], a[52:55], a[96:111]
  ds_read_b64_tr_b16 v[56:57], v74 offset:20480
  ds_read_b64_tr_b16 v[58:59], v74 offset:21504
  s_mov_b32 s46, 33792
  buffer_store_dwordx4 v[104:107], v25, s[24:27], s46 offen
  v_cvt_pk_bf16_f32 v112, v112, v113
  v_cvt_pk_bf16_f32 v113, v114, v115
  v_mfma_f32_32x32x16_bf16 a[112:127], v[60:63], a[52:55], a[112:127]
  ds_read_b64_tr_b16 v[60:61], v75 offset:20480
  ds_read_b64_tr_b16 v[62:63], v75 offset:21504
  s_waitcnt vmcnt(26)
  s_barrier
  v_cvt_pk_bf16_f32 v114, v116, v117
  s_waitcnt lgkmcnt(6)
  v_mfma_f32_32x32x16_bf16 a[128:143], v[40:43], a[52:55], a[128:143]
  ds_read_b64_tr_b16 v[40:41], v76 offset:0
  ds_read_b64_tr_b16 v[42:43], v76 offset:1024
  v_cvt_pk_bf16_f32 v115, v118, v119
  s_mov_b32 s46, 34816
  buffer_store_dwordx4 v[112:115], v25, s[24:27], s46 offen
  v_cvt_pk_bf16_f32 v120, v120, v121
  v_mfma_f32_32x32x16_bf16 a[144:159], v[44:47], a[52:55], a[144:159]
  ds_read_b64_tr_b16 v[44:45], v77 offset:0
  ds_read_b64_tr_b16 v[46:47], v77 offset:1024
  v_cvt_pk_bf16_f32 v121, v122, v123
  v_cvt_pk_bf16_f32 v122, v124, v125
  v_cvt_pk_bf16_f32 v123, v126, v127
  v_mfma_f32_32x32x16_bf16 a[96:111], v[48:51], a[56:59], a[96:111]
  ds_read_b64_tr_b16 v[48:49], v78 offset:0
  ds_read_b64_tr_b16 v[50:51], v78 offset:1024
  s_mov_b32 s46, 35840
  buffer_store_dwordx4 v[120:123], v25, s[24:27], s46 offen
  v_cvt_pk_bf16_f32 v128, v128, v129
  s_waitcnt lgkmcnt(6)
  v_mfma_f32_32x32x16_bf16 a[112:127], v[52:55], a[56:59], a[112:127]
  ds_read_b64_tr_b16 v[52:53], v79 offset:0
  ds_read_b64_tr_b16 v[54:55], v79 offset:1024
  v_cvt_pk_bf16_f32 v129, v130, v131
  v_cvt_pk_bf16_f32 v130, v132, v133
  v_cvt_pk_bf16_f32 v131, v134, v135
  v_mfma_f32_32x32x16_bf16 a[128:143], v[56:59], a[56:59], a[128:143]
  ds_read_b64_tr_b16 v[56:57], v76 offset:4096
  ds_read_b64_tr_b16 v[58:59], v76 offset:5120
  s_mov_b32 s46, 36864
  buffer_store_dwordx4 v[128:131], v25, s[24:27], s46 offen
  v_cvt_pk_bf16_f32 v136, v136, v137
  v_cvt_pk_bf16_f32 v137, v138, v139
  v_mfma_f32_32x32x16_bf16 a[144:159], v[60:63], a[56:59], a[144:159]
  ds_read_b64_tr_b16 v[60:61], v77 offset:4096
  ds_read_b64_tr_b16 v[62:63], v77 offset:5120
  v_cvt_pk_bf16_f32 v138, v140, v141
  v_cvt_pk_bf16_f32 v139, v142, v143
  s_waitcnt lgkmcnt(6)
  v_mfma_f32_32x32x16_bf16 a[96:111], v[40:43], a[60:63], a[96:111]
  ds_read_b64_tr_b16 v[40:41], v78 offset:4096
  ds_read_b64_tr_b16 v[42:43], v78 offset:5120
  s_mov_b32 s46, 37888
  buffer_store_dwordx4 v[136:139], v25, s[24:27], s46 offen
  v_cvt_pk_bf16_f32 v144, v144, v145
  v_cvt_pk_bf16_f32 v145, v146, v147
  v_mfma_f32_32x32x16_bf16 a[112:127], v[44:47], a[60:63], a[112:127]
  ds_read_b64_tr_b16 v[44:45], v79 offset:4096
  ds_read_b64_tr_b16 v[46:47], v79 offset:5120
  v_cvt_pk_bf16_f32 v146, v148, v149
  v_cvt_pk_bf16_f32 v147, v150, v151
  s_mov_b32 s46, 38912
  buffer_store_dwordx4 v[144:147], v25, s[24:27], s46 offen
  v_mfma_f32_32x32x16_bf16 a[128:143], v[48:51], a[60:63], a[128:143]
  ds_read_b64_tr_b16 v[48:49], v76 offset:8192
  ds_read_b64_tr_b16 v[50:51], v76 offset:9216
  v_cvt_pk_bf16_f32 v152, v152, v153
  v_cvt_pk_bf16_f32 v153, v154, v155
  v_cvt_pk_bf16_f32 v154, v156, v157
  s_waitcnt lgkmcnt(6)
  v_mfma_f32_32x32x16_bf16 a[144:159], v[52:55], a[60:63], a[144:159]
  ds_read_b64_tr_b16 v[52:53], v77 offset:8192
  ds_read_b64_tr_b16 v[54:55], v77 offset:9216
  v_cvt_pk_bf16_f32 v155, v158, v159
  s_mov_b32 s46, 39936
  buffer_store_dwordx4 v[152:155], v25, s[24:27], s46 offen
  v_mfma_f32_32x32x16_bf16 a[96:111], v[56:59], a[64:67], a[96:111]
  ds_read_b64_tr_b16 v[56:57], v78 offset:8192
  ds_read_b64_tr_b16 v[58:59], v78 offset:9216
  v_mfma_f32_32x32x16_bf16 a[112:127], v[60:63], a[64:67], a[112:127]
  ds_read_b64_tr_b16 v[60:61], v79 offset:8192
  ds_read_b64_tr_b16 v[62:63], v79 offset:9216
  s_waitcnt vmcnt(23)
  s_barrier
  s_waitcnt lgkmcnt(6)
  v_mfma_f32_32x32x16_bf16 a[128:143], v[40:43], a[64:67], a[128:143]
  ds_read_b64_tr_b16 v[40:41], v7 offset:36864
  ds_read_b64_tr_b16 v[42:43], v7 offset:37888
  v_mfma_f32_32x32x16_bf16 a[144:159], v[44:47], a[64:67], a[144:159]
  ds_read_b64_tr_b16 v[44:45], v8 offset:36864
  ds_read_b64_tr_b16 v[46:47], v8 offset:37888
  v_mfma_f32_32x32x16_bf16 a[96:111], v[48:51], a[68:71], a[96:111]
  ds_read_b64_tr_b16 v[48:49], v9 offset:36864
  ds_read_b64_tr_b16 v[50:51], v9 offset:37888
  s_waitcnt lgkmcnt(6)
  v_mfma_f32_32x32x16_bf16 a[112:127], v[52:55], a[68:71], a[112:127]
  ds_read_b64_tr_b16 v[52:53], v10 offset:36864
  ds_read_b64_tr_b16 v[54:55], v10 offset:37888
  v_mfma_f32_32x32x16_bf16 a[128:143], v[56:59], a[68:71], a[128:143]
  ds_read_b64_tr_b16 v[56:57], v7 offset:40960
  ds_read_b64_tr_b16 v[58:59], v7 offset:41984
  v_mfma_f32_32x32x16_bf16 a[144:159], v[60:63], a[68:71], a[144:159]
  ds_read_b64_tr_b16 v[60:61], v8 offset:40960
  ds_read_b64_tr_b16 v[62:63], v8 offset:41984
  s_waitcnt lgkmcnt(6)
  v_mfma_f32_32x32x16_bf16 a[96:111], v[40:43], a[72:75], a[96:111]
  ds_read_b64_tr_b16 v[40:41], v9 offset:40960
  ds_read_b64_tr_b16 v[42:43], v9 offset:41984
  v_mfma_f32_32x32x16_bf16 a[112:127], v[44:47], a[72:75], a[112:127]
  ds_read_b64_tr_b16 v[44:45], v10 offset:40960
  ds_read_b64_tr_b16 v[46:47], v10 offset:41984
  v_mfma_f32_32x32x16_bf16 a[128:143], v[48:51], a[72:75], a[128:143]
  ds_read_b64_tr_b16 v[48:49], v7 offset:45056
  ds_read_b64_tr_b16 v[50:51], v7 offset:46080
  s_waitcnt lgkmcnt(6)
  v_mfma_f32_32x32x16_bf16 a[144:159], v[52:55], a[72:75], a[144:159]
  ds_read_b64_tr_b16 v[52:53], v8 offset:45056
  ds_read_b64_tr_b16 v[54:55], v8 offset:46080
  v_mfma_f32_32x32x16_bf16 a[96:111], v[56:59], a[76:79], a[96:111]
  ds_read_b64_tr_b16 v[56:57], v9 offset:45056
  ds_read_b64_tr_b16 v[58:59], v9 offset:46080
  v_mfma_f32_32x32x16_bf16 a[112:127], v[60:63], a[76:79], a[112:127]
  ds_read_b64_tr_b16 v[60:61], v10 offset:45056
  ds_read_b64_tr_b16 v[62:63], v10 offset:46080
  s_waitcnt vmcnt(20)
  s_barrier
  s_waitcnt lgkmcnt(6)
  v_mfma_f32_32x32x16_bf16 a[128:143], v[40:43], a[76:79], a[128:143]
  ds_read_b64_tr_b16 v[40:41], v7 offset:0
  ds_read_b64_tr_b16 v[42:43], v7 offset:1024
  v_mfma_f32_32x32x16_bf16 a[144:159], v[44:47], a[76:79], a[144:159]
  ds_read_b64_tr_b16 v[44:45], v8 offset:0
  ds_read_b64_tr_b16 v[46:47], v8 offset:1024
  v_mfma_f32_32x32x16_bf16 a[96:111], v[48:51], a[80:83], a[96:111]
  ds_read_b64_tr_b16 v[48:49], v9 offset:0
  ds_read_b64_tr_b16 v[50:51], v9 offset:1024
  s_waitcnt lgkmcnt(6)
  v_mfma_f32_32x32x16_bf16 a[112:127], v[52:55], a[80:83], a[112:127]
  ds_read_b64_tr_b16 v[52:53], v10 offset:0
  ds_read_b64_tr_b16 v[54:55], v10 offset:1024
  v_mfma_f32_32x32x16_bf16 a[128:143], v[56:59], a[80:83], a[128:143]
  ds_read_b64_tr_b16 v[56:57], v7 offset:4096
  ds_read_b64_tr_b16 v[58:59], v7 offset:5120
  v_mfma_f32_32x32x16_bf16 a[144:159], v[60:63], a[80:83], a[144:159]
  ds_read_b64_tr_b16 v[60:61], v8 offset:4096
  ds_read_b64_tr_b16 v[62:63], v8 offset:5120
  s_waitcnt lgkmcnt(6)
  v_mfma_f32_32x32x16_bf16 a[96:111], v[40:43], a[84:87], a[96:111]
  ds_read_b64_tr_b16 v[40:41], v9 offset:4096
  ds_read_b64_tr_b16 v[42:43], v9 offset:5120
  v_mfma_f32_32x32x16_bf16 a[112:127], v[44:47], a[84:87], a[112:127]
  ds_read_b64_tr_b16 v[44:45], v10 offset:4096
  ds_read_b64_tr_b16 v[46:47], v10 offset:5120
  v_mfma_f32_32x32x16_bf16 a[128:143], v[48:51], a[84:87], a[128:143]
  ds_read_b64_tr_b16 v[48:49], v7 offset:8192
  ds_read_b64_tr_b16 v[50:51], v7 offset:9216
  s_waitcnt lgkmcnt(6)
  v_mfma_f32_32x32x16_bf16 a[144:159], v[52:55], a[84:87], a[144:159]
  ds_read_b64_tr_b16 v[52:53], v8 offset:8192
  ds_read_b64_tr_b16 v[54:55], v8 offset:9216
  v_mfma_f32_32x32x16_bf16 a[96:111], v[56:59], a[88:91], a[96:111]
  ds_read_b64_tr_b16 v[56:57], v9 offset:8192
  ds_read_b64_tr_b16 v[58:59], v9 offset:9216
  v_mfma_f32_32x32x16_bf16 a[112:127], v[60:63], a[88:91], a[112:127]
  ds_read_b64_tr_b16 v[60:61], v10 offset:8192
  ds_read_b64_tr_b16 v[62:63], v10 offset:9216
  s_waitcnt vmcnt(17)
  s_barrier
  s_waitcnt lgkmcnt(6)
  v_mfma_f32_32x32x16_bf16 a[128:143], v[40:43], a[88:91], a[128:143]
  ds_read_b64_tr_b16 v[40:41], v76 offset:12288
  ds_read_b64_tr_b16 v[42:43], v76 offset:13312
  v_mfma_f32_32x32x16_bf16 a[144:159], v[44:47], a[88:91], a[144:159]
  ds_read_b64_tr_b16 v[44:45], v77 offset:12288
  ds_read_b64_tr_b16 v[46:47], v77 offset:13312
  v_mfma_f32_32x32x16_bf16 a[96:111], v[48:51], a[92:95], a[96:111]
  ds_read_b64_tr_b16 v[48:49], v78 offset:12288
  ds_read_b64_tr_b16 v[50:51], v78 offset:13312
  s_waitcnt lgkmcnt(6)
  v_mfma_f32_32x32x16_bf16 a[112:127], v[52:55], a[92:95], a[112:127]
  ds_read_b64_tr_b16 v[52:53], v79 offset:12288
  ds_read_b64_tr_b16 v[54:55], v79 offset:13312
  v_mfma_f32_32x32x16_bf16 a[128:143], v[56:59], a[92:95], a[128:143]
  ds_read_b64_tr_b16 v[56:57], v76 offset:16384
  ds_read_b64_tr_b16 v[58:59], v76 offset:17408
  v_mfma_f32_32x32x16_bf16 a[144:159], v[60:63], a[92:95], a[144:159]
  ds_read_b64_tr_b16 v[60:61], v77 offset:16384
  ds_read_b64_tr_b16 v[62:63], v77 offset:17408
  s_waitcnt lgkmcnt(6)
  v_mfma_f32_32x32x16_bf16 a[160:175], v[40:43], a[48:51], a[160:175]
  ds_read_b64_tr_b16 v[40:41], v78 offset:16384
  ds_read_b64_tr_b16 v[42:43], v78 offset:17408
  v_mfma_f32_32x32x16_bf16 a[176:191], v[44:47], a[48:51], a[176:191]
  ds_read_b64_tr_b16 v[44:45], v79 offset:16384
  ds_read_b64_tr_b16 v[46:47], v79 offset:17408
  v_accvgpr_read_b32 v32, a96
  v_accvgpr_read_b32 v33, a97
  v_cvt_pk_bf16_f32 v64, v32, v33
  v_accvgpr_read_b32 v34, a98
  v_mfma_f32_32x32x16_bf16 a[192:207], v[48:51], a[48:51], a[192:207]
  ds_read_b64_tr_b16 v[48:49], v76 offset:20480
  ds_read_b64_tr_b16 v[50:51], v76 offset:21504
  v_accvgpr_read_b32 v35, a99
  v_cvt_pk_bf16_f32 v65, v34, v35
  v_accvgpr_read_b32 v32, a100
  s_waitcnt lgkmcnt(6)
  v_mfma_f32_32x32x16_bf16 a[208:223], v[52:55], a[48:51], a[208:223]
  ds_read_b64_tr_b16 v[52:53], v77 offset:20480
  ds_read_b64_tr_b16 v[54:55], v77 offset:21504
  v_accvgpr_read_b32 v33, a101
  v_cvt_pk_bf16_f32 v66, v32, v33
  v_accvgpr_read_b32 v34, a102
  v_accvgpr_read_b32 v35, a103
  v_mfma_f32_32x32x16_bf16 a[160:175], v[56:59], a[52:55], a[160:175]
  ds_read_b64_tr_b16 v[56:57], v78 offset:20480
  ds_read_b64_tr_b16 v[58:59], v78 offset:21504
  v_cvt_pk_bf16_f32 v67, v34, v35
  s_mov_b32 s46, 0
  buffer_store_dwordx4 v[64:67], v25, s[24:27], s46 offen
  v_accvgpr_read_b32 v32, a104
  v_mfma_f32_32x32x16_bf16 a[176:191], v[60:63], a[52:55], a[176:191]
  ds_read_b64_tr_b16 v[60:61], v79 offset:20480
  ds_read_b64_tr_b16 v[62:63], v79 offset:21504
  s_waitcnt vmcnt(15)
  s_barrier
  v_accvgpr_read_b32 v33, a105
  s_waitcnt lgkmcnt(6)
  v_mfma_f32_32x32x16_bf16 a[192:207], v[40:43], a[52:55], a[192:207]
  ds_read_b64_tr_b16 v[40:41], v7 offset:12288
  ds_read_b64_tr_b16 v[42:43], v7 offset:13312
  v_cvt_pk_bf16_f32 v68, v32, v33
  v_accvgpr_read_b32 v34, a106
  v_accvgpr_read_b32 v35, a107
  v_cvt_pk_bf16_f32 v69, v34, v35
  v_mfma_f32_32x32x16_bf16 a[208:223], v[44:47], a[52:55], a[208:223]
  ds_read_b64_tr_b16 v[44:45], v8 offset:12288
  ds_read_b64_tr_b16 v[46:47], v8 offset:13312
  v_accvgpr_read_b32 v32, a108
  v_accvgpr_read_b32 v33, a109
  v_cvt_pk_bf16_f32 v70, v32, v33
  v_accvgpr_read_b32 v34, a110
  v_mfma_f32_32x32x16_bf16 a[160:175], v[48:51], a[56:59], a[160:175]
  ds_read_b64_tr_b16 v[48:49], v9 offset:12288
  ds_read_b64_tr_b16 v[50:51], v9 offset:13312
  v_accvgpr_read_b32 v35, a111
  v_cvt_pk_bf16_f32 v71, v34, v35
  s_waitcnt lgkmcnt(6)
  v_mfma_f32_32x32x16_bf16 a[176:191], v[52:55], a[56:59], a[176:191]
  ds_read_b64_tr_b16 v[52:53], v10 offset:12288
  ds_read_b64_tr_b16 v[54:55], v10 offset:13312
  s_mov_b32 s46, 1024
  buffer_store_dwordx4 v[68:71], v25, s[24:27], s46 offen
  v_accvgpr_read_b32 v32, a112
  v_accvgpr_read_b32 v33, a113
  v_mfma_f32_32x32x16_bf16 a[192:207], v[56:59], a[56:59], a[192:207]
  ds_read_b64_tr_b16 v[56:57], v7 offset:16384
  ds_read_b64_tr_b16 v[58:59], v7 offset:17408
  v_cvt_pk_bf16_f32 v64, v32, v33
  v_accvgpr_read_b32 v34, a114
  v_accvgpr_read_b32 v35, a115
  v_cvt_pk_bf16_f32 v65, v34, v35
  v_mfma_f32_32x32x16_bf16 a[208:223], v[60:63], a[56:59], a[208:223]
  ds_read_b64_tr_b16 v[60:61], v8 offset:16384
  ds_read_b64_tr_b16 v[62:63], v8 offset:17408
  v_accvgpr_read_b32 v32, a116
  v_accvgpr_read_b32 v33, a117
  v_cvt_pk_bf16_f32 v66, v32, v33
  s_waitcnt lgkmcnt(6)
  v_mfma_f32_32x32x16_bf16 a[160:175], v[40:43], a[60:63], a[160:175]
  ds_read_b64_tr_b16 v[40:41], v9 offset:16384
  ds_read_b64_tr_b16 v[42:43], v9 offset:17408
  v_accvgpr_read_b32 v34, a118
  v_accvgpr_read_b32 v35, a119
  v_cvt_pk_bf16_f32 v67, v34, v35
  v_mfma_f32_32x32x16_bf16 a[176:191], v[44:47], a[60:63], a[176:191]
  ds_read_b64_tr_b16 v[44:45], v10 offset:16384
  ds_read_b64_tr_b16 v[46:47], v10 offset:17408
  s_mov_b32 s46, 2048
  buffer_store_dwordx4 v[64:67], v25, s[24:27], s46 offen
  v_accvgpr_read_b32 v32, a120
  v_accvgpr_read_b32 v33, a121
  v_mfma_f32_32x32x16_bf16 a[192:207], v[48:51], a[60:63], a[192:207]
  ds_read_b64_tr_b16 v[48:49], v7 offset:20480
  ds_read_b64_tr_b16 v[50:51], v7 offset:21504
  v_cvt_pk_bf16_f32 v68, v32, v33
  v_accvgpr_read_b32 v34, a122
  v_accvgpr_read_b32 v35, a123
  s_waitcnt lgkmcnt(6)
  v_mfma_f32_32x32x16_bf16 a[208:223], v[52:55], a[60:63], a[208:223]
  ds_read_b64_tr_b16 v[52:53], v8 offset:20480
  ds_read_b64_tr_b16 v[54:55], v8 offset:21504
  v_cvt_pk_bf16_f32 v69, v34, v35
  v_accvgpr_read_b32 v32, a124
  v_accvgpr_read_b32 v33, a125
  v_cvt_pk_bf16_f32 v70, v32, v33
  v_mfma_f32_32x32x16_bf16 a[160:175], v[56:59], a[64:67], a[160:175]
  ds_read_b64_tr_b16 v[56:57], v9 offset:20480
  ds_read_b64_tr_b16 v[58:59], v9 offset:21504
  v_accvgpr_read_b32 v34, a126
  v_accvgpr_read_b32 v35, a127
  v_cvt_pk_bf16_f32 v71, v34, v35
  v_mfma_f32_32x32x16_bf16 a[176:191], v[60:63], a[64:67], a[176:191]
  ds_read_b64_tr_b16 v[60:61], v10 offset:20480
  ds_read_b64_tr_b16 v[62:63], v10 offset:21504
  s_waitcnt vmcnt(14)
  s_barrier
  s_waitcnt lgkmcnt(6)
  v_mfma_f32_32x32x16_bf16 a[192:207], v[40:43], a[64:67], a[192:207]
  ds_read_b64_tr_b16 v[40:41], v7 offset:49152
  ds_read_b64_tr_b16 v[42:43], v7 offset:50176
  s_mov_b32 s46, 3072
  buffer_store_dwordx4 v[68:71], v25, s[24:27], s46 offen
  v_accvgpr_read_b32 v32, a128
  v_accvgpr_read_b32 v33, a129
  v_mfma_f32_32x32x16_bf16 a[208:223], v[44:47], a[64:67], a[208:223]
  ds_read_b64_tr_b16 v[44:45], v8 offset:49152
  ds_read_b64_tr_b16 v[46:47], v8 offset:50176
  v_cvt_pk_bf16_f32 v64, v32, v33
  v_accvgpr_read_b32 v34, a130
  v_accvgpr_read_b32 v35, a131
  v_cvt_pk_bf16_f32 v65, v34, v35
  v_mfma_f32_32x32x16_bf16 a[160:175], v[48:51], a[68:71], a[160:175]
  ds_read_b64_tr_b16 v[48:49], v9 offset:49152
  ds_read_b64_tr_b16 v[50:51], v9 offset:50176
  v_accvgpr_read_b32 v32, a132
  v_accvgpr_read_b32 v33, a133
  v_cvt_pk_bf16_f32 v66, v32, v33
  s_waitcnt lgkmcnt(6)
  v_mfma_f32_32x32x16_bf16 a[176:191], v[52:55], a[68:71], a[176:191]
  ds_read_b64_tr_b16 v[52:53], v10 offset:49152
  ds_read_b64_tr_b16 v[54:55], v10 offset:50176
  v_accvgpr_read_b32 v34, a134
  v_accvgpr_read_b32 v35, a135
  v_cvt_pk_bf16_f32 v67, v34, v35
  v_mfma_f32_32x32x16_bf16 a[192:207], v[56:59], a[68:71], a[192:207]
  ds_read_b64_tr_b16 v[56:57], v7 offset:53248
  ds_read_b64_tr_b16 v[58:59], v7 offset:54272
  s_mov_b32 s46, 4096
  buffer_store_dwordx4 v[64:67], v25, s[24:27], s46 offen
  v_accvgpr_read_b32 v32, a136
  v_accvgpr_read_b32 v33, a137
  v_mfma_f32_32x32x16_bf16 a[208:223], v[60:63], a[68:71], a[208:223]
  ds_read_b64_tr_b16 v[60:61], v8 offset:53248
  ds_read_b64_tr_b16 v[62:63], v8 offset:54272
  v_cvt_pk_bf16_f32 v68, v32, v33
  v_accvgpr_read_b32 v34, a138
  v_accvgpr_read_b32 v35, a139
  s_waitcnt lgkmcnt(6)
  v_mfma_f32_32x32x16_bf16 a[160:175], v[40:43], a[72:75], a[160:175]
  ds_read_b64_tr_b16 v[40:41], v9 offset:53248
  ds_read_b64_tr_b16 v[42:43], v9 offset:54272
  v_cvt_pk_bf16_f32 v69, v34, v35
  v_accvgpr_read_b32 v32, a140
  v_accvgpr_read_b32 v33, a141
  v_cvt_pk_bf16_f32 v70, v32, v33
  v_mfma_f32_32x32x16_bf16 a[176:191], v[44:47], a[72:75], a[176:191]
  ds_read_b64_tr_b16 v[44:45], v10 offset:53248
  ds_read_b64_tr_b16 v[46:47], v10 offset:54272
  v_accvgpr_read_b32 v34, a142
  v_accvgpr_read_b32 v35, a143
  v_cvt_pk_bf16_f32 v71, v34, v35
  v_mfma_f32_32x32x16_bf16 a[192:207], v[48:51], a[72:75], a[192:207]
  ds_read_b64_tr_b16 v[48:49], v7 offset:57344
  ds_read_b64_tr_b16 v[50:51], v7 offset:58368
  s_mov_b32 s46, 5120
  buffer_store_dwordx4 v[68:71], v25, s[24:27], s46 offen
  v_accvgpr_read_b32 v32, a144
  s_waitcnt lgkmcnt(6)
  v_mfma_f32_32x32x16_bf16 a[208:223], v[52:55], a[72:75], a[208:223]
  ds_read_b64_tr_b16 v[52:53], v8 offset:57344
  ds_read_b64_tr_b16 v[54:55], v8 offset:58368
  v_accvgpr_read_b32 v33, a145
  v_cvt_pk_bf16_f32 v64, v32, v33
  v_accvgpr_read_b32 v34, a146
  v_accvgpr_read_b32 v35, a147
  v_mfma_f32_32x32x16_bf16 a[160:175], v[56:59], a[76:79], a[160:175]
  ds_read_b64_tr_b16 v[56:57], v9 offset:57344
  ds_read_b64_tr_b16 v[58:59], v9 offset:58368
  v_cvt_pk_bf16_f32 v65, v34, v35
  v_accvgpr_read_b32 v32, a148
  v_accvgpr_read_b32 v33, a149
  v_cvt_pk_bf16_f32 v66, v32, v33
  v_mfma_f32_32x32x16_bf16 a[176:191], v[60:63], a[76:79], a[176:191]
  ds_read_b64_tr_b16 v[60:61], v10 offset:57344
  ds_read_b64_tr_b16 v[62:63], v10 offset:58368
  s_waitcnt vmcnt(14)
  s_barrier
  v_accvgpr_read_b32 v34, a150
  s_waitcnt lgkmcnt(6)
  v_mfma_f32_32x32x16_bf16 a[192:207], v[40:43], a[76:79], a[192:207]
  ds_read_b64_tr_b16 v[40:41], v7 offset:24576
  ds_read_b64_tr_b16 v[42:43], v7 offset:25600
  v_accvgpr_read_b32 v35, a151
  v_cvt_pk_bf16_f32 v67, v34, v35
  s_mov_b32 s46, 6144
  buffer_store_dwordx4 v[64:67], v25, s[24:27], s46 offen
  v_mfma_f32_32x32x16_bf16 a[208:223], v[44:47], a[76:79], a[208:223]
  ds_read_b64_tr_b16 v[44:45], v8 offset:24576
  ds_read_b64_tr_b16 v[46:47], v8 offset:25600
  v_accvgpr_read_b32 v32, a152
  v_accvgpr_read_b32 v33, a153
  v_cvt_pk_bf16_f32 v68, v32, v33
  v_accvgpr_read_b32 v34, a154
  v_mfma_f32_32x32x16_bf16 a[160:175], v[48:51], a[80:83], a[160:175]
  ds_read_b64_tr_b16 v[48:49], v9 offset:24576
  ds_read_b64_tr_b16 v[50:51], v9 offset:25600
  v_accvgpr_read_b32 v35, a155
  v_cvt_pk_bf16_f32 v69, v34, v35
  v_accvgpr_read_b32 v32, a156
  s_waitcnt lgkmcnt(6)
  v_mfma_f32_32x32x16_bf16 a[176:191], v[52:55], a[80:83], a[176:191]
  ds_read_b64_tr_b16 v[52:53], v10 offset:24576
  ds_read_b64_tr_b16 v[54:55], v10 offset:25600
  v_accvgpr_read_b32 v33, a157
  v_cvt_pk_bf16_f32 v70, v32, v33
  v_accvgpr_read_b32 v34, a158
  v_accvgpr_read_b32 v35, a159
  v_mfma_f32_32x32x16_bf16 a[192:207], v[56:59], a[80:83], a[192:207]
  ds_read_b64_tr_b16 v[56:57], v7 offset:28672
  ds_read_b64_tr_b16 v[58:59], v7 offset:29696
  v_cvt_pk_bf16_f32 v71, v34, v35
  s_mov_b32 s46, 7168
  buffer_store_dwordx4 v[68:71], v25, s[24:27], s46 offen
  v_mfma_f32_32x32x16_bf16 a[208:223], v[60:63], a[80:83], a[208:223]
  ds_read_b64_tr_b16 v[60:61], v8 offset:28672
  ds_read_b64_tr_b16 v[62:63], v8 offset:29696
  s_waitcnt lgkmcnt(6)
  v_mfma_f32_32x32x16_bf16 a[160:175], v[40:43], a[84:87], a[160:175]
  ds_read_b64_tr_b16 v[40:41], v9 offset:28672
  ds_read_b64_tr_b16 v[42:43], v9 offset:29696
  v_mfma_f32_32x32x16_bf16 a[176:191], v[44:47], a[84:87], a[176:191]
  ds_read_b64_tr_b16 v[44:45], v10 offset:28672
  ds_read_b64_tr_b16 v[46:47], v10 offset:29696
  v_mfma_f32_32x32x16_bf16 a[192:207], v[48:51], a[84:87], a[192:207]
  ds_read_b64_tr_b16 v[48:49], v7 offset:32768
  ds_read_b64_tr_b16 v[50:51], v7 offset:33792
  s_waitcnt lgkmcnt(6)
  v_mfma_f32_32x32x16_bf16 a[208:223], v[52:55], a[84:87], a[208:223]
  ds_read_b64_tr_b16 v[52:53], v8 offset:32768
  ds_read_b64_tr_b16 v[54:55], v8 offset:33792
  v_mfma_f32_32x32x16_bf16 a[160:175], v[56:59], a[88:91], a[160:175]
  ds_read_b64_tr_b16 v[56:57], v9 offset:32768
  ds_read_b64_tr_b16 v[58:59], v9 offset:33792
  v_mfma_f32_32x32x16_bf16 a[176:191], v[60:63], a[88:91], a[176:191]
  ds_read_b64_tr_b16 v[60:61], v10 offset:32768
  ds_read_b64_tr_b16 v[62:63], v10 offset:33792
  s_barrier
  s_waitcnt lgkmcnt(6)
  v_mfma_f32_32x32x16_bf16 a[192:207], v[40:43], a[88:91], a[192:207]
  v_mfma_f32_32x32x16_bf16 a[208:223], v[44:47], a[88:91], a[208:223]
  v_mfma_f32_32x32x16_bf16 a[160:175], v[48:51], a[92:95], a[160:175]
  s_waitcnt lgkmcnt(0)
  v_mfma_f32_32x32x16_bf16 a[176:191], v[52:55], a[92:95], a[176:191]
  v_mfma_f32_32x32x16_bf16 a[192:207], v[56:59], a[92:95], a[192:207]
  v_mfma_f32_32x32x16_bf16 a[208:223], v[60:63], a[92:95], a[208:223]
  s_nop 7
  v_accvgpr_read_b32 v32, a160
  v_accvgpr_read_b32 v33, a161
  v_cvt_pk_bf16_f32 v64, v32, v33
  v_accvgpr_read_b32 v34, a162
  v_accvgpr_read_b32 v35, a163
  v_cvt_pk_bf16_f32 v65, v34, v35
  v_accvgpr_read_b32 v32, a164
  v_accvgpr_read_b32 v33, a165
  v_cvt_pk_bf16_f32 v66, v32, v33
  v_accvgpr_read_b32 v34, a166
  v_accvgpr_read_b32 v35, a167
  v_cvt_pk_bf16_f32 v67, v34, v35
  s_mov_b32 s46, 8192
  buffer_store_dwordx4 v[64:67], v25, s[24:27], s46 offen
  v_accvgpr_read_b32 v32, a168
  v_accvgpr_read_b32 v33, a169
  v_cvt_pk_bf16_f32 v68, v32, v33
  v_accvgpr_read_b32 v34, a170
  v_accvgpr_read_b32 v35, a171
  v_cvt_pk_bf16_f32 v69, v34, v35
  v_accvgpr_read_b32 v32, a172
  v_accvgpr_read_b32 v33, a173
  v_cvt_pk_bf16_f32 v70, v32, v33
  v_accvgpr_read_b32 v34, a174
  v_accvgpr_read_b32 v35, a175
  v_cvt_pk_bf16_f32 v71, v34, v35
  s_mov_b32 s46, 9216
  buffer_store_dwordx4 v[68:71], v25, s[24:27], s46 offen
  v_accvgpr_read_b32 v32, a176
  v_accvgpr_read_b32 v33, a177
  v_cvt_pk_bf16_f32 v64, v32, v33
  v_accvgpr_read_b32 v34, a178
  v_accvgpr_read_b32 v35, a179
  v_cvt_pk_bf16_f32 v65, v34, v35
  v_accvgpr_read_b32 v32, a180
  v_accvgpr_read_b32 v33, a181
  v_cvt_pk_bf16_f32 v66, v32, v33
  v_accvgpr_read_b32 v34, a182
  v_accvgpr_read_b32 v35, a183
  v_cvt_pk_bf16_f32 v67, v34, v35
  s_mov_b32 s46, 10240
  buffer_store_dwordx4 v[64:67], v25, s[24:27], s46 offen
  v_accvgpr_read_b32 v32, a184
  v_accvgpr_read_b32 v33, a185
  v_cvt_pk_bf16_f32 v68, v32, v33
  v_accvgpr_read_b32 v34, a186
  v_accvgpr_read_b32 v35, a187
  v_cvt_pk_bf16_f32 v69, v34, v35
  v_accvgpr_read_b32 v32, a188
  v_accvgpr_read_b32 v33, a189
  v_cvt_pk_bf16_f32 v70, v32, v33
  v_accvgpr_read_b32 v34, a190
  v_accvgpr_read_b32 v35, a191
  v_cvt_pk_bf16_f32 v71, v34, v35
  s_mov_b32 s46, 11264
  buffer_store_dwordx4 v[68:71], v25, s[24:27], s46 offen
  v_accvgpr_read_b32 v32, a192
  v_accvgpr_read_b32 v33, a193
  v_cvt_pk_bf16_f32 v64, v32, v33
  v_accvgpr_read_b32 v34, a194
  v_accvgpr_read_b32 v35, a195
  v_cvt_pk_bf16_f32 v65, v34, v35
  v_accvgpr_read_b32 v32, a196
  v_accvgpr_read_b32 v33, a197
  v_cvt_pk_bf16_f32 v66, v32, v33
  v_accvgpr_read_b32 v34, a198
  v_accvgpr_read_b32 v35, a199
  v_cvt_pk_bf16_f32 v67, v34, v35
  s_mov_b32 s46, 12288
  buffer_store_dwordx4 v[64:67], v25, s[24:27], s46 offen
  v_accvgpr_read_b32 v32, a200
  v_accvgpr_read_b32 v33, a201
  v_cvt_pk_bf16_f32 v68, v32, v33
  v_accvgpr_read_b32 v34, a202
  v_accvgpr_read_b32 v35, a203
  v_cvt_pk_bf16_f32 v69, v34, v35
  v_accvgpr_read_b32 v32, a204
  v_accvgpr_read_b32 v33, a205
  v_cvt_pk_bf16_f32 v70, v32, v33
  v_accvgpr_read_b32 v34, a206
  v_accvgpr_read_b32 v35, a207
  v_cvt_pk_bf16_f32 v71, v34, v35
  s_mov_b32 s46, 13312
  buffer_store_dwordx4 v[68:71], v25, s[24:27], s46 offen
  v_accvgpr_read_b32 v32, a208
  v_accvgpr_read_b32 v33, a209
  v_cvt_pk_bf16_f32 v64, v32, v33
  v_accvgpr_read_b32 v34, a210
  v_accvgpr_read_b32 v35, a211
  v_cvt_pk_bf16_f32 v65, v34, v35
  v_accvgpr_read_b32 v32, a212
  v_accvgpr_read_b32 v33, a213
  v_cvt_pk_bf16_f32 v66, v32, v33
  v_accvgpr_read_b32 v34, a214
  v_accvgpr_read_b32 v35, a215
  v_cvt_pk_bf16_f32 v67, v34, v35
  s_mov_b32 s46, 14336
  buffer_store_dwordx4 v[64:67], v25, s[24:27], s46 offen
  v_accvgpr_read_b32 v32, a216
  v_accvgpr_read_b32 v33, a217
  v_cvt_pk_bf16_f32 v68, v32, v33
  v_accvgpr_read_b32 v34, a218
  v_accvgpr_read_b32 v35, a219
  v_cvt_pk_bf16_f32 v69, v34, v35
  v_accvgpr_read_b32 v32, a220
  v_accvgpr_read_b32 v33, a221
  v_cvt_pk_bf16_f32 v70, v32, v33
  v_accvgpr_read_b32 v34, a222
  v_accvgpr_read_b32 v35, a223
  v_cvt_pk_bf16_f32 v71, v34, v35
  s_mov_b32 s46, 15360
  buffer_store_dwordx4 v[68:71], v25, s[24:27], s46 offen
  s_waitcnt vmcnt(0)
L_end:
  s_endpgm
Lrare_1:
  s_call_b64 s[48:49], L_rareA10
  s_branch Lback_2
Lrare_5:
  s_call_b64 s[48:49], L_rareA00
  s_branch Lback_6
Lrare_9:
  s_call_b64 s[48:49], L_rareA10
  s_branch Lback_10
Lrare_13:
  s_call_b64 s[48:49], L_rareA01
  s_branch Lback_14
Lrare_17:
  s_call_b64 s[48:49], L_rareA10
  s_branch Lback_18
Lrare_21:
  s_call_b64 s[48:49], L_rareA00
  s_branch Lback_22
Lrare_25:
  s_call_b64 s[48:49], L_rareA10
  s_branch Lback_26
Lrare_29:
  s_call_b64 s[48:49], L_rareA01
  s_branch Lback_30
Lrare_33:
  s_call_b64 s[48:49], L_rareA10
  s_branch Lback_34
Lrare_37:
  s_call_b64 s[48:49], L_rareA00
  s_branch Lback_38
Lrare_41:
  s_call_b64 s[48:49], L_rareA10
  s_branch Lback_42
Lrare_45:
  s_call_b64 s[48:49], L_rareA01
  s_branch Lback_46
Lrare_49:
  s_call_b64 s[48:49], L_rareA10
  s_branch Lback_50
Lrare_53:
  s_call_b64 s[48:49], L_rareA00
  s_branch Lback_54
Lrare_57:
  s_call_b64 s[48:49], L_rareA10
  s_branch Lback_58
Lrare_61:
  s_call_b64 s[48:49], L_rareA10
  s_branch Lback_62
Lrare_65:
  s_call_b64 s[48:49], L_rareA00
  s_branch Lback_66
Lrare_69:
  s_call_b64 s[48:49], L_rareA10
  s_branch Lback_70
Lrare_73:
  s_call_b64 s[48:49], L_rareA01
  s_branch Lback_74
Lrare_77:
  s_call_b64 s[48:49], L_rareA10
  s_branch Lback_78
Lrare_81:
  s_call_b64 s[48:49], L_rareA00
  s_branch Lback_82
Lrare_85:
  s_call_b64 s[48:49], L_rareA10
  s_branch Lback_86
Lrare_89:
  s_call_b64 s[48:49], L_rareA01
  s_branch Lback_90
Lrare_93:
  s_call_b64 s[48:49], L_rareA10
  s_branch Lback_94
Lrare_97:
  s_call_b64 s[48:49], L_rareA00
  s_branch Lback_98
Lrare_101:
  s_call_b64 s[48:49], L_rareA10
  s_branch Lback_102
Lrare_105:
  s_call_b64 s[48:49], L_rareA01
  s_branch Lback_106
Lrare_109:
  s_call_b64 s[48:49], L_rareA10
  s_branch Lback_110
Lrare_113:
  s_call_b64 s[48:49], L_rareA00
  s_branch Lback_114
Lrare_117:
  s_call_b64 s[48:49], L_rareA10
  s_branch Lback_118
LrB_3:
  s_call_b64 s[48:49], L_rareB
  s_branch LbB_4
LrB_7:
  s_call_b64 s[48:49], L_rareB
  s_branch LbB_8
LrB_11:
  s_call_b64 s[48:49], L_rareB
  s_branch LbB_12
LrB_15:
  s_call_b64 s[48:49], L_rareB
  s_branch LbB_16
LrB_19:
  s_call_b64 s[48:49], L_rareB
  s_branch LbB_20
LrB_23:
  s_call_b64 s[48:49], L_rareB
  s_branch LbB_24
LrB_27:
  s_call_b64 s[48:49], L_rareB
  s_branch LbB_28
LrB_31:
  s_call_b64 s[48:49], L_rareB
  s_branch LbB_32
LrB_35:
  s_call_b64 s[48:49], L_rareB
  s_branch LbB_36
LrB_39:
  s_call_b64 s[48:49], L_rareB
  s_branch LbB_40
LrB_43:
  s_call_b64 s[48:49], L_rareB
  s_branch LbB_44
LrB_47:
  s_call_b64 s[48:49], L_rareB
  s_branch LbB_48
LrB_51:
  s_call_b64 s[48:49], L_rareB
  s_branch LbB_52
LrB_55:
  s_call_b64 s[48:49], L_rareB
  s_branch LbB_56
LrB_59:
  s_call_b64 s[48:49], L_rareB
  s_branch LbB_60
LrB_63:
  s_call_b64 s[48:49], L_rareB
  s_branch LbB_64
LrB_67:
  s_call_b64 s[48:49], L_rareB
  s_branch LbB_68
LrB_71:
  s_call_b64 s[48:49], L_rareB
  s_branch LbB_72
LrB_75:
  s_call_b64 s[48:49], L_rareB
  s_branch LbB_76
LrB_79:
  s_call_b64 s[48:49], L_rareB
  s_branch LbB_80
LrB_83:
  s_call_b64 s[48:49], L_rareB
  s_branch LbB_84
LrB_87:
  s_call_b64 s[48:49], L_rareB
  s_branch LbB_88
LrB_91:
  s_call_b64 s[48:49], L_rareB
  s_branch LbB_92
LrB_95:
  s_call_b64 s[48:49], L_rareB
  s_branch LbB_96
LrB_99:
  s_call_b64 s[48:49], L_rareB
  s_branch LbB_100
LrB_103:
  s_call_b64 s[48:49], L_rareB
  s_branch LbB_104
LrB_107:
  s_call_b64 s[48:49], L_rareB
  s_branch LbB_108
LrB_111:
  s_call_b64 s[48:49], L_rareB
  s_branch LbB_112
LrB_115:
  s_call_b64 s[48:49], L_rareB
  s_branch LbB_116
LrB_119:
  s_call_b64 s[48:49], L_rareB
  s_branch LbB_120
L_rareA00:
  s_nop 15
  v_mov_b32 v29, v28
  s_nop 1
  v_permlane32_swap_b32 v28, v29
  v_max3_f32 v28, v28, v29, 0
  v_exp_f32 v30, -v28
  v_sub_f32 v64, v64, v28
  v_sub_f32 v65, v65, v28
  v_sub_f32 v66, v66, v28
  v_sub_f32 v67, v67, v28
  v_sub_f32 v68, v68, v28
  v_sub_f32 v69, v69, v28
  v_sub_f32 v70, v70, v28
  v_sub_f32 v71, v71, v28
  v_sub_f32 v72, v72, v28
  v_sub_f32 v73, v73, v28
  v_sub_f32 v74, v74, v28
  v_sub_f32 v75, v75, v28
  v_sub_f32 v76, v76, v28
  v_sub_f32 v77, v77, v28
  v_sub_f32 v78, v78, v28
  v_sub_f32 v79, v79, v28
  v_sub_f32 v96, v96, v28
  v_sub_f32 v97, v97, v28
  v_sub_f32 v98, v98, v28
  v_sub_f32 v99, v99, v28
  v_sub_f32 v100, v100, v28
  v_sub_f32 v101, v101, v28
  v_sub_f32 v102, v102, v28
  v_sub_f32 v103, v103, v28
  v_sub_f32 v104, v104, v28
  v_sub_f32 v105, v105, v28
  v_sub_f32 v106, v106, v28
  v_sub_f32 v107, v107, v28
  v_sub_f32 v108, v108, v28
  v_sub_f32 v109, v109, v28
  v_sub_f32 v110, v110, v28
  v_sub_f32 v111, v111, v28
  v_mul_f32 v22, v22, v30
  v_mul_f32 v23, v23, v30
  v_mul_f32 v24, v24, v30
  s_mov_b32 s42, 1
  s_nop 3
  s_setpc_b64 s[48:49]
L_rareA01:
  s_nop 15
  v_mov_b32 v29, v28
  s_nop 1
  v_permlane32_swap_b32 v28, v29
  v_max3_f32 v28, v28, v29, 0
  v_exp_f32 v30, -v28
  v_sub_f32 v64, v64, v28
  v_sub_f32 v65, v65, v28
  v_sub_f32 v66, v66, v28
  v_sub_f32 v67, v67, v28
  v_sub_f32 v68, v68, v28
  v_sub_f32 v69, v69, v28
  v_sub_f32 v70, v70, v28
  v_sub_f32 v71, v71, v28
  v_sub_f32 v72, v72, v28
  v_sub_f32 v73, v73, v28
  v_sub_f32 v74, v74, v28
  v_sub_f32 v75, v75, v28
  v_sub_f32 v76, v76, v28
  v_sub_f32 v77, v77, v28
  v_sub_f32 v78, v78, v28
  v_sub_f32 v79, v79, v28
  v_sub_f32 v80, v80, v28
  v_sub_f32 v81, v81, v28
  v_sub_f32 v82, v82, v28
  v_sub_f32 v83, v83, v28
  v_sub_f32 v84, v84, v28
  v_sub_f32 v85, v85, v28
  v_sub_f32 v86, v86, v28
  v_sub_f32 v87, v87, v28
  v_sub_f32 v88, v88, v28
  v_sub_f32 v89, v89, v28
  v_sub_f32 v90, v90, v28
  v_sub_f32 v91, v91, v28
  v_sub_f32 v92, v92, v28
  v_sub_f32 v93, v93, v28
  v_sub_f32 v94, v94, v28
  v_sub_f32 v95, v95, v28
  v_sub_f32 v96, v96, v28
  v_sub_f32 v97, v97, v28
  v_sub_f32 v98, v98, v28
  v_sub_f32 v99, v99, v28
  v_sub_f32 v100, v100, v28
  v_sub_f32 v101, v101, v28
  v_sub_f32 v102, v102, v28
  v_sub_f32 v103, v103, v28
  v_sub_f32 v104, v104, v28
  v_sub_f32 v105, v105, v28
  v_sub_f32 v106, v106, v28
  v_sub_f32 v107, v107, v28
  v_sub_f32 v108, v108, v28
  v_sub_f32 v109, v109, v28
  v_sub_f32 v110, v110, v28
  v_sub_f32 v111, v111, v28
  v_mul_f32 v22, v22, v30
  v_mul_f32 v23, v23, v30
  v_mul_f32 v24, v24, v30
  s_mov_b32 s42, 1
  s_nop 3
  s_setpc_b64 s[48:49]
L_rareA10:
  s_nop 15
  v_mov_b32 v29, v28
  s_nop 1
  v_permlane32_swap_b32 v28, v29
  v_max3_f32 v28, v28, v29, 0
  v_exp_f32 v30, -v28
  v_sub_f32 v80, v80, v28
  v_sub_f32 v81, v81, v28
  v_sub_f32 v82, v82, v28
  v_sub_f32 v83, v83, v28
  v_sub_f32 v84, v84, v28
  v_sub_f32 v85, v85, v28
  v_sub_f32 v86, v86, v28
  v_sub_f32 v87, v87, v28
  v_sub_f32 v88, v88, v28
  v_sub_f32 v89, v89, v28
  v_sub_f32 v90, v90, v28
  v_sub_f32 v91, v91, v28
  v_sub_f32 v92, v92, v28
  v_sub_f32 v93, v93, v28
  v_sub_f32 v94, v94, v28
  v_sub_f32 v95, v95, v28
  v_sub_f32 v96, v96, v28
  v_sub_f32 v97, v97, v28
  v_sub_f32 v98, v98, v28
  v_sub_f32 v99, v99, v28
  v_sub_f32 v100, v100, v28
  v_sub_f32 v101, v101, v28
  v_sub_f32 v102, v102, v28
  v_sub_f32 v103, v103, v28
  v_sub_f32 v104, v104, v28
  v_sub_f32 v105, v105, v28
  v_sub_f32 v106, v106, v28
  v_sub_f32 v107, v107, v28
  v_sub_f32 v108, v108, v28
  v_sub_f32 v109, v109, v28
  v_sub_f32 v110, v110, v28
  v_sub_f32 v111, v111, v28
  v_mul_f32 v22, v22, v30
  v_mul_f32 v23, v23, v30
  v_mul_f32 v24, v24, v30
  s_mov_b32 s42, 1
  s_nop 3
  s_setpc_b64 s[48:49]
L_rareB:
  s_nop 15
  v_mul_f32 v160, v160, v24
  v_mul_f32 v161, v161, v24
  v_mul_f32 v162, v162, v24
  v_mul_f32 v163, v163, v24
  v_mul_f32 v164, v164, v24
  v_mul_f32 v165, v165, v24
  v_mul_f32 v166, v166, v24
  v_mul_f32 v167, v167, v24
  v_mul_f32 v168, v168, v24
  v_mul_f32 v169, v169, v24
  v_mul_f32 v170, v170, v24
  v_mul_f32 v171, v171, v24
  v_mul_f32 v172, v172, v24
  v_mul_f32 v173, v173, v24
  v_mul_f32 v174, v174, v24
  v_mul_f32 v175, v175, v24
  v_mul_f32 v176, v176, v24
  v_mul_f32 v177, v177, v24
  v_mul_f32 v178, v178, v24
  v_mul_f32 v179, v179, v24
  v_mul_f32 v180, v180, v24
  v_mul_f32 v181, v181, v24
  v_mul_f32 v182, v182, v24
  v_mul_f32 v183, v183, v24
  v_mul_f32 v184, v184, v24
  v_mul_f32 v185, v185, v24
  v_mul_f32 v186, v186, v24
  v_mul_f32 v187, v187, v24
  v_mul_f32 v188, v188, v24
  v_mul_f32 v189, v189, v24
  v_mul_f32 v190, v190, v24
  v_mul_f32 v191, v191, v24
  v_mul_f32 v192, v192, v24
  v_mul_f32 v193, v193, v24
  v_mul_f32 v194, v194, v24
  v_mul_f32 v195, v195, v24
  v_mul_f32 v196, v196, v24
  v_mul_f32 v197, v197, v24
  v_mul_f32 v198, v198, v24
  v_mul_f32 v199, v199, v24
  v_mul_f32 v200, v200, v24
  v_mul_f32 v201, v201, v24
  v_mul_f32 v202, v202, v24
  v_mul_f32 v203, v203, v24
  v_mul_f32 v204, v204, v24
  v_mul_f32 v205, v205, v24
  v_mul_f32 v206, v206, v24
  v_mul_f32 v207, v207, v24
  v_mul_f32 v208, v208, v24
  v_mul_f32 v209, v209, v24
  v_mul_f32 v210, v210, v24
  v_mul_f32 v211, v211, v24
  v_mul_f32 v212, v212, v24
  v_mul_f32 v213, v213, v24
  v_mul_f32 v214, v214, v24
  v_mul_f32 v215, v215, v24
  v_mul_f32 v216, v216, v24
  v_mul_f32 v217, v217, v24
  v_mul_f32 v218, v218, v24
  v_mul_f32 v219, v219, v24
  v_mul_f32 v220, v220, v24
  v_mul_f32 v221, v221, v24
  v_mul_f32 v222, v222, v24
  v_mul_f32 v223, v223, v24
  v_mul_f32 v224, v224, v24
  v_mul_f32 v225, v225, v24
  v_mul_f32 v226, v226, v24
  v_mul_f32 v227, v227, v24
  v_mul_f32 v228, v228, v24
  v_mul_f32 v229, v229, v24
  v_mul_f32 v230, v230, v24
  v_mul_f32 v231, v231, v24
  v_mul_f32 v232, v232, v24
  v_mul_f32 v233, v233, v24
  v_mul_f32 v234, v234, v24
  v_mul_f32 v235, v235, v24
  v_mul_f32 v236, v236, v24
  v_mul_f32 v237, v237, v24
  v_mul_f32 v238, v238, v24
  v_mul_f32 v239, v239, v24
  v_mul_f32 v240, v240, v24
  v_mul_f32 v241, v241, v24
  v_mul_f32 v242, v242, v24
  v_mul_f32 v243, v243, v24
  v_mul_f32 v244, v244, v24
  v_mul_f32 v245, v245, v24
  v_mul_f32 v246, v246, v24
  v_mul_f32 v247, v247, v24
  v_mul_f32 v248, v248, v24
  v_mul_f32 v249, v249, v24
  v_mul_f32 v250, v250, v24
  v_mul_f32 v251, v251, v24
  v_mul_f32 v252, v252, v24
  v_mul_f32 v253, v253, v24
  v_mul_f32 v254, v254, v24
  v_mul_f32 v255, v255, v24
  v_mov_b32 v24, 1.0
  s_mov_b32 s42, 0
  s_nop 3
  s_setpc_b64 s[48:49]
.globl reduce_kernel
.p2align 8
.type reduce_kernel,@function
reduce_kernel:
  s_cmp_ge_u32 s2, 640
  s_cbranch_scc1 R_end
  s_load_dwordx2 s[4:5], s[0:1], 80
  s_load_dwordx2 s[8:9], s[0:1], 96
  s_mov_b32 s12, 0x6666667
  s_mul_hi_u32 s13, s2, s12
  s_mul_i32 s14, s13, 40
  s_sub_u32 s14, s2, s14
  v_lshrrev_b32 v1, 6, v0
  v_and_b32 v2, 63, v0
  v_mul_u32_u24 v3, 40960, v1
  v_lshl_add_u32 v3, v2, 4, v3
  s_lshl_b32 s15, s14, 10
  v_add_u32 v3, s15, v3
  v_and_b32 v4, 31, v2
  v_lshl_add_u32 v4, v1, 5, v4
  v_cmp_le_u32 vcc, 112, v4
  v_mov_b32 v5, 2146435072
  s_nop 0
  v_cndmask_b32 v3, v3, v5, vcc
  s_and_b32 s16, s13, 7
  s_lshr_b32 s17, s13, 3
  s_mul_i32 s16, s16, 286720
  s_mul_i32 s17, s17, 1280
  s_add_u32 s16, s16, s17
  s_lshl_b32 s17, s14, 5
  s_add_u32 s16, s16, s17
  v_mul_u32_u24 v6, 2560, v4
  v_lshrrev_b32 v7, 5, v2
  v_lshl_add_u32 v6, v7, 4, v6
  v_add_u32 v6, s16, v6
  v_cndmask_b32 v6, v6, v5, vcc
  s_waitcnt lgkmcnt(0)
  s_mov_b32 s6, 2293760
  s_mov_b32 s7, 0x20000
  s_mul_i32 s18, s13, 2621440
  s_add_u32 s8, s8, s18
  s_addc_u32 s9, s9, 0
  s_mov_b32 s10, 2621440
  s_mov_b32 s11, 0x20000
  s_mov_b32 s20, 0
  s_mov_b32 s21, 163840
  s_mov_b32 s22, 327680
  s_mov_b32 s23, 491520
  s_mov_b32 s24, 655360
  s_mov_b32 s25, 819200
  s_mov_b32 s26, 983040
  s_mov_b32 s27, 1146880
  s_mov_b32 s28, 1310720
  s_mov_b32 s29, 1474560
  s_mov_b32 s30, 1638400
  s_mov_b32 s31, 1802240
  s_mov_b32 s32, 1966080
  s_mov_b32 s33, 2129920
  s_mov_b32 s34, 2293760
  s_mov_b32 s35, 2457600
  buffer_load_dwordx4 v[16:19], v3, s[8:11], s20 offen nt
  buffer_load_dwordx4 v[20:23], v3, s[8:11], s21 offen nt
  buffer_load_dwordx4 v[24:27], v3, s[8:11], s22 offen nt
  buffer_load_dwordx4 v[28:31], v3, s[8:11], s23 offen nt
  buffer_load_dwordx4 v[32:35], v3, s[8:11], s24 offen nt
  buffer_load_dwordx4 v[36:39], v3, s[8:11], s25 offen nt
  buffer_load_dwordx4 v[40:43], v3, s[8:11], s26 offen nt
  buffer_load_dwordx4 v[44:47], v3, s[8:11], s27 offen nt
  buffer_load_dwordx4 v[48:51], v3, s[8:11], s28 offen nt
  buffer_load_dwordx4 v[52:55], v3, s[8:11], s29 offen nt
  buffer_load_dwordx4 v[56:59], v3, s[8:11], s30 offen nt
  buffer_load_dwordx4 v[60:63], v3, s[8:11], s31 offen nt
  buffer_load_dwordx4 v[64:67], v3, s[8:11], s32 offen nt
  buffer_load_dwordx4 v[68:71], v3, s[8:11], s33 offen nt
  buffer_load_dwordx4 v[72:75], v3, s[8:11], s34 offen nt
  buffer_load_dwordx4 v[76:79], v3, s[8:11], s35 offen nt
  s_waitcnt vmcnt(15)
  v_lshlrev_b32 v8, 16, v16
  v_and_b32 v9, 4294901760, v16
  v_lshlrev_b32 v10, 16, v17
  v_and_b32 v11, 4294901760, v17
  v_lshlrev_b32 v12, 16, v18
  v_and_b32 v13, 4294901760, v18
  v_lshlrev_b32 v14, 16, v19
  v_and_b32 v15, 4294901760, v19
  s_waitcnt vmcnt(14)
  v_lshlrev_b32 v80, 16, v20
  v_and_b32 v20, 4294901760, v20
  v_add_f32 v8, v8, v80
  v_add_f32 v9, v9, v20
  v_lshlrev_b32 v80, 16, v21
  v_and_b32 v21, 4294901760, v21
  v_add_f32 v10, v10, v80
  v_add_f32 v11, v11, v21
  v_lshlrev_b32 v80, 16, v22
  v_and_b32 v22, 4294901760, v22
  v_add_f32 v12, v12, v80
  v_add_f32 v13, v13, v22
  v_lshlrev_b32 v80, 16, v23
  v_and_b32 v23, 4294901760, v23
  v_add_f32 v14, v14, v80
  v_add_f32 v15, v15, v23
  s_waitcnt vmcnt(13)
  v_lshlrev_b32 v80, 16, v24
  v_and_b32 v24, 4294901760, v24
  v_add_f32 v8, v8, v80
  v_add_f32 v9, v9, v24
  v_lshlrev_b32 v80, 16, v25
  v_and_b32 v25, 4294901760, v25
  v_add_f32 v10, v10, v80
  v_add_f32 v11, v11, v25
  v_lshlrev_b32 v80, 16, v26
  v_and_b32 v26, 4294901760, v26
  v_add_f32 v12, v12, v80
  v_add_f32 v13, v13, v26
  v_lshlrev_b32 v80, 16, v27
  v_and_b32 v27, 4294901760, v27
  v_add_f32 v14, v14, v80
  v_add_f32 v15, v15, v27
  s_waitcnt vmcnt(12)
  v_lshlrev_b32 v80, 16, v28
  v_and_b32 v28, 4294901760, v28
  v_add_f32 v8, v8, v80
  v_add_f32 v9, v9, v28
  v_lshlrev_b32 v80, 16, v29
  v_and_b32 v29, 4294901760, v29
  v_add_f32 v10, v10, v80
  v_add_f32 v11, v11, v29
  v_lshlrev_b32 v80, 16, v30
  v_and_b32 v30, 4294901760, v30
  v_add_f32 v12, v12, v80
  v_add_f32 v13, v13, v30
  v_lshlrev_b32 v80, 16, v31
  v_and_b32 v31, 4294901760, v31
  v_add_f32 v14, v14, v80
  v_add_f32 v15, v15, v31
  s_waitcnt vmcnt(11)
  v_lshlrev_b32 v80, 16, v32
  v_and_b32 v32, 4294901760, v32
  v_add_f32 v8, v8, v80
  v_add_f32 v9, v9, v32
  v_lshlrev_b32 v80, 16, v33
  v_and_b32 v33, 4294901760, v33
  v_add_f32 v10, v10, v80
  v_add_f32 v11, v11, v33
  v_lshlrev_b32 v80, 16, v34
  v_and_b32 v34, 4294901760, v34
  v_add_f32 v12, v12, v80
  v_add_f32 v13, v13, v34
  v_lshlrev_b32 v80, 16, v35
  v_and_b32 v35, 4294901760, v35
  v_add_f32 v14, v14, v80
  v_add_f32 v15, v15, v35
  s_waitcnt vmcnt(10)
  v_lshlrev_b32 v80, 16, v36
  v_and_b32 v36, 4294901760, v36
  v_add_f32 v8, v8, v80
  v_add_f32 v9, v9, v36
  v_lshlrev_b32 v80, 16, v37
  v_and_b32 v37, 4294901760, v37
  v_add_f32 v10, v10, v80
  v_add_f32 v11, v11, v37
  v_lshlrev_b32 v80, 16, v38
  v_and_b32 v38, 4294901760, v38
  v_add_f32 v12, v12, v80
  v_add_f32 v13, v13, v38
  v_lshlrev_b32 v80, 16, v39
  v_and_b32 v39, 4294901760, v39
  v_add_f32 v14, v14, v80
  v_add_f32 v15, v15, v39
  s_waitcnt vmcnt(9)
  v_lshlrev_b32 v80, 16, v40
  v_and_b32 v40, 4294901760, v40
  v_add_f32 v8, v8, v80
  v_add_f32 v9, v9, v40
  v_lshlrev_b32 v80, 16, v41
  v_and_b32 v41, 4294901760, v41
  v_add_f32 v10, v10, v80
  v_add_f32 v11, v11, v41
  v_lshlrev_b32 v80, 16, v42
  v_and_b32 v42, 4294901760, v42
  v_add_f32 v12, v12, v80
  v_add_f32 v13, v13, v42
  v_lshlrev_b32 v80, 16, v43
  v_and_b32 v43, 4294901760, v43
  v_add_f32 v14, v14, v80
  v_add_f32 v15, v15, v43
  s_waitcnt vmcnt(8)
  v_lshlrev_b32 v80, 16, v44
  v_and_b32 v44, 4294901760, v44
  v_add_f32 v8, v8, v80
  v_add_f32 v9, v9, v44
  v_lshlrev_b32 v80, 16, v45
  v_and_b32 v45, 4294901760, v45
  v_add_f32 v10, v10, v80
  v_add_f32 v11, v11, v45
  v_lshlrev_b32 v80, 16, v46
  v_and_b32 v46, 4294901760, v46
  v_add_f32 v12, v12, v80
  v_add_f32 v13, v13, v46
  v_lshlrev_b32 v80, 16, v47
  v_and_b32 v47, 4294901760, v47
  v_add_f32 v14, v14, v80
  v_add_f32 v15, v15, v47
  s_waitcnt vmcnt(7)
  v_lshlrev_b32 v80, 16, v48
  v_and_b32 v48, 4294901760, v48
  v_add_f32 v8, v8, v80
  v_add_f32 v9, v9, v48
  v_lshlrev_b32 v80, 16, v49
  v_and_b32 v49, 4294901760, v49
  v_add_f32 v10, v10, v80
  v_add_f32 v11, v11, v49
  v_lshlrev_b32 v80, 16, v50
  v_and_b32 v50, 4294901760, v50
  v_add_f32 v12, v12, v80
  v_add_f32 v13, v13, v50
  v_lshlrev_b32 v80, 16, v51
  v_and_b32 v51, 4294901760, v51
  v_add_f32 v14, v14, v80
  v_add_f32 v15, v15, v51
  s_waitcnt vmcnt(6)
  v_lshlrev_b32 v80, 16, v52
  v_and_b32 v52, 4294901760, v52
  v_add_f32 v8, v8, v80
  v_add_f32 v9, v9, v52
  v_lshlrev_b32 v80, 16, v53
  v_and_b32 v53, 4294901760, v53
  v_add_f32 v10, v10, v80
  v_add_f32 v11, v11, v53
  v_lshlrev_b32 v80, 16, v54
  v_and_b32 v54, 4294901760, v54
  v_add_f32 v12, v12, v80
  v_add_f32 v13, v13, v54
  v_lshlrev_b32 v80, 16, v55
  v_and_b32 v55, 4294901760, v55
  v_add_f32 v14, v14, v80
  v_add_f32 v15, v15, v55
  s_waitcnt vmcnt(5)
  v_lshlrev_b32 v80, 16, v56
  v_and_b32 v56, 4294901760, v56
  v_add_f32 v8, v8, v80
  v_add_f32 v9, v9, v56
  v_lshlrev_b32 v80, 16, v57
  v_and_b32 v57, 4294901760, v57
  v_add_f32 v10, v10, v80
  v_add_f32 v11, v11, v57
  v_lshlrev_b32 v80, 16, v58
  v_and_b32 v58, 4294901760, v58
  v_add_f32 v12, v12, v80
  v_add_f32 v13, v13, v58
  v_lshlrev_b32 v80, 16, v59
  v_and_b32 v59, 4294901760, v59
  v_add_f32 v14, v14, v80
  v_add_f32 v15, v15, v59
  s_waitcnt vmcnt(4)
  v_lshlrev_b32 v80, 16, v60
  v_and_b32 v60, 4294901760, v60
  v_add_f32 v8, v8, v80
  v_add_f32 v9, v9, v60
  v_lshlrev_b32 v80, 16, v61
  v_and_b32 v61, 4294901760, v61
  v_add_f32 v10, v10, v80
  v_add_f32 v11, v11, v61
  v_lshlrev_b32 v80, 16, v62
  v_and_b32 v62, 4294901760, v62
  v_add_f32 v12, v12, v80
  v_add_f32 v13, v13, v62
  v_lshlrev_b32 v80, 16, v63
  v_and_b32 v63, 4294901760, v63
  v_add_f32 v14, v14, v80
  v_add_f32 v15, v15, v63
  s_waitcnt vmcnt(3)
  v_lshlrev_b32 v80, 16, v64
  v_and_b32 v64, 4294901760, v64
  v_add_f32 v8, v8, v80
  v_add_f32 v9, v9, v64
  v_lshlrev_b32 v80, 16, v65
  v_and_b32 v65, 4294901760, v65
  v_add_f32 v10, v10, v80
  v_add_f32 v11, v11, v65
  v_lshlrev_b32 v80, 16, v66
  v_and_b32 v66, 4294901760, v66
  v_add_f32 v12, v12, v80
  v_add_f32 v13, v13, v66
  v_lshlrev_b32 v80, 16, v67
  v_and_b32 v67, 4294901760, v67
  v_add_f32 v14, v14, v80
  v_add_f32 v15, v15, v67
  s_waitcnt vmcnt(2)
  v_lshlrev_b32 v80, 16, v68
  v_and_b32 v68, 4294901760, v68
  v_add_f32 v8, v8, v80
  v_add_f32 v9, v9, v68
  v_lshlrev_b32 v80, 16, v69
  v_and_b32 v69, 4294901760, v69
  v_add_f32 v10, v10, v80
  v_add_f32 v11, v11, v69
  v_lshlrev_b32 v80, 16, v70
  v_and_b32 v70, 4294901760, v70
  v_add_f32 v12, v12, v80
  v_add_f32 v13, v13, v70
  v_lshlrev_b32 v80, 16, v71
  v_and_b32 v71, 4294901760, v71
  v_add_f32 v14, v14, v80
  v_add_f32 v15, v15, v71
  s_waitcnt vmcnt(1)
  v_lshlrev_b32 v80, 16, v72
  v_and_b32 v72, 4294901760, v72
  v_add_f32 v8, v8, v80
  v_add_f32 v9, v9, v72
  v_lshlrev_b32 v80, 16, v73
  v_and_b32 v73, 4294901760, v73
  v_add_f32 v10, v10, v80
  v_add_f32 v11, v11, v73
  v_lshlrev_b32 v80, 16, v74
  v_and_b32 v74, 4294901760, v74
  v_add_f32 v12, v12, v80
  v_add_f32 v13, v13, v74
  v_lshlrev_b32 v80, 16, v75
  v_and_b32 v75, 4294901760, v75
  v_add_f32 v14, v14, v80
  v_add_f32 v15, v15, v75
  s_waitcnt vmcnt(0)
  v_lshlrev_b32 v80, 16, v76
  v_and_b32 v76, 4294901760, v76
  v_add_f32 v8, v8, v80
  v_add_f32 v9, v9, v76
  v_lshlrev_b32 v80, 16, v77
  v_and_b32 v77, 4294901760, v77
  v_add_f32 v10, v10, v80
  v_add_f32 v11, v11, v77
  v_lshlrev_b32 v80, 16, v78
  v_and_b32 v78, 4294901760, v78
  v_add_f32 v12, v12, v80
  v_add_f32 v13, v13, v78
  v_lshlrev_b32 v80, 16, v79
  v_and_b32 v79, 4294901760, v79
  v_add_f32 v14, v14, v80
  v_add_f32 v15, v15, v79
  v_cvt_pk_bf16_f32 v16, v8, v9
  v_cvt_pk_bf16_f32 v17, v10, v11
  v_cvt_pk_bf16_f32 v18, v12, v13
  v_cvt_pk_bf16_f32 v19, v14, v15
  buffer_store_dwordx4 v[16:19], v6, s[4:7], 0 offen
R_end:
  s_endpgm
.section .rodata,"a"
.p2align 6
.amdhsa_kernel concat_heads__gqa_block_cached__mha_block_cached__near_ridge_kernel
  .amdhsa_next_free_vgpr 512
  .amdhsa_next_free_sgpr 96
  .amdhsa_accum_offset 256
  .amdhsa_group_segment_fixed_size 0
  .amdhsa_kernarg_size 104
  .amdhsa_user_sgpr_count 2
  .amdhsa_user_sgpr_kernarg_segment_ptr 1
  .amdhsa_system_sgpr_workgroup_id_x 1
.end_amdhsa_kernel
.p2align 6
.amdhsa_kernel reduce_kernel
  .amdhsa_next_free_vgpr 84
  .amdhsa_next_free_sgpr 48
  .amdhsa_accum_offset 84
  .amdhsa_group_segment_fixed_size 0
  .amdhsa_kernarg_size 104
  .amdhsa_user_sgpr_count 2
  .amdhsa_user_sgpr_kernarg_segment_ptr 1
  .amdhsa_system_sgpr_workgroup_id_x 1
.end_amdhsa_kernel
```
